```python
import torch

def _softmax(x, axis=-1):
    return torch.softmax(x, dim=axis)

def _gelu(x):
    return torch.nn.functional.gelu(x, approximate='tanh')

def _silu(x):
    return torch.nn.functional.silu(x)

def _sigmoid(x):
    return torch.sigmoid(x)

def _layernorm(x, axis=-1, eps=1e-05):
    m = x.mean(dim=axis, keepdim=True)
    v = x.var(dim=axis, keepdim=True, unbiased=False)
    return (x - m) / torch.sqrt(v + eps)

def _scatter_add(tgt, idx, src, axis=0):
    return tgt.clone().index_add_(axis, idx, src)

def _segment_sum(src, seg, n):
    out = torch.zeros((n,) + src.shape[1:], dtype=src.dtype)
    return out.index_add_(0, seg, src)

def _pad(x, pw):
    flat = tuple((v for pair in reversed(pw) for v in pair))
    return torch.nn.functional.pad(x, flat)
kernel_name = 'adaLN_cond__sliding_block_cached__glu_gated_reglu__prompt'

def setup_inputs():

    _w = lambda a: (lambda t: t.to(torch.bfloat16) if t.is_floating_point() else t)(torch.as_tensor(a))

    def _A_setup():
        B, Sq, D = (1, 2048, 640)
        Hq, Hkv, Sk, Dh = (32, 32, 2048, 128)
        assert Hq % Hkv == 0, (Hq, Hkv)
        return {'x': _w((lambda *s: torch.randn(*s, dtype=torch.bfloat16) * 0.05)(B, Sq, D)), 'k_cache': _w((lambda *s: torch.randn(*s, dtype=torch.bfloat16) * 1.6)(B, Hkv, Sk, Dh)), 'v_cache': _w((lambda *s: torch.randn(*s, dtype=torch.bfloat16) * 0.8)(B, Hkv, Sk, Dh)), 'wq': _w((lambda *s: torch.randn(*s, dtype=torch.bfloat16) * 1.6)(D, Hq * Dh) * D ** (-0.5)), 'wo': _w((lambda *s: torch.randn(*s, dtype=torch.bfloat16) * 0.8)(Hq * Dh, D) * (Hq * Dh) ** (-0.5))}
    _A_in = _A_setup()

    def _B_setup():
        B, S, D, F = (1, 2048, 640, 1728)
        return {'x': _w((lambda *s: torch.randn(*s, dtype=torch.bfloat16) * 0.05)(B, S, D)), 'W_gate': _w((lambda *s: torch.randn(*s, dtype=torch.bfloat16) * 0.4)(D, F) * (2.0 / D) ** 0.5), 'W_up': _w((lambda *s: torch.randn(*s, dtype=torch.bfloat16) * 0.4)(D, F) * (2.0 / D) ** 0.5), 'W_down': _w((lambda *s: torch.randn(*s, dtype=torch.bfloat16) * 0.4)(F, D) * (1.0 / F) ** 0.5)}
    _B_in = _B_setup()
    return {'A_x': _A_in['x'], 'A_k_cache': _A_in['k_cache'], 'A_v_cache': _A_in['v_cache'], 'A_wq': _A_in['wq'], 'A_wo': _A_in['wo'], 'B_x': _B_in['x'], 'B_W_gate': _B_in['W_gate'], 'B_W_up': _B_in['W_up'], 'B_W_down': _B_in['W_down'], 'c': _w((lambda *s: torch.randn(*s, dtype=torch.bfloat16) * 0.2)(1, 640) * 8.0), 'w_mod': _w((lambda *s: torch.randn(*s, dtype=torch.bfloat16) * 0.2)(640, 6 * 640) * 640 ** (-0.5) * 8.0)}

def reference(A_x, A_k_cache, A_v_cache, A_wq, A_wo, B_x, B_W_gate, B_W_up, B_W_down, c, w_mod):

    def _A_ref(x, k_cache, v_cache, wq, wo):
        B, Sq, D = x.shape
        Hq, Dh = (32, 128)
        Hkv, Sk = (k_cache.shape[1], k_cache.shape[2])
        W = min(4096, max(256, Sk // 4))
        rep = Hq // Hkv
        q = (lambda x, *d: x.permute(*d))((x @ wq).reshape(B, Sq, Hq, Dh), 0, 2, 1, 3)
        k = (lambda x, n, axis: torch.repeat_interleave(x, n, dim=axis))(k_cache[:, :, Sk - W:, :], rep, axis=1)
        v = (lambda x, n, axis: torch.repeat_interleave(x, n, dim=axis))(v_cache[:, :, Sk - W:, :], rep, axis=1)
        scores = torch.einsum('bhqd,bhkd->bhqk', q, k) * Dh ** (-0.5)
        p = _softmax(scores, axis=-1)
        o = torch.einsum('bhqk,bhkd->bhqd', p, v)
        return (lambda x, *d: x.permute(*d))(o, 0, 2, 1, 3).reshape(B, Sq, Hq * Dh) @ wo

    def _B_ref(x, W_gate, W_up, W_down):
        gate = torch.einsum('bsd,df->bsf', x, W_gate)
        up = torch.einsum('bsd,df->bsf', x, W_up)
        gate = gate * (lambda x, dt: x.to(dt))(gate > 0, gate.dtype)
        h = gate * up
        return torch.einsum('bsf,fd->bsd', h, W_down)
    x = A_x
    mod = (_silu(c) @ w_mod).reshape(c.shape[0], 6, 1, -1)
    sa, ca, ga, sb, cb, gb = (mod[:, 0].clone(), mod[:, 1].clone(), mod[:, 2].clone(), mod[:, 3].clone(), mod[:, 4].clone(), mod[:, 5].clone())
    h = _layernorm(x, axis=-1) * (1 + ca) + sa
    x = x + ga * _A_ref(h, A_k_cache, A_v_cache, A_wq, A_wo)
    h = _layernorm(x, axis=-1) * (1 + cb) + sb
    x = x + gb * _B_ref(h, B_W_gate, B_W_up, B_W_down)
    return x
```

```asm
; @launch grid=(256,1,1) block=(256,1,1) lds=163840
.amdgcn_target "amdgcn-amd-amdhsa--gfx950"
.text
.globl adaLN_cond__sliding_block_cached__glu_gated_reglu__prompt_kernel
.p2align 8
.type adaLN_cond__sliding_block_cached__glu_gated_reglu__prompt_kernel,@function
adaLN_cond__sliding_block_cached__glu_gated_reglu__prompt_kernel:
    s_cmp_ge_u32 s2, 256
    s_cbranch_scc1 K1_END
    s_getpc_b64 s[64:65]
M_PC:
    s_add_u32 s64, s64, (M_PC-M_PC)&0xffffffff
    s_addc_u32 s65, s65, ((M_PC-M_PC)>>32)&0xffffffff
    s_mov_b32 s66, K1_END-M_PC
    s_mov_b32 s67, 0x20000
    s_lshr_b32 s3, s2, 3
    s_lshl_b32 s3, s3, 12
    v_lshlrev_b32 v2, 4, v0
    buffer_load_dwordx4 a[0:3], v2, s[64:67], s3 offen
    s_load_dwordx2 s[14:15], s[0:1], 104
    s_load_dwordx2 s[68:69], s[0:1], 0
    v_lshrrev_b32 v1, 6, v0
    s_cmp_lt_u32 s2, 80
    v_mov_b32 v73, 0
    v_readfirstlane_b32 s60, v1
    v_mov_b32 v74, 0
    s_cbranch_scc1 F_G1
    s_cmp_ge_u32 s2, 248
    s_cbranch_scc1 F_NONE
    s_mov_b32 s70, 2621440
    s_mov_b32 s71, 0x20000
    s_sub_u32 s3, s2, 120
    v_and_b32 v102, 7, v0
    v_bfe_u32 v103, v0, 3, 3
    s_and_b32 s4, s60, 1
    s_lshl_b32 s4, s4, 3
    v_add_u32 v102, s4, v102
    s_lshr_b32 s4, s60, 1
    s_mul_i32 s4, s4, 40
    v_add_u32 v103, s4, v103
    v_mul_u32_u24 v104, 1280, v102
    v_lshl_add_u32 v104, v103, 4, v104
    s_mul_i32 s4, s3, 20480
    s_cmp_lt_u32 s2, 120
    s_waitcnt lgkmcnt(0)
    s_cbranch_scc1 F_NOX
    buffer_load_dwordx4 v[80:83], v104, s[68:71], s4 offen nt
    buffer_load_dwordx4 v[84:87], v104, s[68:71], s4 offen offset:128 nt
    buffer_load_dwordx4 v[88:91], v104, s[68:71], s4 offen offset:256 nt
    buffer_load_dwordx4 v[92:95], v104, s[68:71], s4 offen offset:384 nt
    buffer_load_dwordx4 v[96:99], v104, s[68:71], s4 offen offset:512 nt
F_NOX:
    s_add_u32 s62, s14, 878592
    s_addc_u32 s63, s15, 0
    s_load_dword s59, s[62:63], 0
    s_branch M_COMMON
F_G1:
    s_load_dwordx4 s[8:11], s[0:1], 72
    s_lshr_b32 s3, s2, 2
    s_and_b32 s4, s2, 3
    s_mul_i32 s5, s4, 1228800
    s_lshl_b32 s6, s3, 7
    s_add_u32 s5, s5, s6
    s_mul_i32 s6, s4, 320
    v_lshrrev_b32 v2, 3, v0
    v_and_b32 v1, 63, v0
    v_and_b32 v3, 7, v0
    v_mul_u32_u24 v4, 7680, v2
    v_lshl_add_u32 v4, v3, 4, v4
    v_lshlrev_b32 v3, 1, v2
    s_waitcnt lgkmcnt(0)
    s_mov_b32 s20, s10
    s_mov_b32 s21, s11
    s_mov_b32 s22, 0x4b0000
    s_mov_b32 s23, 0x20000
    buffer_load_dwordx4 v[32:35], v4, s[20:23], s5 offen nt
    s_add_u32 s5, s5, 245760
    buffer_load_dwordx4 v[36:39], v4, s[20:23], s5 offen nt
    s_add_u32 s5, s5, 245760
    buffer_load_dwordx4 v[40:43], v4, s[20:23], s5 offen nt
    s_add_u32 s5, s5, 245760
    buffer_load_dwordx4 v[44:47], v4, s[20:23], s5 offen nt
    s_add_u32 s5, s5, 245760
    buffer_load_dwordx4 v[48:51], v4, s[20:23], s5 offen nt
    s_add_u32 s5, s5, 245760
    s_mov_b32 s16, s8
    s_mov_b32 s17, s9
    s_mov_b32 s18, 0x500
    s_mov_b32 s19, 0x20000
    buffer_load_ushort v8, v3, s[16:19], s6 offen offset:0
    buffer_load_ushort v9, v3, s[16:19], s6 offen offset:64
    buffer_load_ushort v10, v3, s[16:19], s6 offen offset:128
    buffer_load_ushort v11, v3, s[16:19], s6 offen offset:192
    buffer_load_ushort v12, v3, s[16:19], s6 offen offset:256
    s_add_u32 s62, s14, 878592
    s_addc_u32 s63, s15, 0
    s_load_dword s59, s[62:63], 0
    s_add_u32 s24, s14, 0xc000
    s_addc_u32 s25, s15, 0
    s_mov_b32 s26, 0xa000
    s_mov_b32 s27, 0x20000
    s_mov_b32 s7, 0xbfb8aa3b
    v_lshlrev_b32 v5, 5, v0
    v_add_u32 v5, 131072, v5
    v_lshlrev_b32 v6, 2, v1
    v_add_u32 v6, 131072, v6
    v_lshlrev_b32 v31, 3, v1
    s_mul_i32 s34, s4, 10240
    s_lshl_b32 s35, s3, 9
    s_add_u32 s34, s34, s35
    s_mov_b64 exec, 0
    s_cmp_eq_u32 s60, 0
    s_cbranch_scc1 F_G1D
    s_branch F_G1C
F_G1W:
    s_mov_b64 exec, -1
    s_waitcnt vmcnt(0)
F_G1C:
    v_lshlrev_b32 v8, 16, v8
    v_mul_f32 v120, s7, v8
    v_lshlrev_b32 v9, 16, v9
    v_mul_f32 v121, s7, v9
    v_lshlrev_b32 v10, 16, v10
    v_mul_f32 v122, s7, v10
    v_lshlrev_b32 v11, 16, v11
    v_mul_f32 v123, s7, v11
    v_lshlrev_b32 v12, 16, v12
    v_mul_f32 v124, s7, v12
    v_exp_f32 v120, v120
    v_exp_f32 v121, v121
    v_exp_f32 v122, v122
    v_exp_f32 v123, v123
    v_exp_f32 v124, v124
    v_add_f32 v120, 1.0, v120
    v_add_f32 v121, 1.0, v121
    v_add_f32 v122, 1.0, v122
    v_add_f32 v123, 1.0, v123
    v_add_f32 v124, 1.0, v124
    v_rcp_f32 v120, v120
    v_rcp_f32 v121, v121
    v_rcp_f32 v122, v122
    v_rcp_f32 v123, v123
    v_rcp_f32 v124, v124
    v_mul_f32 v8, v8, v120
    v_mul_f32 v9, v9, v121
    v_mul_f32 v10, v10, v122
    v_mul_f32 v11, v11, v123
    v_mul_f32 v12, v12, v124
    v_cvt_pk_bf16_f32 v8, v8, v8
    v_cvt_pk_bf16_f32 v9, v9, v9
    v_cvt_pk_bf16_f32 v10, v10, v10
    v_cvt_pk_bf16_f32 v11, v11, v11
    v_cvt_pk_bf16_f32 v12, v12, v12
    v_lshlrev_b32 v8, 16, v8
    v_lshlrev_b32 v9, 16, v9
    v_lshlrev_b32 v10, 16, v10
    v_lshlrev_b32 v11, 16, v11
    v_lshlrev_b32 v12, 16, v12
    v_lshlrev_b32 v28, 16, v32
    v_and_b32 v29, 0xffff0000, v32
    v_mul_f32 v112, v8, v28
    v_mul_f32 v113, v8, v29
    v_lshlrev_b32 v28, 16, v33
    v_and_b32 v29, 0xffff0000, v33
    v_mul_f32 v114, v8, v28
    v_mul_f32 v115, v8, v29
    v_lshlrev_b32 v28, 16, v34
    v_and_b32 v29, 0xffff0000, v34
    v_mul_f32 v116, v8, v28
    v_mul_f32 v117, v8, v29
    v_lshlrev_b32 v28, 16, v35
    v_and_b32 v29, 0xffff0000, v35
    v_mul_f32 v118, v8, v28
    v_mul_f32 v119, v8, v29
    v_lshlrev_b32 v28, 16, v36
    v_and_b32 v29, 0xffff0000, v36
    v_fmac_f32 v112, v9, v28
    v_fmac_f32 v113, v9, v29
    v_lshlrev_b32 v28, 16, v37
    v_and_b32 v29, 0xffff0000, v37
    v_fmac_f32 v114, v9, v28
    v_fmac_f32 v115, v9, v29
    v_lshlrev_b32 v28, 16, v38
    v_and_b32 v29, 0xffff0000, v38
    v_fmac_f32 v116, v9, v28
    v_fmac_f32 v117, v9, v29
    v_lshlrev_b32 v28, 16, v39
    v_and_b32 v29, 0xffff0000, v39
    v_fmac_f32 v118, v9, v28
    v_fmac_f32 v119, v9, v29
    v_lshlrev_b32 v28, 16, v40
    v_and_b32 v29, 0xffff0000, v40
    v_fmac_f32 v112, v10, v28
    v_fmac_f32 v113, v10, v29
    v_lshlrev_b32 v28, 16, v41
    v_and_b32 v29, 0xffff0000, v41
    v_fmac_f32 v114, v10, v28
    v_fmac_f32 v115, v10, v29
    v_lshlrev_b32 v28, 16, v42
    v_and_b32 v29, 0xffff0000, v42
    v_fmac_f32 v116, v10, v28
    v_fmac_f32 v117, v10, v29
    v_lshlrev_b32 v28, 16, v43
    v_and_b32 v29, 0xffff0000, v43
    v_fmac_f32 v118, v10, v28
    v_fmac_f32 v119, v10, v29
    v_lshlrev_b32 v28, 16, v44
    v_and_b32 v29, 0xffff0000, v44
    v_fmac_f32 v112, v11, v28
    v_fmac_f32 v113, v11, v29
    v_lshlrev_b32 v28, 16, v45
    v_and_b32 v29, 0xffff0000, v45
    v_fmac_f32 v114, v11, v28
    v_fmac_f32 v115, v11, v29
    v_lshlrev_b32 v28, 16, v46
    v_and_b32 v29, 0xffff0000, v46
    v_fmac_f32 v116, v11, v28
    v_fmac_f32 v117, v11, v29
    v_lshlrev_b32 v28, 16, v47
    v_and_b32 v29, 0xffff0000, v47
    v_fmac_f32 v118, v11, v28
    v_fmac_f32 v119, v11, v29
    v_lshlrev_b32 v28, 16, v48
    v_and_b32 v29, 0xffff0000, v48
    v_fmac_f32 v112, v12, v28
    v_fmac_f32 v113, v12, v29
    v_lshlrev_b32 v28, 16, v49
    v_and_b32 v29, 0xffff0000, v49
    v_fmac_f32 v114, v12, v28
    v_fmac_f32 v115, v12, v29
    v_lshlrev_b32 v28, 16, v50
    v_and_b32 v29, 0xffff0000, v50
    v_fmac_f32 v116, v12, v28
    v_fmac_f32 v117, v12, v29
    v_lshlrev_b32 v28, 16, v51
    v_and_b32 v29, 0xffff0000, v51
    v_fmac_f32 v118, v12, v28
    v_fmac_f32 v119, v12, v29
    s_cbranch_execz F_G1W
    ds_write_b128 v5, v[112:115]
    ds_write_b128 v5, v[116:119] offset:16
    s_waitcnt lgkmcnt(0)
    s_barrier
    s_cmp_lg_u32 s60, 0
    s_cbranch_scc1 F_G1R
F_G1D:
    ds_read_b32 v128, v6 offset:0
    ds_read_b32 v129, v6 offset:256
    ds_read_b32 v130, v6 offset:512
    ds_read_b32 v131, v6 offset:768
    ds_read_b32 v132, v6 offset:1024
    ds_read_b32 v133, v6 offset:1280
    ds_read_b32 v134, v6 offset:1536
    ds_read_b32 v135, v6 offset:1792
    ds_read_b32 v136, v6 offset:2048
    ds_read_b32 v137, v6 offset:2304
    ds_read_b32 v138, v6 offset:2560
    ds_read_b32 v139, v6 offset:2816
    ds_read_b32 v140, v6 offset:3072
    ds_read_b32 v141, v6 offset:3328
    ds_read_b32 v142, v6 offset:3584
    ds_read_b32 v143, v6 offset:3840
    ds_read_b32 v144, v6 offset:4096
    ds_read_b32 v145, v6 offset:4352
    ds_read_b32 v146, v6 offset:4608
    ds_read_b32 v147, v6 offset:4864
    ds_read_b32 v148, v6 offset:5120
    ds_read_b32 v149, v6 offset:5376
    ds_read_b32 v150, v6 offset:5632
    ds_read_b32 v151, v6 offset:5888
    ds_read_b32 v152, v6 offset:6144
    ds_read_b32 v153, v6 offset:6400
    ds_read_b32 v154, v6 offset:6656
    ds_read_b32 v155, v6 offset:6912
    ds_read_b32 v156, v6 offset:7168
    ds_read_b32 v157, v6 offset:7424
    ds_read_b32 v158, v6 offset:7680
    ds_read_b32 v159, v6 offset:7936
    s_waitcnt lgkmcnt(0)
    v_pk_add_f32 v[128:129], v[128:129], v[132:133]
    v_pk_add_f32 v[130:131], v[130:131], v[134:135]
    v_pk_add_f32 v[128:129], v[128:129], v[136:137]
    v_pk_add_f32 v[130:131], v[130:131], v[138:139]
    v_pk_add_f32 v[128:129], v[128:129], v[140:141]
    v_pk_add_f32 v[130:131], v[130:131], v[142:143]
    v_pk_add_f32 v[128:129], v[128:129], v[144:145]
    v_pk_add_f32 v[130:131], v[130:131], v[146:147]
    v_pk_add_f32 v[128:129], v[128:129], v[148:149]
    v_pk_add_f32 v[130:131], v[130:131], v[150:151]
    v_pk_add_f32 v[128:129], v[128:129], v[152:153]
    v_pk_add_f32 v[130:131], v[130:131], v[154:155]
    v_pk_add_f32 v[128:129], v[128:129], v[156:157]
    v_pk_add_f32 v[130:131], v[130:131], v[158:159]
    v_pk_add_f32 v[128:129], v[128:129], v[130:131]
    v_add_f32 v16, v128, v129
    s_add_u32 s61, s59, 1
    v_mov_b32 v17, s61
    s_cbranch_execz F_G1W
    buffer_store_dwordx2 v[16:17], v31, s[24:27], s34 offen sc1
F_G1R:
    s_branch M_COMMON
F_NONE:
    s_load_dwordx2 s[12:13], s[0:1], 24
    v_and_b32 v1, 63, v0
    v_lshlrev_b32 v1, 4, v1
    s_lshl_b32 s6, s60, 13
    s_and_b32 s5, s2, 7
    s_lshl_b32 s7, s5, 10
    s_add_u32 s6, s6, s7
    s_mov_b32 s7, 0
    s_waitcnt lgkmcnt(0)
    s_add_u32 s62, s14, 878592
    s_addc_u32 s63, s15, 0
    s_load_dword s59, s[62:63], 0
    s_mov_b32 s16, s12
    s_mov_b32 s17, s13
    s_mov_b32 s18, 0x500000
    s_mov_b32 s19, 0x20000
F_NL:
    buffer_load_dwordx4 a[0:3], v1, s[16:19], s6 offen
    s_add_u32 s6, s6, 32768
    buffer_load_dwordx4 a[0:3], v1, s[16:19], s6 offen
    s_add_u32 s6, s6, 32768
    buffer_load_dwordx4 a[0:3], v1, s[16:19], s6 offen
    s_add_u32 s6, s6, 32768
    buffer_load_dwordx4 a[0:3], v1, s[16:19], s6 offen
    s_add_u32 s6, s6, 32768
    buffer_load_dwordx4 a[0:3], v1, s[16:19], s6 offen
    s_add_u32 s6, s6, 32768
    buffer_load_dwordx4 a[0:3], v1, s[16:19], s6 offen
    s_add_u32 s6, s6, 32768
    buffer_load_dwordx4 a[0:3], v1, s[16:19], s6 offen
    s_add_u32 s6, s6, 32768
    buffer_load_dwordx4 a[0:3], v1, s[16:19], s6 offen
    s_add_u32 s6, s6, 32768
    s_add_u32 s7, s7, 1
    s_cmp_lt_u32 s7, 4
    s_cbranch_scc1 F_NL
    s_branch M_COMMON
M_COMMON:
    s_load_dwordx2 s[68:69], s[0:1], 24
    s_load_dwordx2 s[70:71], s[0:1], 104
    s_load_dwordx4 s[64:67], s[0:1], 8
    v_lshrrev_b32 v3, 6, v0
    v_and_b32 v1, 63, v0
    v_readfirstlane_b32 s3, v3
    s_and_b32 s4, s2, 7
    s_lshl_b32 s4, s4, 2
    s_bfe_u32 s41, s2, 0x20003
    s_add_u32 s4, s4, s41
    s_lshr_b32 s5, s2, 5
    s_lshl_b32 s5, s5, 4
    s_lshl_b32 s41, s3, 2
    s_add_u32 s5, s5, s41
    v_lshlrev_b32 v2, 4, v1
    s_lshr_b32 s41, s3, 1
    s_and_b32 s42, s3, 1
    v_lshrrev_b32 v240, 3, v1
    v_and_b32 v241, 7, v1
    v_bfe_u32 v242, v1, 4, 1
    v_lshlrev_b32 v242, 1, v242
    v_xor_b32 v242, v242, v241
    v_xor_b32 v243, 4, v242
    s_lshl_b32 s43, s42, 19
    s_lshl_b32 s41, s41, 7
    s_add_u32 s43, s43, s41
    v_lshlrev_b32 v244, 13, v240
    v_add_u32 v244, s43, v244
    v_lshl_add_u32 v242, v242, 4, v244
    v_lshl_add_u32 v243, v243, 4, v244
    v_add_u32 v4, 0, v242
    v_add_u32 v5, 64512, v243
    v_add_u32 v6, 129024, v242
    v_add_u32 v7, 193536, v243
    v_add_u32 v8, 262144, v242
    v_add_u32 v9, 326656, v243
    v_add_u32 v10, 391168, v242
    v_add_u32 v11, 455680, v243
    v_add_u32 v28, 0, v2
    v_add_u32 v29, 20480, v2
    v_add_u32 v30, 40960, v2
    v_add_u32 v31, 61440, v2
    s_mul_i32 s39, s5, 20480
    s_lshl_b32 s32, s4, 8
    s_mov_b32 s33, s32
    s_mov_b32 s34, 1048576
    s_lshl_b32 s35, s3, 13
    s_add_u32 s36, s35, 4096
    s_mov_b32 s37, 0
    s_waitcnt lgkmcnt(0)
    s_add_u32 s59, s59, 1
    v_mov_b32 v0, s59
    s_mov_b32 s8, s68
    s_mov_b32 s9, s69
    s_mov_b32 s10, 0x500000
    s_mov_b32 s11, 0x20000
    s_mov_b32 s12, s68
    s_mov_b32 s13, s69
    s_mov_b32 s14, 0x500000
    s_mov_b32 s15, 0x20000
    s_add_u32 s16, s70, 0x100000
    s_addc_u32 s17, s71, 0
    s_mov_b32 s18, 0x280000
    s_mov_b32 s19, 0x20000
    s_add_u32 s20, s70, 0x187c000
    s_addc_u32 s21, s71, 0
    s_mov_b32 s22, 0x1000000
    s_mov_b32 s23, 0x20000
    s_mov_b32 s24, s66
    s_mov_b32 s25, s67
    s_mov_b32 s26, 0x1000000
    s_mov_b32 s27, 0x20000
    s_mov_b32 s28, s64
    s_mov_b32 s29, s65
    s_mov_b32 s30, 0x1000000
    s_mov_b32 s31, 0x20000
    s_load_dwordx2 s[64:65], s[0:1], 32
    s_load_dwordx2 s[66:67], s[0:1], 64
    s_load_dwordx4 s[68:71], s[0:1], 48
    v_accvgpr_write_b32 a244, 0
    v_accvgpr_write_b32 a245, 0
    v_accvgpr_write_b32 a246, 0
    v_accvgpr_write_b32 a247, 0
    v_lshrrev_b32 v240, 4, v1
    v_and_b32 v241, 15, v1
    v_lshrrev_b32 v242, 2, v241
    v_and_b32 v243, 3, v241
    v_lshlrev_b32 v243, 3, v243
    v_lshl_add_u32 v244, v240, 3, v242
    v_lshl_add_u32 v244, v244, 7, v243
    v_lshrrev_b32 v245, 3, v241
    v_and_b32 v246, 1, v240
    v_lshl_add_u32 v245, v246, 1, v245
    v_xor_b32 v246, 0, v245
    v_lshl_add_u32 v16, v246, 5, v244
    v_mov_b32 v12, v16
    v_xor_b32 v246, 1, v245
    v_lshl_add_u32 v17, v246, 5, v244
    v_mov_b32 v13, v17
    v_xor_b32 v246, 2, v245
    v_lshl_add_u32 v18, v246, 5, v244
    v_mov_b32 v14, v18
    v_xor_b32 v246, 3, v245
    v_lshl_add_u32 v19, v246, 5, v244
    v_mov_b32 v15, v19
    v_lshl_add_u32 v244, v240, 2, v242
    v_bfe_u32 v245, v244, 1, 2
    v_lshl_add_u32 v244, v244, 7, v243
    v_xor_b32 v246, 0, v245
    v_lshl_add_u32 v20, v246, 5, v244
    v_xor_b32 v246, 1, v245
    v_lshl_add_u32 v21, v246, 5, v244
    v_xor_b32 v246, 2, v245
    v_lshl_add_u32 v22, v246, 5, v244
    v_xor_b32 v246, 3, v245
    v_lshl_add_u32 v23, v246, 5, v244
    v_lshrrev_b32 v245, 1, v241
    v_xor_b32 v245, v245, v240
    v_lshlrev_b32 v244, 7, v241
    v_lshl_add_u32 v26, v245, 4, v244
    v_xor_b32 v245, 4, v245
    v_lshl_add_u32 v27, v245, 4, v244
    v_mov_b32 v240, 0x3f803f80
    v_accvgpr_write_b32 a144, v240
    v_accvgpr_write_b32 a145, v240
    v_accvgpr_write_b32 a146, v240
    v_accvgpr_write_b32 a147, v240
    v_accvgpr_write_b32 a128, 0
    v_accvgpr_write_b32 a129, 0
    v_accvgpr_write_b32 a130, 0
    v_accvgpr_write_b32 a131, 0
    v_accvgpr_write_b32 a132, 0
    v_accvgpr_write_b32 a133, 0
    v_accvgpr_write_b32 a134, 0
    v_accvgpr_write_b32 a135, 0
    v_accvgpr_write_b32 a136, 0
    v_accvgpr_write_b32 a137, 0
    v_accvgpr_write_b32 a138, 0
    v_accvgpr_write_b32 a139, 0
    v_accvgpr_write_b32 a140, 0
    v_accvgpr_write_b32 a141, 0
    v_accvgpr_write_b32 a142, 0
    v_accvgpr_write_b32 a143, 0
    s_mul_i32 s44, s4, 524288
    s_add_u32 s44, s44, 393216
    s_mov_b32 s38, 0x8000
    s_mov_b32 s40, 0
    s_lshl_b32 s41, s2, 2
    s_add_u32 s41, s41, s3
    v_lshrrev_b32 v247, 3, v1
    v_and_b32 v248, 7, v1
    v_lshrrev_b32 v249, 4, v1
    v_lshlrev_b32 v249, 1, v249
    v_xor_b32 v248, v248, v249
    v_lshlrev_b32 v248, 4, v248
    v_mul_u32_u24 v252, 1280, v247
    v_add_u32 v252, v252, v248
    v_mul_u32_u24 v253, 3456, v247
    v_add_u32 v253, v253, v248
    v_mov_b32 v254, v252
    v_and_b32 v247, 15, v1
    v_lshrrev_b32 v248, 4, v1
    v_lshlrev_b32 v248, 4, v248
    v_lshl_add_u32 v248, v247, 6, v248
    v_cmp_gt_u32 vcc, 2, v247
    v_mov_b32 v247, 0x70000000
    s_waitcnt lgkmcnt(0)
    v_cndmask_b32 v255, v247, v248, vcc
    s_mul_hi_u32 s42, s41, 429496730
    s_mul_i32 s43, s42, 10
    s_sub_u32 s43, s41, s43
    s_mul_i32 s45, s42, 40960
    s_lshl_b32 s48, s43, 7
    s_add_u32 s45, s45, s48
    s_mul_i32 s48, s43, 524288
    s_lshl_b32 s42, s42, 10
    s_add_u32 s48, s48, s42
    s_add_u32 s48, s48, 13500416
    s_cmp_ge_u32 s41, 560
    s_cselect_b32 s42, 560, 0
    s_cselect_b32 s43, 1, 0
    s_cselect_b32 s60, s70, s68
    s_cselect_b32 s61, s71, s69
    s_sub_u32 s47, s41, s42
    s_mul_hi_u32 s42, s47, 153391690
    s_mul_i32 s50, s42, 28
    s_sub_u32 s50, s47, s50
    s_mul_i32 s47, s42, 110592
    s_lshl_b32 s53, s50, 7
    s_add_u32 s47, s47, s53
    s_lshl_b32 s50, s50, 3
    s_add_u32 s50, s50, s43
    s_mul_i32 s43, s42, 224
    s_add_u32 s50, s50, s43
    s_lshl_b32 s53, s50, 7
    s_mul_i32 s43, s42, 0
    s_add_u32 s50, s50, s43
    s_lshl_b32 s50, s50, 10
    s_add_u32 s50, s50, 20955136
    s_mov_b32 s62, 2211840
    s_lshl_b32 s42, s42, 7
    s_add_u32 s63, s42, 753664
    s_mov_b32 s52, 0x70000000
    s_mov_b32 s54, 9216
    s_cmp_ge_u32 s41, 796
    s_cbranch_scc1 K1_SB_WGU
    s_cmp_ge_u32 s41, 256
    s_cbranch_scc1 K1_SB_WD
    s_add_u32 s41, s41, 1024
    s_mul_hi_u32 s42, s41, 429496730
    s_mul_i32 s43, s42, 10
    s_sub_u32 s43, s41, s43
    s_mul_i32 s46, s42, 40960
    s_lshl_b32 s49, s43, 7
    s_add_u32 s46, s46, s49
    s_mul_i32 s49, s43, 524288
    s_lshl_b32 s42, s42, 10
    s_add_u32 s49, s49, s42
    s_add_u32 s49, s49, 13500416
    s_mov_b32 s56, s64
    s_mov_b32 s57, s65
    s_mov_b32 s58, 5242880
    s_mov_b32 s51, 131072
    s_mov_b32 s42, 0
    s_branch K1_SB_DONE
K1_SB_WD:
    s_sub_u32 s41, s41, 256
    s_mul_hi_u32 s42, s41, 429496730
    s_mul_i32 s43, s42, 10
    s_sub_u32 s43, s41, s43
    s_mul_i32 s46, s42, 40960
    s_lshl_b32 s49, s43, 7
    s_add_u32 s46, s46, s49
    s_mul_i32 s49, s43, 221184
    s_lshl_b32 s42, s42, 10
    s_add_u32 s49, s49, s42
    s_add_u32 s49, s49, 18743296
    s_mov_b32 s56, s66
    s_mov_b32 s57, s67
    s_mov_b32 s58, 2211840
    s_mov_b32 s51, 55296
    s_mov_b32 s42, 0
    s_branch K1_SB_DONE
K1_SB_WGU:
    s_add_u32 s41, s41, 228
    s_cmp_ge_u32 s41, 560
    s_cselect_b32 s42, 560, 0
    s_cselect_b32 s43, 1, 0
    s_cselect_b32 s56, s70, s68
    s_cselect_b32 s57, s71, s69
    s_sub_u32 s46, s41, s42
    s_mul_hi_u32 s42, s46, 153391690
    s_mul_i32 s49, s42, 28
    s_sub_u32 s49, s46, s49
    s_mul_i32 s46, s42, 110592
    s_lshl_b32 s52, s49, 7
    s_add_u32 s46, s46, s52
    s_lshl_b32 s49, s49, 3
    s_add_u32 s49, s49, s43
    s_mul_i32 s43, s42, 224
    s_add_u32 s49, s49, s43
    s_lshl_b32 s52, s49, 7
    s_mul_i32 s43, s42, 0
    s_add_u32 s49, s49, s43
    s_lshl_b32 s49, s49, 10
    s_add_u32 s49, s49, 20955136
    s_mov_b32 s58, 2211840
    s_lshl_b32 s42, s42, 7
    v_mov_b32 v254, v253
    s_mov_b32 s54, 26624
    s_mov_b32 s51, 2048
    s_cmp_lt_u32 s41, 1120
    s_cselect_b32 s46, s46, 0x70000000
    s_cselect_b32 s49, s49, 0x70000000
    s_cselect_b32 s52, s52, 0x70000000
K1_SB_DONE:
    s_add_u32 s59, s42, 753664
    s_mov_b32 s66, 5242880
    s_mov_b32 s67, 0x20000
    s_sub_u32 s41, s2, 80
    s_cmp_lt_u32 s41, 40
    s_cbranch_scc0 F_G2DONE
    s_load_dwordx2 s[68:69], s[0:1], 80
    s_mov_b32 s70, 4915200
    s_mov_b32 s71, 0x20000
    s_lshl_b32 s42, s3, 3
    v_lshrrev_b32 v32, 3, v1
    v_add_u32 v32, s42, v32
    v_and_b32 v33, 7, v1
    v_mul_u32_u24 v34, 7680, v32
    v_lshl_add_u32 v34, v33, 4, v34
    v_lshlrev_b32 v35, 8, v32
    v_lshl_add_u32 v35, v33, 5, v35
    v_add_u32 v35, 131072, v35
    v_lshlrev_b32 v33, 1, v32
    s_add_u32 s41, s41, 20
    s_lshl_b32 s42, s41, 7
    s_waitcnt lgkmcnt(0)
    buffer_load_dwordx4 v[112:115], v34, s[68:71], s42 offen nt
    s_add_u32 s42, s42, 245760
    buffer_load_dwordx4 v[116:119], v34, s[68:71], s42 offen nt
    s_add_u32 s42, s42, 245760
    buffer_load_dwordx4 v[120:123], v34, s[68:71], s42 offen nt
    s_add_u32 s42, s42, 245760
    buffer_load_dwordx4 v[124:127], v34, s[68:71], s42 offen nt
    s_add_u32 s42, s42, 245760
    buffer_load_dwordx4 v[128:131], v34, s[68:71], s42 offen nt
    s_add_u32 s42, s42, 245760
    buffer_load_dwordx4 v[132:135], v34, s[68:71], s42 offen nt
    s_add_u32 s42, s42, 245760
    buffer_load_dwordx4 v[136:139], v34, s[68:71], s42 offen nt
    s_add_u32 s42, s42, 245760
    buffer_load_dwordx4 v[140:143], v34, s[68:71], s42 offen nt
    s_add_u32 s42, s42, 245760
    buffer_load_dwordx4 v[144:147], v34, s[68:71], s42 offen nt
    s_add_u32 s42, s42, 245760
    buffer_load_dwordx4 v[148:151], v34, s[68:71], s42 offen nt
    s_add_u32 s42, s42, 245760
    buffer_load_dwordx4 v[152:155], v34, s[68:71], s42 offen nt
    s_add_u32 s42, s42, 245760
    buffer_load_dwordx4 v[156:159], v34, s[68:71], s42 offen nt
    s_add_u32 s42, s42, 245760
    buffer_load_dwordx4 v[160:163], v34, s[68:71], s42 offen nt
    s_add_u32 s42, s42, 245760
    buffer_load_dwordx4 v[164:167], v34, s[68:71], s42 offen nt
    s_add_u32 s42, s42, 245760
    buffer_load_dwordx4 v[168:171], v34, s[68:71], s42 offen nt
    s_add_u32 s42, s42, 245760
    buffer_load_dwordx4 v[172:175], v34, s[68:71], s42 offen nt
    s_add_u32 s42, s42, 245760
    buffer_load_dwordx4 v[176:179], v34, s[68:71], s42 offen nt
    s_add_u32 s42, s42, 245760
    buffer_load_dwordx4 v[180:183], v34, s[68:71], s42 offen nt
    s_add_u32 s42, s42, 245760
    buffer_load_dwordx4 v[184:187], v34, s[68:71], s42 offen nt
    s_add_u32 s42, s42, 245760
    buffer_load_dwordx4 v[188:191], v34, s[68:71], s42 offen nt
    s_add_u32 s42, s42, 245760
    s_load_dwordx2 s[68:69], s[0:1], 72
    s_mov_b32 s70, 1280
    v_lshlrev_b32 v36, 2, v1
    v_add_u32 v37, 131072, v36
    s_waitcnt lgkmcnt(0)
    buffer_load_ushort v40, v33, s[68:71], 0 offen offset:0
    buffer_load_ushort v41, v33, s[68:71], 0 offen offset:64
    buffer_load_ushort v42, v33, s[68:71], 0 offen offset:128
    buffer_load_ushort v43, v33, s[68:71], 0 offen offset:192
    buffer_load_ushort v44, v33, s[68:71], 0 offen offset:256
    buffer_load_ushort v45, v33, s[68:71], 0 offen offset:320
    buffer_load_ushort v46, v33, s[68:71], 0 offen offset:384
    buffer_load_ushort v47, v33, s[68:71], 0 offen offset:448
    buffer_load_ushort v48, v33, s[68:71], 0 offen offset:512
    buffer_load_ushort v49, v33, s[68:71], 0 offen offset:576
    buffer_load_ushort v50, v33, s[68:71], 0 offen offset:640
    buffer_load_ushort v51, v33, s[68:71], 0 offen offset:704
    buffer_load_ushort v52, v33, s[68:71], 0 offen offset:768
    buffer_load_ushort v53, v33, s[68:71], 0 offen offset:832
    buffer_load_ushort v54, v33, s[68:71], 0 offen offset:896
    buffer_load_ushort v55, v33, s[68:71], 0 offen offset:960
    buffer_load_ushort v56, v33, s[68:71], 0 offen offset:1024
    buffer_load_ushort v57, v33, s[68:71], 0 offen offset:1088
    buffer_load_ushort v58, v33, s[68:71], 0 offen offset:1152
    buffer_load_ushort v59, v33, s[68:71], 0 offen offset:1216
    s_sub_u32 s68, s16, 1048576
    s_subb_u32 s69, s17, 0
    s_mov_b32 s70, 917504
    s_mov_b32 s42, 0xbfb8aa3b
    s_waitcnt vmcnt(0)
    v_lshlrev_b32 v40, 16, v40
    v_mul_f32 v64, s42, v40
    v_lshlrev_b32 v41, 16, v41
    v_mul_f32 v65, s42, v41
    v_lshlrev_b32 v42, 16, v42
    v_mul_f32 v66, s42, v42
    v_lshlrev_b32 v43, 16, v43
    v_mul_f32 v67, s42, v43
    v_lshlrev_b32 v44, 16, v44
    v_mul_f32 v68, s42, v44
    v_lshlrev_b32 v45, 16, v45
    v_mul_f32 v69, s42, v45
    v_lshlrev_b32 v46, 16, v46
    v_mul_f32 v70, s42, v46
    v_lshlrev_b32 v47, 16, v47
    v_mul_f32 v71, s42, v47
    v_lshlrev_b32 v48, 16, v48
    v_mul_f32 v72, s42, v48
    v_lshlrev_b32 v49, 16, v49
    v_mul_f32 v73, s42, v49
    v_lshlrev_b32 v50, 16, v50
    v_mul_f32 v74, s42, v50
    v_lshlrev_b32 v51, 16, v51
    v_mul_f32 v75, s42, v51
    v_lshlrev_b32 v52, 16, v52
    v_mul_f32 v76, s42, v52
    v_lshlrev_b32 v53, 16, v53
    v_mul_f32 v77, s42, v53
    v_lshlrev_b32 v54, 16, v54
    v_mul_f32 v78, s42, v54
    v_lshlrev_b32 v55, 16, v55
    v_mul_f32 v79, s42, v55
    v_lshlrev_b32 v56, 16, v56
    v_mul_f32 v80, s42, v56
    v_lshlrev_b32 v57, 16, v57
    v_mul_f32 v81, s42, v57
    v_lshlrev_b32 v58, 16, v58
    v_mul_f32 v82, s42, v58
    v_lshlrev_b32 v59, 16, v59
    v_mul_f32 v83, s42, v59
    v_exp_f32 v64, v64
    v_exp_f32 v65, v65
    v_exp_f32 v66, v66
    v_exp_f32 v67, v67
    v_exp_f32 v68, v68
    v_exp_f32 v69, v69
    v_exp_f32 v70, v70
    v_exp_f32 v71, v71
    v_exp_f32 v72, v72
    v_exp_f32 v73, v73
    v_exp_f32 v74, v74
    v_exp_f32 v75, v75
    v_exp_f32 v76, v76
    v_exp_f32 v77, v77
    v_exp_f32 v78, v78
    v_exp_f32 v79, v79
    v_exp_f32 v80, v80
    v_exp_f32 v81, v81
    v_exp_f32 v82, v82
    v_exp_f32 v83, v83
    v_add_f32 v64, 1.0, v64
    v_add_f32 v65, 1.0, v65
    v_add_f32 v66, 1.0, v66
    v_add_f32 v67, 1.0, v67
    v_add_f32 v68, 1.0, v68
    v_add_f32 v69, 1.0, v69
    v_add_f32 v70, 1.0, v70
    v_add_f32 v71, 1.0, v71
    v_add_f32 v72, 1.0, v72
    v_add_f32 v73, 1.0, v73
    v_add_f32 v74, 1.0, v74
    v_add_f32 v75, 1.0, v75
    v_add_f32 v76, 1.0, v76
    v_add_f32 v77, 1.0, v77
    v_add_f32 v78, 1.0, v78
    v_add_f32 v79, 1.0, v79
    v_add_f32 v80, 1.0, v80
    v_add_f32 v81, 1.0, v81
    v_add_f32 v82, 1.0, v82
    v_add_f32 v83, 1.0, v83
    v_rcp_f32 v64, v64
    v_rcp_f32 v65, v65
    v_rcp_f32 v66, v66
    v_rcp_f32 v67, v67
    v_rcp_f32 v68, v68
    v_rcp_f32 v69, v69
    v_rcp_f32 v70, v70
    v_rcp_f32 v71, v71
    v_rcp_f32 v72, v72
    v_rcp_f32 v73, v73
    v_rcp_f32 v74, v74
    v_rcp_f32 v75, v75
    v_rcp_f32 v76, v76
    v_rcp_f32 v77, v77
    v_rcp_f32 v78, v78
    v_rcp_f32 v79, v79
    v_rcp_f32 v80, v80
    v_rcp_f32 v81, v81
    v_rcp_f32 v82, v82
    v_rcp_f32 v83, v83
    v_mul_f32 v40, v40, v64
    v_mul_f32 v41, v41, v65
    v_mul_f32 v42, v42, v66
    v_mul_f32 v43, v43, v67
    v_mul_f32 v44, v44, v68
    v_mul_f32 v45, v45, v69
    v_mul_f32 v46, v46, v70
    v_mul_f32 v47, v47, v71
    v_mul_f32 v48, v48, v72
    v_mul_f32 v49, v49, v73
    v_mul_f32 v50, v50, v74
    v_mul_f32 v51, v51, v75
    v_mul_f32 v52, v52, v76
    v_mul_f32 v53, v53, v77
    v_mul_f32 v54, v54, v78
    v_mul_f32 v55, v55, v79
    v_mul_f32 v56, v56, v80
    v_mul_f32 v57, v57, v81
    v_mul_f32 v58, v58, v82
    v_mul_f32 v59, v59, v83
    v_cvt_pk_bf16_f32 v40, v40, v40
    v_cvt_pk_bf16_f32 v41, v41, v41
    v_cvt_pk_bf16_f32 v42, v42, v42
    v_cvt_pk_bf16_f32 v43, v43, v43
    v_cvt_pk_bf16_f32 v44, v44, v44
    v_cvt_pk_bf16_f32 v45, v45, v45
    v_cvt_pk_bf16_f32 v46, v46, v46
    v_cvt_pk_bf16_f32 v47, v47, v47
    v_cvt_pk_bf16_f32 v48, v48, v48
    v_cvt_pk_bf16_f32 v49, v49, v49
    v_cvt_pk_bf16_f32 v50, v50, v50
    v_cvt_pk_bf16_f32 v51, v51, v51
    v_cvt_pk_bf16_f32 v52, v52, v52
    v_cvt_pk_bf16_f32 v53, v53, v53
    v_cvt_pk_bf16_f32 v54, v54, v54
    v_cvt_pk_bf16_f32 v55, v55, v55
    v_cvt_pk_bf16_f32 v56, v56, v56
    v_cvt_pk_bf16_f32 v57, v57, v57
    v_cvt_pk_bf16_f32 v58, v58, v58
    v_cvt_pk_bf16_f32 v59, v59, v59
    v_lshlrev_b32 v40, 16, v40
    v_lshlrev_b32 v41, 16, v41
    v_lshlrev_b32 v42, 16, v42
    v_lshlrev_b32 v43, 16, v43
    v_lshlrev_b32 v44, 16, v44
    v_lshlrev_b32 v45, 16, v45
    v_lshlrev_b32 v46, 16, v46
    v_lshlrev_b32 v47, 16, v47
    v_lshlrev_b32 v48, 16, v48
    v_lshlrev_b32 v49, 16, v49
    v_lshlrev_b32 v50, 16, v50
    v_lshlrev_b32 v51, 16, v51
    v_lshlrev_b32 v52, 16, v52
    v_lshlrev_b32 v53, 16, v53
    v_lshlrev_b32 v54, 16, v54
    v_lshlrev_b32 v55, 16, v55
    v_lshlrev_b32 v56, 16, v56
    v_lshlrev_b32 v57, 16, v57
    v_lshlrev_b32 v58, 16, v58
    v_lshlrev_b32 v59, 16, v59
    v_lshlrev_b32 v38, 16, v112
    v_and_b32 v39, 0xffff0000, v112
    v_mul_f32 v104, v40, v38
    v_mul_f32 v105, v40, v39
    v_lshlrev_b32 v38, 16, v113
    v_and_b32 v39, 0xffff0000, v113
    v_mul_f32 v106, v40, v38
    v_mul_f32 v107, v40, v39
    v_lshlrev_b32 v38, 16, v114
    v_and_b32 v39, 0xffff0000, v114
    v_mul_f32 v108, v40, v38
    v_mul_f32 v109, v40, v39
    v_lshlrev_b32 v38, 16, v115
    v_and_b32 v39, 0xffff0000, v115
    v_mul_f32 v110, v40, v38
    v_mul_f32 v111, v40, v39
    v_lshlrev_b32 v38, 16, v116
    v_and_b32 v39, 0xffff0000, v116
    v_fmac_f32 v104, v41, v38
    v_fmac_f32 v105, v41, v39
    v_lshlrev_b32 v38, 16, v117
    v_and_b32 v39, 0xffff0000, v117
    v_fmac_f32 v106, v41, v38
    v_fmac_f32 v107, v41, v39
    v_lshlrev_b32 v38, 16, v118
    v_and_b32 v39, 0xffff0000, v118
    v_fmac_f32 v108, v41, v38
    v_fmac_f32 v109, v41, v39
    v_lshlrev_b32 v38, 16, v119
    v_and_b32 v39, 0xffff0000, v119
    v_fmac_f32 v110, v41, v38
    v_fmac_f32 v111, v41, v39
    v_lshlrev_b32 v38, 16, v120
    v_and_b32 v39, 0xffff0000, v120
    v_fmac_f32 v104, v42, v38
    v_fmac_f32 v105, v42, v39
    v_lshlrev_b32 v38, 16, v121
    v_and_b32 v39, 0xffff0000, v121
    v_fmac_f32 v106, v42, v38
    v_fmac_f32 v107, v42, v39
    v_lshlrev_b32 v38, 16, v122
    v_and_b32 v39, 0xffff0000, v122
    v_fmac_f32 v108, v42, v38
    v_fmac_f32 v109, v42, v39
    v_lshlrev_b32 v38, 16, v123
    v_and_b32 v39, 0xffff0000, v123
    v_fmac_f32 v110, v42, v38
    v_fmac_f32 v111, v42, v39
    v_lshlrev_b32 v38, 16, v124
    v_and_b32 v39, 0xffff0000, v124
    v_fmac_f32 v104, v43, v38
    v_fmac_f32 v105, v43, v39
    v_lshlrev_b32 v38, 16, v125
    v_and_b32 v39, 0xffff0000, v125
    v_fmac_f32 v106, v43, v38
    v_fmac_f32 v107, v43, v39
    v_lshlrev_b32 v38, 16, v126
    v_and_b32 v39, 0xffff0000, v126
    v_fmac_f32 v108, v43, v38
    v_fmac_f32 v109, v43, v39
    v_lshlrev_b32 v38, 16, v127
    v_and_b32 v39, 0xffff0000, v127
    v_fmac_f32 v110, v43, v38
    v_fmac_f32 v111, v43, v39
    v_lshlrev_b32 v38, 16, v128
    v_and_b32 v39, 0xffff0000, v128
    v_fmac_f32 v104, v44, v38
    v_fmac_f32 v105, v44, v39
    v_lshlrev_b32 v38, 16, v129
    v_and_b32 v39, 0xffff0000, v129
    v_fmac_f32 v106, v44, v38
    v_fmac_f32 v107, v44, v39
    v_lshlrev_b32 v38, 16, v130
    v_and_b32 v39, 0xffff0000, v130
    v_fmac_f32 v108, v44, v38
    v_fmac_f32 v109, v44, v39
    v_lshlrev_b32 v38, 16, v131
    v_and_b32 v39, 0xffff0000, v131
    v_fmac_f32 v110, v44, v38
    v_fmac_f32 v111, v44, v39
    v_lshlrev_b32 v38, 16, v132
    v_and_b32 v39, 0xffff0000, v132
    v_fmac_f32 v104, v45, v38
    v_fmac_f32 v105, v45, v39
    v_lshlrev_b32 v38, 16, v133
    v_and_b32 v39, 0xffff0000, v133
    v_fmac_f32 v106, v45, v38
    v_fmac_f32 v107, v45, v39
    v_lshlrev_b32 v38, 16, v134
    v_and_b32 v39, 0xffff0000, v134
    v_fmac_f32 v108, v45, v38
    v_fmac_f32 v109, v45, v39
    v_lshlrev_b32 v38, 16, v135
    v_and_b32 v39, 0xffff0000, v135
    v_fmac_f32 v110, v45, v38
    v_fmac_f32 v111, v45, v39
    v_lshlrev_b32 v38, 16, v136
    v_and_b32 v39, 0xffff0000, v136
    v_fmac_f32 v104, v46, v38
    v_fmac_f32 v105, v46, v39
    v_lshlrev_b32 v38, 16, v137
    v_and_b32 v39, 0xffff0000, v137
    v_fmac_f32 v106, v46, v38
    v_fmac_f32 v107, v46, v39
    v_lshlrev_b32 v38, 16, v138
    v_and_b32 v39, 0xffff0000, v138
    v_fmac_f32 v108, v46, v38
    v_fmac_f32 v109, v46, v39
    v_lshlrev_b32 v38, 16, v139
    v_and_b32 v39, 0xffff0000, v139
    v_fmac_f32 v110, v46, v38
    v_fmac_f32 v111, v46, v39
    v_lshlrev_b32 v38, 16, v140
    v_and_b32 v39, 0xffff0000, v140
    v_fmac_f32 v104, v47, v38
    v_fmac_f32 v105, v47, v39
    v_lshlrev_b32 v38, 16, v141
    v_and_b32 v39, 0xffff0000, v141
    v_fmac_f32 v106, v47, v38
    v_fmac_f32 v107, v47, v39
    v_lshlrev_b32 v38, 16, v142
    v_and_b32 v39, 0xffff0000, v142
    v_fmac_f32 v108, v47, v38
    v_fmac_f32 v109, v47, v39
    v_lshlrev_b32 v38, 16, v143
    v_and_b32 v39, 0xffff0000, v143
    v_fmac_f32 v110, v47, v38
    v_fmac_f32 v111, v47, v39
    v_lshlrev_b32 v38, 16, v144
    v_and_b32 v39, 0xffff0000, v144
    v_fmac_f32 v104, v48, v38
    v_fmac_f32 v105, v48, v39
    v_lshlrev_b32 v38, 16, v145
    v_and_b32 v39, 0xffff0000, v145
    v_fmac_f32 v106, v48, v38
    v_fmac_f32 v107, v48, v39
    v_lshlrev_b32 v38, 16, v146
    v_and_b32 v39, 0xffff0000, v146
    v_fmac_f32 v108, v48, v38
    v_fmac_f32 v109, v48, v39
    v_lshlrev_b32 v38, 16, v147
    v_and_b32 v39, 0xffff0000, v147
    v_fmac_f32 v110, v48, v38
    v_fmac_f32 v111, v48, v39
    v_lshlrev_b32 v38, 16, v148
    v_and_b32 v39, 0xffff0000, v148
    v_fmac_f32 v104, v49, v38
    v_fmac_f32 v105, v49, v39
    v_lshlrev_b32 v38, 16, v149
    v_and_b32 v39, 0xffff0000, v149
    v_fmac_f32 v106, v49, v38
    v_fmac_f32 v107, v49, v39
    v_lshlrev_b32 v38, 16, v150
    v_and_b32 v39, 0xffff0000, v150
    v_fmac_f32 v108, v49, v38
    v_fmac_f32 v109, v49, v39
    v_lshlrev_b32 v38, 16, v151
    v_and_b32 v39, 0xffff0000, v151
    v_fmac_f32 v110, v49, v38
    v_fmac_f32 v111, v49, v39
    v_lshlrev_b32 v38, 16, v152
    v_and_b32 v39, 0xffff0000, v152
    v_fmac_f32 v104, v50, v38
    v_fmac_f32 v105, v50, v39
    v_lshlrev_b32 v38, 16, v153
    v_and_b32 v39, 0xffff0000, v153
    v_fmac_f32 v106, v50, v38
    v_fmac_f32 v107, v50, v39
    v_lshlrev_b32 v38, 16, v154
    v_and_b32 v39, 0xffff0000, v154
    v_fmac_f32 v108, v50, v38
    v_fmac_f32 v109, v50, v39
    v_lshlrev_b32 v38, 16, v155
    v_and_b32 v39, 0xffff0000, v155
    v_fmac_f32 v110, v50, v38
    v_fmac_f32 v111, v50, v39
    v_lshlrev_b32 v38, 16, v156
    v_and_b32 v39, 0xffff0000, v156
    v_fmac_f32 v104, v51, v38
    v_fmac_f32 v105, v51, v39
    v_lshlrev_b32 v38, 16, v157
    v_and_b32 v39, 0xffff0000, v157
    v_fmac_f32 v106, v51, v38
    v_fmac_f32 v107, v51, v39
    v_lshlrev_b32 v38, 16, v158
    v_and_b32 v39, 0xffff0000, v158
    v_fmac_f32 v108, v51, v38
    v_fmac_f32 v109, v51, v39
    v_lshlrev_b32 v38, 16, v159
    v_and_b32 v39, 0xffff0000, v159
    v_fmac_f32 v110, v51, v38
    v_fmac_f32 v111, v51, v39
    v_lshlrev_b32 v38, 16, v160
    v_and_b32 v39, 0xffff0000, v160
    v_fmac_f32 v104, v52, v38
    v_fmac_f32 v105, v52, v39
    v_lshlrev_b32 v38, 16, v161
    v_and_b32 v39, 0xffff0000, v161
    v_fmac_f32 v106, v52, v38
    v_fmac_f32 v107, v52, v39
    v_lshlrev_b32 v38, 16, v162
    v_and_b32 v39, 0xffff0000, v162
    v_fmac_f32 v108, v52, v38
    v_fmac_f32 v109, v52, v39
    v_lshlrev_b32 v38, 16, v163
    v_and_b32 v39, 0xffff0000, v163
    v_fmac_f32 v110, v52, v38
    v_fmac_f32 v111, v52, v39
    v_lshlrev_b32 v38, 16, v164
    v_and_b32 v39, 0xffff0000, v164
    v_fmac_f32 v104, v53, v38
    v_fmac_f32 v105, v53, v39
    v_lshlrev_b32 v38, 16, v165
    v_and_b32 v39, 0xffff0000, v165
    v_fmac_f32 v106, v53, v38
    v_fmac_f32 v107, v53, v39
    v_lshlrev_b32 v38, 16, v166
    v_and_b32 v39, 0xffff0000, v166
    v_fmac_f32 v108, v53, v38
    v_fmac_f32 v109, v53, v39
    v_lshlrev_b32 v38, 16, v167
    v_and_b32 v39, 0xffff0000, v167
    v_fmac_f32 v110, v53, v38
    v_fmac_f32 v111, v53, v39
    v_lshlrev_b32 v38, 16, v168
    v_and_b32 v39, 0xffff0000, v168
    v_fmac_f32 v104, v54, v38
    v_fmac_f32 v105, v54, v39
    v_lshlrev_b32 v38, 16, v169
    v_and_b32 v39, 0xffff0000, v169
    v_fmac_f32 v106, v54, v38
    v_fmac_f32 v107, v54, v39
    v_lshlrev_b32 v38, 16, v170
    v_and_b32 v39, 0xffff0000, v170
    v_fmac_f32 v108, v54, v38
    v_fmac_f32 v109, v54, v39
    v_lshlrev_b32 v38, 16, v171
    v_and_b32 v39, 0xffff0000, v171
    v_fmac_f32 v110, v54, v38
    v_fmac_f32 v111, v54, v39
    v_lshlrev_b32 v38, 16, v172
    v_and_b32 v39, 0xffff0000, v172
    v_fmac_f32 v104, v55, v38
    v_fmac_f32 v105, v55, v39
    v_lshlrev_b32 v38, 16, v173
    v_and_b32 v39, 0xffff0000, v173
    v_fmac_f32 v106, v55, v38
    v_fmac_f32 v107, v55, v39
    v_lshlrev_b32 v38, 16, v174
    v_and_b32 v39, 0xffff0000, v174
    v_fmac_f32 v108, v55, v38
    v_fmac_f32 v109, v55, v39
    v_lshlrev_b32 v38, 16, v175
    v_and_b32 v39, 0xffff0000, v175
    v_fmac_f32 v110, v55, v38
    v_fmac_f32 v111, v55, v39
    v_lshlrev_b32 v38, 16, v176
    v_and_b32 v39, 0xffff0000, v176
    v_fmac_f32 v104, v56, v38
    v_fmac_f32 v105, v56, v39
    v_lshlrev_b32 v38, 16, v177
    v_and_b32 v39, 0xffff0000, v177
    v_fmac_f32 v106, v56, v38
    v_fmac_f32 v107, v56, v39
    v_lshlrev_b32 v38, 16, v178
    v_and_b32 v39, 0xffff0000, v178
    v_fmac_f32 v108, v56, v38
    v_fmac_f32 v109, v56, v39
    v_lshlrev_b32 v38, 16, v179
    v_and_b32 v39, 0xffff0000, v179
    v_fmac_f32 v110, v56, v38
    v_fmac_f32 v111, v56, v39
    v_lshlrev_b32 v38, 16, v180
    v_and_b32 v39, 0xffff0000, v180
    v_fmac_f32 v104, v57, v38
    v_fmac_f32 v105, v57, v39
    v_lshlrev_b32 v38, 16, v181
    v_and_b32 v39, 0xffff0000, v181
    v_fmac_f32 v106, v57, v38
    v_fmac_f32 v107, v57, v39
    v_lshlrev_b32 v38, 16, v182
    v_and_b32 v39, 0xffff0000, v182
    v_fmac_f32 v108, v57, v38
    v_fmac_f32 v109, v57, v39
    v_lshlrev_b32 v38, 16, v183
    v_and_b32 v39, 0xffff0000, v183
    v_fmac_f32 v110, v57, v38
    v_fmac_f32 v111, v57, v39
    v_lshlrev_b32 v38, 16, v184
    v_and_b32 v39, 0xffff0000, v184
    v_fmac_f32 v104, v58, v38
    v_fmac_f32 v105, v58, v39
    v_lshlrev_b32 v38, 16, v185
    v_and_b32 v39, 0xffff0000, v185
    v_fmac_f32 v106, v58, v38
    v_fmac_f32 v107, v58, v39
    v_lshlrev_b32 v38, 16, v186
    v_and_b32 v39, 0xffff0000, v186
    v_fmac_f32 v108, v58, v38
    v_fmac_f32 v109, v58, v39
    v_lshlrev_b32 v38, 16, v187
    v_and_b32 v39, 0xffff0000, v187
    v_fmac_f32 v110, v58, v38
    v_fmac_f32 v111, v58, v39
    v_lshlrev_b32 v38, 16, v188
    v_and_b32 v39, 0xffff0000, v188
    v_fmac_f32 v104, v59, v38
    v_fmac_f32 v105, v59, v39
    v_lshlrev_b32 v38, 16, v189
    v_and_b32 v39, 0xffff0000, v189
    v_fmac_f32 v106, v59, v38
    v_fmac_f32 v107, v59, v39
    v_lshlrev_b32 v38, 16, v190
    v_and_b32 v39, 0xffff0000, v190
    v_fmac_f32 v108, v59, v38
    v_fmac_f32 v109, v59, v39
    v_lshlrev_b32 v38, 16, v191
    v_and_b32 v39, 0xffff0000, v191
    v_fmac_f32 v110, v59, v38
    v_fmac_f32 v111, v59, v39
    ds_write_b128 v35, v[104:107]
    ds_write_b128 v35, v[108:111] offset:16
    s_waitcnt lgkmcnt(0)
    s_barrier
    s_cmp_lg_u32 s3, 0
    s_cbranch_scc1 F_G2DONE
    ds_read_b32 v192, v37 offset:0
    ds_read_b32 v193, v37 offset:256
    ds_read_b32 v194, v37 offset:512
    ds_read_b32 v195, v37 offset:768
    ds_read_b32 v196, v37 offset:1024
    ds_read_b32 v197, v37 offset:1280
    ds_read_b32 v198, v37 offset:1536
    ds_read_b32 v199, v37 offset:1792
    ds_read_b32 v200, v37 offset:2048
    ds_read_b32 v201, v37 offset:2304
    ds_read_b32 v202, v37 offset:2560
    ds_read_b32 v203, v37 offset:2816
    ds_read_b32 v204, v37 offset:3072
    ds_read_b32 v205, v37 offset:3328
    ds_read_b32 v206, v37 offset:3584
    ds_read_b32 v207, v37 offset:3840
    ds_read_b32 v208, v37 offset:4096
    ds_read_b32 v209, v37 offset:4352
    ds_read_b32 v210, v37 offset:4608
    ds_read_b32 v211, v37 offset:4864
    ds_read_b32 v212, v37 offset:5120
    ds_read_b32 v213, v37 offset:5376
    ds_read_b32 v214, v37 offset:5632
    ds_read_b32 v215, v37 offset:5888
    ds_read_b32 v216, v37 offset:6144
    ds_read_b32 v217, v37 offset:6400
    ds_read_b32 v218, v37 offset:6656
    ds_read_b32 v219, v37 offset:6912
    ds_read_b32 v220, v37 offset:7168
    ds_read_b32 v221, v37 offset:7424
    ds_read_b32 v222, v37 offset:7680
    ds_read_b32 v223, v37 offset:7936
    s_waitcnt lgkmcnt(0)
    v_pk_add_f32 v[192:193], v[192:193], v[196:197]
    v_pk_add_f32 v[194:195], v[194:195], v[198:199]
    v_pk_add_f32 v[192:193], v[192:193], v[200:201]
    v_pk_add_f32 v[194:195], v[194:195], v[202:203]
    v_pk_add_f32 v[192:193], v[192:193], v[204:205]
    v_pk_add_f32 v[194:195], v[194:195], v[206:207]
    v_pk_add_f32 v[192:193], v[192:193], v[208:209]
    v_pk_add_f32 v[194:195], v[194:195], v[210:211]
    v_pk_add_f32 v[192:193], v[192:193], v[212:213]
    v_pk_add_f32 v[194:195], v[194:195], v[214:215]
    v_pk_add_f32 v[192:193], v[192:193], v[216:217]
    v_pk_add_f32 v[194:195], v[194:195], v[218:219]
    v_pk_add_f32 v[192:193], v[192:193], v[220:221]
    v_pk_add_f32 v[194:195], v[194:195], v[222:223]
    v_pk_add_f32 v[192:193], v[192:193], v[194:195]
    v_add_f32 v38, v192, v193
    v_cvt_pk_bf16_f32 v38, v38, v38
    v_lshlrev_b32 v38, 16, v38
    s_sub_u32 s42, s41, 40
    s_cmp_lt_u32 s42, 10
    s_cbranch_scc0 F_NOADD
    v_add_f32 v38, 1.0, v38
    v_cvt_pk_bf16_f32 v38, v38, v38
    v_lshlrev_b32 v38, 16, v38
F_NOADD:
    s_lshl_b32 s42, s41, 8
    buffer_store_dword v38, v36, s[68:71], s42 offen sc1
    s_sub_u32 s42, s41, 30
    s_cmp_lt_u32 s42, 20
    s_cbranch_scc0 F_NOTAB
    s_cmp_lt_u32 s42, 10
    s_cselect_b32 s43, 884752, 884752
    s_cselect_b32 s43, s43, 882176
    s_lshl_b32 s42, s42, 8
    s_add_u32 s43, s43, s42
    v_lshrrev_b32 v32, 5, v1
    v_lshlrev_b32 v32, 7, v32
    v_bfe_u32 v33, v1, 2, 2
    v_lshl_add_u32 v32, v33, 5, v32
    v_bfe_u32 v33, v1, 4, 1
    v_lshl_add_u32 v32, v33, 3, v32
    v_and_b32 v33, 3, v1
    v_lshl_add_u32 v32, v33, 1, v32
    buffer_store_short_d16_hi v38, v32, s[68:71], s43 offen sc1
F_NOTAB:
    s_lshl_b32 s41, s41, 2
    s_add_u32 s41, s41, 877488
    v_mov_b32 v33, 0
    s_mov_b64 exec, 1
    s_waitcnt vmcnt(0)
    buffer_store_dword v0, v33, s[68:71], s41 offen sc1
    s_mov_b64 exec, -1
F_G2DONE:
    s_sub_u32 s41, s2, 120
    s_cmp_lt_u32 s41, 128
    s_cbranch_scc0 F_LSKIP
    s_lshr_b32 s42, s3, 1
    v_lshlrev_b32 v72, 5, v103
    v_add_u32 v72, 131072, v72
    v_lshrrev_b32 v73, 2, v103
    v_lshlrev_b32 v73, 10, v73
    v_and_b32 v107, 3, v103
    v_lshl_add_u32 v107, v107, 4, v102
    v_lshl_add_u32 v73, v107, 4, v73
    s_lshl_b32 s43, s3, 6
    v_add_u32 v78, s43, v1
    v_lshlrev_b32 v74, 3, v78
    v_mov_b32 v76, 0x70000000
    v_lshlrev_b32 v77, 2, v78
    v_add_u32 v77, 131072, v77
    v_lshlrev_b32 v105, 2, v102
    v_add_u32 v105, 139264, v105
    s_lshl_b32 s42, s42, 6
    v_add_u32 v106, s42, v105
    s_mov_b64 exec, 0
    s_cmp_ge_u32 s3, 2
    s_cbranch_scc1 F_L2
    s_branch F_LNC
F_LNW:
    s_mov_b64 exec, -1
    s_waitcnt vmcnt(0)
F_LNC:
    v_lshlrev_b32 v32, 16, v80
    v_and_b32 v33, 0xffff0000, v80
    v_lshlrev_b32 v34, 16, v81
    v_and_b32 v35, 0xffff0000, v81
    v_lshlrev_b32 v36, 16, v82
    v_and_b32 v37, 0xffff0000, v82
    v_lshlrev_b32 v38, 16, v83
    v_and_b32 v39, 0xffff0000, v83
    v_lshlrev_b32 v40, 16, v84
    v_and_b32 v41, 0xffff0000, v84
    v_lshlrev_b32 v42, 16, v85
    v_and_b32 v43, 0xffff0000, v85
    v_lshlrev_b32 v44, 16, v86
    v_and_b32 v45, 0xffff0000, v86
    v_lshlrev_b32 v46, 16, v87
    v_and_b32 v47, 0xffff0000, v87
    v_lshlrev_b32 v48, 16, v88
    v_and_b32 v49, 0xffff0000, v88
    v_lshlrev_b32 v50, 16, v89
    v_and_b32 v51, 0xffff0000, v89
    v_lshlrev_b32 v52, 16, v90
    v_and_b32 v53, 0xffff0000, v90
    v_lshlrev_b32 v54, 16, v91
    v_and_b32 v55, 0xffff0000, v91
    v_lshlrev_b32 v56, 16, v92
    v_and_b32 v57, 0xffff0000, v92
    v_lshlrev_b32 v58, 16, v93
    v_and_b32 v59, 0xffff0000, v93
    v_lshlrev_b32 v60, 16, v94
    v_and_b32 v61, 0xffff0000, v94
    v_lshlrev_b32 v62, 16, v95
    v_and_b32 v63, 0xffff0000, v95
    v_lshlrev_b32 v64, 16, v96
    v_and_b32 v65, 0xffff0000, v96
    v_lshlrev_b32 v66, 16, v97
    v_and_b32 v67, 0xffff0000, v97
    v_lshlrev_b32 v68, 16, v98
    v_and_b32 v69, 0xffff0000, v98
    v_lshlrev_b32 v70, 16, v99
    v_and_b32 v71, 0xffff0000, v99
    v_pk_add_f32 v[100:101], v[32:33], v[34:35]
    v_pk_add_f32 v[100:101], v[100:101], v[36:37]
    v_pk_add_f32 v[100:101], v[100:101], v[38:39]
    v_pk_add_f32 v[100:101], v[100:101], v[40:41]
    v_pk_add_f32 v[100:101], v[100:101], v[42:43]
    v_pk_add_f32 v[100:101], v[100:101], v[44:45]
    v_pk_add_f32 v[100:101], v[100:101], v[46:47]
    v_pk_add_f32 v[100:101], v[100:101], v[48:49]
    v_pk_add_f32 v[100:101], v[100:101], v[50:51]
    v_pk_add_f32 v[100:101], v[100:101], v[52:53]
    v_pk_add_f32 v[100:101], v[100:101], v[54:55]
    v_pk_add_f32 v[100:101], v[100:101], v[56:57]
    v_pk_add_f32 v[100:101], v[100:101], v[58:59]
    v_pk_add_f32 v[100:101], v[100:101], v[60:61]
    v_pk_add_f32 v[100:101], v[100:101], v[62:63]
    v_pk_add_f32 v[100:101], v[100:101], v[64:65]
    v_pk_add_f32 v[100:101], v[100:101], v[66:67]
    v_pk_add_f32 v[100:101], v[100:101], v[68:69]
    v_pk_add_f32 v[100:101], v[100:101], v[70:71]
    v_add_f32 v100, v100, v101
    s_nop 1
    v_add_f32_dpp v100, v100, v100 row_ror:8 row_mask:0xf bank_mask:0xf
    v_mov_b32 v107, v100
    s_nop 1
    v_permlane16_swap_b32 v100, v107
    s_nop 1
    v_add_f32 v100, v100, v107
    v_mov_b32 v107, v100
    s_nop 1
    v_permlane32_swap_b32 v100, v107
    s_nop 1
    v_add_f32 v100, v100, v107
    ds_write_b32 v106, v100 offset:0
    s_waitcnt lgkmcnt(0)
    s_cbranch_execz F_LB0
    s_barrier
F_LB0:
    ds_read2_b32 v[110:111], v105 offset0:0 offset1:16
    s_waitcnt lgkmcnt(0)
    v_add_f32 v100, v110, v111
    v_mul_f32 v100, 0xbacccccd, v100
    v_pk_add_f32 v[32:33], v[32:33], v[100:101] op_sel_hi:[1,0]
    v_pk_add_f32 v[34:35], v[34:35], v[100:101] op_sel_hi:[1,0]
    v_pk_add_f32 v[36:37], v[36:37], v[100:101] op_sel_hi:[1,0]
    v_pk_add_f32 v[38:39], v[38:39], v[100:101] op_sel_hi:[1,0]
    v_pk_add_f32 v[40:41], v[40:41], v[100:101] op_sel_hi:[1,0]
    v_pk_add_f32 v[42:43], v[42:43], v[100:101] op_sel_hi:[1,0]
    v_pk_add_f32 v[44:45], v[44:45], v[100:101] op_sel_hi:[1,0]
    v_pk_add_f32 v[46:47], v[46:47], v[100:101] op_sel_hi:[1,0]
    v_pk_add_f32 v[48:49], v[48:49], v[100:101] op_sel_hi:[1,0]
    v_pk_add_f32 v[50:51], v[50:51], v[100:101] op_sel_hi:[1,0]
    v_pk_add_f32 v[52:53], v[52:53], v[100:101] op_sel_hi:[1,0]
    v_pk_add_f32 v[54:55], v[54:55], v[100:101] op_sel_hi:[1,0]
    v_pk_add_f32 v[56:57], v[56:57], v[100:101] op_sel_hi:[1,0]
    v_pk_add_f32 v[58:59], v[58:59], v[100:101] op_sel_hi:[1,0]
    v_pk_add_f32 v[60:61], v[60:61], v[100:101] op_sel_hi:[1,0]
    v_pk_add_f32 v[62:63], v[62:63], v[100:101] op_sel_hi:[1,0]
    v_pk_add_f32 v[64:65], v[64:65], v[100:101] op_sel_hi:[1,0]
    v_pk_add_f32 v[66:67], v[66:67], v[100:101] op_sel_hi:[1,0]
    v_pk_add_f32 v[68:69], v[68:69], v[100:101] op_sel_hi:[1,0]
    v_pk_add_f32 v[70:71], v[70:71], v[100:101] op_sel_hi:[1,0]
    v_pk_mul_f32 v[100:101], v[32:33], v[32:33]
    v_pk_fma_f32 v[100:101], v[34:35], v[34:35], v[100:101]
    v_pk_fma_f32 v[100:101], v[36:37], v[36:37], v[100:101]
    v_pk_fma_f32 v[100:101], v[38:39], v[38:39], v[100:101]
    v_pk_fma_f32 v[100:101], v[40:41], v[40:41], v[100:101]
    v_pk_fma_f32 v[100:101], v[42:43], v[42:43], v[100:101]
    v_pk_fma_f32 v[100:101], v[44:45], v[44:45], v[100:101]
    v_pk_fma_f32 v[100:101], v[46:47], v[46:47], v[100:101]
    v_pk_fma_f32 v[100:101], v[48:49], v[48:49], v[100:101]
    v_pk_fma_f32 v[100:101], v[50:51], v[50:51], v[100:101]
    v_pk_fma_f32 v[100:101], v[52:53], v[52:53], v[100:101]
    v_pk_fma_f32 v[100:101], v[54:55], v[54:55], v[100:101]
    v_pk_fma_f32 v[100:101], v[56:57], v[56:57], v[100:101]
    v_pk_fma_f32 v[100:101], v[58:59], v[58:59], v[100:101]
    v_pk_fma_f32 v[100:101], v[60:61], v[60:61], v[100:101]
    v_pk_fma_f32 v[100:101], v[62:63], v[62:63], v[100:101]
    v_pk_fma_f32 v[100:101], v[64:65], v[64:65], v[100:101]
    v_pk_fma_f32 v[100:101], v[66:67], v[66:67], v[100:101]
    v_pk_fma_f32 v[100:101], v[68:69], v[68:69], v[100:101]
    v_pk_fma_f32 v[100:101], v[70:71], v[70:71], v[100:101]
    v_add_f32 v100, v100, v101
    s_nop 1
    v_add_f32_dpp v100, v100, v100 row_ror:8 row_mask:0xf bank_mask:0xf
    v_mov_b32 v107, v100
    s_nop 1
    v_permlane16_swap_b32 v100, v107
    s_nop 1
    v_add_f32 v100, v100, v107
    v_mov_b32 v107, v100
    s_nop 1
    v_permlane32_swap_b32 v100, v107
    s_nop 1
    v_add_f32 v100, v100, v107
    ds_write_b32 v106, v100 offset:128
    s_waitcnt lgkmcnt(0)
    s_cbranch_execz F_LB1
    s_barrier
F_LB1:
    ds_read2_b32 v[110:111], v105 offset0:32 offset1:48
    s_waitcnt lgkmcnt(0)
    v_add_f32 v100, v110, v111
    v_mov_b32 v101, 0x3727c5ac
    v_fmac_f32 v101, 0x3acccccd, v100
    v_rsq_f32 v101, v101
    s_nop 0
    v_mul_f32 v100, 0x3e0293ee, v101
    v_pk_mul_f32 v[32:33], v[32:33], v[100:101] op_sel_hi:[1,0]
    v_pk_mul_f32 v[34:35], v[34:35], v[100:101] op_sel_hi:[1,0]
    v_pk_mul_f32 v[36:37], v[36:37], v[100:101] op_sel_hi:[1,0]
    v_pk_mul_f32 v[38:39], v[38:39], v[100:101] op_sel_hi:[1,0]
    v_pk_mul_f32 v[40:41], v[40:41], v[100:101] op_sel_hi:[1,0]
    v_pk_mul_f32 v[42:43], v[42:43], v[100:101] op_sel_hi:[1,0]
    v_pk_mul_f32 v[44:45], v[44:45], v[100:101] op_sel_hi:[1,0]
    v_pk_mul_f32 v[46:47], v[46:47], v[100:101] op_sel_hi:[1,0]
    v_pk_mul_f32 v[48:49], v[48:49], v[100:101] op_sel_hi:[1,0]
    v_pk_mul_f32 v[50:51], v[50:51], v[100:101] op_sel_hi:[1,0]
    v_pk_mul_f32 v[52:53], v[52:53], v[100:101] op_sel_hi:[1,0]
    v_pk_mul_f32 v[54:55], v[54:55], v[100:101] op_sel_hi:[1,0]
    v_pk_mul_f32 v[56:57], v[56:57], v[100:101] op_sel_hi:[1,0]
    v_pk_mul_f32 v[58:59], v[58:59], v[100:101] op_sel_hi:[1,0]
    v_pk_mul_f32 v[60:61], v[60:61], v[100:101] op_sel_hi:[1,0]
    v_pk_mul_f32 v[62:63], v[62:63], v[100:101] op_sel_hi:[1,0]
    v_pk_mul_f32 v[64:65], v[64:65], v[100:101] op_sel_hi:[1,0]
    v_pk_mul_f32 v[66:67], v[66:67], v[100:101] op_sel_hi:[1,0]
    v_pk_mul_f32 v[68:69], v[68:69], v[100:101] op_sel_hi:[1,0]
    v_pk_mul_f32 v[70:71], v[70:71], v[100:101] op_sel_hi:[1,0]
    s_cbranch_execz F_LNW
F_LSKIP:
    s_sub_u32 s41, s2, 120
    s_cmp_lt_u32 s41, 128
    s_cbranch_scc0 F_LDONE
    s_sub_u32 s68, s16, 999424
    s_subb_u32 s69, s17, 0
    s_mov_b32 s70, 868352
    s_mov_b32 s71, 0x20000
    v_mov_b32 v79, 0
    s_mov_b32 s43, 0
    v_mul_u32_u24 v112, 13108, v1
    v_lshrrev_b32 v112, 16, v112
    v_mul_u32_u24 v112, 0, v112
    v_lshl_add_u32 v112, v1, 11, v112
    s_lshl_b32 s42, s3, 9
    s_add_u32 s42, s42, 4
F_TPOLL:
    buffer_load_dword v113, v112, s[68:71], s42 offen sc1
    s_add_u32 s43, s43, 1
    s_waitcnt vmcnt(0)
    v_cmp_eq_u32 vcc, v0, v113
    s_and_b32 s41, vcc_lo, 0xfffff
    s_cmp_eq_u32 s41, 0xfffff
    s_cbranch_scc1 F_LPOLL
    s_sleep 1
    s_cmp_lt_u32 s43, 0x40000
    s_cbranch_scc1 F_TPOLL
F_LPOLL:
    s_mov_b32 s42, 0
    buffer_load_dwordx2 v[112:113], v74, s[68:71], s42 offen offset:0 sc1
    buffer_load_dwordx2 v[114:115], v74, s[68:71], s42 offen offset:2048 sc1
    s_mov_b32 s42, 4096
    buffer_load_dwordx2 v[116:117], v74, s[68:71], s42 offen offset:0 sc1
    buffer_load_dwordx2 v[118:119], v74, s[68:71], s42 offen offset:2048 sc1
    s_mov_b32 s42, 8192
    buffer_load_dwordx2 v[120:121], v74, s[68:71], s42 offen offset:0 sc1
    s_mov_b32 s42, 10240
    buffer_load_dwordx2 v[122:123], v74, s[68:71], s42 offen offset:0 sc1
    buffer_load_dwordx2 v[124:125], v74, s[68:71], s42 offen offset:2048 sc1
    s_mov_b32 s42, 14336
    buffer_load_dwordx2 v[126:127], v74, s[68:71], s42 offen offset:0 sc1
    buffer_load_dwordx2 v[128:129], v74, s[68:71], s42 offen offset:2048 sc1
    s_mov_b32 s42, 18432
    buffer_load_dwordx2 v[130:131], v74, s[68:71], s42 offen offset:0 sc1
    s_mov_b32 s42, 20480
    buffer_load_dwordx2 v[132:133], v74, s[68:71], s42 offen offset:0 sc1
    buffer_load_dwordx2 v[134:135], v74, s[68:71], s42 offen offset:2048 sc1
    s_mov_b32 s42, 24576
    buffer_load_dwordx2 v[136:137], v74, s[68:71], s42 offen offset:0 sc1
    buffer_load_dwordx2 v[138:139], v74, s[68:71], s42 offen offset:2048 sc1
    s_mov_b32 s42, 28672
    buffer_load_dwordx2 v[140:141], v74, s[68:71], s42 offen offset:0 sc1
    s_mov_b32 s42, 30720
    buffer_load_dwordx2 v[142:143], v74, s[68:71], s42 offen offset:0 sc1
    buffer_load_dwordx2 v[144:145], v74, s[68:71], s42 offen offset:2048 sc1
    s_mov_b32 s42, 34816
    buffer_load_dwordx2 v[146:147], v74, s[68:71], s42 offen offset:0 sc1
    buffer_load_dwordx2 v[148:149], v74, s[68:71], s42 offen offset:2048 sc1
    s_mov_b32 s42, 38912
    buffer_load_dwordx2 v[150:151], v74, s[68:71], s42 offen offset:0 sc1
    s_add_u32 s43, s43, 1
    s_waitcnt vmcnt(0)
F_L2:
    v_xor_b32 v113, v0, v113
    v_xor_b32 v115, v0, v115
    v_xor_b32 v117, v0, v117
    v_xor_b32 v119, v0, v119
    v_xor_b32 v121, v0, v121
    v_xor_b32 v123, v0, v123
    v_xor_b32 v125, v0, v125
    v_xor_b32 v127, v0, v127
    v_xor_b32 v129, v0, v129
    v_xor_b32 v131, v0, v131
    v_xor_b32 v133, v0, v133
    v_xor_b32 v135, v0, v135
    v_xor_b32 v137, v0, v137
    v_xor_b32 v139, v0, v139
    v_xor_b32 v141, v0, v141
    v_xor_b32 v143, v0, v143
    v_xor_b32 v145, v0, v145
    v_xor_b32 v147, v0, v147
    v_xor_b32 v149, v0, v149
    v_xor_b32 v151, v0, v151
    v_or3_b32 v113, v113, v115, v117
    v_or3_b32 v113, v113, v119, v121
    v_or3_b32 v113, v113, v123, v125
    v_or3_b32 v113, v113, v127, v129
    v_or3_b32 v113, v113, v131, v133
    v_or3_b32 v113, v113, v135, v137
    v_or3_b32 v113, v113, v139, v141
    v_or3_b32 v113, v113, v143, v145
    v_or3_b32 v113, v113, v147, v149
    v_or_b32 v113, v113, v151
    v_cmp_ne_u32 vcc, 0, v113
    s_cbranch_vccz F_LOK
    s_sleep 2
    s_cmp_lt_u32 s43, 0x40000
    s_cbranch_scc1 F_LPOLL
F_LOK:
    v_cmp_le_u32 vcc, 128, v78
    v_add_f32 v112, v112, v122
    v_add_f32 v132, v132, v142
    v_add_f32 v114, v114, v124
    v_add_f32 v134, v134, v144
    v_add_f32 v116, v116, v126
    v_add_f32 v136, v136, v146
    v_add_f32 v118, v118, v128
    v_add_f32 v138, v138, v148
    v_add_f32 v120, v120, v130
    v_add_f32 v140, v140, v150
    v_add_f32 v112, v112, v132
    v_add_f32 v114, v114, v134
    v_add_f32 v116, v116, v136
    v_add_f32 v118, v118, v138
    v_add_f32 v120, v120, v140
    v_cvt_pk_bf16_f32 v112, v112, v112
    v_cvt_pk_bf16_f32 v114, v114, v114
    v_cvt_pk_bf16_f32 v116, v116, v116
    v_cvt_pk_bf16_f32 v118, v118, v118
    v_cvt_pk_bf16_f32 v120, v120, v120
    v_lshlrev_b32 v112, 16, v112
    v_lshlrev_b32 v114, 16, v114
    v_lshlrev_b32 v116, 16, v116
    v_lshlrev_b32 v118, 16, v118
    v_lshlrev_b32 v120, 16, v120
    v_add_f32 v117, 1.0, v116
    v_add_f32 v119, 1.0, v118
    v_add_f32 v121, 1.0, v120
    v_cvt_pk_bf16_f32 v117, v117, v117
    v_cvt_pk_bf16_f32 v119, v119, v119
    v_cvt_pk_bf16_f32 v121, v121, v121
    v_lshlrev_b32 v117, 16, v117
    v_lshlrev_b32 v119, 16, v119
    v_lshlrev_b32 v121, 16, v121
    v_mul_f32 v112, 0x3e0293ee, v112
    v_mul_f32 v114, 0x3e0293ee, v114
    v_mul_f32 v116, 0x3e0293ee, v116
    v_cndmask_b32 v117, v116, v117, vcc
    ds_write_b32 v77, v112 offset:0
    ds_write_b32 v77, v114 offset:1024
    ds_write_b32 v77, v117 offset:2048
    ds_write_b32 v77, v119 offset:3072
    ds_write_b32 v77, v121 offset:4096
    s_sub_u32 s41, s2, 120
    s_mul_i32 s42, s41, 20480
    s_lshr_b32 s43, s41, 2
    s_lshl_b32 s43, s43, 5
    s_and_b32 s41, s41, 3
    s_lshl_b32 s41, s41, 2
    s_add_u32 s43, s43, s41
    s_add_u32 s43, s43, s3
    s_lshl_b32 s43, s43, 2
    s_add_u32 s43, s43, 824320
    s_add_u32 s41, s42, 4096
    s_waitcnt lgkmcnt(0)
    s_cbranch_execz F_L3
    s_barrier
F_L3:
    ds_read_b128 v[112:115], v72 offset:2560
    ds_read_b128 v[116:119], v72 offset:2576
    ds_read_b128 v[120:123], v72 offset:0
    ds_read_b128 v[124:127], v72 offset:16
    ds_read_b128 v[128:131], v72 offset:2816
    ds_read_b128 v[132:135], v72 offset:2832
    ds_read_b128 v[136:139], v72 offset:256
    ds_read_b128 v[140:143], v72 offset:272
    ds_read_b128 v[144:147], v72 offset:3072
    ds_read_b128 v[148:151], v72 offset:3088
    ds_read_b128 v[152:155], v72 offset:512
    ds_read_b128 v[156:159], v72 offset:528
    ds_read_b128 v[160:163], v72 offset:3328
    ds_read_b128 v[164:167], v72 offset:3344
    ds_read_b128 v[168:171], v72 offset:768
    ds_read_b128 v[172:175], v72 offset:784
    ds_read_b128 v[176:179], v72 offset:3584
    ds_read_b128 v[180:183], v72 offset:3600
    ds_read_b128 v[184:187], v72 offset:1024
    ds_read_b128 v[188:191], v72 offset:1040
    s_waitcnt lgkmcnt(15)
    v_pk_fma_f32 v[120:121], v[32:33], v[112:113], v[120:121]
    v_pk_fma_f32 v[122:123], v[34:35], v[114:115], v[122:123]
    v_pk_fma_f32 v[124:125], v[36:37], v[116:117], v[124:125]
    v_pk_fma_f32 v[126:127], v[38:39], v[118:119], v[126:127]
    v_cvt_pk_bf16_f32 v112, v120, v121
    v_cvt_pk_bf16_f32 v113, v122, v123
    v_cvt_pk_bf16_f32 v114, v124, v125
    v_cvt_pk_bf16_f32 v115, v126, v127
    s_cbranch_execz F_L40
    buffer_store_dwordx4 v[112:115], v73, s[16:19], s42 offen offset:0 sc1
F_L40:
    s_waitcnt lgkmcnt(12)
    v_pk_fma_f32 v[136:137], v[40:41], v[128:129], v[136:137]
    v_pk_fma_f32 v[138:139], v[42:43], v[130:131], v[138:139]
    v_pk_fma_f32 v[140:141], v[44:45], v[132:133], v[140:141]
    v_pk_fma_f32 v[142:143], v[46:47], v[134:135], v[142:143]
    v_cvt_pk_bf16_f32 v128, v136, v137
    v_cvt_pk_bf16_f32 v129, v138, v139
    v_cvt_pk_bf16_f32 v130, v140, v141
    v_cvt_pk_bf16_f32 v131, v142, v143
    s_cbranch_execz F_L41
    buffer_store_dwordx4 v[128:131], v73, s[16:19], s42 offen offset:2048 sc1
F_L41:
    s_waitcnt lgkmcnt(8)
    v_pk_fma_f32 v[152:153], v[48:49], v[144:145], v[152:153]
    v_pk_fma_f32 v[154:155], v[50:51], v[146:147], v[154:155]
    v_pk_fma_f32 v[156:157], v[52:53], v[148:149], v[156:157]
    v_pk_fma_f32 v[158:159], v[54:55], v[150:151], v[158:159]
    v_cvt_pk_bf16_f32 v144, v152, v153
    v_cvt_pk_bf16_f32 v145, v154, v155
    v_cvt_pk_bf16_f32 v146, v156, v157
    v_cvt_pk_bf16_f32 v147, v158, v159
    s_cbranch_execz F_L42
    buffer_store_dwordx4 v[144:147], v73, s[16:19], s41 offen offset:0 sc1
F_L42:
    s_waitcnt lgkmcnt(4)
    v_pk_fma_f32 v[168:169], v[56:57], v[160:161], v[168:169]
    v_pk_fma_f32 v[170:171], v[58:59], v[162:163], v[170:171]
    v_pk_fma_f32 v[172:173], v[60:61], v[164:165], v[172:173]
    v_pk_fma_f32 v[174:175], v[62:63], v[166:167], v[174:175]
    v_cvt_pk_bf16_f32 v160, v168, v169
    v_cvt_pk_bf16_f32 v161, v170, v171
    v_cvt_pk_bf16_f32 v162, v172, v173
    v_cvt_pk_bf16_f32 v163, v174, v175
    s_cbranch_execz F_L43
    buffer_store_dwordx4 v[160:163], v73, s[16:19], s41 offen offset:2048 sc1
F_L43:
    s_waitcnt lgkmcnt(0)
    v_pk_fma_f32 v[184:185], v[64:65], v[176:177], v[184:185]
    v_pk_fma_f32 v[186:187], v[66:67], v[178:179], v[186:187]
    v_pk_fma_f32 v[188:189], v[68:69], v[180:181], v[188:189]
    v_pk_fma_f32 v[190:191], v[70:71], v[182:183], v[190:191]
    v_cvt_pk_bf16_f32 v176, v184, v185
    v_cvt_pk_bf16_f32 v177, v186, v187
    v_cvt_pk_bf16_f32 v178, v188, v189
    v_cvt_pk_bf16_f32 v179, v190, v191
    s_cbranch_execz F_L44
    s_add_u32 s41, s41, 4096
    buffer_store_dwordx4 v[176:179], v73, s[16:19], s41 offen offset:0 sc1
F_L44:
    s_cbranch_execz F_LNW
    s_mov_b64 exec, 1
    s_waitcnt vmcnt(0)
    buffer_store_dword v0, v79, s[68:71], s43 offen sc1
    s_mov_b64 exec, -1
F_LDONE:
    s_add_u32 m0, s37, s35
    s_nop 0
    buffer_load_dwordx4 v4, s[8:11], s32 offen offset:0 lds
    buffer_load_dwordx4 v5, s[8:11], s32 offen offset:1024 lds
    buffer_load_dwordx4 v6, s[8:11], s32 offen offset:2048 lds
    buffer_load_dwordx4 v7, s[8:11], s32 offen offset:3072 lds
    s_add_u32 m0, s37, s36
    s_nop 0
    buffer_load_dwordx4 v8, s[12:15], s33 offen offset:0 lds
    buffer_load_dwordx4 v9, s[12:15], s33 offen offset:1024 lds
    buffer_load_dwordx4 v10, s[12:15], s33 offen offset:2048 lds
    buffer_load_dwordx4 v11, s[12:15], s33 offen offset:3072 lds
    s_add_u32 s32, s32, s34
    s_add_u32 s33, s33, s34
    s_add_u32 s37, s37, 0x8000
    s_and_b32 s37, s37, 0x1ffff
    s_cmp_lt_u32 s2, 80
    s_cbranch_scc0 F_G1MD
    s_lshr_b32 s41, s2, 3
    s_lshl_b32 s41, s41, 2
    s_add_u32 s41, s41, s3
    s_mul_i32 s42, s41, 106496
    s_add_u32 s42, s42, 1048576
    s_and_b32 s43, s2, 7
    s_lshl_b32 s43, s43, 10
    s_add_u32 s42, s42, s43
    s_lshl_b32 s41, s41, 10
    buffer_load_dwordx4 a[0:3], v2, s[8:11], s42 offen
    s_add_u32 s42, s42, 8192
    buffer_load_dwordx4 a[0:3], v2, s[8:11], s42 offen
    s_add_u32 s42, s42, 8192
    buffer_load_dwordx4 a[0:3], v2, s[8:11], s42 offen
    s_add_u32 s42, s42, 8192
    buffer_load_dwordx4 a[0:3], v2, s[8:11], s42 offen
    s_add_u32 s42, s42, 8192
    buffer_load_dwordx4 a[0:3], v2, s[8:11], s42 offen
    s_add_u32 s42, s42, 8192
    buffer_load_dwordx4 a[0:3], v2, s[8:11], s42 offen
    s_add_u32 s42, s42, 8192
    buffer_load_dwordx4 a[0:3], v2, s[8:11], s42 offen
    s_add_u32 s42, s42, 8192
    buffer_load_dwordx4 a[0:3], v2, s[8:11], s42 offen
    s_add_u32 s42, s42, 8192
    buffer_load_dwordx4 a[0:3], v2, s[8:11], s42 offen
    s_add_u32 s42, s42, 8192
    buffer_load_dwordx4 a[0:3], v2, s[8:11], s42 offen
    s_add_u32 s42, s42, 8192
    buffer_load_dwordx4 a[0:3], v2, s[8:11], s42 offen
    s_add_u32 s42, s42, 8192
    buffer_load_dwordx4 a[0:3], v2, s[8:11], s42 offen
    s_add_u32 s42, s42, 8192
    buffer_load_dwordx4 a[0:3], v2, s[8:11], s42 offen
    s_add_u32 s42, s42, 8192
F_G1MD:
    s_cmp_lg_u32 s3, 0
    s_cbranch_scc1 TH_GO
    s_sub_u32 s68, s16, 196608
    s_subb_u32 s69, s17, 0
    s_mov_b32 s70, 65536
    s_mov_b32 s71, 0x20000
    s_lshl_b32 s43, s5, 5
    s_add_u32 s43, s43, 21504
    v_lshrrev_b32 v240, 4, v1
    v_lshlrev_b32 v240, 7, v240
    v_and_b32 v3, 15, v1
    v_lshl_add_u32 v240, v3, 2, v240
    s_mov_b32 s41, 0
TH_POLL:
    buffer_load_dword v3, v240, s[68:71], s43 offen sc1
    s_add_u32 s41, s41, 1
    s_waitcnt vmcnt(0) lgkmcnt(0)
    v_cmp_ne_u32 vcc, v0, v3
    s_cbranch_vccz TH_GO
    s_sleep 4
    s_cmp_lt_u32 s41, 0x80000
    s_cbranch_scc1 TH_POLL
TH_GO:
    s_waitcnt vmcnt(0)
    s_barrier
    buffer_load_dwordx4 a[0:3], v28, s[16:19], s39 offen offset:0 sc1
    buffer_load_dwordx4 a[4:7], v29, s[16:19], s39 offen offset:0 sc1
    buffer_load_dwordx4 a[8:11], v30, s[16:19], s39 offen offset:0 sc1
    buffer_load_dwordx4 a[12:15], v31, s[16:19], s39 offen offset:0 sc1
    s_add_u32 m0, s37, s35
    s_nop 0
    buffer_load_dwordx4 v4, s[8:11], s32 offen offset:0 lds
    buffer_load_dwordx4 v5, s[8:11], s32 offen offset:1024 lds
    buffer_load_dwordx4 v6, s[8:11], s32 offen offset:2048 lds
    buffer_load_dwordx4 v7, s[8:11], s32 offen offset:3072 lds
    s_add_u32 m0, s37, s36
    s_nop 0
    buffer_load_dwordx4 v8, s[12:15], s33 offen offset:0 lds
    buffer_load_dwordx4 v9, s[12:15], s33 offen offset:1024 lds
    buffer_load_dwordx4 v10, s[12:15], s33 offen offset:2048 lds
    buffer_load_dwordx4 v11, s[12:15], s33 offen offset:3072 lds
    s_add_u32 s32, s32, s34
    s_add_u32 s33, s33, s34
    s_add_u32 s37, s37, 0x8000
    s_and_b32 s37, s37, 0x1ffff
    ds_read_b64_tr_b16 a[148:149], v16 offset:0
    ds_read_b64_tr_b16 a[150:151], v16 offset:512
    ds_read_b64_tr_b16 a[152:153], v17 offset:0
    ds_read_b64_tr_b16 a[154:155], v17 offset:512
    ds_read_b64_tr_b16 a[156:157], v18 offset:0
    ds_read_b64_tr_b16 a[158:159], v18 offset:512
    ds_read_b64_tr_b16 a[160:161], v19 offset:0
    ds_read_b64_tr_b16 a[162:163], v19 offset:512
    ds_read_b64_tr_b16 a[164:165], v16 offset:16384
    ds_read_b64_tr_b16 a[166:167], v16 offset:16896
    ds_read_b64_tr_b16 a[168:169], v17 offset:16384
    ds_read_b64_tr_b16 a[170:171], v17 offset:16896
    ds_read_b64_tr_b16 a[172:173], v18 offset:16384
    ds_read_b64_tr_b16 a[174:175], v18 offset:16896
    buffer_load_dwordx4 a[16:19], v28, s[16:19], s39 offen offset:1024 sc1
    buffer_load_dwordx4 a[20:23], v29, s[16:19], s39 offen offset:1024 sc1
    buffer_load_dwordx4 a[24:27], v30, s[16:19], s39 offen offset:1024 sc1
    buffer_load_dwordx4 a[28:31], v31, s[16:19], s39 offen offset:1024 sc1
    buffer_load_dwordx4 a[32:35], v28, s[16:19], s39 offen offset:2048 sc1
    buffer_load_dwordx4 a[36:39], v29, s[16:19], s39 offen offset:2048 sc1
    buffer_load_dwordx4 a[40:43], v30, s[16:19], s39 offen offset:2048 sc1
    buffer_load_dwordx4 a[44:47], v31, s[16:19], s39 offen offset:2048 sc1
    buffer_load_dwordx4 a[48:51], v28, s[16:19], s39 offen offset:3072 sc1
    buffer_load_dwordx4 a[52:55], v29, s[16:19], s39 offen offset:3072 sc1
    buffer_load_dwordx4 a[56:59], v30, s[16:19], s39 offen offset:3072 sc1
    buffer_load_dwordx4 a[60:63], v31, s[16:19], s39 offen offset:3072 sc1
    s_add_u32 s39, s39, 4096
    buffer_load_dwordx4 a[64:67], v28, s[16:19], s39 offen offset:0 sc1
    buffer_load_dwordx4 a[68:71], v29, s[16:19], s39 offen offset:0 sc1
    buffer_load_dwordx4 a[72:75], v30, s[16:19], s39 offen offset:0 sc1
    buffer_load_dwordx4 a[76:79], v31, s[16:19], s39 offen offset:0 sc1
    v_add_u32 v48, 0x10000, v16
    v_add_u32 v49, 0x10000, v17
    v_add_u32 v50, 0x10000, v18
    v_add_u32 v51, 0x10000, v19
K1_QLOOP:
    s_waitcnt vmcnt(24)
    s_waitcnt lgkmcnt(6)
    v_mfma_f32_16x16x32_bf16 v[112:115], a[148:151], a[0:3], 0
    ds_read_b64_tr_b16 a[176:177], v19 offset:16384
    ds_read_b64_tr_b16 a[178:179], v19 offset:16896
    v_mfma_f32_16x16x32_bf16 v[116:119], a[148:151], a[4:7], 0
    s_add_u32 m0, s37, s35
    v_mfma_f32_16x16x32_bf16 v[120:123], a[148:151], a[8:11], 0
    buffer_load_dwordx4 v4, s[8:11], s32 offen offset:0 lds
    v_mfma_f32_16x16x32_bf16 v[124:127], a[148:151], a[12:15], 0
    buffer_load_dwordx4 v5, s[8:11], s32 offen offset:1024 lds
    v_mfma_f32_16x16x32_bf16 v[128:131], a[152:155], a[0:3], 0
    ds_read_b64_tr_b16 a[148:149], v16 offset:4096
    ds_read_b64_tr_b16 a[150:151], v16 offset:4608
    v_mfma_f32_16x16x32_bf16 v[132:135], a[152:155], a[4:7], 0
    v_mfma_f32_16x16x32_bf16 v[136:139], a[152:155], a[8:11], 0
    v_mfma_f32_16x16x32_bf16 v[140:143], a[152:155], a[12:15], 0
    v_mfma_f32_16x16x32_bf16 v[144:147], a[156:159], a[0:3], 0
    ds_read_b64_tr_b16 a[152:153], v17 offset:4096
    ds_read_b64_tr_b16 a[154:155], v17 offset:4608
    v_mfma_f32_16x16x32_bf16 v[148:151], a[156:159], a[4:7], 0
    buffer_load_dwordx4 a[80:83], v28, s[16:19], s39 offen offset:1024 sc1
    v_mfma_f32_16x16x32_bf16 v[152:155], a[156:159], a[8:11], 0
    buffer_load_dwordx4 a[84:87], v29, s[16:19], s39 offen offset:1024 sc1
    v_mfma_f32_16x16x32_bf16 v[156:159], a[156:159], a[12:15], 0
    buffer_load_dwordx4 a[88:91], v30, s[16:19], s39 offen offset:1024 sc1
    v_mfma_f32_16x16x32_bf16 v[160:163], a[160:163], a[0:3], 0
    ds_read_b64_tr_b16 a[156:157], v18 offset:4096
    ds_read_b64_tr_b16 a[158:159], v18 offset:4608
    v_mfma_f32_16x16x32_bf16 v[164:167], a[160:163], a[4:7], 0
    buffer_load_dwordx4 a[92:95], v31, s[16:19], s39 offen offset:1024 sc1
    v_mfma_f32_16x16x32_bf16 v[168:171], a[160:163], a[8:11], 0
    v_mfma_f32_16x16x32_bf16 v[172:175], a[160:163], a[12:15], 0
    s_waitcnt lgkmcnt(6)
    v_mfma_f32_16x16x32_bf16 v[176:179], a[164:167], a[0:3], 0
    ds_read_b64_tr_b16 a[160:161], v19 offset:4096
    ds_read_b64_tr_b16 a[162:163], v19 offset:4608
    v_mfma_f32_16x16x32_bf16 v[180:183], a[164:167], a[4:7], 0
    v_mfma_f32_16x16x32_bf16 v[184:187], a[164:167], a[8:11], 0
    v_mfma_f32_16x16x32_bf16 v[188:191], a[164:167], a[12:15], 0
    v_mfma_f32_16x16x32_bf16 v[192:195], a[168:171], a[0:3], 0
    ds_read_b64_tr_b16 a[164:165], v16 offset:20480
    ds_read_b64_tr_b16 a[166:167], v16 offset:20992
    v_mfma_f32_16x16x32_bf16 v[196:199], a[168:171], a[4:7], 0
    v_mfma_f32_16x16x32_bf16 v[200:203], a[168:171], a[8:11], 0
    v_mfma_f32_16x16x32_bf16 v[204:207], a[168:171], a[12:15], 0
    v_mfma_f32_16x16x32_bf16 v[208:211], a[172:175], a[0:3], 0
    ds_read_b64_tr_b16 a[168:169], v17 offset:20480
    ds_read_b64_tr_b16 a[170:171], v17 offset:20992
    v_mfma_f32_16x16x32_bf16 v[212:215], a[172:175], a[4:7], 0
    v_mfma_f32_16x16x32_bf16 v[216:219], a[172:175], a[8:11], 0
    v_mfma_f32_16x16x32_bf16 v[220:223], a[172:175], a[12:15], 0
    v_mfma_f32_16x16x32_bf16 v[224:227], a[176:179], a[0:3], 0
    ds_read_b64_tr_b16 a[172:173], v18 offset:20480
    ds_read_b64_tr_b16 a[174:175], v18 offset:20992
    v_mfma_f32_16x16x32_bf16 v[228:231], a[176:179], a[4:7], 0
    v_mfma_f32_16x16x32_bf16 v[232:235], a[176:179], a[8:11], 0
    v_mfma_f32_16x16x32_bf16 v[236:239], a[176:179], a[12:15], 0
    s_waitcnt vmcnt(18)
    s_waitcnt lgkmcnt(6)
    v_mfma_f32_16x16x32_bf16 v[112:115], a[148:151], a[16:19], v[112:115]
    ds_read_b64_tr_b16 a[176:177], v19 offset:20480
    ds_read_b64_tr_b16 a[178:179], v19 offset:20992
    v_mfma_f32_16x16x32_bf16 v[116:119], a[148:151], a[20:23], v[116:119]
    buffer_load_dwordx4 v6, s[8:11], s32 offen offset:2048 lds
    v_mfma_f32_16x16x32_bf16 v[120:123], a[148:151], a[24:27], v[120:123]
    buffer_load_dwordx4 v7, s[8:11], s32 offen offset:3072 lds
    v_mfma_f32_16x16x32_bf16 v[124:127], a[148:151], a[28:31], v[124:127]
    v_mfma_f32_16x16x32_bf16 v[128:131], a[152:155], a[16:19], v[128:131]
    ds_read_b64_tr_b16 a[148:149], v16 offset:8192
    ds_read_b64_tr_b16 a[150:151], v16 offset:8704
    v_mfma_f32_16x16x32_bf16 v[132:135], a[152:155], a[20:23], v[132:135]
    v_mfma_f32_16x16x32_bf16 v[136:139], a[152:155], a[24:27], v[136:139]
    v_mfma_f32_16x16x32_bf16 v[140:143], a[152:155], a[28:31], v[140:143]
    v_mfma_f32_16x16x32_bf16 v[144:147], a[156:159], a[16:19], v[144:147]
    ds_read_b64_tr_b16 a[152:153], v17 offset:8192
    ds_read_b64_tr_b16 a[154:155], v17 offset:8704
    v_mfma_f32_16x16x32_bf16 v[148:151], a[156:159], a[20:23], v[148:151]
    buffer_load_dwordx4 a[96:99], v28, s[16:19], s39 offen offset:2048 sc1
    v_mfma_f32_16x16x32_bf16 v[152:155], a[156:159], a[24:27], v[152:155]
    buffer_load_dwordx4 a[100:103], v29, s[16:19], s39 offen offset:2048 sc1
    v_mfma_f32_16x16x32_bf16 v[156:159], a[156:159], a[28:31], v[156:159]
    buffer_load_dwordx4 a[104:107], v30, s[16:19], s39 offen offset:2048 sc1
    v_mfma_f32_16x16x32_bf16 v[160:163], a[160:163], a[16:19], v[160:163]
    ds_read_b64_tr_b16 a[156:157], v18 offset:8192
    ds_read_b64_tr_b16 a[158:159], v18 offset:8704
    v_mfma_f32_16x16x32_bf16 v[164:167], a[160:163], a[20:23], v[164:167]
    buffer_load_dwordx4 a[108:111], v31, s[16:19], s39 offen offset:2048 sc1
    v_mfma_f32_16x16x32_bf16 v[168:171], a[160:163], a[24:27], v[168:171]
    v_mfma_f32_16x16x32_bf16 v[172:175], a[160:163], a[28:31], v[172:175]
    s_waitcnt lgkmcnt(6)
    v_mfma_f32_16x16x32_bf16 v[176:179], a[164:167], a[16:19], v[176:179]
    ds_read_b64_tr_b16 a[160:161], v19 offset:8192
    ds_read_b64_tr_b16 a[162:163], v19 offset:8704
    v_mfma_f32_16x16x32_bf16 v[180:183], a[164:167], a[20:23], v[180:183]
    v_mfma_f32_16x16x32_bf16 v[184:187], a[164:167], a[24:27], v[184:187]
    v_mfma_f32_16x16x32_bf16 v[188:191], a[164:167], a[28:31], v[188:191]
    v_mfma_f32_16x16x32_bf16 v[192:195], a[168:171], a[16:19], v[192:195]
    ds_read_b64_tr_b16 a[164:165], v16 offset:24576
    ds_read_b64_tr_b16 a[166:167], v16 offset:25088
    v_mfma_f32_16x16x32_bf16 v[196:199], a[168:171], a[20:23], v[196:199]
    v_mfma_f32_16x16x32_bf16 v[200:203], a[168:171], a[24:27], v[200:203]
    v_mfma_f32_16x16x32_bf16 v[204:207], a[168:171], a[28:31], v[204:207]
    v_mfma_f32_16x16x32_bf16 v[208:211], a[172:175], a[16:19], v[208:211]
    ds_read_b64_tr_b16 a[168:169], v17 offset:24576
    ds_read_b64_tr_b16 a[170:171], v17 offset:25088
    v_mfma_f32_16x16x32_bf16 v[212:215], a[172:175], a[20:23], v[212:215]
    v_mfma_f32_16x16x32_bf16 v[216:219], a[172:175], a[24:27], v[216:219]
    v_mfma_f32_16x16x32_bf16 v[220:223], a[172:175], a[28:31], v[220:223]
    v_mfma_f32_16x16x32_bf16 v[224:227], a[176:179], a[16:19], v[224:227]
    ds_read_b64_tr_b16 a[172:173], v18 offset:24576
    ds_read_b64_tr_b16 a[174:175], v18 offset:25088
    v_mfma_f32_16x16x32_bf16 v[228:231], a[176:179], a[20:23], v[228:231]
    v_mfma_f32_16x16x32_bf16 v[232:235], a[176:179], a[24:27], v[232:235]
    v_mfma_f32_16x16x32_bf16 v[236:239], a[176:179], a[28:31], v[236:239]
    s_waitcnt vmcnt(20)
    s_waitcnt lgkmcnt(6)
    v_mfma_f32_16x16x32_bf16 v[112:115], a[148:151], a[32:35], v[112:115]
    ds_read_b64_tr_b16 a[176:177], v19 offset:24576
    ds_read_b64_tr_b16 a[178:179], v19 offset:25088
    v_mfma_f32_16x16x32_bf16 v[116:119], a[148:151], a[36:39], v[116:119]
    s_add_u32 m0, s37, s36
    v_mfma_f32_16x16x32_bf16 v[120:123], a[148:151], a[40:43], v[120:123]
    buffer_load_dwordx4 v8, s[12:15], s33 offen offset:0 lds
    v_mfma_f32_16x16x32_bf16 v[124:127], a[148:151], a[44:47], v[124:127]
    buffer_load_dwordx4 v9, s[12:15], s33 offen offset:1024 lds
    v_mfma_f32_16x16x32_bf16 v[128:131], a[152:155], a[32:35], v[128:131]
    ds_read_b64_tr_b16 a[148:149], v16 offset:12288
    ds_read_b64_tr_b16 a[150:151], v16 offset:12800
    v_mfma_f32_16x16x32_bf16 v[132:135], a[152:155], a[36:39], v[132:135]
    v_mfma_f32_16x16x32_bf16 v[136:139], a[152:155], a[40:43], v[136:139]
    v_mfma_f32_16x16x32_bf16 v[140:143], a[152:155], a[44:47], v[140:143]
    v_mfma_f32_16x16x32_bf16 v[144:147], a[156:159], a[32:35], v[144:147]
    ds_read_b64_tr_b16 a[152:153], v17 offset:12288
    ds_read_b64_tr_b16 a[154:155], v17 offset:12800
    v_mfma_f32_16x16x32_bf16 v[148:151], a[156:159], a[36:39], v[148:151]
    buffer_load_dwordx4 a[112:115], v28, s[16:19], s39 offen offset:3072 sc1
    v_mfma_f32_16x16x32_bf16 v[152:155], a[156:159], a[40:43], v[152:155]
    buffer_load_dwordx4 a[116:119], v29, s[16:19], s39 offen offset:3072 sc1
    v_mfma_f32_16x16x32_bf16 v[156:159], a[156:159], a[44:47], v[156:159]
    buffer_load_dwordx4 a[120:123], v30, s[16:19], s39 offen offset:3072 sc1
    v_mfma_f32_16x16x32_bf16 v[160:163], a[160:163], a[32:35], v[160:163]
    ds_read_b64_tr_b16 a[156:157], v18 offset:12288
    ds_read_b64_tr_b16 a[158:159], v18 offset:12800
    v_mfma_f32_16x16x32_bf16 v[164:167], a[160:163], a[36:39], v[164:167]
    buffer_load_dwordx4 a[124:127], v31, s[16:19], s39 offen offset:3072 sc1
    v_mfma_f32_16x16x32_bf16 v[168:171], a[160:163], a[40:43], v[168:171]
    v_mfma_f32_16x16x32_bf16 v[172:175], a[160:163], a[44:47], v[172:175]
    s_waitcnt lgkmcnt(6)
    v_mfma_f32_16x16x32_bf16 v[176:179], a[164:167], a[32:35], v[176:179]
    ds_read_b64_tr_b16 a[160:161], v19 offset:12288
    ds_read_b64_tr_b16 a[162:163], v19 offset:12800
    v_mfma_f32_16x16x32_bf16 v[180:183], a[164:167], a[36:39], v[180:183]
    v_mfma_f32_16x16x32_bf16 v[184:187], a[164:167], a[40:43], v[184:187]
    v_mfma_f32_16x16x32_bf16 v[188:191], a[164:167], a[44:47], v[188:191]
    v_mfma_f32_16x16x32_bf16 v[192:195], a[168:171], a[32:35], v[192:195]
    ds_read_b64_tr_b16 a[164:165], v16 offset:28672
    ds_read_b64_tr_b16 a[166:167], v16 offset:29184
    v_mfma_f32_16x16x32_bf16 v[196:199], a[168:171], a[36:39], v[196:199]
    v_mfma_f32_16x16x32_bf16 v[200:203], a[168:171], a[40:43], v[200:203]
    v_mfma_f32_16x16x32_bf16 v[204:207], a[168:171], a[44:47], v[204:207]
    v_mfma_f32_16x16x32_bf16 v[208:211], a[172:175], a[32:35], v[208:211]
    ds_read_b64_tr_b16 a[168:169], v17 offset:28672
    ds_read_b64_tr_b16 a[170:171], v17 offset:29184
    v_mfma_f32_16x16x32_bf16 v[212:215], a[172:175], a[36:39], v[212:215]
    v_mfma_f32_16x16x32_bf16 v[216:219], a[172:175], a[40:43], v[216:219]
    v_mfma_f32_16x16x32_bf16 v[220:223], a[172:175], a[44:47], v[220:223]
    v_mfma_f32_16x16x32_bf16 v[224:227], a[176:179], a[32:35], v[224:227]
    ds_read_b64_tr_b16 a[172:173], v18 offset:28672
    ds_read_b64_tr_b16 a[174:175], v18 offset:29184
    v_mfma_f32_16x16x32_bf16 v[228:231], a[176:179], a[36:39], v[228:231]
    v_mfma_f32_16x16x32_bf16 v[232:235], a[176:179], a[40:43], v[232:235]
    v_mfma_f32_16x16x32_bf16 v[236:239], a[176:179], a[44:47], v[236:239]
    s_waitcnt vmcnt(22)
    s_waitcnt lgkmcnt(6)
    v_mfma_f32_16x16x32_bf16 v[112:115], a[148:151], a[48:51], v[112:115]
    ds_read_b64_tr_b16 a[176:177], v19 offset:28672
    ds_read_b64_tr_b16 a[178:179], v19 offset:29184
    v_mfma_f32_16x16x32_bf16 v[116:119], a[148:151], a[52:55], v[116:119]
    buffer_load_dwordx4 v10, s[12:15], s33 offen offset:2048 lds
    v_mfma_f32_16x16x32_bf16 v[120:123], a[148:151], a[56:59], v[120:123]
    buffer_load_dwordx4 v11, s[12:15], s33 offen offset:3072 lds
    v_mfma_f32_16x16x32_bf16 v[124:127], a[148:151], a[60:63], v[124:127]
    s_waitcnt vmcnt(36)
    s_barrier
    v_mfma_f32_16x16x32_bf16 v[128:131], a[152:155], a[48:51], v[128:131]
    ds_read_b64_tr_b16 a[148:149], v16 offset:32768
    ds_read_b64_tr_b16 a[150:151], v16 offset:33280
    v_mfma_f32_16x16x32_bf16 v[132:135], a[152:155], a[52:55], v[132:135]
    v_mfma_f32_16x16x32_bf16 v[136:139], a[152:155], a[56:59], v[136:139]
    v_mfma_f32_16x16x32_bf16 v[140:143], a[152:155], a[60:63], v[140:143]
    v_mfma_f32_16x16x32_bf16 v[144:147], a[156:159], a[48:51], v[144:147]
    ds_read_b64_tr_b16 a[152:153], v17 offset:32768
    ds_read_b64_tr_b16 a[154:155], v17 offset:33280
    v_mfma_f32_16x16x32_bf16 v[148:151], a[156:159], a[52:55], v[148:151]
    s_add_u32 s39, s39, 4096
    v_mfma_f32_16x16x32_bf16 v[152:155], a[156:159], a[56:59], v[152:155]
    buffer_load_dwordx4 a[180:183], v28, s[16:19], s39 offen offset:0 sc1
    v_mfma_f32_16x16x32_bf16 v[156:159], a[156:159], a[60:63], v[156:159]
    buffer_load_dwordx4 a[184:187], v29, s[16:19], s39 offen offset:0 sc1
    v_mfma_f32_16x16x32_bf16 v[160:163], a[160:163], a[48:51], v[160:163]
    ds_read_b64_tr_b16 a[156:157], v18 offset:32768
    ds_read_b64_tr_b16 a[158:159], v18 offset:33280
    v_mfma_f32_16x16x32_bf16 v[164:167], a[160:163], a[52:55], v[164:167]
    buffer_load_dwordx4 a[188:191], v30, s[16:19], s39 offen offset:0 sc1
    v_mfma_f32_16x16x32_bf16 v[168:171], a[160:163], a[56:59], v[168:171]
    buffer_load_dwordx4 a[192:195], v31, s[16:19], s39 offen offset:0 sc1
    v_mfma_f32_16x16x32_bf16 v[172:175], a[160:163], a[60:63], v[172:175]
    s_waitcnt lgkmcnt(6)
    v_mfma_f32_16x16x32_bf16 v[176:179], a[164:167], a[48:51], v[176:179]
    ds_read_b64_tr_b16 a[160:161], v19 offset:32768
    ds_read_b64_tr_b16 a[162:163], v19 offset:33280
    v_mfma_f32_16x16x32_bf16 v[180:183], a[164:167], a[52:55], v[180:183]
    s_add_u32 s32, s32, s34
    s_add_u32 s33, s33, s34
    v_mfma_f32_16x16x32_bf16 v[184:187], a[164:167], a[56:59], v[184:187]
    s_add_u32 s37, s37, 0x8000
    s_and_b32 s37, s37, 0x1ffff
    v_mfma_f32_16x16x32_bf16 v[188:191], a[164:167], a[60:63], v[188:191]
    v_mfma_f32_16x16x32_bf16 v[192:195], a[168:171], a[48:51], v[192:195]
    ds_read_b64_tr_b16 a[164:165], v16 offset:49152
    ds_read_b64_tr_b16 a[166:167], v16 offset:49664
    v_mfma_f32_16x16x32_bf16 v[196:199], a[168:171], a[52:55], v[196:199]
    v_mfma_f32_16x16x32_bf16 v[200:203], a[168:171], a[56:59], v[200:203]
    v_mfma_f32_16x16x32_bf16 v[204:207], a[168:171], a[60:63], v[204:207]
    v_mfma_f32_16x16x32_bf16 v[208:211], a[172:175], a[48:51], v[208:211]
    ds_read_b64_tr_b16 a[168:169], v17 offset:49152
    ds_read_b64_tr_b16 a[170:171], v17 offset:49664
    v_mfma_f32_16x16x32_bf16 v[212:215], a[172:175], a[52:55], v[212:215]
    v_mfma_f32_16x16x32_bf16 v[216:219], a[172:175], a[56:59], v[216:219]
    v_mfma_f32_16x16x32_bf16 v[220:223], a[172:175], a[60:63], v[220:223]
    v_mfma_f32_16x16x32_bf16 v[224:227], a[176:179], a[48:51], v[224:227]
    ds_read_b64_tr_b16 a[172:173], v18 offset:49152
    ds_read_b64_tr_b16 a[174:175], v18 offset:49664
    v_mfma_f32_16x16x32_bf16 v[228:231], a[176:179], a[52:55], v[228:231]
    v_mfma_f32_16x16x32_bf16 v[232:235], a[176:179], a[56:59], v[232:235]
    v_mfma_f32_16x16x32_bf16 v[236:239], a[176:179], a[60:63], v[236:239]
    s_waitcnt vmcnt(24)
    s_waitcnt lgkmcnt(6)
    v_mfma_f32_16x16x32_bf16 v[112:115], a[148:151], a[64:67], v[112:115]
    ds_read_b64_tr_b16 a[176:177], v19 offset:49152
    ds_read_b64_tr_b16 a[178:179], v19 offset:49664
    v_mfma_f32_16x16x32_bf16 v[116:119], a[148:151], a[68:71], v[116:119]
    s_add_u32 m0, s37, s35
    v_mfma_f32_16x16x32_bf16 v[120:123], a[148:151], a[72:75], v[120:123]
    buffer_load_dwordx4 v4, s[8:11], s32 offen offset:0 lds
    v_mfma_f32_16x16x32_bf16 v[124:127], a[148:151], a[76:79], v[124:127]
    buffer_load_dwordx4 v5, s[8:11], s32 offen offset:1024 lds
    v_mfma_f32_16x16x32_bf16 v[128:131], a[152:155], a[64:67], v[128:131]
    ds_read_b64_tr_b16 a[148:149], v16 offset:36864
    ds_read_b64_tr_b16 a[150:151], v16 offset:37376
    v_mfma_f32_16x16x32_bf16 v[132:135], a[152:155], a[68:71], v[132:135]
    v_mfma_f32_16x16x32_bf16 v[136:139], a[152:155], a[72:75], v[136:139]
    v_mfma_f32_16x16x32_bf16 v[140:143], a[152:155], a[76:79], v[140:143]
    v_mfma_f32_16x16x32_bf16 v[144:147], a[156:159], a[64:67], v[144:147]
    ds_read_b64_tr_b16 a[152:153], v17 offset:36864
    ds_read_b64_tr_b16 a[154:155], v17 offset:37376
    v_mfma_f32_16x16x32_bf16 v[148:151], a[156:159], a[68:71], v[148:151]
    buffer_load_dwordx4 a[196:199], v28, s[16:19], s39 offen offset:1024 sc1
    v_mfma_f32_16x16x32_bf16 v[152:155], a[156:159], a[72:75], v[152:155]
    buffer_load_dwordx4 a[200:203], v29, s[16:19], s39 offen offset:1024 sc1
    v_mfma_f32_16x16x32_bf16 v[156:159], a[156:159], a[76:79], v[156:159]
    buffer_load_dwordx4 a[204:207], v30, s[16:19], s39 offen offset:1024 sc1
    v_mfma_f32_16x16x32_bf16 v[160:163], a[160:163], a[64:67], v[160:163]
    ds_read_b64_tr_b16 a[156:157], v18 offset:36864
    ds_read_b64_tr_b16 a[158:159], v18 offset:37376
    v_mfma_f32_16x16x32_bf16 v[164:167], a[160:163], a[68:71], v[164:167]
    buffer_load_dwordx4 a[208:211], v31, s[16:19], s39 offen offset:1024 sc1
    v_mfma_f32_16x16x32_bf16 v[168:171], a[160:163], a[72:75], v[168:171]
    v_mfma_f32_16x16x32_bf16 v[172:175], a[160:163], a[76:79], v[172:175]
    s_waitcnt lgkmcnt(6)
    v_mfma_f32_16x16x32_bf16 v[176:179], a[164:167], a[64:67], v[176:179]
    ds_read_b64_tr_b16 a[160:161], v19 offset:36864
    ds_read_b64_tr_b16 a[162:163], v19 offset:37376
    v_mfma_f32_16x16x32_bf16 v[180:183], a[164:167], a[68:71], v[180:183]
    v_mfma_f32_16x16x32_bf16 v[184:187], a[164:167], a[72:75], v[184:187]
    v_mfma_f32_16x16x32_bf16 v[188:191], a[164:167], a[76:79], v[188:191]
    v_mfma_f32_16x16x32_bf16 v[192:195], a[168:171], a[64:67], v[192:195]
    ds_read_b64_tr_b16 a[164:165], v16 offset:53248
    ds_read_b64_tr_b16 a[166:167], v16 offset:53760
    v_mfma_f32_16x16x32_bf16 v[196:199], a[168:171], a[68:71], v[196:199]
    v_mfma_f32_16x16x32_bf16 v[200:203], a[168:171], a[72:75], v[200:203]
    v_mfma_f32_16x16x32_bf16 v[204:207], a[168:171], a[76:79], v[204:207]
    v_mfma_f32_16x16x32_bf16 v[208:211], a[172:175], a[64:67], v[208:211]
    ds_read_b64_tr_b16 a[168:169], v17 offset:53248
    ds_read_b64_tr_b16 a[170:171], v17 offset:53760
    v_mfma_f32_16x16x32_bf16 v[212:215], a[172:175], a[68:71], v[212:215]
    v_mfma_f32_16x16x32_bf16 v[216:219], a[172:175], a[72:75], v[216:219]
    v_mfma_f32_16x16x32_bf16 v[220:223], a[172:175], a[76:79], v[220:223]
    v_mfma_f32_16x16x32_bf16 v[224:227], a[176:179], a[64:67], v[224:227]
    ds_read_b64_tr_b16 a[172:173], v18 offset:53248
    ds_read_b64_tr_b16 a[174:175], v18 offset:53760
    v_mfma_f32_16x16x32_bf16 v[228:231], a[176:179], a[68:71], v[228:231]
    v_mfma_f32_16x16x32_bf16 v[232:235], a[176:179], a[72:75], v[232:235]
    v_mfma_f32_16x16x32_bf16 v[236:239], a[176:179], a[76:79], v[236:239]
    s_waitcnt vmcnt(24)
    s_waitcnt lgkmcnt(6)
    v_mfma_f32_16x16x32_bf16 v[112:115], a[148:151], a[80:83], v[112:115]
    ds_read_b64_tr_b16 a[176:177], v19 offset:53248
    ds_read_b64_tr_b16 a[178:179], v19 offset:53760
    v_mfma_f32_16x16x32_bf16 v[116:119], a[148:151], a[84:87], v[116:119]
    buffer_load_dwordx4 v6, s[8:11], s32 offen offset:2048 lds
    v_mfma_f32_16x16x32_bf16 v[120:123], a[148:151], a[88:91], v[120:123]
    buffer_load_dwordx4 v7, s[8:11], s32 offen offset:3072 lds
    v_mfma_f32_16x16x32_bf16 v[124:127], a[148:151], a[92:95], v[124:127]
    v_mfma_f32_16x16x32_bf16 v[128:131], a[152:155], a[80:83], v[128:131]
    ds_read_b64_tr_b16 a[148:149], v16 offset:40960
    ds_read_b64_tr_b16 a[150:151], v16 offset:41472
    v_mfma_f32_16x16x32_bf16 v[132:135], a[152:155], a[84:87], v[132:135]
    v_mfma_f32_16x16x32_bf16 v[136:139], a[152:155], a[88:91], v[136:139]
    v_mfma_f32_16x16x32_bf16 v[140:143], a[152:155], a[92:95], v[140:143]
    v_mfma_f32_16x16x32_bf16 v[144:147], a[156:159], a[80:83], v[144:147]
    ds_read_b64_tr_b16 a[152:153], v17 offset:40960
    ds_read_b64_tr_b16 a[154:155], v17 offset:41472
    v_mfma_f32_16x16x32_bf16 v[148:151], a[156:159], a[84:87], v[148:151]
    buffer_load_dwordx4 a[212:215], v28, s[16:19], s39 offen offset:2048 sc1
    v_mfma_f32_16x16x32_bf16 v[152:155], a[156:159], a[88:91], v[152:155]
    buffer_load_dwordx4 a[216:219], v29, s[16:19], s39 offen offset:2048 sc1
    v_mfma_f32_16x16x32_bf16 v[156:159], a[156:159], a[92:95], v[156:159]
    buffer_load_dwordx4 a[220:223], v30, s[16:19], s39 offen offset:2048 sc1
    v_mfma_f32_16x16x32_bf16 v[160:163], a[160:163], a[80:83], v[160:163]
    ds_read_b64_tr_b16 a[156:157], v18 offset:40960
    ds_read_b64_tr_b16 a[158:159], v18 offset:41472
    v_mfma_f32_16x16x32_bf16 v[164:167], a[160:163], a[84:87], v[164:167]
    buffer_load_dwordx4 a[224:227], v31, s[16:19], s39 offen offset:2048 sc1
    v_mfma_f32_16x16x32_bf16 v[168:171], a[160:163], a[88:91], v[168:171]
    v_mfma_f32_16x16x32_bf16 v[172:175], a[160:163], a[92:95], v[172:175]
    s_waitcnt lgkmcnt(6)
    v_mfma_f32_16x16x32_bf16 v[176:179], a[164:167], a[80:83], v[176:179]
    ds_read_b64_tr_b16 a[160:161], v19 offset:40960
    ds_read_b64_tr_b16 a[162:163], v19 offset:41472
    v_mfma_f32_16x16x32_bf16 v[180:183], a[164:167], a[84:87], v[180:183]
    v_mfma_f32_16x16x32_bf16 v[184:187], a[164:167], a[88:91], v[184:187]
    v_mfma_f32_16x16x32_bf16 v[188:191], a[164:167], a[92:95], v[188:191]
    v_mfma_f32_16x16x32_bf16 v[192:195], a[168:171], a[80:83], v[192:195]
    ds_read_b64_tr_b16 a[164:165], v16 offset:57344
    ds_read_b64_tr_b16 a[166:167], v16 offset:57856
    v_mfma_f32_16x16x32_bf16 v[196:199], a[168:171], a[84:87], v[196:199]
    v_mfma_f32_16x16x32_bf16 v[200:203], a[168:171], a[88:91], v[200:203]
    v_mfma_f32_16x16x32_bf16 v[204:207], a[168:171], a[92:95], v[204:207]
    v_mfma_f32_16x16x32_bf16 v[208:211], a[172:175], a[80:83], v[208:211]
    ds_read_b64_tr_b16 a[168:169], v17 offset:57344
    ds_read_b64_tr_b16 a[170:171], v17 offset:57856
    v_mfma_f32_16x16x32_bf16 v[212:215], a[172:175], a[84:87], v[212:215]
    v_mfma_f32_16x16x32_bf16 v[216:219], a[172:175], a[88:91], v[216:219]
    v_mfma_f32_16x16x32_bf16 v[220:223], a[172:175], a[92:95], v[220:223]
    v_mfma_f32_16x16x32_bf16 v[224:227], a[176:179], a[80:83], v[224:227]
    ds_read_b64_tr_b16 a[172:173], v18 offset:57344
    ds_read_b64_tr_b16 a[174:175], v18 offset:57856
    v_mfma_f32_16x16x32_bf16 v[228:231], a[176:179], a[84:87], v[228:231]
    v_mfma_f32_16x16x32_bf16 v[232:235], a[176:179], a[88:91], v[232:235]
    v_mfma_f32_16x16x32_bf16 v[236:239], a[176:179], a[92:95], v[236:239]
    s_waitcnt vmcnt(24)
    s_waitcnt lgkmcnt(6)
    v_mfma_f32_16x16x32_bf16 v[112:115], a[148:151], a[96:99], v[112:115]
    ds_read_b64_tr_b16 a[176:177], v19 offset:57344
    ds_read_b64_tr_b16 a[178:179], v19 offset:57856
    v_mfma_f32_16x16x32_bf16 v[116:119], a[148:151], a[100:103], v[116:119]
    s_add_u32 m0, s37, s36
    v_mfma_f32_16x16x32_bf16 v[120:123], a[148:151], a[104:107], v[120:123]
    buffer_load_dwordx4 v8, s[12:15], s33 offen offset:0 lds
    v_mfma_f32_16x16x32_bf16 v[124:127], a[148:151], a[108:111], v[124:127]
    buffer_load_dwordx4 v9, s[12:15], s33 offen offset:1024 lds
    v_mfma_f32_16x16x32_bf16 v[128:131], a[152:155], a[96:99], v[128:131]
    ds_read_b64_tr_b16 a[148:149], v16 offset:45056
    ds_read_b64_tr_b16 a[150:151], v16 offset:45568
    v_mfma_f32_16x16x32_bf16 v[132:135], a[152:155], a[100:103], v[132:135]
    v_mfma_f32_16x16x32_bf16 v[136:139], a[152:155], a[104:107], v[136:139]
    v_mfma_f32_16x16x32_bf16 v[140:143], a[152:155], a[108:111], v[140:143]
    v_mfma_f32_16x16x32_bf16 v[144:147], a[156:159], a[96:99], v[144:147]
    ds_read_b64_tr_b16 a[152:153], v17 offset:45056
    ds_read_b64_tr_b16 a[154:155], v17 offset:45568
    v_mfma_f32_16x16x32_bf16 v[148:151], a[156:159], a[100:103], v[148:151]
    buffer_load_dwordx4 a[228:231], v28, s[16:19], s39 offen offset:3072 sc1
    v_mfma_f32_16x16x32_bf16 v[152:155], a[156:159], a[104:107], v[152:155]
    buffer_load_dwordx4 a[232:235], v29, s[16:19], s39 offen offset:3072 sc1
    v_mfma_f32_16x16x32_bf16 v[156:159], a[156:159], a[108:111], v[156:159]
    buffer_load_dwordx4 a[236:239], v30, s[16:19], s39 offen offset:3072 sc1
    v_mfma_f32_16x16x32_bf16 v[160:163], a[160:163], a[96:99], v[160:163]
    ds_read_b64_tr_b16 a[156:157], v18 offset:45056
    ds_read_b64_tr_b16 a[158:159], v18 offset:45568
    v_mfma_f32_16x16x32_bf16 v[164:167], a[160:163], a[100:103], v[164:167]
    buffer_load_dwordx4 a[240:243], v31, s[16:19], s39 offen offset:3072 sc1
    v_mfma_f32_16x16x32_bf16 v[168:171], a[160:163], a[104:107], v[168:171]
    v_mfma_f32_16x16x32_bf16 v[172:175], a[160:163], a[108:111], v[172:175]
    s_waitcnt lgkmcnt(6)
    v_mfma_f32_16x16x32_bf16 v[176:179], a[164:167], a[96:99], v[176:179]
    ds_read_b64_tr_b16 a[160:161], v19 offset:45056
    ds_read_b64_tr_b16 a[162:163], v19 offset:45568
    v_mfma_f32_16x16x32_bf16 v[180:183], a[164:167], a[100:103], v[180:183]
    v_mfma_f32_16x16x32_bf16 v[184:187], a[164:167], a[104:107], v[184:187]
    v_mfma_f32_16x16x32_bf16 v[188:191], a[164:167], a[108:111], v[188:191]
    v_mfma_f32_16x16x32_bf16 v[192:195], a[168:171], a[96:99], v[192:195]
    ds_read_b64_tr_b16 a[164:165], v16 offset:61440
    ds_read_b64_tr_b16 a[166:167], v16 offset:61952
    v_mfma_f32_16x16x32_bf16 v[196:199], a[168:171], a[100:103], v[196:199]
    v_mfma_f32_16x16x32_bf16 v[200:203], a[168:171], a[104:107], v[200:203]
    v_mfma_f32_16x16x32_bf16 v[204:207], a[168:171], a[108:111], v[204:207]
    v_mfma_f32_16x16x32_bf16 v[208:211], a[172:175], a[96:99], v[208:211]
    ds_read_b64_tr_b16 a[168:169], v17 offset:61440
    ds_read_b64_tr_b16 a[170:171], v17 offset:61952
    v_mfma_f32_16x16x32_bf16 v[212:215], a[172:175], a[100:103], v[212:215]
    v_mfma_f32_16x16x32_bf16 v[216:219], a[172:175], a[104:107], v[216:219]
    v_mfma_f32_16x16x32_bf16 v[220:223], a[172:175], a[108:111], v[220:223]
    v_mfma_f32_16x16x32_bf16 v[224:227], a[176:179], a[96:99], v[224:227]
    ds_read_b64_tr_b16 a[172:173], v18 offset:61440
    ds_read_b64_tr_b16 a[174:175], v18 offset:61952
    v_mfma_f32_16x16x32_bf16 v[228:231], a[176:179], a[100:103], v[228:231]
    v_mfma_f32_16x16x32_bf16 v[232:235], a[176:179], a[104:107], v[232:235]
    v_mfma_f32_16x16x32_bf16 v[236:239], a[176:179], a[108:111], v[236:239]
    s_waitcnt vmcnt(24)
    s_waitcnt lgkmcnt(6)
    v_mfma_f32_16x16x32_bf16 v[112:115], a[148:151], a[112:115], v[112:115]
    ds_read_b64_tr_b16 a[176:177], v19 offset:61440
    ds_read_b64_tr_b16 a[178:179], v19 offset:61952
    v_mfma_f32_16x16x32_bf16 v[116:119], a[148:151], a[116:119], v[116:119]
    buffer_load_dwordx4 v10, s[12:15], s33 offen offset:2048 lds
    v_mfma_f32_16x16x32_bf16 v[120:123], a[148:151], a[120:123], v[120:123]
    buffer_load_dwordx4 v11, s[12:15], s33 offen offset:3072 lds
    v_mfma_f32_16x16x32_bf16 v[124:127], a[148:151], a[124:127], v[124:127]
    s_waitcnt vmcnt(24)
    s_barrier
    v_mfma_f32_16x16x32_bf16 v[128:131], a[152:155], a[112:115], v[128:131]
    ds_read_b64_tr_b16 a[148:149], v48 offset:0
    ds_read_b64_tr_b16 a[150:151], v48 offset:512
    v_mfma_f32_16x16x32_bf16 v[132:135], a[152:155], a[116:119], v[132:135]
    v_mfma_f32_16x16x32_bf16 v[136:139], a[152:155], a[120:123], v[136:139]
    v_mfma_f32_16x16x32_bf16 v[140:143], a[152:155], a[124:127], v[140:143]
    v_mfma_f32_16x16x32_bf16 v[144:147], a[156:159], a[112:115], v[144:147]
    ds_read_b64_tr_b16 a[152:153], v49 offset:0
    ds_read_b64_tr_b16 a[154:155], v49 offset:512
    v_mfma_f32_16x16x32_bf16 v[148:151], a[156:159], a[116:119], v[148:151]
    s_add_u32 s39, s39, 4096
    v_mfma_f32_16x16x32_bf16 v[152:155], a[156:159], a[120:123], v[152:155]
    buffer_load_dwordx4 a[0:3], v28, s[16:19], s39 offen offset:0 sc1
    v_mfma_f32_16x16x32_bf16 v[156:159], a[156:159], a[124:127], v[156:159]
    buffer_load_dwordx4 a[4:7], v29, s[16:19], s39 offen offset:0 sc1
    v_mfma_f32_16x16x32_bf16 v[160:163], a[160:163], a[112:115], v[160:163]
    ds_read_b64_tr_b16 a[156:157], v50 offset:0
    ds_read_b64_tr_b16 a[158:159], v50 offset:512
    v_mfma_f32_16x16x32_bf16 v[164:167], a[160:163], a[116:119], v[164:167]
    buffer_load_dwordx4 a[8:11], v30, s[16:19], s39 offen offset:0 sc1
    v_mfma_f32_16x16x32_bf16 v[168:171], a[160:163], a[120:123], v[168:171]
    buffer_load_dwordx4 a[12:15], v31, s[16:19], s39 offen offset:0 sc1
    v_mfma_f32_16x16x32_bf16 v[172:175], a[160:163], a[124:127], v[172:175]
    s_waitcnt lgkmcnt(6)
    v_mfma_f32_16x16x32_bf16 v[176:179], a[164:167], a[112:115], v[176:179]
    ds_read_b64_tr_b16 a[160:161], v51 offset:0
    ds_read_b64_tr_b16 a[162:163], v51 offset:512
    v_mfma_f32_16x16x32_bf16 v[180:183], a[164:167], a[116:119], v[180:183]
    s_add_u32 s32, s32, s34
    s_add_u32 s33, s33, s34
    v_mfma_f32_16x16x32_bf16 v[184:187], a[164:167], a[120:123], v[184:187]
    s_add_u32 s37, s37, 0x8000
    s_and_b32 s37, s37, 0x1ffff
    v_mfma_f32_16x16x32_bf16 v[188:191], a[164:167], a[124:127], v[188:191]
    v_mfma_f32_16x16x32_bf16 v[192:195], a[168:171], a[112:115], v[192:195]
    ds_read_b64_tr_b16 a[164:165], v48 offset:16384
    ds_read_b64_tr_b16 a[166:167], v48 offset:16896
    v_mfma_f32_16x16x32_bf16 v[196:199], a[168:171], a[116:119], v[196:199]
    v_mfma_f32_16x16x32_bf16 v[200:203], a[168:171], a[120:123], v[200:203]
    v_mfma_f32_16x16x32_bf16 v[204:207], a[168:171], a[124:127], v[204:207]
    v_mfma_f32_16x16x32_bf16 v[208:211], a[172:175], a[112:115], v[208:211]
    ds_read_b64_tr_b16 a[168:169], v49 offset:16384
    ds_read_b64_tr_b16 a[170:171], v49 offset:16896
    v_mfma_f32_16x16x32_bf16 v[212:215], a[172:175], a[116:119], v[212:215]
    v_mfma_f32_16x16x32_bf16 v[216:219], a[172:175], a[120:123], v[216:219]
    v_mfma_f32_16x16x32_bf16 v[220:223], a[172:175], a[124:127], v[220:223]
    v_mfma_f32_16x16x32_bf16 v[224:227], a[176:179], a[112:115], v[224:227]
    ds_read_b64_tr_b16 a[172:173], v50 offset:16384
    ds_read_b64_tr_b16 a[174:175], v50 offset:16896
    v_mfma_f32_16x16x32_bf16 v[228:231], a[176:179], a[116:119], v[228:231]
    v_mfma_f32_16x16x32_bf16 v[232:235], a[176:179], a[120:123], v[232:235]
    v_mfma_f32_16x16x32_bf16 v[236:239], a[176:179], a[124:127], v[236:239]
    s_waitcnt vmcnt(24)
    s_waitcnt lgkmcnt(6)
    v_mfma_f32_16x16x32_bf16 v[112:115], a[148:151], a[180:183], v[112:115]
    ds_read_b64_tr_b16 a[176:177], v51 offset:16384
    ds_read_b64_tr_b16 a[178:179], v51 offset:16896
    v_mfma_f32_16x16x32_bf16 v[116:119], a[148:151], a[184:187], v[116:119]
    s_add_u32 m0, s37, s35
    v_mfma_f32_16x16x32_bf16 v[120:123], a[148:151], a[188:191], v[120:123]
    buffer_load_dwordx4 v4, s[8:11], s32 offen offset:0 lds
    v_mfma_f32_16x16x32_bf16 v[124:127], a[148:151], a[192:195], v[124:127]
    buffer_load_dwordx4 v5, s[8:11], s32 offen offset:1024 lds
    v_mfma_f32_16x16x32_bf16 v[128:131], a[152:155], a[180:183], v[128:131]
    ds_read_b64_tr_b16 a[148:149], v48 offset:4096
    ds_read_b64_tr_b16 a[150:151], v48 offset:4608
    v_mfma_f32_16x16x32_bf16 v[132:135], a[152:155], a[184:187], v[132:135]
    v_mfma_f32_16x16x32_bf16 v[136:139], a[152:155], a[188:191], v[136:139]
    v_mfma_f32_16x16x32_bf16 v[140:143], a[152:155], a[192:195], v[140:143]
    v_mfma_f32_16x16x32_bf16 v[144:147], a[156:159], a[180:183], v[144:147]
    ds_read_b64_tr_b16 a[152:153], v49 offset:4096
    ds_read_b64_tr_b16 a[154:155], v49 offset:4608
    v_mfma_f32_16x16x32_bf16 v[148:151], a[156:159], a[184:187], v[148:151]
    buffer_load_dwordx4 a[16:19], v28, s[16:19], s39 offen offset:1024 sc1
    v_mfma_f32_16x16x32_bf16 v[152:155], a[156:159], a[188:191], v[152:155]
    buffer_load_dwordx4 a[20:23], v29, s[16:19], s39 offen offset:1024 sc1
    v_mfma_f32_16x16x32_bf16 v[156:159], a[156:159], a[192:195], v[156:159]
    buffer_load_dwordx4 a[24:27], v30, s[16:19], s39 offen offset:1024 sc1
    v_mfma_f32_16x16x32_bf16 v[160:163], a[160:163], a[180:183], v[160:163]
    ds_read_b64_tr_b16 a[156:157], v50 offset:4096
    ds_read_b64_tr_b16 a[158:159], v50 offset:4608
    v_mfma_f32_16x16x32_bf16 v[164:167], a[160:163], a[184:187], v[164:167]
    buffer_load_dwordx4 a[28:31], v31, s[16:19], s39 offen offset:1024 sc1
    v_mfma_f32_16x16x32_bf16 v[168:171], a[160:163], a[188:191], v[168:171]
    v_mfma_f32_16x16x32_bf16 v[172:175], a[160:163], a[192:195], v[172:175]
    s_waitcnt lgkmcnt(6)
    v_mfma_f32_16x16x32_bf16 v[176:179], a[164:167], a[180:183], v[176:179]
    ds_read_b64_tr_b16 a[160:161], v51 offset:4096
    ds_read_b64_tr_b16 a[162:163], v51 offset:4608
    v_mfma_f32_16x16x32_bf16 v[180:183], a[164:167], a[184:187], v[180:183]
    v_mfma_f32_16x16x32_bf16 v[184:187], a[164:167], a[188:191], v[184:187]
    v_mfma_f32_16x16x32_bf16 v[188:191], a[164:167], a[192:195], v[188:191]
    v_mfma_f32_16x16x32_bf16 v[192:195], a[168:171], a[180:183], v[192:195]
    ds_read_b64_tr_b16 a[164:165], v48 offset:20480
    ds_read_b64_tr_b16 a[166:167], v48 offset:20992
    v_mfma_f32_16x16x32_bf16 v[196:199], a[168:171], a[184:187], v[196:199]
    v_mfma_f32_16x16x32_bf16 v[200:203], a[168:171], a[188:191], v[200:203]
    v_mfma_f32_16x16x32_bf16 v[204:207], a[168:171], a[192:195], v[204:207]
    v_mfma_f32_16x16x32_bf16 v[208:211], a[172:175], a[180:183], v[208:211]
    ds_read_b64_tr_b16 a[168:169], v49 offset:20480
    ds_read_b64_tr_b16 a[170:171], v49 offset:20992
    v_mfma_f32_16x16x32_bf16 v[212:215], a[172:175], a[184:187], v[212:215]
    v_mfma_f32_16x16x32_bf16 v[216:219], a[172:175], a[188:191], v[216:219]
    v_mfma_f32_16x16x32_bf16 v[220:223], a[172:175], a[192:195], v[220:223]
    v_mfma_f32_16x16x32_bf16 v[224:227], a[176:179], a[180:183], v[224:227]
    ds_read_b64_tr_b16 a[172:173], v50 offset:20480
    ds_read_b64_tr_b16 a[174:175], v50 offset:20992
    v_mfma_f32_16x16x32_bf16 v[228:231], a[176:179], a[184:187], v[228:231]
    v_mfma_f32_16x16x32_bf16 v[232:235], a[176:179], a[188:191], v[232:235]
    v_mfma_f32_16x16x32_bf16 v[236:239], a[176:179], a[192:195], v[236:239]
    s_waitcnt vmcnt(24)
    s_waitcnt lgkmcnt(6)
    v_mfma_f32_16x16x32_bf16 v[112:115], a[148:151], a[196:199], v[112:115]
    ds_read_b64_tr_b16 a[176:177], v51 offset:20480
    ds_read_b64_tr_b16 a[178:179], v51 offset:20992
    v_mfma_f32_16x16x32_bf16 v[116:119], a[148:151], a[200:203], v[116:119]
    buffer_load_dwordx4 v6, s[8:11], s32 offen offset:2048 lds
    v_mfma_f32_16x16x32_bf16 v[120:123], a[148:151], a[204:207], v[120:123]
    buffer_load_dwordx4 v7, s[8:11], s32 offen offset:3072 lds
    v_mfma_f32_16x16x32_bf16 v[124:127], a[148:151], a[208:211], v[124:127]
    v_mfma_f32_16x16x32_bf16 v[128:131], a[152:155], a[196:199], v[128:131]
    ds_read_b64_tr_b16 a[148:149], v48 offset:8192
    ds_read_b64_tr_b16 a[150:151], v48 offset:8704
    v_mfma_f32_16x16x32_bf16 v[132:135], a[152:155], a[200:203], v[132:135]
    v_mfma_f32_16x16x32_bf16 v[136:139], a[152:155], a[204:207], v[136:139]
    v_mfma_f32_16x16x32_bf16 v[140:143], a[152:155], a[208:211], v[140:143]
    v_mfma_f32_16x16x32_bf16 v[144:147], a[156:159], a[196:199], v[144:147]
    ds_read_b64_tr_b16 a[152:153], v49 offset:8192
    ds_read_b64_tr_b16 a[154:155], v49 offset:8704
    v_mfma_f32_16x16x32_bf16 v[148:151], a[156:159], a[200:203], v[148:151]
    buffer_load_dwordx4 a[32:35], v28, s[16:19], s39 offen offset:2048 sc1
    v_mfma_f32_16x16x32_bf16 v[152:155], a[156:159], a[204:207], v[152:155]
    buffer_load_dwordx4 a[36:39], v29, s[16:19], s39 offen offset:2048 sc1
    v_mfma_f32_16x16x32_bf16 v[156:159], a[156:159], a[208:211], v[156:159]
    buffer_load_dwordx4 a[40:43], v30, s[16:19], s39 offen offset:2048 sc1
    v_mfma_f32_16x16x32_bf16 v[160:163], a[160:163], a[196:199], v[160:163]
    ds_read_b64_tr_b16 a[156:157], v50 offset:8192
    ds_read_b64_tr_b16 a[158:159], v50 offset:8704
    v_mfma_f32_16x16x32_bf16 v[164:167], a[160:163], a[200:203], v[164:167]
    buffer_load_dwordx4 a[44:47], v31, s[16:19], s39 offen offset:2048 sc1
    v_mfma_f32_16x16x32_bf16 v[168:171], a[160:163], a[204:207], v[168:171]
    v_mfma_f32_16x16x32_bf16 v[172:175], a[160:163], a[208:211], v[172:175]
    s_waitcnt lgkmcnt(6)
    v_mfma_f32_16x16x32_bf16 v[176:179], a[164:167], a[196:199], v[176:179]
    ds_read_b64_tr_b16 a[160:161], v51 offset:8192
    ds_read_b64_tr_b16 a[162:163], v51 offset:8704
    v_mfma_f32_16x16x32_bf16 v[180:183], a[164:167], a[200:203], v[180:183]
    v_mfma_f32_16x16x32_bf16 v[184:187], a[164:167], a[204:207], v[184:187]
    v_mfma_f32_16x16x32_bf16 v[188:191], a[164:167], a[208:211], v[188:191]
    v_mfma_f32_16x16x32_bf16 v[192:195], a[168:171], a[196:199], v[192:195]
    ds_read_b64_tr_b16 a[164:165], v48 offset:24576
    ds_read_b64_tr_b16 a[166:167], v48 offset:25088
    v_mfma_f32_16x16x32_bf16 v[196:199], a[168:171], a[200:203], v[196:199]
    v_mfma_f32_16x16x32_bf16 v[200:203], a[168:171], a[204:207], v[200:203]
    v_mfma_f32_16x16x32_bf16 v[204:207], a[168:171], a[208:211], v[204:207]
    v_mfma_f32_16x16x32_bf16 v[208:211], a[172:175], a[196:199], v[208:211]
    ds_read_b64_tr_b16 a[168:169], v49 offset:24576
    ds_read_b64_tr_b16 a[170:171], v49 offset:25088
    v_mfma_f32_16x16x32_bf16 v[212:215], a[172:175], a[200:203], v[212:215]
    v_mfma_f32_16x16x32_bf16 v[216:219], a[172:175], a[204:207], v[216:219]
    v_mfma_f32_16x16x32_bf16 v[220:223], a[172:175], a[208:211], v[220:223]
    v_mfma_f32_16x16x32_bf16 v[224:227], a[176:179], a[196:199], v[224:227]
    ds_read_b64_tr_b16 a[172:173], v50 offset:24576
    ds_read_b64_tr_b16 a[174:175], v50 offset:25088
    v_mfma_f32_16x16x32_bf16 v[228:231], a[176:179], a[200:203], v[228:231]
    v_mfma_f32_16x16x32_bf16 v[232:235], a[176:179], a[204:207], v[232:235]
    v_mfma_f32_16x16x32_bf16 v[236:239], a[176:179], a[208:211], v[236:239]
    s_waitcnt vmcnt(24)
    s_waitcnt lgkmcnt(6)
    v_mfma_f32_16x16x32_bf16 v[112:115], a[148:151], a[212:215], v[112:115]
    ds_read_b64_tr_b16 a[176:177], v51 offset:24576
    ds_read_b64_tr_b16 a[178:179], v51 offset:25088
    v_mfma_f32_16x16x32_bf16 v[116:119], a[148:151], a[216:219], v[116:119]
    s_add_u32 m0, s37, s36
    v_mfma_f32_16x16x32_bf16 v[120:123], a[148:151], a[220:223], v[120:123]
    buffer_load_dwordx4 v8, s[12:15], s33 offen offset:0 lds
    v_mfma_f32_16x16x32_bf16 v[124:127], a[148:151], a[224:227], v[124:127]
    buffer_load_dwordx4 v9, s[12:15], s33 offen offset:1024 lds
    v_mfma_f32_16x16x32_bf16 v[128:131], a[152:155], a[212:215], v[128:131]
    ds_read_b64_tr_b16 a[148:149], v48 offset:12288
    ds_read_b64_tr_b16 a[150:151], v48 offset:12800
    v_mfma_f32_16x16x32_bf16 v[132:135], a[152:155], a[216:219], v[132:135]
    v_mfma_f32_16x16x32_bf16 v[136:139], a[152:155], a[220:223], v[136:139]
    v_mfma_f32_16x16x32_bf16 v[140:143], a[152:155], a[224:227], v[140:143]
    v_mfma_f32_16x16x32_bf16 v[144:147], a[156:159], a[212:215], v[144:147]
    ds_read_b64_tr_b16 a[152:153], v49 offset:12288
    ds_read_b64_tr_b16 a[154:155], v49 offset:12800
    v_mfma_f32_16x16x32_bf16 v[148:151], a[156:159], a[216:219], v[148:151]
    buffer_load_dwordx4 a[48:51], v28, s[16:19], s39 offen offset:3072 sc1
    v_mfma_f32_16x16x32_bf16 v[152:155], a[156:159], a[220:223], v[152:155]
    buffer_load_dwordx4 a[52:55], v29, s[16:19], s39 offen offset:3072 sc1
    v_mfma_f32_16x16x32_bf16 v[156:159], a[156:159], a[224:227], v[156:159]
    buffer_load_dwordx4 a[56:59], v30, s[16:19], s39 offen offset:3072 sc1
    v_mfma_f32_16x16x32_bf16 v[160:163], a[160:163], a[212:215], v[160:163]
    ds_read_b64_tr_b16 a[156:157], v50 offset:12288
    ds_read_b64_tr_b16 a[158:159], v50 offset:12800
    v_mfma_f32_16x16x32_bf16 v[164:167], a[160:163], a[216:219], v[164:167]
    buffer_load_dwordx4 a[60:63], v31, s[16:19], s39 offen offset:3072 sc1
    v_mfma_f32_16x16x32_bf16 v[168:171], a[160:163], a[220:223], v[168:171]
    v_mfma_f32_16x16x32_bf16 v[172:175], a[160:163], a[224:227], v[172:175]
    s_waitcnt lgkmcnt(6)
    v_mfma_f32_16x16x32_bf16 v[176:179], a[164:167], a[212:215], v[176:179]
    ds_read_b64_tr_b16 a[160:161], v51 offset:12288
    ds_read_b64_tr_b16 a[162:163], v51 offset:12800
    v_mfma_f32_16x16x32_bf16 v[180:183], a[164:167], a[216:219], v[180:183]
    v_mfma_f32_16x16x32_bf16 v[184:187], a[164:167], a[220:223], v[184:187]
    v_mfma_f32_16x16x32_bf16 v[188:191], a[164:167], a[224:227], v[188:191]
    v_mfma_f32_16x16x32_bf16 v[192:195], a[168:171], a[212:215], v[192:195]
    ds_read_b64_tr_b16 a[164:165], v48 offset:28672
    ds_read_b64_tr_b16 a[166:167], v48 offset:29184
    v_mfma_f32_16x16x32_bf16 v[196:199], a[168:171], a[216:219], v[196:199]
    v_mfma_f32_16x16x32_bf16 v[200:203], a[168:171], a[220:223], v[200:203]
    v_mfma_f32_16x16x32_bf16 v[204:207], a[168:171], a[224:227], v[204:207]
    v_mfma_f32_16x16x32_bf16 v[208:211], a[172:175], a[212:215], v[208:211]
    ds_read_b64_tr_b16 a[168:169], v49 offset:28672
    ds_read_b64_tr_b16 a[170:171], v49 offset:29184
    v_mfma_f32_16x16x32_bf16 v[212:215], a[172:175], a[216:219], v[212:215]
    v_mfma_f32_16x16x32_bf16 v[216:219], a[172:175], a[220:223], v[216:219]
    v_mfma_f32_16x16x32_bf16 v[220:223], a[172:175], a[224:227], v[220:223]
    v_mfma_f32_16x16x32_bf16 v[224:227], a[176:179], a[212:215], v[224:227]
    ds_read_b64_tr_b16 a[172:173], v50 offset:28672
    ds_read_b64_tr_b16 a[174:175], v50 offset:29184
    v_mfma_f32_16x16x32_bf16 v[228:231], a[176:179], a[216:219], v[228:231]
    v_mfma_f32_16x16x32_bf16 v[232:235], a[176:179], a[220:223], v[232:235]
    v_mfma_f32_16x16x32_bf16 v[236:239], a[176:179], a[224:227], v[236:239]
    s_waitcnt vmcnt(24)
    s_waitcnt lgkmcnt(6)
    v_mfma_f32_16x16x32_bf16 v[112:115], a[148:151], a[228:231], v[112:115]
    ds_read_b64_tr_b16 a[176:177], v51 offset:28672
    ds_read_b64_tr_b16 a[178:179], v51 offset:29184
    v_mfma_f32_16x16x32_bf16 v[116:119], a[148:151], a[232:235], v[116:119]
    buffer_load_dwordx4 v10, s[12:15], s33 offen offset:2048 lds
    v_mfma_f32_16x16x32_bf16 v[120:123], a[148:151], a[236:239], v[120:123]
    buffer_load_dwordx4 v11, s[12:15], s33 offen offset:3072 lds
    v_mfma_f32_16x16x32_bf16 v[124:127], a[148:151], a[240:243], v[124:127]
    s_waitcnt vmcnt(24)
    s_barrier
    v_mfma_f32_16x16x32_bf16 v[128:131], a[152:155], a[228:231], v[128:131]
    ds_read_b64_tr_b16 a[148:149], v48 offset:32768
    ds_read_b64_tr_b16 a[150:151], v48 offset:33280
    v_mfma_f32_16x16x32_bf16 v[132:135], a[152:155], a[232:235], v[132:135]
    v_mfma_f32_16x16x32_bf16 v[136:139], a[152:155], a[236:239], v[136:139]
    v_mfma_f32_16x16x32_bf16 v[140:143], a[152:155], a[240:243], v[140:143]
    v_mfma_f32_16x16x32_bf16 v[144:147], a[156:159], a[228:231], v[144:147]
    ds_read_b64_tr_b16 a[152:153], v49 offset:32768
    ds_read_b64_tr_b16 a[154:155], v49 offset:33280
    v_mfma_f32_16x16x32_bf16 v[148:151], a[156:159], a[232:235], v[148:151]
    s_add_u32 s39, s39, 4096
    v_mfma_f32_16x16x32_bf16 v[152:155], a[156:159], a[236:239], v[152:155]
    buffer_load_dwordx4 a[64:67], v28, s[16:19], s39 offen offset:0 sc1
    v_mfma_f32_16x16x32_bf16 v[156:159], a[156:159], a[240:243], v[156:159]
    buffer_load_dwordx4 a[68:71], v29, s[16:19], s39 offen offset:0 sc1
    v_mfma_f32_16x16x32_bf16 v[160:163], a[160:163], a[228:231], v[160:163]
    ds_read_b64_tr_b16 a[156:157], v50 offset:32768
    ds_read_b64_tr_b16 a[158:159], v50 offset:33280
    v_mfma_f32_16x16x32_bf16 v[164:167], a[160:163], a[232:235], v[164:167]
    buffer_load_dwordx4 a[72:75], v30, s[16:19], s39 offen offset:0 sc1
    v_mfma_f32_16x16x32_bf16 v[168:171], a[160:163], a[236:239], v[168:171]
    buffer_load_dwordx4 a[76:79], v31, s[16:19], s39 offen offset:0 sc1
    v_mfma_f32_16x16x32_bf16 v[172:175], a[160:163], a[240:243], v[172:175]
    s_waitcnt lgkmcnt(6)
    v_mfma_f32_16x16x32_bf16 v[176:179], a[164:167], a[228:231], v[176:179]
    ds_read_b64_tr_b16 a[160:161], v51 offset:32768
    ds_read_b64_tr_b16 a[162:163], v51 offset:33280
    v_mfma_f32_16x16x32_bf16 v[180:183], a[164:167], a[232:235], v[180:183]
    s_add_u32 s32, s32, s34
    s_add_u32 s33, s33, s34
    v_mfma_f32_16x16x32_bf16 v[184:187], a[164:167], a[236:239], v[184:187]
    s_add_u32 s37, s37, 0x8000
    s_and_b32 s37, s37, 0x1ffff
    v_mfma_f32_16x16x32_bf16 v[188:191], a[164:167], a[240:243], v[188:191]
    s_lshr_b32 s41, s3, 1
    s_and_b32 s42, s3, 1
    v_mfma_f32_16x16x32_bf16 v[192:195], a[168:171], a[228:231], v[192:195]
    ds_read_b64_tr_b16 a[164:165], v48 offset:49152
    ds_read_b64_tr_b16 a[166:167], v48 offset:49664
    v_mfma_f32_16x16x32_bf16 v[196:199], a[168:171], a[232:235], v[196:199]
    v_lshrrev_b32 v240, 3, v1
    v_and_b32 v241, 7, v1
    v_mfma_f32_16x16x32_bf16 v[200:203], a[168:171], a[236:239], v[200:203]
    v_lshrrev_b32 v242, 4, v1
    v_xor_b32 v243, v242, v241
    v_mfma_f32_16x16x32_bf16 v[204:207], a[168:171], a[240:243], v[204:207]
    v_lshlrev_b32 v242, 1, v242
    v_xor_b32 v242, v242, v241
    v_mfma_f32_16x16x32_bf16 v[208:211], a[172:175], a[228:231], v[208:211]
    ds_read_b64_tr_b16 a[168:169], v49 offset:49152
    ds_read_b64_tr_b16 a[170:171], v49 offset:49664
    v_mfma_f32_16x16x32_bf16 v[212:215], a[172:175], a[232:235], v[212:215]
    s_lshl_b32 s43, s42, 13
    s_lshl_b32 s41, s41, 7
    v_mfma_f32_16x16x32_bf16 v[216:219], a[172:175], a[236:239], v[216:219]
    s_add_u32 s43, s43, s41
    v_lshlrev_b32 v244, 8, v240
    v_mfma_f32_16x16x32_bf16 v[220:223], a[172:175], a[240:243], v[220:223]
    v_add_u32 v244, s43, v244
    v_lshl_add_u32 v242, v242, 4, v244
    v_mfma_f32_16x16x32_bf16 v[224:227], a[176:179], a[228:231], v[224:227]
    ds_read_b64_tr_b16 a[172:173], v50 offset:49152
    ds_read_b64_tr_b16 a[174:175], v50 offset:49664
    v_mfma_f32_16x16x32_bf16 v[228:231], a[176:179], a[232:235], v[228:231]
    v_xor_b32 v245, 4, v243
    v_lshl_add_u32 v243, v243, 4, v244
    v_mfma_f32_16x16x32_bf16 v[232:235], a[176:179], a[236:239], v[232:235]
    v_lshl_add_u32 v245, v245, 4, v244
    v_add_u32 v4, 0, v242
    v_mfma_f32_16x16x32_bf16 v[236:239], a[176:179], a[240:243], v[236:239]
    s_waitcnt vmcnt(24)
    s_waitcnt lgkmcnt(6)
    v_mfma_f32_16x16x32_bf16 v[112:115], a[148:151], a[0:3], v[112:115]
    ds_read_b64_tr_b16 a[176:177], v51 offset:49152
    ds_read_b64_tr_b16 a[178:179], v51 offset:49664
    v_mfma_f32_16x16x32_bf16 v[116:119], a[148:151], a[4:7], v[116:119]
    v_add_u32 v8, 0, v243
    v_add_u32 v5, 1024, v242
    v_mfma_f32_16x16x32_bf16 v[120:123], a[148:151], a[8:11], v[120:123]
    v_add_u32 v9, 1024, v245
    v_add_u32 v6, 2048, v242
    v_mfma_f32_16x16x32_bf16 v[124:127], a[148:151], a[12:15], v[124:127]
    v_add_u32 v10, 2048, v243
    v_add_u32 v7, 3072, v242
    v_mfma_f32_16x16x32_bf16 v[128:131], a[152:155], a[0:3], v[128:131]
    ds_read_b64_tr_b16 a[148:149], v48 offset:36864
    ds_read_b64_tr_b16 a[150:151], v48 offset:37376
    v_mfma_f32_16x16x32_bf16 v[132:135], a[152:155], a[4:7], v[132:135]
    v_add_u32 v11, 3072, v245
    s_mov_b32 s8, s24
    v_mfma_f32_16x16x32_bf16 v[136:139], a[152:155], a[8:11], v[136:139]
    s_mov_b32 s9, s25
    s_mov_b32 s10, s26
    v_mfma_f32_16x16x32_bf16 v[140:143], a[152:155], a[12:15], v[140:143]
    s_mov_b32 s12, s28
    s_mov_b32 s13, s29
    v_mfma_f32_16x16x32_bf16 v[144:147], a[156:159], a[0:3], v[144:147]
    ds_read_b64_tr_b16 a[152:153], v49 offset:36864
    ds_read_b64_tr_b16 a[154:155], v49 offset:37376
    v_mfma_f32_16x16x32_bf16 v[148:151], a[156:159], a[4:7], v[148:151]
    s_mov_b32 s14, s30
    s_mov_b32 s33, s44
    v_mfma_f32_16x16x32_bf16 v[152:155], a[156:159], a[8:11], v[152:155]
    s_sub_u32 s32, s44, 16384
    s_mov_b32 s34, 16384
    v_mfma_f32_16x16x32_bf16 v[156:159], a[156:159], a[12:15], v[156:159]
    s_lshl_b32 s35, s3, 12
    s_add_u32 s36, s35, 16384
    v_mfma_f32_16x16x32_bf16 v[160:163], a[160:163], a[0:3], v[160:163]
    ds_read_b64_tr_b16 a[156:157], v50 offset:36864
    ds_read_b64_tr_b16 a[158:159], v50 offset:37376
    v_mfma_f32_16x16x32_bf16 v[164:167], a[160:163], a[4:7], v[164:167]
    buffer_load_dwordx4 a[80:83], v28, s[16:19], s39 offen offset:1024 sc1
    v_mfma_f32_16x16x32_bf16 v[168:171], a[160:163], a[8:11], v[168:171]
    buffer_load_dwordx4 a[84:87], v29, s[16:19], s39 offen offset:1024 sc1
    v_mfma_f32_16x16x32_bf16 v[172:175], a[160:163], a[12:15], v[172:175]
    s_waitcnt lgkmcnt(6)
    v_mfma_f32_16x16x32_bf16 v[176:179], a[164:167], a[0:3], v[176:179]
    ds_read_b64_tr_b16 a[160:161], v51 offset:36864
    ds_read_b64_tr_b16 a[162:163], v51 offset:37376
    v_mfma_f32_16x16x32_bf16 v[180:183], a[164:167], a[4:7], v[180:183]
    buffer_load_dwordx4 a[88:91], v30, s[16:19], s39 offen offset:1024 sc1
    v_mfma_f32_16x16x32_bf16 v[184:187], a[164:167], a[8:11], v[184:187]
    buffer_load_dwordx4 a[92:95], v31, s[16:19], s39 offen offset:1024 sc1
    v_mfma_f32_16x16x32_bf16 v[188:191], a[164:167], a[12:15], v[188:191]
    v_mfma_f32_16x16x32_bf16 v[192:195], a[168:171], a[0:3], v[192:195]
    ds_read_b64_tr_b16 a[164:165], v48 offset:53248
    ds_read_b64_tr_b16 a[166:167], v48 offset:53760
    v_mfma_f32_16x16x32_bf16 v[196:199], a[168:171], a[4:7], v[196:199]
    v_mfma_f32_16x16x32_bf16 v[200:203], a[168:171], a[8:11], v[200:203]
    v_mfma_f32_16x16x32_bf16 v[204:207], a[168:171], a[12:15], v[204:207]
    v_mfma_f32_16x16x32_bf16 v[208:211], a[172:175], a[0:3], v[208:211]
    ds_read_b64_tr_b16 a[168:169], v49 offset:53248
    ds_read_b64_tr_b16 a[170:171], v49 offset:53760
    v_mfma_f32_16x16x32_bf16 v[212:215], a[172:175], a[4:7], v[212:215]
    v_mfma_f32_16x16x32_bf16 v[216:219], a[172:175], a[8:11], v[216:219]
    v_mfma_f32_16x16x32_bf16 v[220:223], a[172:175], a[12:15], v[220:223]
    v_mfma_f32_16x16x32_bf16 v[224:227], a[176:179], a[0:3], v[224:227]
    ds_read_b64_tr_b16 a[172:173], v50 offset:53248
    ds_read_b64_tr_b16 a[174:175], v50 offset:53760
    v_mfma_f32_16x16x32_bf16 v[228:231], a[176:179], a[4:7], v[228:231]
    v_mfma_f32_16x16x32_bf16 v[232:235], a[176:179], a[8:11], v[232:235]
    v_mfma_f32_16x16x32_bf16 v[236:239], a[176:179], a[12:15], v[236:239]
    s_waitcnt vmcnt(22)
    s_waitcnt lgkmcnt(6)
    v_mfma_f32_16x16x32_bf16 v[112:115], a[148:151], a[16:19], v[112:115]
    ds_read_b64_tr_b16 a[176:177], v51 offset:53248
    ds_read_b64_tr_b16 a[178:179], v51 offset:53760
    v_mfma_f32_16x16x32_bf16 v[116:119], a[148:151], a[20:23], v[116:119]
    v_mfma_f32_16x16x32_bf16 v[120:123], a[148:151], a[24:27], v[120:123]
    v_mfma_f32_16x16x32_bf16 v[124:127], a[148:151], a[28:31], v[124:127]
    v_mfma_f32_16x16x32_bf16 v[128:131], a[152:155], a[16:19], v[128:131]
    ds_read_b64_tr_b16 a[148:149], v48 offset:40960
    ds_read_b64_tr_b16 a[150:151], v48 offset:41472
    v_mfma_f32_16x16x32_bf16 v[132:135], a[152:155], a[20:23], v[132:135]
    v_mfma_f32_16x16x32_bf16 v[136:139], a[152:155], a[24:27], v[136:139]
    v_mfma_f32_16x16x32_bf16 v[140:143], a[152:155], a[28:31], v[140:143]
    v_mfma_f32_16x16x32_bf16 v[144:147], a[156:159], a[16:19], v[144:147]
    ds_read_b64_tr_b16 a[152:153], v49 offset:40960
    ds_read_b64_tr_b16 a[154:155], v49 offset:41472
    v_mfma_f32_16x16x32_bf16 v[148:151], a[156:159], a[20:23], v[148:151]
    buffer_load_dwordx4 a[96:99], v28, s[16:19], s39 offen offset:2048 sc1
    v_mfma_f32_16x16x32_bf16 v[152:155], a[156:159], a[24:27], v[152:155]
    buffer_load_dwordx4 a[100:103], v29, s[16:19], s39 offen offset:2048 sc1
    v_mfma_f32_16x16x32_bf16 v[156:159], a[156:159], a[28:31], v[156:159]
    buffer_load_dwordx4 a[104:107], v30, s[16:19], s39 offen offset:2048 sc1
    v_mfma_f32_16x16x32_bf16 v[160:163], a[160:163], a[16:19], v[160:163]
    ds_read_b64_tr_b16 a[156:157], v50 offset:40960
    ds_read_b64_tr_b16 a[158:159], v50 offset:41472
    v_mfma_f32_16x16x32_bf16 v[164:167], a[160:163], a[20:23], v[164:167]
    buffer_load_dwordx4 a[108:111], v31, s[16:19], s39 offen offset:2048 sc1
    v_mfma_f32_16x16x32_bf16 v[168:171], a[160:163], a[24:27], v[168:171]
    v_mfma_f32_16x16x32_bf16 v[172:175], a[160:163], a[28:31], v[172:175]
    s_waitcnt lgkmcnt(6)
    v_mfma_f32_16x16x32_bf16 v[176:179], a[164:167], a[16:19], v[176:179]
    ds_read_b64_tr_b16 a[160:161], v51 offset:40960
    ds_read_b64_tr_b16 a[162:163], v51 offset:41472
    v_mfma_f32_16x16x32_bf16 v[180:183], a[164:167], a[20:23], v[180:183]
    v_mfma_f32_16x16x32_bf16 v[184:187], a[164:167], a[24:27], v[184:187]
    v_mfma_f32_16x16x32_bf16 v[188:191], a[164:167], a[28:31], v[188:191]
    v_mfma_f32_16x16x32_bf16 v[192:195], a[168:171], a[16:19], v[192:195]
    ds_read_b64_tr_b16 a[164:165], v48 offset:57344
    ds_read_b64_tr_b16 a[166:167], v48 offset:57856
    v_mfma_f32_16x16x32_bf16 v[196:199], a[168:171], a[20:23], v[196:199]
    v_mfma_f32_16x16x32_bf16 v[200:203], a[168:171], a[24:27], v[200:203]
    v_mfma_f32_16x16x32_bf16 v[204:207], a[168:171], a[28:31], v[204:207]
    v_mfma_f32_16x16x32_bf16 v[208:211], a[172:175], a[16:19], v[208:211]
    ds_read_b64_tr_b16 a[168:169], v49 offset:57344
    ds_read_b64_tr_b16 a[170:171], v49 offset:57856
    v_mfma_f32_16x16x32_bf16 v[212:215], a[172:175], a[20:23], v[212:215]
    v_mfma_f32_16x16x32_bf16 v[216:219], a[172:175], a[24:27], v[216:219]
    v_mfma_f32_16x16x32_bf16 v[220:223], a[172:175], a[28:31], v[220:223]
    v_mfma_f32_16x16x32_bf16 v[224:227], a[176:179], a[16:19], v[224:227]
    ds_read_b64_tr_b16 a[172:173], v50 offset:57344
    ds_read_b64_tr_b16 a[174:175], v50 offset:57856
    v_mfma_f32_16x16x32_bf16 v[228:231], a[176:179], a[20:23], v[228:231]
    v_mfma_f32_16x16x32_bf16 v[232:235], a[176:179], a[24:27], v[232:235]
    v_mfma_f32_16x16x32_bf16 v[236:239], a[176:179], a[28:31], v[236:239]
    s_waitcnt vmcnt(20)
    s_waitcnt lgkmcnt(6)
    v_mfma_f32_16x16x32_bf16 v[112:115], a[148:151], a[32:35], v[112:115]
    ds_read_b64_tr_b16 a[176:177], v51 offset:57344
    ds_read_b64_tr_b16 a[178:179], v51 offset:57856
    v_mfma_f32_16x16x32_bf16 v[116:119], a[148:151], a[36:39], v[116:119]
    s_add_u32 m0, s37, s36
    v_mfma_f32_16x16x32_bf16 v[120:123], a[148:151], a[40:43], v[120:123]
    buffer_load_dwordx4 v8, s[12:15], s33 offen offset:0 nt lds
    v_mfma_f32_16x16x32_bf16 v[124:127], a[148:151], a[44:47], v[124:127]
    buffer_load_dwordx4 v9, s[12:15], s33 offen offset:1024 nt lds
    v_mfma_f32_16x16x32_bf16 v[128:131], a[152:155], a[32:35], v[128:131]
    ds_read_b64_tr_b16 a[148:149], v48 offset:45056
    ds_read_b64_tr_b16 a[150:151], v48 offset:45568
    v_mfma_f32_16x16x32_bf16 v[132:135], a[152:155], a[36:39], v[132:135]
    v_mfma_f32_16x16x32_bf16 v[136:139], a[152:155], a[40:43], v[136:139]
    v_mfma_f32_16x16x32_bf16 v[140:143], a[152:155], a[44:47], v[140:143]
    v_mfma_f32_16x16x32_bf16 v[144:147], a[156:159], a[32:35], v[144:147]
    ds_read_b64_tr_b16 a[152:153], v49 offset:45056
    ds_read_b64_tr_b16 a[154:155], v49 offset:45568
    v_mfma_f32_16x16x32_bf16 v[148:151], a[156:159], a[36:39], v[148:151]
    buffer_load_dwordx4 a[112:115], v28, s[16:19], s39 offen offset:3072 sc1
    v_mfma_f32_16x16x32_bf16 v[152:155], a[156:159], a[40:43], v[152:155]
    buffer_load_dwordx4 a[116:119], v29, s[16:19], s39 offen offset:3072 sc1
    v_mfma_f32_16x16x32_bf16 v[156:159], a[156:159], a[44:47], v[156:159]
    buffer_load_dwordx4 a[120:123], v30, s[16:19], s39 offen offset:3072 sc1
    v_mfma_f32_16x16x32_bf16 v[160:163], a[160:163], a[32:35], v[160:163]
    ds_read_b64_tr_b16 a[156:157], v50 offset:45056
    ds_read_b64_tr_b16 a[158:159], v50 offset:45568
    v_mfma_f32_16x16x32_bf16 v[164:167], a[160:163], a[36:39], v[164:167]
    buffer_load_dwordx4 a[124:127], v31, s[16:19], s39 offen offset:3072 sc1
    v_mfma_f32_16x16x32_bf16 v[168:171], a[160:163], a[40:43], v[168:171]
    v_mfma_f32_16x16x32_bf16 v[172:175], a[160:163], a[44:47], v[172:175]
    s_waitcnt lgkmcnt(6)
    v_mfma_f32_16x16x32_bf16 v[176:179], a[164:167], a[32:35], v[176:179]
    ds_read_b64_tr_b16 a[160:161], v51 offset:45056
    ds_read_b64_tr_b16 a[162:163], v51 offset:45568
    v_mfma_f32_16x16x32_bf16 v[180:183], a[164:167], a[36:39], v[180:183]
    v_mfma_f32_16x16x32_bf16 v[184:187], a[164:167], a[40:43], v[184:187]
    v_mfma_f32_16x16x32_bf16 v[188:191], a[164:167], a[44:47], v[188:191]
    v_mfma_f32_16x16x32_bf16 v[192:195], a[168:171], a[32:35], v[192:195]
    ds_read_b64_tr_b16 a[164:165], v48 offset:61440
    ds_read_b64_tr_b16 a[166:167], v48 offset:61952
    v_mfma_f32_16x16x32_bf16 v[196:199], a[168:171], a[36:39], v[196:199]
    v_mfma_f32_16x16x32_bf16 v[200:203], a[168:171], a[40:43], v[200:203]
    v_mfma_f32_16x16x32_bf16 v[204:207], a[168:171], a[44:47], v[204:207]
    v_mfma_f32_16x16x32_bf16 v[208:211], a[172:175], a[32:35], v[208:211]
    ds_read_b64_tr_b16 a[168:169], v49 offset:61440
    ds_read_b64_tr_b16 a[170:171], v49 offset:61952
    v_mfma_f32_16x16x32_bf16 v[212:215], a[172:175], a[36:39], v[212:215]
    v_mfma_f32_16x16x32_bf16 v[216:219], a[172:175], a[40:43], v[216:219]
    v_mfma_f32_16x16x32_bf16 v[220:223], a[172:175], a[44:47], v[220:223]
    v_mfma_f32_16x16x32_bf16 v[224:227], a[176:179], a[32:35], v[224:227]
    ds_read_b64_tr_b16 a[172:173], v50 offset:61440
    ds_read_b64_tr_b16 a[174:175], v50 offset:61952
    v_mfma_f32_16x16x32_bf16 v[228:231], a[176:179], a[36:39], v[228:231]
    v_mfma_f32_16x16x32_bf16 v[232:235], a[176:179], a[40:43], v[232:235]
    v_mfma_f32_16x16x32_bf16 v[236:239], a[176:179], a[44:47], v[236:239]
    s_waitcnt vmcnt(20)
    s_waitcnt lgkmcnt(6)
    v_mfma_f32_16x16x32_bf16 v[112:115], a[148:151], a[48:51], v[112:115]
    ds_read_b64_tr_b16 a[176:177], v51 offset:61440
    ds_read_b64_tr_b16 a[178:179], v51 offset:61952
    v_mfma_f32_16x16x32_bf16 v[116:119], a[148:151], a[52:55], v[116:119]
    buffer_load_dwordx4 v10, s[12:15], s33 offen offset:2048 nt lds
    v_mfma_f32_16x16x32_bf16 v[120:123], a[148:151], a[56:59], v[120:123]
    buffer_load_dwordx4 v11, s[12:15], s33 offen offset:3072 nt lds
    v_mfma_f32_16x16x32_bf16 v[124:127], a[148:151], a[60:63], v[124:127]
    s_waitcnt vmcnt(20)
    s_barrier
    v_mfma_f32_16x16x32_bf16 v[128:131], a[152:155], a[48:51], v[128:131]
    ds_read_b64_tr_b16 a[148:149], v16 offset:0
    ds_read_b64_tr_b16 a[150:151], v16 offset:512
    v_mfma_f32_16x16x32_bf16 v[132:135], a[152:155], a[52:55], v[132:135]
    v_mfma_f32_16x16x32_bf16 v[136:139], a[152:155], a[56:59], v[136:139]
    v_mfma_f32_16x16x32_bf16 v[140:143], a[152:155], a[60:63], v[140:143]
    v_mfma_f32_16x16x32_bf16 v[144:147], a[156:159], a[48:51], v[144:147]
    ds_read_b64_tr_b16 a[152:153], v17 offset:0
    ds_read_b64_tr_b16 a[154:155], v17 offset:512
    v_mfma_f32_16x16x32_bf16 v[148:151], a[156:159], a[52:55], v[148:151]
    v_mfma_f32_16x16x32_bf16 v[152:155], a[156:159], a[56:59], v[152:155]
    v_mfma_f32_16x16x32_bf16 v[156:159], a[156:159], a[60:63], v[156:159]
    v_mfma_f32_16x16x32_bf16 v[160:163], a[160:163], a[48:51], v[160:163]
    ds_read_b64_tr_b16 a[156:157], v18 offset:0
    ds_read_b64_tr_b16 a[158:159], v18 offset:512
    v_mfma_f32_16x16x32_bf16 v[164:167], a[160:163], a[52:55], v[164:167]
    v_mfma_f32_16x16x32_bf16 v[168:171], a[160:163], a[56:59], v[168:171]
    v_mfma_f32_16x16x32_bf16 v[172:175], a[160:163], a[60:63], v[172:175]
    s_waitcnt lgkmcnt(6)
    v_mfma_f32_16x16x32_bf16 v[176:179], a[164:167], a[48:51], v[176:179]
    ds_read_b64_tr_b16 a[160:161], v19 offset:0
    ds_read_b64_tr_b16 a[162:163], v19 offset:512
    v_mfma_f32_16x16x32_bf16 v[180:183], a[164:167], a[52:55], v[180:183]
    s_add_u32 s32, s32, s34
    s_add_u32 s33, s33, s34
    v_mfma_f32_16x16x32_bf16 v[184:187], a[164:167], a[56:59], v[184:187]
    s_add_u32 s37, s37, 0x8000
    s_and_b32 s37, s37, 0x1ffff
    v_mfma_f32_16x16x32_bf16 v[188:191], a[164:167], a[60:63], v[188:191]
    v_mfma_f32_16x16x32_bf16 v[192:195], a[168:171], a[48:51], v[192:195]
    ds_read_b64_tr_b16 a[164:165], v16 offset:16384
    ds_read_b64_tr_b16 a[166:167], v16 offset:16896
    v_mfma_f32_16x16x32_bf16 v[196:199], a[168:171], a[52:55], v[196:199]
    v_mfma_f32_16x16x32_bf16 v[200:203], a[168:171], a[56:59], v[200:203]
    v_mfma_f32_16x16x32_bf16 v[204:207], a[168:171], a[60:63], v[204:207]
    v_mfma_f32_16x16x32_bf16 v[208:211], a[172:175], a[48:51], v[208:211]
    ds_read_b64_tr_b16 a[168:169], v17 offset:16384
    ds_read_b64_tr_b16 a[170:171], v17 offset:16896
    v_mfma_f32_16x16x32_bf16 v[212:215], a[172:175], a[52:55], v[212:215]
    v_mfma_f32_16x16x32_bf16 v[216:219], a[172:175], a[56:59], v[216:219]
    v_mfma_f32_16x16x32_bf16 v[220:223], a[172:175], a[60:63], v[220:223]
    v_mfma_f32_16x16x32_bf16 v[224:227], a[176:179], a[48:51], v[224:227]
    ds_read_b64_tr_b16 a[172:173], v18 offset:16384
    ds_read_b64_tr_b16 a[174:175], v18 offset:16896
    v_mfma_f32_16x16x32_bf16 v[228:231], a[176:179], a[52:55], v[228:231]
    v_mfma_f32_16x16x32_bf16 v[232:235], a[176:179], a[56:59], v[232:235]
    v_mfma_f32_16x16x32_bf16 v[236:239], a[176:179], a[60:63], v[236:239]
    s_waitcnt vmcnt(16)
    s_waitcnt lgkmcnt(6)
    v_mfma_f32_16x16x32_bf16 v[112:115], a[148:151], a[64:67], v[112:115]
    ds_read_b64_tr_b16 a[176:177], v19 offset:16384
    ds_read_b64_tr_b16 a[178:179], v19 offset:16896
    v_mfma_f32_16x16x32_bf16 v[116:119], a[148:151], a[68:71], v[116:119]
    s_add_u32 m0, s37, s35
    v_mfma_f32_16x16x32_bf16 v[120:123], a[148:151], a[72:75], v[120:123]
    buffer_load_dwordx4 v4, s[8:11], s32 offen offset:0 nt lds
    v_mfma_f32_16x16x32_bf16 v[124:127], a[148:151], a[76:79], v[124:127]
    buffer_load_dwordx4 v5, s[8:11], s32 offen offset:1024 nt lds
    v_mfma_f32_16x16x32_bf16 v[128:131], a[152:155], a[64:67], v[128:131]
    ds_read_b64_tr_b16 a[148:149], v16 offset:4096
    ds_read_b64_tr_b16 a[150:151], v16 offset:4608
    v_mfma_f32_16x16x32_bf16 v[132:135], a[152:155], a[68:71], v[132:135]
    v_mfma_f32_16x16x32_bf16 v[136:139], a[152:155], a[72:75], v[136:139]
    v_mfma_f32_16x16x32_bf16 v[140:143], a[152:155], a[76:79], v[140:143]
    v_mfma_f32_16x16x32_bf16 v[144:147], a[156:159], a[64:67], v[144:147]
    ds_read_b64_tr_b16 a[152:153], v17 offset:4096
    ds_read_b64_tr_b16 a[154:155], v17 offset:4608
    v_mfma_f32_16x16x32_bf16 v[148:151], a[156:159], a[68:71], v[148:151]
    v_mfma_f32_16x16x32_bf16 v[152:155], a[156:159], a[72:75], v[152:155]
    v_mfma_f32_16x16x32_bf16 v[156:159], a[156:159], a[76:79], v[156:159]
    v_mfma_f32_16x16x32_bf16 v[160:163], a[160:163], a[64:67], v[160:163]
    ds_read_b64_tr_b16 a[156:157], v18 offset:4096
    ds_read_b64_tr_b16 a[158:159], v18 offset:4608
    v_mfma_f32_16x16x32_bf16 v[164:167], a[160:163], a[68:71], v[164:167]
    v_mfma_f32_16x16x32_bf16 v[168:171], a[160:163], a[72:75], v[168:171]
    v_mfma_f32_16x16x32_bf16 v[172:175], a[160:163], a[76:79], v[172:175]
    s_waitcnt lgkmcnt(6)
    v_mfma_f32_16x16x32_bf16 v[176:179], a[164:167], a[64:67], v[176:179]
    ds_read_b64_tr_b16 a[160:161], v19 offset:4096
    ds_read_b64_tr_b16 a[162:163], v19 offset:4608
    v_mfma_f32_16x16x32_bf16 v[180:183], a[164:167], a[68:71], v[180:183]
    v_mfma_f32_16x16x32_bf16 v[184:187], a[164:167], a[72:75], v[184:187]
    v_mfma_f32_16x16x32_bf16 v[188:191], a[164:167], a[76:79], v[188:191]
    v_mfma_f32_16x16x32_bf16 v[192:195], a[168:171], a[64:67], v[192:195]
    ds_read_b64_tr_b16 a[164:165], v16 offset:20480
    ds_read_b64_tr_b16 a[166:167], v16 offset:20992
    v_mfma_f32_16x16x32_bf16 v[196:199], a[168:171], a[68:71], v[196:199]
    v_mfma_f32_16x16x32_bf16 v[200:203], a[168:171], a[72:75], v[200:203]
    v_mfma_f32_16x16x32_bf16 v[204:207], a[168:171], a[76:79], v[204:207]
    v_mfma_f32_16x16x32_bf16 v[208:211], a[172:175], a[64:67], v[208:211]
    ds_read_b64_tr_b16 a[168:169], v17 offset:20480
    ds_read_b64_tr_b16 a[170:171], v17 offset:20992
    v_mfma_f32_16x16x32_bf16 v[212:215], a[172:175], a[68:71], v[212:215]
    v_mfma_f32_16x16x32_bf16 v[216:219], a[172:175], a[72:75], v[216:219]
    v_mfma_f32_16x16x32_bf16 v[220:223], a[172:175], a[76:79], v[220:223]
    v_mfma_f32_16x16x32_bf16 v[224:227], a[176:179], a[64:67], v[224:227]
    ds_read_b64_tr_b16 a[172:173], v18 offset:20480
    ds_read_b64_tr_b16 a[174:175], v18 offset:20992
    v_mfma_f32_16x16x32_bf16 v[228:231], a[176:179], a[68:71], v[228:231]
    v_mfma_f32_16x16x32_bf16 v[232:235], a[176:179], a[72:75], v[232:235]
    v_mfma_f32_16x16x32_bf16 v[236:239], a[176:179], a[76:79], v[236:239]
    s_waitcnt vmcnt(14)
    s_waitcnt lgkmcnt(6)
    v_mfma_f32_16x16x32_bf16 v[112:115], a[148:151], a[80:83], v[112:115]
    ds_read_b64_tr_b16 a[176:177], v19 offset:20480
    ds_read_b64_tr_b16 a[178:179], v19 offset:20992
    v_mfma_f32_16x16x32_bf16 v[116:119], a[148:151], a[84:87], v[116:119]
    buffer_load_dwordx4 v6, s[8:11], s32 offen offset:2048 nt lds
    v_mfma_f32_16x16x32_bf16 v[120:123], a[148:151], a[88:91], v[120:123]
    buffer_load_dwordx4 v7, s[8:11], s32 offen offset:3072 nt lds
    v_mfma_f32_16x16x32_bf16 v[124:127], a[148:151], a[92:95], v[124:127]
    v_mfma_f32_16x16x32_bf16 v[128:131], a[152:155], a[80:83], v[128:131]
    ds_read_b64_tr_b16 a[148:149], v16 offset:8192
    ds_read_b64_tr_b16 a[150:151], v16 offset:8704
    v_mfma_f32_16x16x32_bf16 v[132:135], a[152:155], a[84:87], v[132:135]
    v_mfma_f32_16x16x32_bf16 v[136:139], a[152:155], a[88:91], v[136:139]
    v_mfma_f32_16x16x32_bf16 v[140:143], a[152:155], a[92:95], v[140:143]
    v_mfma_f32_16x16x32_bf16 v[144:147], a[156:159], a[80:83], v[144:147]
    ds_read_b64_tr_b16 a[152:153], v17 offset:8192
    ds_read_b64_tr_b16 a[154:155], v17 offset:8704
    v_mfma_f32_16x16x32_bf16 v[148:151], a[156:159], a[84:87], v[148:151]
    v_mfma_f32_16x16x32_bf16 v[152:155], a[156:159], a[88:91], v[152:155]
    v_mfma_f32_16x16x32_bf16 v[156:159], a[156:159], a[92:95], v[156:159]
    v_mfma_f32_16x16x32_bf16 v[160:163], a[160:163], a[80:83], v[160:163]
    ds_read_b64_tr_b16 a[156:157], v18 offset:8192
    ds_read_b64_tr_b16 a[158:159], v18 offset:8704
    v_mfma_f32_16x16x32_bf16 v[164:167], a[160:163], a[84:87], v[164:167]
    v_mfma_f32_16x16x32_bf16 v[168:171], a[160:163], a[88:91], v[168:171]
    v_mfma_f32_16x16x32_bf16 v[172:175], a[160:163], a[92:95], v[172:175]
    s_waitcnt lgkmcnt(6)
    v_mfma_f32_16x16x32_bf16 v[176:179], a[164:167], a[80:83], v[176:179]
    ds_read_b64_tr_b16 a[160:161], v19 offset:8192
    ds_read_b64_tr_b16 a[162:163], v19 offset:8704
    v_mfma_f32_16x16x32_bf16 v[180:183], a[164:167], a[84:87], v[180:183]
    s_sub_u32 s16, s16, 917504
    s_subb_u32 s17, s17, 0
    v_mfma_f32_16x16x32_bf16 v[184:187], a[164:167], a[88:91], v[184:187]
    s_mov_b32 s18, 25542656
    v_add_u32 v24, 0x8000, v26
    v_mfma_f32_16x16x32_bf16 v[188:191], a[164:167], a[92:95], v[188:191]
    v_add_u32 v25, 0x8000, v27
    v_mfma_f32_16x16x32_bf16 v[192:195], a[168:171], a[80:83], v[192:195]
    ds_read_b64_tr_b16 a[164:165], v16 offset:24576
    ds_read_b64_tr_b16 a[166:167], v16 offset:25088
    v_mfma_f32_16x16x32_bf16 v[196:199], a[168:171], a[84:87], v[196:199]
    v_mfma_f32_16x16x32_bf16 v[200:203], a[168:171], a[88:91], v[200:203]
    v_mfma_f32_16x16x32_bf16 v[204:207], a[168:171], a[92:95], v[204:207]
    v_mfma_f32_16x16x32_bf16 v[208:211], a[172:175], a[80:83], v[208:211]
    ds_read_b64_tr_b16 a[168:169], v17 offset:24576
    ds_read_b64_tr_b16 a[170:171], v17 offset:25088
    v_mfma_f32_16x16x32_bf16 v[212:215], a[172:175], a[84:87], v[212:215]
    v_mfma_f32_16x16x32_bf16 v[216:219], a[172:175], a[88:91], v[216:219]
    v_mfma_f32_16x16x32_bf16 v[220:223], a[172:175], a[92:95], v[220:223]
    v_mfma_f32_16x16x32_bf16 v[224:227], a[176:179], a[80:83], v[224:227]
    ds_read_b64_tr_b16 a[172:173], v18 offset:24576
    ds_read_b64_tr_b16 a[174:175], v18 offset:25088
    v_mfma_f32_16x16x32_bf16 v[228:231], a[176:179], a[84:87], v[228:231]
    v_mfma_f32_16x16x32_bf16 v[232:235], a[176:179], a[88:91], v[232:235]
    v_mfma_f32_16x16x32_bf16 v[236:239], a[176:179], a[92:95], v[236:239]
    s_waitcnt vmcnt(12)
    s_waitcnt lgkmcnt(6)
    v_mfma_f32_16x16x32_bf16 v[112:115], a[148:151], a[96:99], v[112:115]
    ds_read_b64_tr_b16 a[176:177], v19 offset:24576
    ds_read_b64_tr_b16 a[178:179], v19 offset:25088
    v_mfma_f32_16x16x32_bf16 v[116:119], a[148:151], a[100:103], v[116:119]
    s_add_u32 m0, s37, s36
    v_mfma_f32_16x16x32_bf16 v[120:123], a[148:151], a[104:107], v[120:123]
    buffer_load_dwordx4 v8, s[12:15], s33 offen offset:0 nt lds
    v_mfma_f32_16x16x32_bf16 v[124:127], a[148:151], a[108:111], v[124:127]
    buffer_load_dwordx4 v9, s[12:15], s33 offen offset:1024 nt lds
    v_mfma_f32_16x16x32_bf16 v[128:131], a[152:155], a[96:99], v[128:131]
    ds_read_b64_tr_b16 a[148:149], v16 offset:12288
    ds_read_b64_tr_b16 a[150:151], v16 offset:12800
    v_mfma_f32_16x16x32_bf16 v[132:135], a[152:155], a[100:103], v[132:135]
    buffer_load_dwordx4 v10, s[12:15], s33 offen offset:2048 nt lds
    v_mfma_f32_16x16x32_bf16 v[136:139], a[152:155], a[104:107], v[136:139]
    buffer_load_dwordx4 v11, s[12:15], s33 offen offset:3072 nt lds
    v_mfma_f32_16x16x32_bf16 v[140:143], a[152:155], a[108:111], v[140:143]
    v_mfma_f32_16x16x32_bf16 v[144:147], a[156:159], a[96:99], v[144:147]
    ds_read_b64_tr_b16 a[152:153], v17 offset:12288
    ds_read_b64_tr_b16 a[154:155], v17 offset:12800
    v_mfma_f32_16x16x32_bf16 v[148:151], a[156:159], a[100:103], v[148:151]
    v_mfma_f32_16x16x32_bf16 v[152:155], a[156:159], a[104:107], v[152:155]
    v_mfma_f32_16x16x32_bf16 v[156:159], a[156:159], a[108:111], v[156:159]
    v_mfma_f32_16x16x32_bf16 v[160:163], a[160:163], a[96:99], v[160:163]
    ds_read_b64_tr_b16 a[156:157], v18 offset:12288
    ds_read_b64_tr_b16 a[158:159], v18 offset:12800
    v_mfma_f32_16x16x32_bf16 v[164:167], a[160:163], a[100:103], v[164:167]
    v_mfma_f32_16x16x32_bf16 v[168:171], a[160:163], a[104:107], v[168:171]
    v_mfma_f32_16x16x32_bf16 v[172:175], a[160:163], a[108:111], v[172:175]
    s_waitcnt lgkmcnt(6)
    v_mfma_f32_16x16x32_bf16 v[176:179], a[164:167], a[96:99], v[176:179]
    ds_read_b64_tr_b16 a[160:161], v19 offset:12288
    ds_read_b64_tr_b16 a[162:163], v19 offset:12800
    v_mfma_f32_16x16x32_bf16 v[180:183], a[164:167], a[100:103], v[180:183]
    s_add_u32 s32, s32, s34
    s_add_u32 s33, s33, s34
    v_mfma_f32_16x16x32_bf16 v[184:187], a[164:167], a[104:107], v[184:187]
    s_add_u32 s37, s37, 0x8000
    s_and_b32 s37, s37, 0x1ffff
    v_mfma_f32_16x16x32_bf16 v[188:191], a[164:167], a[108:111], v[188:191]
    v_mfma_f32_16x16x32_bf16 v[192:195], a[168:171], a[96:99], v[192:195]
    ds_read_b64_tr_b16 a[164:165], v16 offset:28672
    ds_read_b64_tr_b16 a[166:167], v16 offset:29184
    v_mfma_f32_16x16x32_bf16 v[196:199], a[168:171], a[100:103], v[196:199]
    v_mfma_f32_16x16x32_bf16 v[200:203], a[168:171], a[104:107], v[200:203]
    v_mfma_f32_16x16x32_bf16 v[204:207], a[168:171], a[108:111], v[204:207]
    s_waitcnt vmcnt(8)
    s_barrier
    v_mfma_f32_16x16x32_bf16 v[208:211], a[172:175], a[96:99], v[208:211]
    ds_read_b64_tr_b16 a[168:169], v17 offset:28672
    ds_read_b64_tr_b16 a[170:171], v17 offset:29184
    v_mfma_f32_16x16x32_bf16 v[212:215], a[172:175], a[100:103], v[212:215]
    v_mfma_f32_16x16x32_bf16 v[216:219], a[172:175], a[104:107], v[216:219]
    v_mfma_f32_16x16x32_bf16 v[220:223], a[172:175], a[108:111], v[220:223]
    v_mfma_f32_16x16x32_bf16 v[224:227], a[176:179], a[96:99], v[224:227]
    ds_read_b64_tr_b16 a[172:173], v18 offset:28672
    ds_read_b64_tr_b16 a[174:175], v18 offset:29184
    v_mfma_f32_16x16x32_bf16 v[228:231], a[176:179], a[100:103], v[228:231]
    v_mfma_f32_16x16x32_bf16 v[232:235], a[176:179], a[104:107], v[232:235]
    v_mfma_f32_16x16x32_bf16 v[236:239], a[176:179], a[108:111], v[236:239]
    s_waitcnt vmcnt(10)
    s_waitcnt lgkmcnt(0)
    v_mfma_f32_16x16x32_bf16 v[112:115], a[148:151], a[112:115], v[112:115]
    ds_read_b64_tr_b16 a[176:177], v19 offset:28672
    ds_read_b64_tr_b16 a[178:179], v19 offset:29184
    v_mfma_f32_16x16x32_bf16 v[128:131], a[152:155], a[112:115], v[128:131]
    ds_read_b128 a[180:183], v24 offset:16384
    v_mfma_f32_16x16x32_bf16 v[144:147], a[156:159], a[112:115], v[144:147]
    ds_read_b128 a[196:199], v24 offset:18432
    v_mfma_f32_16x16x32_bf16 v[160:163], a[160:163], a[112:115], v[160:163]
    ds_read_b128 a[184:187], v25 offset:16384
    v_mfma_f32_16x16x32_bf16 v[176:179], a[164:167], a[112:115], v[176:179]
    ds_read_b128 a[200:203], v25 offset:18432
    v_mfma_f32_16x16x32_bf16 v[192:195], a[168:171], a[112:115], v[192:195]
    ds_read_b128 a[188:191], v24 offset:24576
    v_mfma_f32_16x16x32_bf16 v[208:211], a[172:175], a[112:115], v[208:211]
    ds_read_b128 a[204:207], v24 offset:26624
    s_waitcnt lgkmcnt(6)
    v_mfma_f32_16x16x32_bf16 v[224:227], a[176:179], a[112:115], v[224:227]
    ds_read_b128 a[192:195], v25 offset:24576
    v_mfma_f32_16x16x32_bf16 v[116:119], a[148:151], a[116:119], v[116:119]
    ds_read_b128 a[208:211], v25 offset:26624
    v_mfma_f32_16x16x32_bf16 v[132:135], a[152:155], a[116:119], v[132:135]
    ds_read_b128 a[212:215], v24 offset:20480
    v_mfma_f32_16x16x32_bf16 v[148:151], a[156:159], a[116:119], v[148:151]
    v_cvt_pk_bf16_f32 v240, v112, v113
    v_cvt_pk_bf16_f32 v242, v128, v129
    v_mfma_f32_16x16x32_bf16 v[164:167], a[160:163], a[116:119], v[164:167]
    v_cvt_pk_bf16_f32 v241, v114, v115
    v_cvt_pk_bf16_f32 v243, v130, v131
    v_mfma_f32_16x16x32_bf16 v[180:183], a[164:167], a[116:119], v[180:183]
    v_cvt_pk_bf16_f32 v244, v144, v145
    v_cvt_pk_bf16_f32 v246, v160, v161
    v_mfma_f32_16x16x32_bf16 v[196:199], a[168:171], a[116:119], v[196:199]
    v_cvt_pk_bf16_f32 v245, v146, v147
    v_cvt_pk_bf16_f32 v247, v162, v163
    v_mfma_f32_16x16x32_bf16 v[212:215], a[172:175], a[116:119], v[212:215]
    v_permlane32_swap_b32 v240, v242
    v_permlane32_swap_b32 v241, v243
    v_mfma_f32_16x16x32_bf16 v[228:231], a[176:179], a[116:119], v[228:231]
    v_permlane32_swap_b32 v244, v246
    ds_read_b128 a[228:231], v24 offset:22528
    v_mfma_f32_16x16x32_bf16 v[120:123], a[148:151], a[120:123], v[120:123]
    v_permlane32_swap_b32 v245, v247
    v_permlane16_swap_b32 v240, v242
    v_mfma_f32_16x16x32_bf16 v[136:139], a[152:155], a[120:123], v[136:139]
    v_permlane16_swap_b32 v241, v243
    ds_read_b128 a[216:219], v25 offset:20480
    v_mfma_f32_16x16x32_bf16 v[152:155], a[156:159], a[120:123], v[152:155]
    v_permlane16_swap_b32 v244, v246
    v_permlane16_swap_b32 v245, v247
    v_mfma_f32_16x16x32_bf16 v[168:171], a[160:163], a[120:123], v[168:171]
    ds_read_b128 a[232:235], v25 offset:22528
    v_accvgpr_write_b32 a64, v240
    v_mfma_f32_16x16x32_bf16 v[184:187], a[164:167], a[120:123], v[184:187]
    v_accvgpr_write_b32 a66, v242
    ds_read_b128 a[220:223], v24 offset:28672
    v_mfma_f32_16x16x32_bf16 v[200:203], a[168:171], a[120:123], v[200:203]
    v_accvgpr_write_b32 a65, v241
    v_accvgpr_write_b32 a67, v243
    v_accvgpr_write_b32 a68, v244
    ds_read_b128 a[236:239], v24 offset:30720
    v_mfma_f32_16x16x32_bf16 v[216:219], a[172:175], a[120:123], v[216:219]
    v_accvgpr_write_b32 a70, v246
    v_accvgpr_write_b32 a69, v245
    ds_read_b128 a[224:227], v25 offset:28672
    v_mfma_f32_16x16x32_bf16 v[232:235], a[176:179], a[120:123], v[232:235]
    v_accvgpr_write_b32 a71, v247
    v_cvt_pk_bf16_f32 v240, v176, v177
    ds_read_b128 a[240:243], v25 offset:30720
    v_mfma_f32_16x16x32_bf16 v[124:127], a[148:151], a[124:127], v[124:127]
    v_cvt_pk_bf16_f32 v242, v192, v193
    v_cvt_pk_bf16_f32 v241, v178, v179
    v_mfma_f32_16x16x32_bf16 v[140:143], a[152:155], a[124:127], v[140:143]
    v_cvt_pk_bf16_f32 v243, v194, v195
    v_cvt_pk_bf16_f32 v244, v208, v209
    v_cvt_pk_bf16_f32 v246, v224, v225
    v_mfma_f32_16x16x32_bf16 v[156:159], a[156:159], a[124:127], v[156:159]
    v_cvt_pk_bf16_f32 v245, v210, v211
    v_cvt_pk_bf16_f32 v247, v226, v227
    v_mfma_f32_16x16x32_bf16 v[172:175], a[160:163], a[124:127], v[172:175]
    v_permlane32_swap_b32 v240, v242
    v_permlane32_swap_b32 v241, v243
    v_mfma_f32_16x16x32_bf16 v[188:191], a[164:167], a[124:127], v[188:191]
    v_permlane32_swap_b32 v244, v246
    v_permlane32_swap_b32 v245, v247
    v_permlane16_swap_b32 v240, v242
    v_mfma_f32_16x16x32_bf16 v[204:207], a[168:171], a[124:127], v[204:207]
    v_permlane16_swap_b32 v241, v243
    v_permlane16_swap_b32 v244, v246
    v_mfma_f32_16x16x32_bf16 v[220:223], a[172:175], a[124:127], v[220:223]
    v_permlane16_swap_b32 v245, v247
    v_accvgpr_write_b32 a72, v240
    v_mfma_f32_16x16x32_bf16 v[236:239], a[176:179], a[124:127], v[236:239]
    v_accvgpr_write_b32 a74, v242
    v_accvgpr_write_b32 a73, v241
    v_accvgpr_write_b32 a75, v243
    v_accvgpr_write_b32 a76, v244
    v_accvgpr_write_b32 a78, v246
    v_accvgpr_write_b32 a77, v245
    v_accvgpr_write_b32 a79, v247
    v_lshlrev_b32 v250, 2, v1
    s_mov_b32 s41, 746496
    buffer_load_dword v3, v250, s[16:19], s41 offen sc1
    s_lshl_b32 s6, s3, 13
    s_add_u32 s6, s6, 131072
    s_waitcnt lgkmcnt(0)
    v_mfma_f32_16x16x32_bf16 v[48:51], a[180:183], a[64:67], 0
    v_cvt_pk_bf16_f32 v240, v116, v117
    v_cvt_pk_bf16_f32 v242, v132, v133
    v_mfma_f32_16x16x32_bf16 v[52:55], a[196:199], a[64:67], 0
    v_cvt_pk_bf16_f32 v241, v118, v119
    v_cvt_pk_bf16_f32 v243, v134, v135
    v_mfma_f32_16x16x32_bf16 v[80:83], a[212:215], a[64:67], 0
    v_cvt_pk_bf16_f32 v244, v148, v149
    v_cvt_pk_bf16_f32 v246, v164, v165
    v_mfma_f32_16x16x32_bf16 v[84:87], a[228:231], a[64:67], 0
    v_cvt_pk_bf16_f32 v245, v150, v151
    v_cvt_pk_bf16_f32 v247, v166, v167
    v_mfma_f32_16x16x32_bf16 v[48:51], a[184:187], a[68:71], v[48:51]
    s_add_u32 m0, s37, s35
    v_permlane32_swap_b32 v240, v242
    v_mfma_f32_16x16x32_bf16 v[52:55], a[200:203], a[68:71], v[52:55]
    v_permlane32_swap_b32 v241, v243
    v_permlane32_swap_b32 v244, v246
    v_mfma_f32_16x16x32_bf16 v[80:83], a[216:219], a[68:71], v[80:83]
    v_permlane32_swap_b32 v245, v247
    v_permlane16_swap_b32 v240, v242
    v_mfma_f32_16x16x32_bf16 v[84:87], a[232:235], a[68:71], v[84:87]
    v_permlane16_swap_b32 v241, v243
    v_permlane16_swap_b32 v244, v246
    v_mfma_f32_16x16x32_bf16 v[48:51], a[188:191], a[72:75], v[48:51]
    v_permlane16_swap_b32 v245, v247
    s_nop 0
    v_accvgpr_write_b32 a80, v240
    v_mfma_f32_16x16x32_bf16 v[52:55], a[204:207], a[72:75], v[52:55]
    v_accvgpr_write_b32 a82, v242
    v_accvgpr_write_b32 a81, v241
    v_accvgpr_write_b32 a83, v243
    v_accvgpr_write_b32 a84, v244
    v_mfma_f32_16x16x32_bf16 v[80:83], a[220:223], a[72:75], v[80:83]
    v_accvgpr_write_b32 a86, v246
    v_accvgpr_write_b32 a85, v245
    v_accvgpr_write_b32 a87, v247
    buffer_load_dwordx4 v4, s[8:11], s32 offen offset:0 nt lds
    v_mfma_f32_16x16x32_bf16 v[84:87], a[236:239], a[72:75], v[84:87]
    v_cvt_pk_bf16_f32 v240, v180, v181
    v_cvt_pk_bf16_f32 v242, v196, v197
    v_cvt_pk_bf16_f32 v241, v182, v183
    v_mfma_f32_16x16x32_bf16 v[48:51], a[192:195], a[76:79], v[48:51]
    v_cvt_pk_bf16_f32 v243, v198, v199
    v_cvt_pk_bf16_f32 v244, v212, v213
    v_cvt_pk_bf16_f32 v246, v228, v229
    v_cvt_pk_bf16_f32 v245, v214, v215
    v_mfma_f32_16x16x32_bf16 v[52:55], a[208:211], a[76:79], v[52:55]
    v_cvt_pk_bf16_f32 v247, v230, v231
    buffer_load_dwordx4 v5, s[8:11], s32 offen offset:1024 nt lds
    v_permlane32_swap_b32 v240, v242
    v_mfma_f32_16x16x32_bf16 v[80:83], a[224:227], a[76:79], v[80:83]
    v_permlane32_swap_b32 v241, v243
    v_permlane32_swap_b32 v244, v246
    v_permlane32_swap_b32 v245, v247
    v_permlane16_swap_b32 v240, v242
    v_mfma_f32_16x16x32_bf16 v[84:87], a[240:243], a[76:79], v[84:87]
    v_permlane16_swap_b32 v241, v243
    v_permlane16_swap_b32 v244, v246
    v_permlane16_swap_b32 v245, v247
    buffer_load_dwordx4 v6, s[8:11], s32 offen offset:2048 nt lds
    v_accvgpr_write_b32 a88, v240
    v_accvgpr_write_b32 a90, v242
    v_accvgpr_write_b32 a89, v241
    v_accvgpr_write_b32 a91, v243
    v_accvgpr_write_b32 a92, v244
    v_accvgpr_write_b32 a94, v246
    v_accvgpr_write_b32 a93, v245
    v_accvgpr_write_b32 a95, v247
    buffer_load_dwordx4 v7, s[8:11], s32 offen offset:3072 nt lds
    v_mfma_f32_16x16x32_bf16 v[56:59], a[180:183], a[80:83], 0
    v_cvt_pk_bf16_f32 v240, v120, v121
    v_cvt_pk_bf16_f32 v242, v136, v137
    v_mfma_f32_16x16x32_bf16 v[60:63], a[196:199], a[80:83], 0
    v_cvt_pk_bf16_f32 v241, v122, v123
    v_cvt_pk_bf16_f32 v243, v138, v139
    v_mfma_f32_16x16x32_bf16 v[88:91], a[212:215], a[80:83], 0
    v_cvt_pk_bf16_f32 v244, v152, v153
    v_cvt_pk_bf16_f32 v246, v168, v169
    v_mfma_f32_16x16x32_bf16 v[92:95], a[228:231], a[80:83], 0
    v_cvt_pk_bf16_f32 v245, v154, v155
    v_cvt_pk_bf16_f32 v247, v170, v171
    v_mfma_f32_16x16x32_bf16 v[56:59], a[184:187], a[84:87], v[56:59]
    v_permlane32_swap_b32 v240, v242
    v_permlane32_swap_b32 v241, v243
    v_mfma_f32_16x16x32_bf16 v[60:63], a[200:203], a[84:87], v[60:63]
    v_permlane32_swap_b32 v244, v246
    v_permlane32_swap_b32 v245, v247
    v_permlane16_swap_b32 v240, v242
    v_permlane16_swap_b32 v241, v243
    v_permlane16_swap_b32 v244, v246
    v_mfma_f32_16x16x32_bf16 v[88:91], a[216:219], a[84:87], v[88:91]
    s_add_u32 m0, s37, s36
    v_permlane16_swap_b32 v245, v247
    v_accvgpr_write_b32 a96, v240
    v_accvgpr_write_b32 a98, v242
    v_accvgpr_write_b32 a97, v241
    v_accvgpr_write_b32 a99, v243
    v_accvgpr_write_b32 a100, v244
    v_mfma_f32_16x16x32_bf16 v[92:95], a[232:235], a[84:87], v[92:95]
    v_accvgpr_write_b32 a102, v246
    v_accvgpr_write_b32 a101, v245
    v_accvgpr_write_b32 a103, v247
    v_cvt_pk_bf16_f32 v240, v184, v185
    v_cvt_pk_bf16_f32 v242, v200, v201
    v_cvt_pk_bf16_f32 v241, v186, v187
    v_cvt_pk_bf16_f32 v243, v202, v203
    v_cvt_pk_bf16_f32 v244, v216, v217
    v_mfma_f32_16x16x32_bf16 v[56:59], a[188:191], a[88:91], v[56:59]
    v_cvt_pk_bf16_f32 v246, v232, v233
    s_nop 0
    v_cvt_pk_bf16_f32 v245, v218, v219
    v_cvt_pk_bf16_f32 v247, v234, v235
    v_permlane32_swap_b32 v240, v242
    v_permlane32_swap_b32 v241, v243
    v_permlane32_swap_b32 v244, v246
    v_mfma_f32_16x16x32_bf16 v[60:63], a[204:207], a[88:91], v[60:63]
    v_permlane32_swap_b32 v245, v247
    v_permlane16_swap_b32 v240, v242
    v_permlane16_swap_b32 v241, v243
    v_permlane16_swap_b32 v244, v246
    v_permlane16_swap_b32 v245, v247
    v_accvgpr_write_b32 a104, v240
    v_accvgpr_write_b32 a106, v242
    v_mfma_f32_16x16x32_bf16 v[88:91], a[220:223], a[88:91], v[88:91]
    v_accvgpr_write_b32 a105, v241
    v_accvgpr_write_b32 a107, v243
    v_accvgpr_write_b32 a108, v244
    buffer_load_dwordx4 v8, s[12:15], s33 offen offset:0 nt lds
    v_accvgpr_write_b32 a110, v246
    v_accvgpr_write_b32 a109, v245
    v_accvgpr_write_b32 a111, v247
    v_mfma_f32_16x16x32_bf16 v[92:95], a[236:239], a[88:91], v[92:95]
    v_max3_f32 v248, v48, v49, v50
    v_max3_f32 v249, v51, v52, v53
    v_max3_f32 v248, v248, v54, v55
    v_max3_f32 v249, v249, v80, v81
    v_max3_f32 v248, v248, v82, v83
    v_max3_f32 v249, v249, v84, v85
    v_max3_f32 v248, v248, v86, v87
    v_mfma_f32_16x16x32_bf16 v[56:59], a[192:195], a[92:95], v[56:59]
    v_max_f32 v248, v248, v249
    v_mov_b32 v249, v248
    s_nop 1
    v_permlane16_swap_b32 v248, v249
    s_nop 0
    buffer_load_dwordx4 v9, s[12:15], s33 offen offset:1024 nt lds
    v_mfma_f32_16x16x32_bf16 v[60:63], a[208:211], a[92:95], v[60:63]
    v_max_f32 v248, v248, v249
    v_mov_b32 v249, v248
    s_nop 1
    v_permlane32_swap_b32 v248, v249
    s_nop 0
    v_max_f32 v248, v248, v249
    v_mfma_f32_16x16x32_bf16 v[88:91], a[224:227], a[92:95], v[88:91]
    v_sub_f32 v32, 0, v248
    v_sub_f32 v33, 0, v248
    v_sub_f32 v34, 0, v248
    v_sub_f32 v35, 0, v248
    v_pk_add_f32 v[48:49], v[48:49], v[32:33]
    v_pk_add_f32 v[50:51], v[50:51], v[32:33]
    v_pk_add_f32 v[52:53], v[52:53], v[32:33]
    v_mfma_f32_16x16x32_bf16 v[92:95], a[240:243], a[92:95], v[92:95]
    v_pk_add_f32 v[54:55], v[54:55], v[32:33]
    v_pk_add_f32 v[80:81], v[80:81], v[32:33]
    buffer_load_dwordx4 v10, s[12:15], s33 offen offset:2048 nt lds
    v_pk_add_f32 v[82:83], v[82:83], v[32:33]
    v_pk_add_f32 v[84:85], v[84:85], v[32:33]
    v_pk_add_f32 v[86:87], v[86:87], v[32:33]
    v_exp_f32 v48, v48
    v_exp_f32 v49, v49
    v_exp_f32 v50, v50
    v_exp_f32 v51, v51
    v_cvt_pk_bf16_f32 v48, v48, v49
    v_exp_f32 v52, v52
    v_exp_f32 v53, v53
    v_cvt_pk_bf16_f32 v49, v50, v51
    v_exp_f32 v54, v54
    v_exp_f32 v55, v55
    v_cvt_pk_bf16_f32 v50, v52, v53
    s_nop 0
    buffer_load_dwordx4 v11, s[12:15], s33 offen offset:3072 nt lds
    v_cvt_pk_bf16_f32 v51, v54, v55
    v_mfma_f32_16x16x32_bf16 v[64:67], a[180:183], a[96:99], 0
    v_cvt_pk_bf16_f32 v240, v124, v125
    v_cvt_pk_bf16_f32 v242, v140, v141
    v_mfma_f32_16x16x32_bf16 v[68:71], a[196:199], a[96:99], 0
    v_cvt_pk_bf16_f32 v241, v126, v127
    v_cvt_pk_bf16_f32 v243, v142, v143
    v_mfma_f32_16x16x32_bf16 v[96:99], a[212:215], a[96:99], 0
    v_cvt_pk_bf16_f32 v244, v156, v157
    v_cvt_pk_bf16_f32 v246, v172, v173
    v_mfma_f32_16x16x32_bf16 v[100:103], a[228:231], a[96:99], 0
    v_cvt_pk_bf16_f32 v245, v158, v159
    v_cvt_pk_bf16_f32 v247, v174, v175
    v_mfma_f32_16x16x32_bf16 v[64:67], a[184:187], a[100:103], v[64:67]
    v_permlane32_swap_b32 v240, v242
    v_permlane32_swap_b32 v241, v243
    v_mfma_f32_16x16x32_bf16 v[68:71], a[200:203], a[100:103], v[68:71]
    v_permlane32_swap_b32 v244, v246
    v_permlane32_swap_b32 v245, v247
    v_permlane16_swap_b32 v240, v242
    v_permlane16_swap_b32 v241, v243
    v_mfma_f32_16x16x32_bf16 v[96:99], a[216:219], a[100:103], v[96:99]
    v_permlane16_swap_b32 v244, v246
    s_add_u32 s32, s32, s34
    v_permlane16_swap_b32 v245, v247
    v_accvgpr_write_b32 a112, v240
    v_accvgpr_write_b32 a114, v242
    v_accvgpr_write_b32 a113, v241
    v_accvgpr_write_b32 a115, v243
    v_mfma_f32_16x16x32_bf16 v[100:103], a[232:235], a[100:103], v[100:103]
    v_accvgpr_write_b32 a116, v244
    v_accvgpr_write_b32 a118, v246
    v_accvgpr_write_b32 a117, v245
    v_accvgpr_write_b32 a119, v247
    v_cvt_pk_bf16_f32 v240, v188, v189
    v_cvt_pk_bf16_f32 v242, v204, v205
    v_cvt_pk_bf16_f32 v241, v190, v191
    v_cvt_pk_bf16_f32 v243, v206, v207
    v_mfma_f32_16x16x32_bf16 v[64:67], a[188:191], a[104:107], v[64:67]
    v_cvt_pk_bf16_f32 v244, v220, v221
    v_cvt_pk_bf16_f32 v246, v236, v237
    s_add_u32 s33, s33, s34
    v_cvt_pk_bf16_f32 v245, v222, v223
    v_cvt_pk_bf16_f32 v247, v238, v239
    v_permlane32_swap_b32 v240, v242
    v_permlane32_swap_b32 v241, v243
    v_mfma_f32_16x16x32_bf16 v[68:71], a[204:207], a[104:107], v[68:71]
    v_permlane32_swap_b32 v244, v246
    v_permlane32_swap_b32 v245, v247
    v_permlane16_swap_b32 v240, v242
    v_permlane16_swap_b32 v241, v243
    v_permlane16_swap_b32 v244, v246
    v_permlane16_swap_b32 v245, v247
    v_accvgpr_write_b32 a120, v240
    v_mfma_f32_16x16x32_bf16 v[96:99], a[220:223], a[104:107], v[96:99]
    v_accvgpr_write_b32 a122, v242
    v_accvgpr_write_b32 a121, v241
    v_accvgpr_write_b32 a123, v243
    v_accvgpr_write_b32 a124, v244
    s_add_u32 s37, s37, 0x8000
    v_accvgpr_write_b32 a126, v246
    v_accvgpr_write_b32 a125, v245
    v_mfma_f32_16x16x32_bf16 v[100:103], a[236:239], a[104:107], v[100:103]
    v_accvgpr_write_b32 a127, v247
    v_max3_f32 v248, v56, v57, v58
    v_max3_f32 v249, v59, v60, v61
    v_max3_f32 v248, v248, v62, v63
    v_max3_f32 v249, v249, v88, v89
    v_max3_f32 v248, v248, v90, v91
    v_max3_f32 v249, v249, v92, v93
    v_mfma_f32_16x16x32_bf16 v[64:67], a[192:195], a[108:111], v[64:67]
    v_max3_f32 v248, v248, v94, v95
    v_max_f32 v248, v248, v249
    v_mov_b32 v249, v248
    s_nop 1
    v_permlane16_swap_b32 v248, v249
    s_nop 0
    v_mfma_f32_16x16x32_bf16 v[68:71], a[208:211], a[108:111], v[68:71]
    s_and_b32 s37, s37, 0x1ffff
    v_max_f32 v248, v248, v249
    v_mov_b32 v249, v248
    s_nop 1
    v_permlane32_swap_b32 v248, v249
    s_nop 0
    v_mfma_f32_16x16x32_bf16 v[96:99], a[224:227], a[108:111], v[96:99]
    v_max_f32 v248, v248, v249
    v_sub_f32 v36, 0, v248
    v_sub_f32 v37, 0, v248
    v_sub_f32 v38, 0, v248
    v_sub_f32 v39, 0, v248
    v_pk_add_f32 v[56:57], v[56:57], v[36:37]
    v_pk_add_f32 v[58:59], v[58:59], v[36:37]
    v_mfma_f32_16x16x32_bf16 v[100:103], a[240:243], a[108:111], v[100:103]
    v_pk_add_f32 v[60:61], v[60:61], v[36:37]
    v_pk_add_f32 v[62:63], v[62:63], v[36:37]
    v_pk_add_f32 v[88:89], v[88:89], v[36:37]
    s_add_u32 m0, s6, 0
    v_pk_add_f32 v[90:91], v[90:91], v[36:37]
    v_pk_add_f32 v[92:93], v[92:93], v[36:37]
    v_pk_add_f32 v[94:95], v[94:95], v[36:37]
    v_exp_f32 v56, v56
    v_exp_f32 v57, v57
    v_exp_f32 v58, v58
    v_exp_f32 v59, v59
    v_cvt_pk_bf16_f32 v56, v56, v57
    v_exp_f32 v60, v60
    v_exp_f32 v61, v61
    v_cvt_pk_bf16_f32 v57, v58, v59
    v_exp_f32 v62, v62
    v_exp_f32 v63, v63
    v_cvt_pk_bf16_f32 v58, v60, v61
    s_nop 0
    s_nop 0
    v_cvt_pk_bf16_f32 v59, v62, v63
    v_mfma_f32_16x16x32_bf16 v[72:75], a[180:183], a[112:115], 0
    v_max3_f32 v248, v64, v65, v66
    v_max3_f32 v249, v67, v68, v69
    v_mfma_f32_16x16x32_bf16 v[76:79], a[196:199], a[112:115], 0
    v_max3_f32 v248, v248, v70, v71
    v_max3_f32 v249, v249, v96, v97
    v_mfma_f32_16x16x32_bf16 v[104:107], a[212:215], a[112:115], 0
    v_max3_f32 v248, v248, v98, v99
    v_max3_f32 v249, v249, v100, v101
    v_mfma_f32_16x16x32_bf16 v[108:111], a[228:231], a[112:115], 0
    buffer_load_dwordx4 v252, s[64:67], s45 offen offset:0 nt lds
    v_mfma_f32_16x16x32_bf16 v[72:75], a[184:187], a[116:119], v[72:75]
    v_max3_f32 v248, v248, v102, v103
    v_max_f32 v248, v248, v249
    v_mfma_f32_16x16x32_bf16 v[76:79], a[200:203], a[116:119], v[76:79]
    v_mov_b32 v249, v248
    v_mfma_f32_16x16x32_bf16 v[104:107], a[216:219], a[116:119], v[104:107]
    s_nop 1
    v_mfma_f32_16x16x32_bf16 v[108:111], a[232:235], a[116:119], v[108:111]
    v_permlane16_swap_b32 v248, v249
    s_nop 0
    s_add_u32 s45, s45, 9216
    v_max_f32 v248, v248, v249
    v_mfma_f32_16x16x32_bf16 v[72:75], a[188:191], a[120:123], v[72:75]
    v_mov_b32 v249, v248
    s_nop 1
    v_permlane32_swap_b32 v248, v249
    v_mfma_f32_16x16x32_bf16 v[76:79], a[204:207], a[120:123], v[76:79]
    s_nop 0
    v_max_f32 v248, v248, v249
    buffer_load_dwordx4 v252, s[64:67], s45 offen offset:1024 nt lds
    v_sub_f32 v40, 0, v248
    v_mfma_f32_16x16x32_bf16 v[104:107], a[220:223], a[120:123], v[104:107]
    v_sub_f32 v41, 0, v248
    v_sub_f32 v42, 0, v248
    v_sub_f32 v43, 0, v248
    v_pk_add_f32 v[64:65], v[64:65], v[40:41]
    v_mfma_f32_16x16x32_bf16 v[108:111], a[236:239], a[120:123], v[108:111]
    v_pk_add_f32 v[66:67], v[66:67], v[40:41]
    s_add_u32 s45, s45, 9216
    v_pk_add_f32 v[68:69], v[68:69], v[40:41]
    v_pk_add_f32 v[70:71], v[70:71], v[40:41]
    v_mfma_f32_16x16x32_bf16 v[72:75], a[192:195], a[124:127], v[72:75]
    v_pk_add_f32 v[96:97], v[96:97], v[40:41]
    v_pk_add_f32 v[98:99], v[98:99], v[40:41]
    v_pk_add_f32 v[100:101], v[100:101], v[40:41]
    v_pk_add_f32 v[102:103], v[102:103], v[40:41]
    v_mfma_f32_16x16x32_bf16 v[76:79], a[208:211], a[124:127], v[76:79]
    buffer_load_dwordx4 v252, s[64:67], s45 offen offset:2048 nt lds
    v_exp_f32 v64, v64
    v_mfma_f32_16x16x32_bf16 v[104:107], a[224:227], a[124:127], v[104:107]
    v_exp_f32 v65, v65
    v_exp_f32 v66, v66
    v_mfma_f32_16x16x32_bf16 v[108:111], a[240:243], a[124:127], v[108:111]
    v_exp_f32 v67, v67
    v_cvt_pk_bf16_f32 v64, v64, v65
    v_exp_f32 v68, v68
    s_add_u32 s45, s45, 9216
    v_exp_f32 v69, v69
    v_cvt_pk_bf16_f32 v65, v66, v67
    v_exp_f32 v70, v70
    v_exp_f32 v71, v71
    v_cvt_pk_bf16_f32 v66, v68, v69
    s_nop 0
    buffer_load_dwordx4 v252, s[64:67], s45 offen offset:3072 nt lds
    v_cvt_pk_bf16_f32 v67, v70, v71
    s_mov_b32 s38, 0x10000
    v_add_u32 v12, s38, v20
    v_add_u32 v13, s38, v21
    v_add_u32 v14, s38, v22
    v_add_u32 v15, s38, v23
    v_add_u32 v24, s38, v26
    v_add_u32 v25, s38, v27
    s_add_u32 s38, s38, 0x8000
    s_and_b32 s38, s38, 0x1ffff
    s_waitcnt vmcnt(13)
    s_barrier
    ds_read_b64_tr_b16 a[148:149], v12 offset:0
    ds_read_b64_tr_b16 a[150:151], v12 offset:2048
    ds_read_b64_tr_b16 a[152:153], v13 offset:0
    ds_read_b64_tr_b16 a[154:155], v13 offset:2048
    ds_read_b64_tr_b16 a[156:157], v14 offset:0
    ds_read_b64_tr_b16 a[158:159], v14 offset:2048
    ds_read_b64_tr_b16 a[160:161], v15 offset:0
    ds_read_b64_tr_b16 a[162:163], v15 offset:2048
    ds_read_b64_tr_b16 a[164:165], v12 offset:8192
    ds_read_b64_tr_b16 a[166:167], v12 offset:10240
    ds_read_b64_tr_b16 a[168:169], v13 offset:8192
    ds_read_b64_tr_b16 a[170:171], v13 offset:10240
    ds_read_b64_tr_b16 a[172:173], v14 offset:8192
    ds_read_b64_tr_b16 a[174:175], v14 offset:10240
    v_mfma_f32_32x32x16_bf16 v[112:127], a[244:247], a[244:247], 0
    v_max3_f32 v248, v72, v73, v74
    v_max3_f32 v249, v75, v76, v77
    v_max3_f32 v248, v248, v78, v79
    v_max3_f32 v249, v249, v104, v105
    v_max3_f32 v248, v248, v106, v107
    v_mfma_f32_32x32x16_bf16 v[128:143], a[244:247], a[244:247], 0
    v_max3_f32 v249, v249, v108, v109
    v_max3_f32 v248, v248, v110, v111
    v_max_f32 v248, v248, v249
    v_mov_b32 v249, v248
    s_nop 1
    v_mfma_f32_32x32x16_bf16 v[144:159], a[244:247], a[244:247], 0
    v_permlane16_swap_b32 v248, v249
    s_nop 0
    v_max_f32 v248, v248, v249
    v_mov_b32 v249, v248
    s_nop 1
    v_mfma_f32_32x32x16_bf16 v[160:175], a[244:247], a[244:247], 0
    v_permlane32_swap_b32 v248, v249
    s_nop 0
    v_max_f32 v248, v248, v249
    v_sub_f32 v44, 0, v248
    v_sub_f32 v45, 0, v248
    v_mfma_f32_32x32x16_bf16 v[176:191], a[244:247], a[244:247], 0
    v_sub_f32 v46, 0, v248
    v_sub_f32 v47, 0, v248
    v_pk_add_f32 v[72:73], v[72:73], v[44:45]
    v_pk_add_f32 v[74:75], v[74:75], v[44:45]
    v_pk_add_f32 v[76:77], v[76:77], v[44:45]
    v_mfma_f32_32x32x16_bf16 v[192:207], a[244:247], a[244:247], 0
    v_pk_add_f32 v[78:79], v[78:79], v[44:45]
    v_pk_add_f32 v[104:105], v[104:105], v[44:45]
    v_pk_add_f32 v[106:107], v[106:107], v[44:45]
    v_pk_add_f32 v[108:109], v[108:109], v[44:45]
    v_pk_add_f32 v[110:111], v[110:111], v[44:45]
    v_mfma_f32_32x32x16_bf16 v[208:223], a[244:247], a[244:247], 0
    v_exp_f32 v72, v72
    v_exp_f32 v73, v73
    v_exp_f32 v74, v74
    v_exp_f32 v75, v75
    v_cvt_pk_bf16_f32 v72, v72, v73
    v_mfma_f32_32x32x16_bf16 v[224:239], a[244:247], a[244:247], 0
    v_exp_f32 v76, v76
    v_exp_f32 v77, v77
    v_cvt_pk_bf16_f32 v73, v74, v75
    v_exp_f32 v78, v78
    v_exp_f32 v79, v79
    v_cvt_pk_bf16_f32 v74, v76, v77
    s_nop 0
    v_cvt_pk_bf16_f32 v75, v78, v79
    s_mov_b32 s40, 0
    s_waitcnt lgkmcnt(6)
    v_mfma_f32_16x16x32_bf16 v[112:115], a[148:151], v[48:51], v[112:115]
    ds_read_b64_tr_b16 a[176:177], v15 offset:8192
    ds_read_b64_tr_b16 a[178:179], v15 offset:10240
    v_mfma_f32_16x16x32_bf16 v[116:119], a[148:151], v[56:59], v[116:119]
    v_exp_f32 v80, v80
    v_mfma_f32_16x16x32_bf16 v[120:123], a[148:151], v[64:67], v[120:123]
    v_exp_f32 v81, v81
    v_mfma_f32_16x16x32_bf16 v[124:127], a[148:151], v[72:75], v[124:127]
    s_add_u32 m0, s37, s35
    v_add_u32 v16, s6, v20
    v_mfma_f32_16x16x32_bf16 v[128:131], a[152:155], v[48:51], v[128:131]
    ds_read_b128 a[148:151], v24 offset:16384
    v_add_u32 v17, s6, v21
    v_mfma_f32_16x16x32_bf16 v[132:135], a[152:155], v[56:59], v[132:135]
    v_exp_f32 v82, v82
    v_mfma_f32_16x16x32_bf16 v[136:139], a[152:155], v[64:67], v[136:139]
    buffer_load_dwordx4 v4, s[8:11], s32 offen offset:0 nt lds
    v_mfma_f32_16x16x32_bf16 v[140:143], a[152:155], v[72:75], v[140:143]
    v_exp_f32 v83, v83
    v_mfma_f32_16x16x32_bf16 v[144:147], a[156:159], v[48:51], v[144:147]
    ds_read_b128 a[152:155], v24 offset:18432
    v_cvt_pk_bf16_f32 v80, v80, v81
    v_mfma_f32_16x16x32_bf16 v[148:151], a[156:159], v[56:59], v[148:151]
    v_exp_f32 v84, v84
    v_mfma_f32_16x16x32_bf16 v[152:155], a[156:159], v[64:67], v[152:155]
    v_exp_f32 v85, v85
    v_mfma_f32_16x16x32_bf16 v[156:159], a[156:159], v[72:75], v[156:159]
    buffer_load_dwordx4 v5, s[8:11], s32 offen offset:1024 nt lds
    v_mfma_f32_16x16x32_bf16 v[160:163], a[160:163], v[48:51], v[160:163]
    ds_read_b128 a[156:159], v25 offset:16384
    v_cvt_pk_bf16_f32 v81, v82, v83
    v_mfma_f32_16x16x32_bf16 v[164:167], a[160:163], v[56:59], v[164:167]
    v_exp_f32 v86, v86
    v_mfma_f32_16x16x32_bf16 v[168:171], a[160:163], v[64:67], v[168:171]
    v_exp_f32 v87, v87
    v_mfma_f32_16x16x32_bf16 v[172:175], a[160:163], v[72:75], v[172:175]
    v_cvt_pk_bf16_f32 v82, v84, v85
    s_waitcnt lgkmcnt(3)
    v_mfma_f32_16x16x32_bf16 v[176:179], a[164:167], v[48:51], v[176:179]
    ds_read_b128 a[160:163], v25 offset:18432
    v_add_u32 v18, s6, v22
    v_mfma_f32_16x16x32_bf16 v[180:183], a[164:167], v[56:59], v[180:183]
    v_exp_f32 v88, v88
    v_mfma_f32_16x16x32_bf16 v[184:187], a[164:167], v[64:67], v[184:187]
    buffer_load_dwordx4 v6, s[8:11], s32 offen offset:2048 nt lds
    v_mfma_f32_16x16x32_bf16 v[188:191], a[164:167], v[72:75], v[188:191]
    v_exp_f32 v89, v89
    v_mfma_f32_16x16x32_bf16 v[192:195], a[168:171], v[48:51], v[192:195]
    ds_read_b128 a[164:167], v24 offset:24576
    v_cvt_pk_bf16_f32 v83, v86, v87
    v_mfma_f32_16x16x32_bf16 v[196:199], a[168:171], v[56:59], v[196:199]
    v_exp_f32 v90, v90
    v_mfma_f32_16x16x32_bf16 v[200:203], a[168:171], v[64:67], v[200:203]
    v_exp_f32 v91, v91
    v_mfma_f32_16x16x32_bf16 v[204:207], a[168:171], v[72:75], v[204:207]
    buffer_load_dwordx4 v7, s[8:11], s32 offen offset:3072 nt lds
    v_mfma_f32_16x16x32_bf16 v[208:211], a[172:175], v[48:51], v[208:211]
    ds_read_b128 a[168:171], v24 offset:26624
    v_cvt_pk_bf16_f32 v88, v88, v89
    v_mfma_f32_16x16x32_bf16 v[212:215], a[172:175], v[56:59], v[212:215]
    v_exp_f32 v92, v92
    v_mfma_f32_16x16x32_bf16 v[216:219], a[172:175], v[64:67], v[216:219]
    v_exp_f32 v93, v93
    v_mfma_f32_16x16x32_bf16 v[220:223], a[172:175], v[72:75], v[220:223]
    v_cvt_pk_bf16_f32 v89, v90, v91
    s_add_u32 m0, s37, s36
    v_mfma_f32_16x16x32_bf16 v[224:227], a[176:179], v[48:51], v[224:227]
    v_exp_f32 v94, v94
    v_mfma_f32_16x16x32_bf16 v[228:231], a[176:179], v[56:59], v[228:231]
    buffer_load_dwordx4 v8, s[12:15], s33 offen offset:0 nt lds
    v_mfma_f32_16x16x32_bf16 v[232:235], a[176:179], v[64:67], v[232:235]
    ds_read_b128 a[172:175], v25 offset:24576
    v_add_u32 v19, s6, v23
    v_mfma_f32_16x16x32_bf16 v[236:239], a[176:179], v[72:75], v[236:239]
    v_exp_f32 v95, v95
    v_mfma_f32_16x16x32_bf16 a[128:131], a[144:147], v[48:51], a[128:131]
    v_cvt_pk_bf16_f32 v90, v92, v93
    v_mov_b32 v28, 0x70000000
    v_mfma_f32_16x16x32_bf16 a[132:135], a[144:147], v[56:59], a[132:135]
    v_exp_f32 v96, v96
    v_mfma_f32_16x16x32_bf16 a[136:139], a[144:147], v[64:67], a[136:139]
    v_exp_f32 v97, v97
    v_mfma_f32_16x16x32_bf16 a[140:143], a[144:147], v[72:75], a[140:143]
    v_cvt_pk_bf16_f32 v91, v94, v95
    s_waitcnt lgkmcnt(3)
    v_mfma_f32_16x16x32_bf16 v[48:51], a[148:151], a[64:67], v[32:35]
    ds_read_b128 a[176:179], v25 offset:26624
    v_cmp_eq_u32 vcc, 0, v1
    v_mfma_f32_16x16x32_bf16 v[56:59], a[148:151], a[80:83], v[36:39]
    buffer_load_dwordx4 v9, s[12:15], s33 offen offset:1024 nt lds
    v_mfma_f32_16x16x32_bf16 v[64:67], a[148:151], a[96:99], v[40:43]
    v_exp_f32 v98, v98
    v_mfma_f32_16x16x32_bf16 v[72:75], a[148:151], a[112:115], v[44:47]
    v_exp_f32 v99, v99
    v_mfma_f32_16x16x32_bf16 v[52:55], a[152:155], a[64:67], v[32:35]
    ds_read_b64_tr_b16 a[148:149], v12 offset:4096
    ds_read_b64_tr_b16 a[150:151], v12 offset:6144
    v_mfma_f32_16x16x32_bf16 v[60:63], a[152:155], a[80:83], v[36:39]
    v_cvt_pk_bf16_f32 v96, v96, v97
    v_mfma_f32_16x16x32_bf16 v[68:71], a[152:155], a[96:99], v[40:43]
    buffer_load_dwordx4 v10, s[12:15], s33 offen offset:2048 nt lds
    v_mfma_f32_16x16x32_bf16 v[76:79], a[152:155], a[112:115], v[44:47]
    v_exp_f32 v100, v100
    v_mfma_f32_16x16x32_bf16 v[48:51], a[156:159], a[68:71], v[48:51]
    v_cndmask_b32 v28, v28, v1, vcc
    ds_read_b64_tr_b16 a[152:153], v13 offset:4096
    v_mfma_f32_16x16x32_bf16 v[56:59], a[156:159], a[84:87], v[56:59]
    ds_read_b64_tr_b16 a[154:155], v13 offset:6144
    v_mfma_f32_16x16x32_bf16 v[64:67], a[156:159], a[100:103], v[64:67]
    v_exp_f32 v101, v101
    v_mfma_f32_16x16x32_bf16 v[72:75], a[156:159], a[116:119], v[72:75]
    v_cvt_pk_bf16_f32 v97, v98, v99
    v_mfma_f32_16x16x32_bf16 v[52:55], a[160:163], a[68:71], v[52:55]
    v_exp_f32 v102, v102
    v_mfma_f32_16x16x32_bf16 v[60:63], a[160:163], a[84:87], v[60:63]
    ds_read_b64_tr_b16 a[156:157], v14 offset:4096
    ds_read_b64_tr_b16 a[158:159], v14 offset:6144
    v_mfma_f32_16x16x32_bf16 v[68:71], a[160:163], a[100:103], v[68:71]
    buffer_load_dwordx4 v11, s[12:15], s33 offen offset:3072 nt lds
    v_mfma_f32_16x16x32_bf16 v[76:79], a[160:163], a[116:119], v[76:79]
    s_waitcnt lgkmcnt(6)
    v_mfma_f32_16x16x32_bf16 v[48:51], a[164:167], a[72:75], v[48:51]
    v_exp_f32 v103, v103
    v_mfma_f32_16x16x32_bf16 v[56:59], a[164:167], a[88:91], v[56:59]
    v_cvt_pk_bf16_f32 v98, v100, v101
    ds_read_b64_tr_b16 a[160:161], v15 offset:4096
    v_mfma_f32_16x16x32_bf16 v[64:67], a[164:167], a[104:107], v[64:67]
    v_exp_f32 v104, v104
    v_mfma_f32_16x16x32_bf16 v[72:75], a[164:167], a[120:123], v[72:75]
    ds_read_b64_tr_b16 a[162:163], v15 offset:6144
    s_add_u32 s32, s32, s34
    v_mfma_f32_16x16x32_bf16 v[52:55], a[168:171], a[72:75], v[52:55]
    v_exp_f32 v105, v105
    v_mfma_f32_16x16x32_bf16 v[60:63], a[168:171], a[88:91], v[60:63]
    v_cvt_pk_bf16_f32 v99, v102, v103
    ds_read_b64_tr_b16 a[164:165], v12 offset:12288
    v_mfma_f32_16x16x32_bf16 v[68:71], a[168:171], a[104:107], v[68:71]
    v_exp_f32 v106, v106
    v_mfma_f32_16x16x32_bf16 v[76:79], a[168:171], a[120:123], v[76:79]
    ds_read_b64_tr_b16 a[166:167], v12 offset:14336
    s_add_u32 s33, s33, s34
    v_mfma_f32_16x16x32_bf16 v[48:51], a[172:175], a[76:79], v[48:51]
    v_exp_f32 v107, v107
    v_mfma_f32_16x16x32_bf16 v[56:59], a[172:175], a[92:95], v[56:59]
    v_cvt_pk_bf16_f32 v104, v104, v105
    ds_read_b64_tr_b16 a[168:169], v13 offset:12288
    v_mfma_f32_16x16x32_bf16 v[64:67], a[172:175], a[108:111], v[64:67]
    v_exp_f32 v108, v108
    v_mfma_f32_16x16x32_bf16 v[72:75], a[172:175], a[124:127], v[72:75]
    ds_read_b64_tr_b16 a[170:171], v13 offset:14336
    s_add_u32 s37, s37, 0x8000
    v_mfma_f32_16x16x32_bf16 v[52:55], a[176:179], a[76:79], v[52:55]
    v_exp_f32 v109, v109
    v_mfma_f32_16x16x32_bf16 v[60:63], a[176:179], a[92:95], v[60:63]
    v_cvt_pk_bf16_f32 v105, v106, v107
    v_exp_f32 v110, v110
    v_exp_f32 v111, v111
    v_cvt_pk_bf16_f32 v106, v108, v109
    v_mfma_f32_16x16x32_bf16 v[68:71], a[176:179], a[108:111], v[68:71]
    v_cvt_pk_bf16_f32 v107, v110, v111
    ds_read_b64_tr_b16 a[172:173], v14 offset:12288
    v_mfma_f32_16x16x32_bf16 v[76:79], a[176:179], a[124:127], v[76:79]
    ds_read_b64_tr_b16 a[174:175], v14 offset:14336
    s_waitcnt lgkmcnt(6)
    v_mfma_f32_16x16x32_bf16 v[112:115], a[148:151], v[80:83], v[112:115]
    s_and_b32 s37, s37, 0x1ffff
    s_mov_b32 s64, s56
    v_mfma_f32_16x16x32_bf16 v[116:119], a[148:151], v[88:91], v[116:119]
    s_mov_b32 s65, s57
    s_mov_b32 s66, s58
    s_add_u32 m0, s6, 4096
    v_mfma_f32_16x16x32_bf16 v[120:123], a[148:151], v[96:99], v[120:123]
    buffer_load_dwordx4 v254, s[64:67], s46 offen offset:0 nt lds
    v_mfma_f32_16x16x32_bf16 v[124:127], a[148:151], v[104:107], v[124:127]
    ds_read_b64_tr_b16 a[176:177], v15 offset:12288
    ds_read_b64_tr_b16 a[178:179], v15 offset:14336
    v_mfma_f32_16x16x32_bf16 v[128:131], a[152:155], v[80:83], v[128:131]
    v_exp_f32 v48, v48
    v_mfma_f32_16x16x32_bf16 v[132:135], a[152:155], v[88:91], v[132:135]
    ds_read_b128 a[148:151], v24 offset:20480
    s_add_u32 s46, s46, s54
    v_mfma_f32_16x16x32_bf16 v[136:139], a[152:155], v[96:99], v[136:139]
    v_exp_f32 v49, v49
    v_mfma_f32_16x16x32_bf16 v[140:143], a[152:155], v[104:107], v[140:143]
    v_exp_f32 v50, v50
    v_mfma_f32_16x16x32_bf16 v[144:147], a[156:159], v[80:83], v[144:147]
    buffer_load_dwordx4 v254, s[64:67], s46 offen offset:1024 nt lds
    v_mfma_f32_16x16x32_bf16 v[148:151], a[156:159], v[88:91], v[148:151]
    v_exp_f32 v51, v51
    v_mfma_f32_16x16x32_bf16 v[152:155], a[156:159], v[96:99], v[152:155]
    ds_read_b128 a[152:155], v24 offset:22528
    v_cvt_pk_bf16_f32 v48, v48, v49
    v_mfma_f32_16x16x32_bf16 v[156:159], a[156:159], v[104:107], v[156:159]
    v_exp_f32 v52, v52
    v_mfma_f32_16x16x32_bf16 v[160:163], a[160:163], v[80:83], v[160:163]
    v_exp_f32 v53, v53
    v_mfma_f32_16x16x32_bf16 v[164:167], a[160:163], v[88:91], v[164:167]
    ds_read_b128 a[156:159], v25 offset:20480
    v_cvt_pk_bf16_f32 v49, v50, v51
    v_mfma_f32_16x16x32_bf16 v[168:171], a[160:163], v[96:99], v[168:171]
    v_exp_f32 v54, v54
    v_mfma_f32_16x16x32_bf16 v[172:175], a[160:163], v[104:107], v[172:175]
    s_add_u32 s46, s46, s54
    s_waitcnt lgkmcnt(3)
    v_mfma_f32_16x16x32_bf16 v[176:179], a[164:167], v[80:83], v[176:179]
    buffer_load_dwordx4 v254, s[64:67], s46 offen offset:2048 nt lds
    v_mfma_f32_16x16x32_bf16 v[180:183], a[164:167], v[88:91], v[180:183]
    ds_read_b128 a[160:163], v25 offset:22528
    s_add_u32 s46, s46, s54
    v_mfma_f32_16x16x32_bf16 v[184:187], a[164:167], v[96:99], v[184:187]
    v_exp_f32 v55, v55
    v_mfma_f32_16x16x32_bf16 v[188:191], a[164:167], v[104:107], v[188:191]
    v_cvt_pk_bf16_f32 v50, v52, v53
    v_mfma_f32_16x16x32_bf16 v[192:195], a[168:171], v[80:83], v[192:195]
    v_exp_f32 v56, v56
    v_mfma_f32_16x16x32_bf16 v[196:199], a[168:171], v[88:91], v[196:199]
    ds_read_b128 a[164:167], v24 offset:28672
    v_mfma_f32_16x16x32_bf16 v[200:203], a[168:171], v[96:99], v[200:203]
    v_exp_f32 v57, v57
    v_mfma_f32_16x16x32_bf16 v[204:207], a[168:171], v[104:107], v[204:207]
    v_cvt_pk_bf16_f32 v51, v54, v55
    v_mfma_f32_16x16x32_bf16 v[208:211], a[172:175], v[80:83], v[208:211]
    v_exp_f32 v58, v58
    v_mfma_f32_16x16x32_bf16 v[212:215], a[172:175], v[88:91], v[212:215]
    buffer_load_dwordx4 v254, s[64:67], s46 offen offset:3072 nt lds
    v_mfma_f32_16x16x32_bf16 v[216:219], a[172:175], v[96:99], v[216:219]
    ds_read_b128 a[168:171], v24 offset:30720
    v_mfma_f32_16x16x32_bf16 v[220:223], a[172:175], v[104:107], v[220:223]
    v_exp_f32 v59, v59
    v_mfma_f32_16x16x32_bf16 v[224:227], a[176:179], v[80:83], v[224:227]
    v_cvt_pk_bf16_f32 v56, v56, v57
    ds_read_b128 a[172:175], v25 offset:28672
    v_mfma_f32_16x16x32_bf16 v[228:231], a[176:179], v[88:91], v[228:231]
    v_exp_f32 v60, v60
    v_mfma_f32_16x16x32_bf16 v[232:235], a[176:179], v[96:99], v[232:235]
    v_exp_f32 v61, v61
    v_mfma_f32_16x16x32_bf16 v[236:239], a[176:179], v[104:107], v[236:239]
    v_cvt_pk_bf16_f32 v57, v58, v59
    v_mfma_f32_16x16x32_bf16 a[128:131], a[144:147], v[80:83], a[128:131]
    v_exp_f32 v62, v62
    v_mfma_f32_16x16x32_bf16 a[132:135], a[144:147], v[88:91], a[132:135]
    v_exp_f32 v63, v63
    v_mfma_f32_16x16x32_bf16 a[136:139], a[144:147], v[96:99], a[136:139]
    v_cvt_pk_bf16_f32 v58, v60, v61
    v_mfma_f32_16x16x32_bf16 a[140:143], a[144:147], v[104:107], a[140:143]
    s_waitcnt lgkmcnt(3)
    v_mfma_f32_16x16x32_bf16 v[80:83], a[148:151], a[64:67], v[32:35]
    v_exp_f32 v64, v64
    v_mfma_f32_16x16x32_bf16 v[88:91], a[148:151], a[80:83], v[36:39]
    ds_read_b128 a[176:179], v25 offset:30720
    v_mfma_f32_16x16x32_bf16 v[96:99], a[148:151], a[96:99], v[40:43]
    v_exp_f32 v65, v65
    v_mfma_f32_16x16x32_bf16 v[104:107], a[148:151], a[112:115], v[44:47]
    s_waitcnt vmcnt(16)
    s_barrier
    v_mfma_f32_16x16x32_bf16 v[84:87], a[152:155], a[64:67], v[32:35]
    v_cvt_pk_bf16_f32 v59, v62, v63
    ds_read_b64_tr_b16 a[148:149], v12 offset:32768
    v_mfma_f32_16x16x32_bf16 v[92:95], a[152:155], a[80:83], v[36:39]
    v_exp_f32 v66, v66
    v_mfma_f32_16x16x32_bf16 v[100:103], a[152:155], a[96:99], v[40:43]
    ds_read_b64_tr_b16 a[150:151], v12 offset:34816
    v_mfma_f32_16x16x32_bf16 v[108:111], a[152:155], a[112:115], v[44:47]
    v_exp_f32 v67, v67
    v_mfma_f32_16x16x32_bf16 v[80:83], a[156:159], a[68:71], v[80:83]
    v_cvt_pk_bf16_f32 v64, v64, v65
    ds_read_b64_tr_b16 a[152:153], v13 offset:32768
    v_mfma_f32_16x16x32_bf16 v[88:91], a[156:159], a[84:87], v[88:91]
    v_exp_f32 v68, v68
    v_mfma_f32_16x16x32_bf16 v[96:99], a[156:159], a[100:103], v[96:99]
    ds_read_b64_tr_b16 a[154:155], v13 offset:34816
    v_mfma_f32_16x16x32_bf16 v[104:107], a[156:159], a[116:119], v[104:107]
    v_exp_f32 v69, v69
    v_mfma_f32_16x16x32_bf16 v[84:87], a[160:163], a[68:71], v[84:87]
    v_cvt_pk_bf16_f32 v65, v66, v67
    ds_read_b64_tr_b16 a[156:157], v14 offset:32768
    v_mfma_f32_16x16x32_bf16 v[92:95], a[160:163], a[84:87], v[92:95]
    v_exp_f32 v70, v70
    v_mfma_f32_16x16x32_bf16 v[100:103], a[160:163], a[100:103], v[100:103]
    ds_read_b64_tr_b16 a[158:159], v14 offset:34816
    v_mfma_f32_16x16x32_bf16 v[108:111], a[160:163], a[116:119], v[108:111]
    s_waitcnt lgkmcnt(6)
    v_mfma_f32_16x16x32_bf16 v[80:83], a[164:167], a[72:75], v[80:83]
    v_exp_f32 v71, v71
    v_mfma_f32_16x16x32_bf16 v[88:91], a[164:167], a[88:91], v[88:91]
    v_cvt_pk_bf16_f32 v66, v68, v69
    ds_read_b64_tr_b16 a[160:161], v15 offset:32768
    v_mfma_f32_16x16x32_bf16 v[96:99], a[164:167], a[104:107], v[96:99]
    v_exp_f32 v72, v72
    v_mfma_f32_16x16x32_bf16 v[104:107], a[164:167], a[120:123], v[104:107]
    ds_read_b64_tr_b16 a[162:163], v15 offset:34816
    v_mfma_f32_16x16x32_bf16 v[84:87], a[168:171], a[72:75], v[84:87]
    v_exp_f32 v73, v73
    v_mfma_f32_16x16x32_bf16 v[92:95], a[168:171], a[88:91], v[92:95]
    v_cvt_pk_bf16_f32 v67, v70, v71
    ds_read_b64_tr_b16 a[164:165], v12 offset:40960
    v_mfma_f32_16x16x32_bf16 v[100:103], a[168:171], a[104:107], v[100:103]
    v_exp_f32 v74, v74
    v_mfma_f32_16x16x32_bf16 v[108:111], a[168:171], a[120:123], v[108:111]
    ds_read_b64_tr_b16 a[166:167], v12 offset:43008
    v_mfma_f32_16x16x32_bf16 v[80:83], a[172:175], a[76:79], v[80:83]
    v_exp_f32 v75, v75
    v_mfma_f32_16x16x32_bf16 v[88:91], a[172:175], a[92:95], v[88:91]
    v_cvt_pk_bf16_f32 v72, v72, v73
    ds_read_b64_tr_b16 a[168:169], v13 offset:40960
    v_mfma_f32_16x16x32_bf16 v[96:99], a[172:175], a[108:111], v[96:99]
    v_exp_f32 v76, v76
    v_mfma_f32_16x16x32_bf16 v[104:107], a[172:175], a[124:127], v[104:107]
    ds_read_b64_tr_b16 a[170:171], v13 offset:43008
    v_mfma_f32_16x16x32_bf16 v[84:87], a[176:179], a[76:79], v[84:87]
    v_exp_f32 v77, v77
    v_mfma_f32_16x16x32_bf16 v[92:95], a[176:179], a[92:95], v[92:95]
    v_cvt_pk_bf16_f32 v73, v74, v75
    v_exp_f32 v78, v78
    v_exp_f32 v79, v79
    v_cvt_pk_bf16_f32 v74, v76, v77
    v_mfma_f32_16x16x32_bf16 v[100:103], a[176:179], a[108:111], v[100:103]
    v_cvt_pk_bf16_f32 v75, v78, v79
    ds_read_b64_tr_b16 a[172:173], v14 offset:40960
    v_mfma_f32_16x16x32_bf16 v[108:111], a[176:179], a[124:127], v[108:111]
    ds_read_b64_tr_b16 a[174:175], v14 offset:43008
    v_cmp_eq_u32 vcc, v0, v3
    s_and_b32 s41, vcc_hi, 0xff
    s_and_b32 s41, s41, vcc_lo
    s_cmp_eq_u32 vcc_lo, -1
    s_cselect_b32 s41, s41, 0
    s_cmp_eq_u32 s41, 0xff
    s_cbranch_scc0 TG_SLOW
TG2_GO:
    v_and_b32 v240, 1, v1
    v_lshlrev_b32 v240, 4, v240
    v_lshrrev_b32 v241, 4, v1
    v_lshl_add_u32 v240, v241, 5, v240
    buffer_load_dwordx4 a[248:251], v240, s[16:19], s59 offen sc1
    buffer_load_dwordx4 a[252:255], v240, s[16:19], s63 offen sc1
    s_waitcnt lgkmcnt(6)
    v_mfma_f32_16x16x32_bf16 v[112:115], a[148:151], v[48:51], v[112:115]
    ds_read_b64_tr_b16 a[176:177], v15 offset:40960
    ds_read_b64_tr_b16 a[178:179], v15 offset:43008
    v_mfma_f32_16x16x32_bf16 v[116:119], a[148:151], v[56:59], v[116:119]
    v_exp_f32 v80, v80
    v_mfma_f32_16x16x32_bf16 v[120:123], a[148:151], v[64:67], v[120:123]
    v_exp_f32 v81, v81
    v_mfma_f32_16x16x32_bf16 v[124:127], a[148:151], v[72:75], v[124:127]
    s_add_u32 m0, s37, s35
    v_mfma_f32_16x16x32_bf16 v[128:131], a[152:155], v[48:51], v[128:131]
    ds_read_b128 a[148:151], v24 offset:49152
    v_mfma_f32_16x16x32_bf16 v[132:135], a[152:155], v[56:59], v[132:135]
    v_exp_f32 v82, v82
    v_mfma_f32_16x16x32_bf16 v[136:139], a[152:155], v[64:67], v[136:139]
    buffer_load_dwordx4 v4, s[8:11], s32 offen offset:0 nt lds
    v_mfma_f32_16x16x32_bf16 v[140:143], a[152:155], v[72:75], v[140:143]
    v_exp_f32 v83, v83
    v_mfma_f32_16x16x32_bf16 v[144:147], a[156:159], v[48:51], v[144:147]
    ds_read_b128 a[152:155], v24 offset:51200
    v_cvt_pk_bf16_f32 v80, v80, v81
    v_mfma_f32_16x16x32_bf16 v[148:151], a[156:159], v[56:59], v[148:151]
    v_exp_f32 v84, v84
    v_mfma_f32_16x16x32_bf16 v[152:155], a[156:159], v[64:67], v[152:155]
    v_exp_f32 v85, v85
    v_mfma_f32_16x16x32_bf16 v[156:159], a[156:159], v[72:75], v[156:159]
    buffer_load_dwordx4 v5, s[8:11], s32 offen offset:1024 nt lds
    v_mfma_f32_16x16x32_bf16 v[160:163], a[160:163], v[48:51], v[160:163]
    ds_read_b128 a[156:159], v25 offset:49152
    v_cvt_pk_bf16_f32 v81, v82, v83
    v_mfma_f32_16x16x32_bf16 v[164:167], a[160:163], v[56:59], v[164:167]
    v_exp_f32 v86, v86
    v_mfma_f32_16x16x32_bf16 v[168:171], a[160:163], v[64:67], v[168:171]
    v_exp_f32 v87, v87
    v_mfma_f32_16x16x32_bf16 v[172:175], a[160:163], v[72:75], v[172:175]
    v_cvt_pk_bf16_f32 v82, v84, v85
    s_waitcnt lgkmcnt(3)
    v_mfma_f32_16x16x32_bf16 v[176:179], a[164:167], v[48:51], v[176:179]
    ds_read_b128 a[160:163], v25 offset:51200
    v_mfma_f32_16x16x32_bf16 v[180:183], a[164:167], v[56:59], v[180:183]
    v_exp_f32 v88, v88
    v_mfma_f32_16x16x32_bf16 v[184:187], a[164:167], v[64:67], v[184:187]
    buffer_load_dwordx4 v6, s[8:11], s32 offen offset:2048 nt lds
    v_mfma_f32_16x16x32_bf16 v[188:191], a[164:167], v[72:75], v[188:191]
    v_exp_f32 v89, v89
    v_mfma_f32_16x16x32_bf16 v[192:195], a[168:171], v[48:51], v[192:195]
    ds_read_b128 a[164:167], v24 offset:57344
    v_cvt_pk_bf16_f32 v83, v86, v87
    v_mfma_f32_16x16x32_bf16 v[196:199], a[168:171], v[56:59], v[196:199]
    v_exp_f32 v90, v90
    v_mfma_f32_16x16x32_bf16 v[200:203], a[168:171], v[64:67], v[200:203]
    v_exp_f32 v91, v91
    v_mfma_f32_16x16x32_bf16 v[204:207], a[168:171], v[72:75], v[204:207]
    buffer_load_dwordx4 v7, s[8:11], s32 offen offset:3072 nt lds
    v_mfma_f32_16x16x32_bf16 v[208:211], a[172:175], v[48:51], v[208:211]
    ds_read_b128 a[168:171], v24 offset:59392
    v_cvt_pk_bf16_f32 v88, v88, v89
    v_mfma_f32_16x16x32_bf16 v[212:215], a[172:175], v[56:59], v[212:215]
    v_exp_f32 v92, v92
    v_mfma_f32_16x16x32_bf16 v[216:219], a[172:175], v[64:67], v[216:219]
    v_exp_f32 v93, v93
    v_mfma_f32_16x16x32_bf16 v[220:223], a[172:175], v[72:75], v[220:223]
    v_cvt_pk_bf16_f32 v89, v90, v91
    s_add_u32 m0, s37, s36
    v_mfma_f32_16x16x32_bf16 v[224:227], a[176:179], v[48:51], v[224:227]
    v_exp_f32 v94, v94
    v_mfma_f32_16x16x32_bf16 v[228:231], a[176:179], v[56:59], v[228:231]
    buffer_load_dwordx4 v8, s[12:15], s33 offen offset:0 nt lds
    v_mfma_f32_16x16x32_bf16 v[232:235], a[176:179], v[64:67], v[232:235]
    ds_read_b128 a[172:175], v25 offset:57344
    v_mfma_f32_16x16x32_bf16 v[236:239], a[176:179], v[72:75], v[236:239]
    v_exp_f32 v95, v95
    v_mfma_f32_16x16x32_bf16 a[128:131], a[144:147], v[48:51], a[128:131]
    v_cvt_pk_bf16_f32 v90, v92, v93
    v_mfma_f32_16x16x32_bf16 a[132:135], a[144:147], v[56:59], a[132:135]
    v_exp_f32 v96, v96
    v_mfma_f32_16x16x32_bf16 a[136:139], a[144:147], v[64:67], a[136:139]
    v_exp_f32 v97, v97
    v_mfma_f32_16x16x32_bf16 a[140:143], a[144:147], v[72:75], a[140:143]
    v_cvt_pk_bf16_f32 v91, v94, v95
    s_waitcnt lgkmcnt(3)
    v_mfma_f32_16x16x32_bf16 v[48:51], a[148:151], a[64:67], v[32:35]
    ds_read_b128 a[176:179], v25 offset:59392
    v_mfma_f32_16x16x32_bf16 v[56:59], a[148:151], a[80:83], v[36:39]
    buffer_load_dwordx4 v9, s[12:15], s33 offen offset:1024 nt lds
    v_mfma_f32_16x16x32_bf16 v[64:67], a[148:151], a[96:99], v[40:43]
    v_exp_f32 v98, v98
    v_mfma_f32_16x16x32_bf16 v[72:75], a[148:151], a[112:115], v[44:47]
    v_exp_f32 v99, v99
    v_mfma_f32_16x16x32_bf16 v[52:55], a[152:155], a[64:67], v[32:35]
    ds_read_b64_tr_b16 a[148:149], v12 offset:36864
    ds_read_b64_tr_b16 a[150:151], v12 offset:38912
    v_mfma_f32_16x16x32_bf16 v[60:63], a[152:155], a[80:83], v[36:39]
    v_cvt_pk_bf16_f32 v96, v96, v97
    v_mfma_f32_16x16x32_bf16 v[68:71], a[152:155], a[96:99], v[40:43]
    buffer_load_dwordx4 v10, s[12:15], s33 offen offset:2048 nt lds
    v_mfma_f32_16x16x32_bf16 v[76:79], a[152:155], a[112:115], v[44:47]
    v_exp_f32 v100, v100
    v_mfma_f32_16x16x32_bf16 v[48:51], a[156:159], a[68:71], v[48:51]
    ds_read_b64_tr_b16 a[152:153], v13 offset:36864
    ds_read_b64_tr_b16 a[154:155], v13 offset:38912
    v_mfma_f32_16x16x32_bf16 v[56:59], a[156:159], a[84:87], v[56:59]
    v_exp_f32 v101, v101
    v_mfma_f32_16x16x32_bf16 v[64:67], a[156:159], a[100:103], v[64:67]
    v_cvt_pk_bf16_f32 v97, v98, v99
    v_mfma_f32_16x16x32_bf16 v[72:75], a[156:159], a[116:119], v[72:75]
    v_exp_f32 v102, v102
    v_mfma_f32_16x16x32_bf16 v[52:55], a[160:163], a[68:71], v[52:55]
    ds_read_b64_tr_b16 a[156:157], v14 offset:36864
    ds_read_b64_tr_b16 a[158:159], v14 offset:38912
    v_mfma_f32_16x16x32_bf16 v[60:63], a[160:163], a[84:87], v[60:63]
    buffer_load_dwordx4 v11, s[12:15], s33 offen offset:3072 nt lds
    v_mfma_f32_16x16x32_bf16 v[68:71], a[160:163], a[100:103], v[68:71]
    v_exp_f32 v103, v103
    v_mfma_f32_16x16x32_bf16 v[76:79], a[160:163], a[116:119], v[76:79]
    v_cvt_pk_bf16_f32 v98, v100, v101
    s_waitcnt lgkmcnt(6)
    v_mfma_f32_16x16x32_bf16 v[48:51], a[164:167], a[72:75], v[48:51]
    v_exp_f32 v104, v104
    v_mfma_f32_16x16x32_bf16 v[56:59], a[164:167], a[88:91], v[56:59]
    ds_read_b64_tr_b16 a[160:161], v15 offset:36864
    ds_read_b64_tr_b16 a[162:163], v15 offset:38912
    v_mfma_f32_16x16x32_bf16 v[64:67], a[164:167], a[104:107], v[64:67]
    v_exp_f32 v105, v105
    v_mfma_f32_16x16x32_bf16 v[72:75], a[164:167], a[120:123], v[72:75]
    v_cvt_pk_bf16_f32 v99, v102, v103
    s_add_u32 s32, s32, s34
    v_mfma_f32_16x16x32_bf16 v[52:55], a[168:171], a[72:75], v[52:55]
    s_waitcnt vmcnt(22)
    ds_read_b64_tr_b16 a[164:165], v12 offset:45056
    v_mfma_f32_16x16x32_bf16 v[60:63], a[168:171], a[88:91], v[60:63]
    v_exp_f32 v106, v106
    v_mfma_f32_16x16x32_bf16 v[68:71], a[168:171], a[104:107], v[68:71]
    ds_read_b64_tr_b16 a[166:167], v12 offset:47104
    ds_read_b64_tr_b16 a[0:1], v16 offset:0
    v_mfma_f32_16x16x32_bf16 v[76:79], a[168:171], a[120:123], v[76:79]
    v_exp_f32 v107, v107
    v_mfma_f32_16x16x32_bf16 v[48:51], a[172:175], a[76:79], v[48:51]
    ds_read_b64_tr_b16 a[2:3], v16 offset:2048
    v_cvt_pk_bf16_f32 v104, v104, v105
    v_mfma_f32_16x16x32_bf16 v[56:59], a[172:175], a[92:95], v[56:59]
    ds_read_b64_tr_b16 a[4:5], v17 offset:0
    ds_read_b64_tr_b16 a[168:169], v13 offset:45056
    v_mfma_f32_16x16x32_bf16 v[64:67], a[172:175], a[108:111], v[64:67]
    v_exp_f32 v108, v108
    v_mfma_f32_16x16x32_bf16 v[72:75], a[172:175], a[124:127], v[72:75]
    ds_read_b64_tr_b16 a[170:171], v13 offset:47104
    ds_read_b64_tr_b16 a[6:7], v17 offset:2048
    v_mfma_f32_16x16x32_bf16 v[52:55], a[176:179], a[76:79], v[52:55]
    ds_read_b64_tr_b16 a[8:9], v18 offset:0
    v_exp_f32 v109, v109
    v_mfma_f32_16x16x32_bf16 v[60:63], a[176:179], a[92:95], v[60:63]
    ds_read_b64_tr_b16 a[10:11], v18 offset:2048
    v_cvt_pk_bf16_f32 v105, v106, v107
    v_exp_f32 v110, v110
    v_exp_f32 v111, v111
    v_cvt_pk_bf16_f32 v106, v108, v109
    v_mfma_f32_16x16x32_bf16 v[68:71], a[176:179], a[108:111], v[68:71]
    ds_read_b64_tr_b16 a[12:13], v19 offset:0
    v_cvt_pk_bf16_f32 v107, v110, v111
    v_mfma_f32_16x16x32_bf16 v[76:79], a[176:179], a[124:127], v[76:79]
    ds_read_b64_tr_b16 a[172:173], v14 offset:45056
    ds_read_b64_tr_b16 a[174:175], v14 offset:47104
    ds_read_b64_tr_b16 a[14:15], v19 offset:2048
    s_waitcnt lgkmcnt(14)
    v_mfma_f32_16x16x32_bf16 v[112:115], a[148:151], v[80:83], v[112:115]
    s_add_u32 s33, s33, s34
    s_add_u32 s37, s37, 0x8000
    v_mfma_f32_16x16x32_bf16 v[116:119], a[148:151], v[88:91], v[116:119]
    s_and_b32 s37, s37, 0x1ffff
    ds_read_b64_tr_b16 a[176:177], v15 offset:45056
    v_mfma_f32_16x16x32_bf16 v[120:123], a[148:151], v[96:99], v[120:123]
    ds_read_b64_tr_b16 a[178:179], v15 offset:47104
    v_mfma_f32_16x16x32_bf16 v[124:127], a[148:151], v[104:107], v[124:127]
    v_exp_f32 v48, v48
    v_mfma_f32_16x16x32_bf16 v[128:131], a[152:155], v[80:83], v[128:131]
    ds_read_b128 a[148:151], v24 offset:53248
    v_mfma_f32_16x16x32_bf16 v[132:135], a[152:155], v[88:91], v[132:135]
    v_exp_f32 v49, v49
    v_mfma_f32_16x16x32_bf16 v[136:139], a[152:155], v[96:99], v[136:139]
    v_exp_f32 v50, v50
    v_mfma_f32_16x16x32_bf16 v[140:143], a[152:155], v[104:107], v[140:143]
    v_exp_f32 v51, v51
    v_mfma_f32_16x16x32_bf16 v[144:147], a[156:159], v[80:83], v[144:147]
    s_waitcnt lgkmcnt(3)
    ds_read_b128 a[152:155], v24 offset:55296
    v_mfma_f32_16x16x32_bf16 v[148:151], a[156:159], v[88:91], v[148:151]
    buffer_store_dwordx4 a[0:3], v2, s[16:19], s48 offen sc1
    v_mfma_f32_16x16x32_bf16 v[152:155], a[156:159], v[96:99], v[152:155]
    s_add_u32 s48, s48, 131072
    v_cvt_pk_bf16_f32 v48, v48, v49
    v_mfma_f32_16x16x32_bf16 v[156:159], a[156:159], v[104:107], v[156:159]
    v_exp_f32 v52, v52
    v_mfma_f32_16x16x32_bf16 v[160:163], a[160:163], v[80:83], v[160:163]
    v_exp_f32 v53, v53
    v_mfma_f32_16x16x32_bf16 v[164:167], a[160:163], v[88:91], v[164:167]
    ds_read_b128 a[156:159], v25 offset:53248
    v_cvt_pk_bf16_f32 v49, v50, v51
    v_mfma_f32_16x16x32_bf16 v[168:171], a[160:163], v[96:99], v[168:171]
    buffer_store_dwordx4 a[4:7], v2, s[16:19], s48 offen sc1
    v_mfma_f32_16x16x32_bf16 v[172:175], a[160:163], v[104:107], v[172:175]
    s_add_u32 s48, s48, 131072
    s_waitcnt lgkmcnt(3)
    v_mfma_f32_16x16x32_bf16 v[176:179], a[164:167], v[80:83], v[176:179]
    v_exp_f32 v54, v54
    v_mfma_f32_16x16x32_bf16 v[180:183], a[164:167], v[88:91], v[180:183]
    ds_read_b128 a[160:163], v25 offset:55296
    v_mfma_f32_16x16x32_bf16 v[184:187], a[164:167], v[96:99], v[184:187]
    buffer_store_dwordx4 a[8:11], v2, s[16:19], s48 offen sc1
    v_mfma_f32_16x16x32_bf16 v[188:191], a[164:167], v[104:107], v[188:191]
    s_add_u32 s48, s48, 131072
    v_exp_f32 v55, v55
    v_mfma_f32_16x16x32_bf16 v[192:195], a[168:171], v[80:83], v[192:195]
    v_cvt_pk_bf16_f32 v50, v52, v53
    ds_read_b128 a[164:167], v24 offset:61440
    v_mfma_f32_16x16x32_bf16 v[196:199], a[168:171], v[88:91], v[196:199]
    v_exp_f32 v56, v56
    v_mfma_f32_16x16x32_bf16 v[200:203], a[168:171], v[96:99], v[200:203]
    buffer_store_dwordx4 a[12:15], v2, s[16:19], s48 offen sc1
    v_mfma_f32_16x16x32_bf16 v[204:207], a[168:171], v[104:107], v[204:207]
    v_exp_f32 v57, v57
    v_mfma_f32_16x16x32_bf16 v[208:211], a[172:175], v[80:83], v[208:211]
    v_cvt_pk_bf16_f32 v51, v54, v55
    ds_read_b128 a[168:171], v24 offset:63488
    v_mfma_f32_16x16x32_bf16 v[212:215], a[172:175], v[88:91], v[212:215]
    v_exp_f32 v58, v58
    v_mfma_f32_16x16x32_bf16 v[216:219], a[172:175], v[96:99], v[216:219]
    v_exp_f32 v59, v59
    v_mfma_f32_16x16x32_bf16 v[220:223], a[172:175], v[104:107], v[220:223]
    v_cvt_pk_bf16_f32 v56, v56, v57
    v_mfma_f32_16x16x32_bf16 v[224:227], a[176:179], v[80:83], v[224:227]
    v_exp_f32 v60, v60
    v_mfma_f32_16x16x32_bf16 v[228:231], a[176:179], v[88:91], v[228:231]
    v_exp_f32 v61, v61
    v_mfma_f32_16x16x32_bf16 v[232:235], a[176:179], v[96:99], v[232:235]
    v_cvt_pk_bf16_f32 v57, v58, v59
    ds_read_b128 a[172:175], v25 offset:61440
    v_mfma_f32_16x16x32_bf16 v[236:239], a[176:179], v[104:107], v[236:239]
    v_exp_f32 v62, v62
    v_mfma_f32_16x16x32_bf16 a[128:131], a[144:147], v[80:83], a[128:131]
    v_exp_f32 v63, v63
    v_mfma_f32_16x16x32_bf16 a[132:135], a[144:147], v[88:91], a[132:135]
    v_cvt_pk_bf16_f32 v58, v60, v61
    v_mfma_f32_16x16x32_bf16 a[136:139], a[144:147], v[96:99], a[136:139]
    v_exp_f32 v64, v64
    v_mfma_f32_16x16x32_bf16 a[140:143], a[144:147], v[104:107], a[140:143]
    s_waitcnt lgkmcnt(3)
    v_mfma_f32_16x16x32_bf16 v[80:83], a[148:151], a[64:67], v[32:35]
    ds_read_b128 a[176:179], v25 offset:63488
    v_mfma_f32_16x16x32_bf16 v[88:91], a[148:151], a[80:83], v[36:39]
    v_exp_f32 v65, v65
    v_mfma_f32_16x16x32_bf16 v[96:99], a[148:151], a[96:99], v[40:43]
    v_cvt_pk_bf16_f32 v59, v62, v63
    v_mfma_f32_16x16x32_bf16 v[104:107], a[148:151], a[112:115], v[44:47]
    s_waitcnt vmcnt(18)
    s_barrier
    v_mfma_f32_16x16x32_bf16 v[84:87], a[152:155], a[64:67], v[32:35]
    v_exp_f32 v66, v66
    v_mfma_f32_16x16x32_bf16 v[92:95], a[152:155], a[80:83], v[36:39]
    ds_read_b64_tr_b16 a[148:149], v20 offset:0
    ds_read_b64_tr_b16 a[150:151], v20 offset:2048
    v_mfma_f32_16x16x32_bf16 v[100:103], a[152:155], a[96:99], v[40:43]
    v_exp_f32 v67, v67
    v_mfma_f32_16x16x32_bf16 v[108:111], a[152:155], a[112:115], v[44:47]
    v_cvt_pk_bf16_f32 v64, v64, v65
    v_mfma_f32_16x16x32_bf16 v[80:83], a[156:159], a[68:71], v[80:83]
    v_exp_f32 v68, v68
    v_mfma_f32_16x16x32_bf16 v[88:91], a[156:159], a[84:87], v[88:91]
    ds_read_b64_tr_b16 a[152:153], v21 offset:0
    ds_read_b64_tr_b16 a[154:155], v21 offset:2048
    v_mfma_f32_16x16x32_bf16 v[96:99], a[156:159], a[100:103], v[96:99]
    v_exp_f32 v69, v69
    v_mfma_f32_16x16x32_bf16 v[104:107], a[156:159], a[116:119], v[104:107]
    v_cvt_pk_bf16_f32 v65, v66, v67
    v_mfma_f32_16x16x32_bf16 v[84:87], a[160:163], a[68:71], v[84:87]
    v_exp_f32 v70, v70
    v_mfma_f32_16x16x32_bf16 v[92:95], a[160:163], a[84:87], v[92:95]
    ds_read_b64_tr_b16 a[156:157], v22 offset:0
    ds_read_b64_tr_b16 a[158:159], v22 offset:2048
    v_mfma_f32_16x16x32_bf16 v[100:103], a[160:163], a[100:103], v[100:103]
    v_exp_f32 v71, v71
    v_mfma_f32_16x16x32_bf16 v[108:111], a[160:163], a[116:119], v[108:111]
    v_cvt_pk_bf16_f32 v66, v68, v69
    s_waitcnt lgkmcnt(6)
    v_mfma_f32_16x16x32_bf16 v[80:83], a[164:167], a[72:75], v[80:83]
    v_exp_f32 v72, v72
    v_mfma_f32_16x16x32_bf16 v[88:91], a[164:167], a[88:91], v[88:91]
    ds_read_b64_tr_b16 a[160:161], v23 offset:0
    ds_read_b64_tr_b16 a[162:163], v23 offset:2048
    v_mfma_f32_16x16x32_bf16 v[96:99], a[164:167], a[104:107], v[96:99]
    v_exp_f32 v73, v73
    v_mfma_f32_16x16x32_bf16 v[104:107], a[164:167], a[120:123], v[104:107]
    v_cvt_pk_bf16_f32 v67, v70, v71
    v_mfma_f32_16x16x32_bf16 v[84:87], a[168:171], a[72:75], v[84:87]
    v_exp_f32 v74, v74
    v_mfma_f32_16x16x32_bf16 v[92:95], a[168:171], a[88:91], v[92:95]
    ds_read_b64_tr_b16 a[164:165], v20 offset:8192
    ds_read_b64_tr_b16 a[166:167], v20 offset:10240
    v_mfma_f32_16x16x32_bf16 v[100:103], a[168:171], a[104:107], v[100:103]
    v_exp_f32 v75, v75
    v_mfma_f32_16x16x32_bf16 v[108:111], a[168:171], a[120:123], v[108:111]
    v_cvt_pk_bf16_f32 v72, v72, v73
    v_mfma_f32_16x16x32_bf16 v[80:83], a[172:175], a[76:79], v[80:83]
    v_exp_f32 v76, v76
    v_mfma_f32_16x16x32_bf16 v[88:91], a[172:175], a[92:95], v[88:91]
    ds_read_b64_tr_b16 a[168:169], v21 offset:8192
    ds_read_b64_tr_b16 a[170:171], v21 offset:10240
    v_mfma_f32_16x16x32_bf16 v[96:99], a[172:175], a[108:111], v[96:99]
    v_exp_f32 v77, v77
    v_mfma_f32_16x16x32_bf16 v[104:107], a[172:175], a[124:127], v[104:107]
    v_cvt_pk_bf16_f32 v73, v74, v75
    v_mfma_f32_16x16x32_bf16 v[84:87], a[176:179], a[76:79], v[84:87]
    v_exp_f32 v78, v78
    v_mfma_f32_16x16x32_bf16 v[92:95], a[176:179], a[92:95], v[92:95]
    v_exp_f32 v79, v79
    v_cvt_pk_bf16_f32 v74, v76, v77
    v_mfma_f32_16x16x32_bf16 v[100:103], a[176:179], a[108:111], v[100:103]
    v_cvt_pk_bf16_f32 v75, v78, v79
    ds_read_b64_tr_b16 a[172:173], v22 offset:8192
    v_mfma_f32_16x16x32_bf16 v[108:111], a[176:179], a[124:127], v[108:111]
    ds_read_b64_tr_b16 a[174:175], v22 offset:10240
    s_waitcnt lgkmcnt(6)
    v_mfma_f32_16x16x32_bf16 v[112:115], a[148:151], v[48:51], v[112:115]
    ds_read_b64_tr_b16 a[176:177], v23 offset:8192
    ds_read_b64_tr_b16 a[178:179], v23 offset:10240
    v_mfma_f32_16x16x32_bf16 v[116:119], a[148:151], v[56:59], v[116:119]
    v_exp_f32 v80, v80
    v_mfma_f32_16x16x32_bf16 v[120:123], a[148:151], v[64:67], v[120:123]
    v_exp_f32 v81, v81
    v_mfma_f32_16x16x32_bf16 v[124:127], a[148:151], v[72:75], v[124:127]
    s_add_u32 m0, s37, s35
    v_mfma_f32_16x16x32_bf16 v[128:131], a[152:155], v[48:51], v[128:131]
    ds_read_b128 a[148:151], v26 offset:16384
    v_mfma_f32_16x16x32_bf16 v[132:135], a[152:155], v[56:59], v[132:135]
    v_exp_f32 v82, v82
    v_mfma_f32_16x16x32_bf16 v[136:139], a[152:155], v[64:67], v[136:139]
    buffer_load_dwordx4 v4, s[8:11], s32 offen offset:0 nt lds
    v_mfma_f32_16x16x32_bf16 v[140:143], a[152:155], v[72:75], v[140:143]
    v_exp_f32 v83, v83
    v_mfma_f32_16x16x32_bf16 v[144:147], a[156:159], v[48:51], v[144:147]
    ds_read_b128 a[152:155], v26 offset:18432
    v_cvt_pk_bf16_f32 v80, v80, v81
    v_mfma_f32_16x16x32_bf16 v[148:151], a[156:159], v[56:59], v[148:151]
    v_exp_f32 v84, v84
    v_mfma_f32_16x16x32_bf16 v[152:155], a[156:159], v[64:67], v[152:155]
    v_exp_f32 v85, v85
    v_mfma_f32_16x16x32_bf16 v[156:159], a[156:159], v[72:75], v[156:159]
    buffer_load_dwordx4 v5, s[8:11], s32 offen offset:1024 nt lds
    v_mfma_f32_16x16x32_bf16 v[160:163], a[160:163], v[48:51], v[160:163]
    ds_read_b128 a[156:159], v27 offset:16384
    v_cvt_pk_bf16_f32 v81, v82, v83
    v_mfma_f32_16x16x32_bf16 v[164:167], a[160:163], v[56:59], v[164:167]
    v_exp_f32 v86, v86
    v_mfma_f32_16x16x32_bf16 v[168:171], a[160:163], v[64:67], v[168:171]
    v_exp_f32 v87, v87
    v_mfma_f32_16x16x32_bf16 v[172:175], a[160:163], v[72:75], v[172:175]
    v_cvt_pk_bf16_f32 v82, v84, v85
    s_waitcnt lgkmcnt(3)
    v_mfma_f32_16x16x32_bf16 v[176:179], a[164:167], v[48:51], v[176:179]
    ds_read_b128 a[160:163], v27 offset:18432
    v_mfma_f32_16x16x32_bf16 v[180:183], a[164:167], v[56:59], v[180:183]
    v_exp_f32 v88, v88
    v_mfma_f32_16x16x32_bf16 v[184:187], a[164:167], v[64:67], v[184:187]
    buffer_load_dwordx4 v6, s[8:11], s32 offen offset:2048 nt lds
    v_mfma_f32_16x16x32_bf16 v[188:191], a[164:167], v[72:75], v[188:191]
    v_exp_f32 v89, v89
    v_mfma_f32_16x16x32_bf16 v[192:195], a[168:171], v[48:51], v[192:195]
    ds_read_b128 a[164:167], v26 offset:24576
    v_cvt_pk_bf16_f32 v83, v86, v87
    v_mfma_f32_16x16x32_bf16 v[196:199], a[168:171], v[56:59], v[196:199]
    v_exp_f32 v90, v90
    v_mfma_f32_16x16x32_bf16 v[200:203], a[168:171], v[64:67], v[200:203]
    v_exp_f32 v91, v91
    v_mfma_f32_16x16x32_bf16 v[204:207], a[168:171], v[72:75], v[204:207]
    buffer_load_dwordx4 v7, s[8:11], s32 offen offset:3072 nt lds
    v_mfma_f32_16x16x32_bf16 v[208:211], a[172:175], v[48:51], v[208:211]
    ds_read_b128 a[168:171], v26 offset:26624
    v_cvt_pk_bf16_f32 v88, v88, v89
    v_mfma_f32_16x16x32_bf16 v[212:215], a[172:175], v[56:59], v[212:215]
    v_exp_f32 v92, v92
    v_mfma_f32_16x16x32_bf16 v[216:219], a[172:175], v[64:67], v[216:219]
    v_exp_f32 v93, v93
    v_mfma_f32_16x16x32_bf16 v[220:223], a[172:175], v[72:75], v[220:223]
    v_cvt_pk_bf16_f32 v89, v90, v91
    s_add_u32 m0, s37, s36
    v_mfma_f32_16x16x32_bf16 v[224:227], a[176:179], v[48:51], v[224:227]
    v_exp_f32 v94, v94
    v_mfma_f32_16x16x32_bf16 v[228:231], a[176:179], v[56:59], v[228:231]
    buffer_load_dwordx4 v8, s[12:15], s33 offen offset:0 nt lds
    v_mfma_f32_16x16x32_bf16 v[232:235], a[176:179], v[64:67], v[232:235]
    ds_read_b128 a[172:175], v27 offset:24576
    v_mfma_f32_16x16x32_bf16 v[236:239], a[176:179], v[72:75], v[236:239]
    v_exp_f32 v95, v95
    v_mfma_f32_16x16x32_bf16 a[128:131], a[144:147], v[48:51], a[128:131]
    v_cvt_pk_bf16_f32 v90, v92, v93
    v_mfma_f32_16x16x32_bf16 a[132:135], a[144:147], v[56:59], a[132:135]
    v_exp_f32 v96, v96
    v_mfma_f32_16x16x32_bf16 a[136:139], a[144:147], v[64:67], a[136:139]
    v_exp_f32 v97, v97
    v_mfma_f32_16x16x32_bf16 a[140:143], a[144:147], v[72:75], a[140:143]
    v_cvt_pk_bf16_f32 v91, v94, v95
    s_waitcnt lgkmcnt(3)
    v_mfma_f32_16x16x32_bf16 v[48:51], a[148:151], a[64:67], v[32:35]
    ds_read_b128 a[176:179], v27 offset:26624
    v_mfma_f32_16x16x32_bf16 v[56:59], a[148:151], a[80:83], v[36:39]
    buffer_load_dwordx4 v9, s[12:15], s33 offen offset:1024 nt lds
    v_mfma_f32_16x16x32_bf16 v[64:67], a[148:151], a[96:99], v[40:43]
    v_exp_f32 v98, v98
    v_mfma_f32_16x16x32_bf16 v[72:75], a[148:151], a[112:115], v[44:47]
    v_exp_f32 v99, v99
    v_mfma_f32_16x16x32_bf16 v[52:55], a[152:155], a[64:67], v[32:35]
    ds_read_b64_tr_b16 a[148:149], v20 offset:4096
    ds_read_b64_tr_b16 a[150:151], v20 offset:6144
    v_mfma_f32_16x16x32_bf16 v[60:63], a[152:155], a[80:83], v[36:39]
    v_cvt_pk_bf16_f32 v96, v96, v97
    v_mfma_f32_16x16x32_bf16 v[68:71], a[152:155], a[96:99], v[40:43]
    buffer_load_dwordx4 v10, s[12:15], s33 offen offset:2048 nt lds
    v_mfma_f32_16x16x32_bf16 v[76:79], a[152:155], a[112:115], v[44:47]
    v_exp_f32 v100, v100
    v_mfma_f32_16x16x32_bf16 v[48:51], a[156:159], a[68:71], v[48:51]
    ds_read_b64_tr_b16 a[152:153], v21 offset:4096
    ds_read_b64_tr_b16 a[154:155], v21 offset:6144
    v_mfma_f32_16x16x32_bf16 v[56:59], a[156:159], a[84:87], v[56:59]
    v_exp_f32 v101, v101
    v_mfma_f32_16x16x32_bf16 v[64:67], a[156:159], a[100:103], v[64:67]
    v_cvt_pk_bf16_f32 v97, v98, v99
    v_mfma_f32_16x16x32_bf16 v[72:75], a[156:159], a[116:119], v[72:75]
    v_exp_f32 v102, v102
    v_mfma_f32_16x16x32_bf16 v[52:55], a[160:163], a[68:71], v[52:55]
    ds_read_b64_tr_b16 a[156:157], v22 offset:4096
    ds_read_b64_tr_b16 a[158:159], v22 offset:6144
    v_mfma_f32_16x16x32_bf16 v[60:63], a[160:163], a[84:87], v[60:63]
    buffer_load_dwordx4 v11, s[12:15], s33 offen offset:3072 nt lds
    v_mfma_f32_16x16x32_bf16 v[68:71], a[160:163], a[100:103], v[68:71]
    v_exp_f32 v103, v103
    v_mfma_f32_16x16x32_bf16 v[76:79], a[160:163], a[116:119], v[76:79]
    v_cvt_pk_bf16_f32 v98, v100, v101
    s_waitcnt lgkmcnt(6)
    v_mfma_f32_16x16x32_bf16 v[48:51], a[164:167], a[72:75], v[48:51]
    v_exp_f32 v104, v104
    v_mfma_f32_16x16x32_bf16 v[56:59], a[164:167], a[88:91], v[56:59]
    ds_read_b64_tr_b16 a[160:161], v23 offset:4096
    ds_read_b64_tr_b16 a[162:163], v23 offset:6144
    v_mfma_f32_16x16x32_bf16 v[64:67], a[164:167], a[104:107], v[64:67]
    v_exp_f32 v105, v105
    v_mfma_f32_16x16x32_bf16 v[72:75], a[164:167], a[120:123], v[72:75]
    v_cvt_pk_bf16_f32 v99, v102, v103
    s_add_u32 s32, s32, s34
    v_mfma_f32_16x16x32_bf16 v[52:55], a[168:171], a[72:75], v[52:55]
    v_exp_f32 v106, v106
    v_mfma_f32_16x16x32_bf16 v[60:63], a[168:171], a[88:91], v[60:63]
    ds_read_b64_tr_b16 a[164:165], v20 offset:12288
    ds_read_b64_tr_b16 a[166:167], v20 offset:14336
    v_mfma_f32_16x16x32_bf16 v[68:71], a[168:171], a[104:107], v[68:71]
    v_exp_f32 v107, v107
    v_mfma_f32_16x16x32_bf16 v[76:79], a[168:171], a[120:123], v[76:79]
    v_cvt_pk_bf16_f32 v104, v104, v105
    s_add_u32 s33, s33, s34
    v_mfma_f32_16x16x32_bf16 v[48:51], a[172:175], a[76:79], v[48:51]
    v_exp_f32 v108, v108
    v_mfma_f32_16x16x32_bf16 v[56:59], a[172:175], a[92:95], v[56:59]
    ds_read_b64_tr_b16 a[168:169], v21 offset:12288
    ds_read_b64_tr_b16 a[170:171], v21 offset:14336
    v_mfma_f32_16x16x32_bf16 v[64:67], a[172:175], a[108:111], v[64:67]
    s_add_u32 s37, s37, 0x8000
    s_and_b32 s37, s37, 0x1ffff
    v_mfma_f32_16x16x32_bf16 v[72:75], a[172:175], a[124:127], v[72:75]
    s_mov_b32 s64, s60
    s_mov_b32 s65, s61
    s_mov_b32 s66, s62
    s_add_u32 m0, s6, 0
    v_mfma_f32_16x16x32_bf16 v[52:55], a[176:179], a[76:79], v[52:55]
    buffer_load_dwordx4 v253, s[64:67], s47 offen offset:0 nt lds
    v_exp_f32 v109, v109
    v_mfma_f32_16x16x32_bf16 v[60:63], a[176:179], a[92:95], v[60:63]
    v_cvt_pk_bf16_f32 v105, v106, v107
    v_exp_f32 v110, v110
    v_exp_f32 v111, v111
    v_cvt_pk_bf16_f32 v106, v108, v109
    v_mfma_f32_16x16x32_bf16 v[68:71], a[176:179], a[108:111], v[68:71]
    v_cvt_pk_bf16_f32 v107, v110, v111
    ds_read_b64_tr_b16 a[172:173], v22 offset:12288
    v_mfma_f32_16x16x32_bf16 v[76:79], a[176:179], a[124:127], v[76:79]
    ds_read_b64_tr_b16 a[174:175], v22 offset:14336
    s_waitcnt lgkmcnt(6)
    v_mfma_f32_16x16x32_bf16 v[112:115], a[148:151], v[80:83], v[112:115]
    s_add_u32 s47, s47, 26624
    buffer_load_dwordx4 v253, s[64:67], s47 offen offset:1024 nt lds
    v_mfma_f32_16x16x32_bf16 v[116:119], a[148:151], v[88:91], v[116:119]
    ds_read_b64_tr_b16 a[176:177], v23 offset:12288
    ds_read_b64_tr_b16 a[178:179], v23 offset:14336
    v_mfma_f32_16x16x32_bf16 v[120:123], a[148:151], v[96:99], v[120:123]
    s_add_u32 s47, s47, 26624
    v_mfma_f32_16x16x32_bf16 v[124:127], a[148:151], v[104:107], v[124:127]
    buffer_load_dwordx4 v253, s[64:67], s47 offen offset:2048 nt lds
    v_mfma_f32_16x16x32_bf16 v[128:131], a[152:155], v[80:83], v[128:131]
    v_exp_f32 v48, v48
    v_mfma_f32_16x16x32_bf16 v[132:135], a[152:155], v[88:91], v[132:135]
    ds_read_b128 a[148:151], v26 offset:20480
    s_add_u32 s47, s47, 26624
    v_mfma_f32_16x16x32_bf16 v[136:139], a[152:155], v[96:99], v[136:139]
    v_exp_f32 v49, v49
    v_mfma_f32_16x16x32_bf16 v[140:143], a[152:155], v[104:107], v[140:143]
    s_waitcnt vmcnt(23)
    ds_read_b64_tr_b16 a[0:1], v16 offset:4096
    v_mfma_f32_16x16x32_bf16 v[144:147], a[156:159], v[80:83], v[144:147]
    buffer_load_dwordx4 v253, s[64:67], s47 offen offset:3072 nt lds
    v_mfma_f32_16x16x32_bf16 v[148:151], a[156:159], v[88:91], v[148:151]
    v_exp_f32 v50, v50
    v_mfma_f32_16x16x32_bf16 v[152:155], a[156:159], v[96:99], v[152:155]
    v_exp_f32 v51, v51
    v_mfma_f32_16x16x32_bf16 v[156:159], a[156:159], v[104:107], v[156:159]
    ds_read_b128 a[152:155], v26 offset:22528
    ds_read_b64_tr_b16 a[2:3], v16 offset:6144
    v_mfma_f32_16x16x32_bf16 v[160:163], a[160:163], v[80:83], v[160:163]
    ds_read_b64_tr_b16 a[4:5], v17 offset:4096
    v_cvt_pk_bf16_f32 v48, v48, v49
    v_mfma_f32_16x16x32_bf16 v[164:167], a[160:163], v[88:91], v[164:167]
    ds_read_b64_tr_b16 a[6:7], v17 offset:6144
    v_exp_f32 v52, v52
    v_mfma_f32_16x16x32_bf16 v[168:171], a[160:163], v[96:99], v[168:171]
    ds_read_b64_tr_b16 a[8:9], v18 offset:4096
    v_exp_f32 v53, v53
    v_mfma_f32_16x16x32_bf16 v[172:175], a[160:163], v[104:107], v[172:175]
    ds_read_b128 a[156:159], v27 offset:20480
    ds_read_b64_tr_b16 a[10:11], v18 offset:6144
    s_waitcnt lgkmcnt(9)
    v_mfma_f32_16x16x32_bf16 v[176:179], a[164:167], v[80:83], v[176:179]
    ds_read_b64_tr_b16 a[12:13], v19 offset:4096
    v_cvt_pk_bf16_f32 v49, v50, v51
    v_mfma_f32_16x16x32_bf16 v[180:183], a[164:167], v[88:91], v[180:183]
    ds_read_b64_tr_b16 a[14:15], v19 offset:6144
    v_exp_f32 v54, v54
    v_mfma_f32_16x16x32_bf16 v[184:187], a[164:167], v[96:99], v[184:187]
    ds_read_b128 a[160:163], v27 offset:22528
    v_mfma_f32_16x16x32_bf16 v[188:191], a[164:167], v[104:107], v[188:191]
    v_exp_f32 v55, v55
    v_mfma_f32_16x16x32_bf16 v[192:195], a[168:171], v[80:83], v[192:195]
    v_cvt_pk_bf16_f32 v50, v52, v53
    ds_read_b128 a[164:167], v26 offset:28672
    v_mfma_f32_16x16x32_bf16 v[196:199], a[168:171], v[88:91], v[196:199]
    v_exp_f32 v56, v56
    v_mfma_f32_16x16x32_bf16 v[200:203], a[168:171], v[96:99], v[200:203]
    v_exp_f32 v57, v57
    v_mfma_f32_16x16x32_bf16 v[204:207], a[168:171], v[104:107], v[204:207]
    v_cvt_pk_bf16_f32 v51, v54, v55
    v_mfma_f32_16x16x32_bf16 v[208:211], a[172:175], v[80:83], v[208:211]
    v_exp_f32 v58, v58
    v_mfma_f32_16x16x32_bf16 v[212:215], a[172:175], v[88:91], v[212:215]
    ds_read_b128 a[168:171], v26 offset:30720
    v_mfma_f32_16x16x32_bf16 v[216:219], a[172:175], v[96:99], v[216:219]
    s_waitcnt lgkmcnt(3)
    v_mfma_f32_16x16x32_bf16 v[220:223], a[172:175], v[104:107], v[220:223]
    v_exp_f32 v59, v59
    v_mfma_f32_16x16x32_bf16 v[224:227], a[176:179], v[80:83], v[224:227]
    v_cvt_pk_bf16_f32 v56, v56, v57
    ds_read_b128 a[172:175], v27 offset:28672
    v_mfma_f32_16x16x32_bf16 v[228:231], a[176:179], v[88:91], v[228:231]
    buffer_store_dwordx4 a[0:3], v2, s[16:19], s49 offen sc1
    s_add_u32 s49, s49, s51
    v_mfma_f32_16x16x32_bf16 v[240:243], a[0:3], a[248:251], 0
    v_exp_f32 v60, v60
    v_mfma_f32_16x16x32_bf16 v[232:235], a[176:179], v[96:99], v[232:235]
    v_exp_f32 v61, v61
    v_mfma_f32_16x16x32_bf16 v[236:239], a[176:179], v[104:107], v[236:239]
    v_cvt_pk_bf16_f32 v57, v58, v59
    v_mfma_f32_16x16x32_bf16 a[128:131], a[144:147], v[80:83], a[128:131]
    buffer_store_dwordx4 a[4:7], v2, s[16:19], s49 offen sc1
    v_mfma_f32_16x16x32_bf16 a[132:135], a[144:147], v[88:91], a[132:135]
    s_add_u32 s49, s49, s51
    v_mfma_f32_16x16x32_bf16 v[244:247], a[4:7], a[248:251], 0
    v_exp_f32 v62, v62
    v_mfma_f32_16x16x32_bf16 a[136:139], a[144:147], v[96:99], a[136:139]
    v_exp_f32 v63, v63
    v_mfma_f32_16x16x32_bf16 a[140:143], a[144:147], v[104:107], a[140:143]
    v_cvt_pk_bf16_f32 v58, v60, v61
    s_waitcnt lgkmcnt(3)
    v_mfma_f32_16x16x32_bf16 v[80:83], a[148:151], a[64:67], v[32:35]
    buffer_store_dwordx4 a[8:11], v2, s[16:19], s49 offen sc1
    v_mfma_f32_16x16x32_bf16 v[88:91], a[148:151], a[80:83], v[36:39]
    s_add_u32 s49, s49, s51
    v_mfma_f32_16x16x32_bf16 v[248:251], a[8:11], a[248:251], 0
    v_mfma_f32_16x16x32_bf16 v[96:99], a[148:151], a[96:99], v[40:43]
    v_exp_f32 v64, v64
    v_mfma_f32_16x16x32_bf16 v[104:107], a[148:151], a[112:115], v[44:47]
    ds_read_b128 a[176:179], v27 offset:30720
    v_exp_f32 v65, v65
    s_waitcnt vmcnt(19)
    s_barrier
    v_mfma_f32_16x16x32_bf16 v[84:87], a[152:155], a[64:67], v[32:35]
    v_cvt_pk_bf16_f32 v59, v62, v63
    ds_read_b64_tr_b16 a[148:149], v20 offset:32768
    v_mfma_f32_16x16x32_bf16 v[92:95], a[152:155], a[80:83], v[36:39]
    buffer_store_dwordx4 a[12:15], v2, s[16:19], s49 offen sc1
    v_mfma_f32_16x16x32_bf16 v[100:103], a[152:155], a[96:99], v[40:43]
    v_exp_f32 v66, v66
    v_mfma_f32_16x16x32_bf16 v[108:111], a[152:155], a[112:115], v[44:47]
    ds_read_b64_tr_b16 a[150:151], v20 offset:34816
    v_exp_f32 v67, v67
    v_mfma_f32_16x16x32_bf16 v[80:83], a[156:159], a[68:71], v[80:83]
    v_cvt_pk_bf16_f32 v64, v64, v65
    ds_read_b64_tr_b16 a[152:153], v21 offset:32768
    v_mfma_f32_16x16x32_bf16 v[88:91], a[156:159], a[84:87], v[88:91]
    v_exp_f32 v68, v68
    v_mfma_f32_16x16x32_bf16 v[96:99], a[156:159], a[100:103], v[96:99]
    ds_read_b64_tr_b16 a[154:155], v21 offset:34816
    v_mfma_f32_16x16x32_bf16 v[104:107], a[156:159], a[116:119], v[104:107]
    v_exp_f32 v69, v69
    v_mfma_f32_16x16x32_bf16 v[84:87], a[160:163], a[68:71], v[84:87]
    buffer_store_dwordx4 v[240:243], v255, s[16:19], s52 offen offset:0 sc1
    v_mfma_f32_16x16x32_bf16 v[92:95], a[160:163], a[84:87], v[92:95]
    v_cvt_pk_bf16_f32 v65, v66, v67
    ds_read_b64_tr_b16 a[156:157], v22 offset:32768
    v_mfma_f32_16x16x32_bf16 v[100:103], a[160:163], a[100:103], v[100:103]
    v_mfma_f32_16x16x32_bf16 v[240:243], a[12:15], a[248:251], 0
    v_exp_f32 v70, v70
    v_mfma_f32_16x16x32_bf16 v[108:111], a[160:163], a[116:119], v[108:111]
    ds_read_b64_tr_b16 a[158:159], v22 offset:34816
    s_waitcnt lgkmcnt(6)
    v_mfma_f32_16x16x32_bf16 v[80:83], a[164:167], a[72:75], v[80:83]
    v_exp_f32 v71, v71
    v_mfma_f32_16x16x32_bf16 v[88:91], a[164:167], a[88:91], v[88:91]
    buffer_store_dwordx4 v[244:247], v255, s[16:19], s52 offen offset:256 sc1
    v_cvt_pk_bf16_f32 v66, v68, v69
    v_mfma_f32_16x16x32_bf16 v[96:99], a[164:167], a[104:107], v[96:99]
    v_exp_f32 v72, v72
    v_mfma_f32_16x16x32_bf16 v[104:107], a[164:167], a[120:123], v[104:107]
    ds_read_b64_tr_b16 a[160:161], v23 offset:32768
    ds_read_b64_tr_b16 a[162:163], v23 offset:34816
    v_mfma_f32_16x16x32_bf16 v[84:87], a[168:171], a[72:75], v[84:87]
    buffer_store_dwordx4 v[248:251], v255, s[16:19], s52 offen offset:512 sc1
    v_exp_f32 v73, v73
    v_mfma_f32_16x16x32_bf16 v[92:95], a[168:171], a[88:91], v[92:95]
    v_cvt_pk_bf16_f32 v67, v70, v71
    ds_read_b64_tr_b16 a[164:165], v20 offset:40960
    v_mfma_f32_16x16x32_bf16 v[100:103], a[168:171], a[104:107], v[100:103]
    v_exp_f32 v74, v74
    v_mfma_f32_16x16x32_bf16 v[108:111], a[168:171], a[120:123], v[108:111]
    ds_read_b64_tr_b16 a[166:167], v20 offset:43008
    v_mfma_f32_16x16x32_bf16 v[80:83], a[172:175], a[76:79], v[80:83]
    v_exp_f32 v75, v75
    v_mfma_f32_16x16x32_bf16 v[88:91], a[172:175], a[92:95], v[88:91]
    v_cvt_pk_bf16_f32 v72, v72, v73
    ds_read_b64_tr_b16 a[168:169], v21 offset:40960
    v_mfma_f32_16x16x32_bf16 v[96:99], a[172:175], a[108:111], v[96:99]
    buffer_store_dwordx4 v[240:243], v255, s[16:19], s52 offen offset:768 sc1
    v_exp_f32 v76, v76
    v_mfma_f32_16x16x32_bf16 v[104:107], a[172:175], a[124:127], v[104:107]
    ds_read_b64_tr_b16 a[170:171], v21 offset:43008
    v_mfma_f32_16x16x32_bf16 v[84:87], a[176:179], a[76:79], v[84:87]
    v_exp_f32 v77, v77
    v_mfma_f32_16x16x32_bf16 v[92:95], a[176:179], a[92:95], v[92:95]
    v_cvt_pk_bf16_f32 v73, v74, v75
    v_exp_f32 v78, v78
    v_exp_f32 v79, v79
    v_cvt_pk_bf16_f32 v74, v76, v77
    v_mfma_f32_16x16x32_bf16 v[100:103], a[176:179], a[108:111], v[100:103]
    v_cvt_pk_bf16_f32 v75, v78, v79
    ds_read_b64_tr_b16 a[172:173], v22 offset:40960
    v_mfma_f32_16x16x32_bf16 v[108:111], a[176:179], a[124:127], v[108:111]
    ds_read_b64_tr_b16 a[174:175], v22 offset:43008
    s_waitcnt lgkmcnt(6)
    v_mfma_f32_16x16x32_bf16 v[112:115], a[148:151], v[48:51], v[112:115]
    ds_read_b64_tr_b16 a[176:177], v23 offset:40960
    ds_read_b64_tr_b16 a[178:179], v23 offset:43008
    v_mfma_f32_16x16x32_bf16 v[116:119], a[148:151], v[56:59], v[116:119]
    v_exp_f32 v80, v80
    v_mfma_f32_16x16x32_bf16 v[120:123], a[148:151], v[64:67], v[120:123]
    v_exp_f32 v81, v81
    v_mfma_f32_16x16x32_bf16 v[124:127], a[148:151], v[72:75], v[124:127]
    s_add_u32 m0, s37, s35
    v_mfma_f32_16x16x32_bf16 v[128:131], a[152:155], v[48:51], v[128:131]
    ds_read_b128 a[148:151], v26 offset:49152
    v_mfma_f32_16x16x32_bf16 v[132:135], a[152:155], v[56:59], v[132:135]
    v_exp_f32 v82, v82
    v_mfma_f32_16x16x32_bf16 v[136:139], a[152:155], v[64:67], v[136:139]
    buffer_load_dwordx4 v4, s[8:11], s32 offen offset:0 nt lds
    v_mfma_f32_16x16x32_bf16 v[140:143], a[152:155], v[72:75], v[140:143]
    v_exp_f32 v83, v83
    v_mfma_f32_16x16x32_bf16 v[144:147], a[156:159], v[48:51], v[144:147]
    ds_read_b128 a[152:155], v26 offset:51200
    v_cvt_pk_bf16_f32 v80, v80, v81
    v_mfma_f32_16x16x32_bf16 v[148:151], a[156:159], v[56:59], v[148:151]
    v_exp_f32 v84, v84
    v_mfma_f32_16x16x32_bf16 v[152:155], a[156:159], v[64:67], v[152:155]
    v_exp_f32 v85, v85
    v_mfma_f32_16x16x32_bf16 v[156:159], a[156:159], v[72:75], v[156:159]
    buffer_load_dwordx4 v5, s[8:11], s32 offen offset:1024 nt lds
    v_mfma_f32_16x16x32_bf16 v[160:163], a[160:163], v[48:51], v[160:163]
    ds_read_b128 a[156:159], v27 offset:49152
    v_cvt_pk_bf16_f32 v81, v82, v83
    v_mfma_f32_16x16x32_bf16 v[164:167], a[160:163], v[56:59], v[164:167]
    v_exp_f32 v86, v86
    v_mfma_f32_16x16x32_bf16 v[168:171], a[160:163], v[64:67], v[168:171]
    v_exp_f32 v87, v87
    v_mfma_f32_16x16x32_bf16 v[172:175], a[160:163], v[72:75], v[172:175]
    v_cvt_pk_bf16_f32 v82, v84, v85
    s_waitcnt lgkmcnt(3)
    v_mfma_f32_16x16x32_bf16 v[176:179], a[164:167], v[48:51], v[176:179]
    ds_read_b128 a[160:163], v27 offset:51200
    v_mfma_f32_16x16x32_bf16 v[180:183], a[164:167], v[56:59], v[180:183]
    v_exp_f32 v88, v88
    v_mfma_f32_16x16x32_bf16 v[184:187], a[164:167], v[64:67], v[184:187]
    buffer_load_dwordx4 v6, s[8:11], s32 offen offset:2048 nt lds
    v_mfma_f32_16x16x32_bf16 v[188:191], a[164:167], v[72:75], v[188:191]
    v_exp_f32 v89, v89
    v_mfma_f32_16x16x32_bf16 v[192:195], a[168:171], v[48:51], v[192:195]
    ds_read_b128 a[164:167], v26 offset:57344
    v_cvt_pk_bf16_f32 v83, v86, v87
    v_mfma_f32_16x16x32_bf16 v[196:199], a[168:171], v[56:59], v[196:199]
    v_exp_f32 v90, v90
    v_mfma_f32_16x16x32_bf16 v[200:203], a[168:171], v[64:67], v[200:203]
    v_exp_f32 v91, v91
    v_mfma_f32_16x16x32_bf16 v[204:207], a[168:171], v[72:75], v[204:207]
    buffer_load_dwordx4 v7, s[8:11], s32 offen offset:3072 nt lds
    v_mfma_f32_16x16x32_bf16 v[208:211], a[172:175], v[48:51], v[208:211]
    ds_read_b128 a[168:171], v26 offset:59392
    v_cvt_pk_bf16_f32 v88, v88, v89
    v_mfma_f32_16x16x32_bf16 v[212:215], a[172:175], v[56:59], v[212:215]
    v_exp_f32 v92, v92
    v_mfma_f32_16x16x32_bf16 v[216:219], a[172:175], v[64:67], v[216:219]
    v_exp_f32 v93, v93
    v_mfma_f32_16x16x32_bf16 v[220:223], a[172:175], v[72:75], v[220:223]
    v_cvt_pk_bf16_f32 v89, v90, v91
    s_add_u32 m0, s37, s36
    v_mfma_f32_16x16x32_bf16 v[224:227], a[176:179], v[48:51], v[224:227]
    v_exp_f32 v94, v94
    v_mfma_f32_16x16x32_bf16 v[228:231], a[176:179], v[56:59], v[228:231]
    buffer_load_dwordx4 v8, s[12:15], s33 offen offset:0 nt lds
    v_mfma_f32_16x16x32_bf16 v[232:235], a[176:179], v[64:67], v[232:235]
    ds_read_b128 a[172:175], v27 offset:57344
    v_mfma_f32_16x16x32_bf16 v[236:239], a[176:179], v[72:75], v[236:239]
    v_exp_f32 v95, v95
    v_mfma_f32_16x16x32_bf16 a[128:131], a[144:147], v[48:51], a[128:131]
    v_cvt_pk_bf16_f32 v90, v92, v93
    v_mfma_f32_16x16x32_bf16 a[132:135], a[144:147], v[56:59], a[132:135]
    v_exp_f32 v96, v96
    v_mfma_f32_16x16x32_bf16 a[136:139], a[144:147], v[64:67], a[136:139]
    v_exp_f32 v97, v97
    v_mfma_f32_16x16x32_bf16 a[140:143], a[144:147], v[72:75], a[140:143]
    v_cvt_pk_bf16_f32 v91, v94, v95
    s_waitcnt lgkmcnt(3)
    v_mfma_f32_16x16x32_bf16 v[48:51], a[148:151], a[64:67], v[32:35]
    ds_read_b128 a[176:179], v27 offset:59392
    v_mfma_f32_16x16x32_bf16 v[56:59], a[148:151], a[80:83], v[36:39]
    buffer_load_dwordx4 v9, s[12:15], s33 offen offset:1024 nt lds
    v_mfma_f32_16x16x32_bf16 v[64:67], a[148:151], a[96:99], v[40:43]
    v_exp_f32 v98, v98
    v_mfma_f32_16x16x32_bf16 v[72:75], a[148:151], a[112:115], v[44:47]
    v_exp_f32 v99, v99
    v_mfma_f32_16x16x32_bf16 v[52:55], a[152:155], a[64:67], v[32:35]
    ds_read_b64_tr_b16 a[148:149], v20 offset:36864
    ds_read_b64_tr_b16 a[150:151], v20 offset:38912
    v_mfma_f32_16x16x32_bf16 v[60:63], a[152:155], a[80:83], v[36:39]
    v_cvt_pk_bf16_f32 v96, v96, v97
    v_mfma_f32_16x16x32_bf16 v[68:71], a[152:155], a[96:99], v[40:43]
    buffer_load_dwordx4 v10, s[12:15], s33 offen offset:2048 nt lds
    v_mfma_f32_16x16x32_bf16 v[76:79], a[152:155], a[112:115], v[44:47]
    v_exp_f32 v100, v100
    v_mfma_f32_16x16x32_bf16 v[48:51], a[156:159], a[68:71], v[48:51]
    ds_read_b64_tr_b16 a[152:153], v21 offset:36864
    ds_read_b64_tr_b16 a[154:155], v21 offset:38912
    v_mfma_f32_16x16x32_bf16 v[56:59], a[156:159], a[84:87], v[56:59]
    v_exp_f32 v101, v101
    v_mfma_f32_16x16x32_bf16 v[64:67], a[156:159], a[100:103], v[64:67]
    v_cvt_pk_bf16_f32 v97, v98, v99
    v_mfma_f32_16x16x32_bf16 v[72:75], a[156:159], a[116:119], v[72:75]
    v_exp_f32 v102, v102
    v_mfma_f32_16x16x32_bf16 v[52:55], a[160:163], a[68:71], v[52:55]
    ds_read_b64_tr_b16 a[156:157], v22 offset:36864
    ds_read_b64_tr_b16 a[158:159], v22 offset:38912
    v_mfma_f32_16x16x32_bf16 v[60:63], a[160:163], a[84:87], v[60:63]
    buffer_load_dwordx4 v11, s[12:15], s33 offen offset:3072 nt lds
    v_mfma_f32_16x16x32_bf16 v[68:71], a[160:163], a[100:103], v[68:71]
    v_exp_f32 v103, v103
    v_mfma_f32_16x16x32_bf16 v[76:79], a[160:163], a[116:119], v[76:79]
    v_cvt_pk_bf16_f32 v98, v100, v101
    s_waitcnt lgkmcnt(6)
    v_mfma_f32_16x16x32_bf16 v[48:51], a[164:167], a[72:75], v[48:51]
    v_exp_f32 v104, v104
    v_mfma_f32_16x16x32_bf16 v[56:59], a[164:167], a[88:91], v[56:59]
    ds_read_b64_tr_b16 a[160:161], v23 offset:36864
    ds_read_b64_tr_b16 a[162:163], v23 offset:38912
    v_mfma_f32_16x16x32_bf16 v[64:67], a[164:167], a[104:107], v[64:67]
    v_exp_f32 v105, v105
    v_mfma_f32_16x16x32_bf16 v[72:75], a[164:167], a[120:123], v[72:75]
    v_cvt_pk_bf16_f32 v99, v102, v103
    s_add_u32 s32, s32, s34
    v_mfma_f32_16x16x32_bf16 v[52:55], a[168:171], a[72:75], v[52:55]
    v_exp_f32 v106, v106
    v_mfma_f32_16x16x32_bf16 v[60:63], a[168:171], a[88:91], v[60:63]
    ds_read_b64_tr_b16 a[164:165], v20 offset:45056
    ds_read_b64_tr_b16 a[166:167], v20 offset:47104
    v_mfma_f32_16x16x32_bf16 v[68:71], a[168:171], a[104:107], v[68:71]
    v_exp_f32 v107, v107
    v_mfma_f32_16x16x32_bf16 v[76:79], a[168:171], a[120:123], v[76:79]
    v_cvt_pk_bf16_f32 v104, v104, v105
    s_add_u32 s33, s33, s34
    v_mfma_f32_16x16x32_bf16 v[48:51], a[172:175], a[76:79], v[48:51]
    v_exp_f32 v108, v108
    v_mfma_f32_16x16x32_bf16 v[56:59], a[172:175], a[92:95], v[56:59]
    ds_read_b64_tr_b16 a[168:169], v21 offset:45056
    ds_read_b64_tr_b16 a[170:171], v21 offset:47104
    v_mfma_f32_16x16x32_bf16 v[64:67], a[172:175], a[108:111], v[64:67]
    v_exp_f32 v109, v109
    v_mfma_f32_16x16x32_bf16 v[72:75], a[172:175], a[124:127], v[72:75]
    v_cvt_pk_bf16_f32 v105, v106, v107
    s_add_u32 s37, s37, 0x8000
    v_mfma_f32_16x16x32_bf16 v[52:55], a[176:179], a[76:79], v[52:55]
    v_exp_f32 v110, v110
    v_mfma_f32_16x16x32_bf16 v[60:63], a[176:179], a[92:95], v[60:63]
    v_exp_f32 v111, v111
    v_cvt_pk_bf16_f32 v106, v108, v109
    v_mfma_f32_16x16x32_bf16 v[68:71], a[176:179], a[108:111], v[68:71]
    v_cvt_pk_bf16_f32 v107, v110, v111
    ds_read_b64_tr_b16 a[172:173], v22 offset:45056
    v_mfma_f32_16x16x32_bf16 v[76:79], a[176:179], a[124:127], v[76:79]
    ds_read_b64_tr_b16 a[174:175], v22 offset:47104
    s_waitcnt lgkmcnt(6)
    v_mfma_f32_16x16x32_bf16 v[112:115], a[148:151], v[80:83], v[112:115]
    s_and_b32 s37, s37, 0x1ffff
    ds_read_b64_tr_b16 a[176:177], v23 offset:45056
    v_mfma_f32_16x16x32_bf16 v[116:119], a[148:151], v[88:91], v[116:119]
    ds_read_b64_tr_b16 a[178:179], v23 offset:47104
    v_mfma_f32_16x16x32_bf16 v[120:123], a[148:151], v[96:99], v[120:123]
    v_exp_f32 v48, v48
    v_mfma_f32_16x16x32_bf16 v[124:127], a[148:151], v[104:107], v[124:127]
    v_exp_f32 v49, v49
    v_mfma_f32_16x16x32_bf16 v[128:131], a[152:155], v[80:83], v[128:131]
    ds_read_b128 a[148:151], v26 offset:53248
    v_mfma_f32_16x16x32_bf16 v[132:135], a[152:155], v[88:91], v[132:135]
    v_exp_f32 v50, v50
    v_mfma_f32_16x16x32_bf16 v[136:139], a[152:155], v[96:99], v[136:139]
    v_exp_f32 v51, v51
    v_mfma_f32_16x16x32_bf16 v[140:143], a[152:155], v[104:107], v[140:143]
    v_cvt_pk_bf16_f32 v48, v48, v49
    v_mfma_f32_16x16x32_bf16 v[144:147], a[156:159], v[80:83], v[144:147]
    ds_read_b128 a[152:155], v26 offset:55296
    v_mfma_f32_16x16x32_bf16 v[148:151], a[156:159], v[88:91], v[148:151]
    v_exp_f32 v52, v52
    v_mfma_f32_16x16x32_bf16 v[152:155], a[156:159], v[96:99], v[152:155]
    v_exp_f32 v53, v53
    v_mfma_f32_16x16x32_bf16 v[156:159], a[156:159], v[104:107], v[156:159]
    v_cvt_pk_bf16_f32 v49, v50, v51
    v_mfma_f32_16x16x32_bf16 v[160:163], a[160:163], v[80:83], v[160:163]
    ds_read_b128 a[156:159], v27 offset:53248
    v_mfma_f32_16x16x32_bf16 v[164:167], a[160:163], v[88:91], v[164:167]
    v_exp_f32 v54, v54
    v_mfma_f32_16x16x32_bf16 v[168:171], a[160:163], v[96:99], v[168:171]
    v_exp_f32 v55, v55
    v_mfma_f32_16x16x32_bf16 v[172:175], a[160:163], v[104:107], v[172:175]
    v_cvt_pk_bf16_f32 v50, v52, v53
    s_waitcnt lgkmcnt(3)
    v_mfma_f32_16x16x32_bf16 v[176:179], a[164:167], v[80:83], v[176:179]
    ds_read_b128 a[160:163], v27 offset:55296
    v_mfma_f32_16x16x32_bf16 v[180:183], a[164:167], v[88:91], v[180:183]
    v_exp_f32 v56, v56
    v_mfma_f32_16x16x32_bf16 v[184:187], a[164:167], v[96:99], v[184:187]
    v_exp_f32 v57, v57
    v_mfma_f32_16x16x32_bf16 v[188:191], a[164:167], v[104:107], v[188:191]
    v_cvt_pk_bf16_f32 v51, v54, v55
    v_mfma_f32_16x16x32_bf16 v[192:195], a[168:171], v[80:83], v[192:195]
    ds_read_b128 a[164:167], v26 offset:61440
    v_mfma_f32_16x16x32_bf16 v[196:199], a[168:171], v[88:91], v[196:199]
    v_exp_f32 v58, v58
    v_mfma_f32_16x16x32_bf16 v[200:203], a[168:171], v[96:99], v[200:203]
    v_exp_f32 v59, v59
    v_mfma_f32_16x16x32_bf16 v[204:207], a[168:171], v[104:107], v[204:207]
    v_cvt_pk_bf16_f32 v56, v56, v57
    v_mfma_f32_16x16x32_bf16 v[208:211], a[172:175], v[80:83], v[208:211]
    ds_read_b128 a[168:171], v26 offset:63488
    v_mfma_f32_16x16x32_bf16 v[212:215], a[172:175], v[88:91], v[212:215]
    v_exp_f32 v60, v60
    v_mfma_f32_16x16x32_bf16 v[216:219], a[172:175], v[96:99], v[216:219]
    v_exp_f32 v61, v61
    v_mfma_f32_16x16x32_bf16 v[220:223], a[172:175], v[104:107], v[220:223]
    v_cvt_pk_bf16_f32 v57, v58, v59
    v_mfma_f32_16x16x32_bf16 v[224:227], a[176:179], v[80:83], v[224:227]
    v_exp_f32 v62, v62
    v_mfma_f32_16x16x32_bf16 v[228:231], a[176:179], v[88:91], v[228:231]
    ds_read_b128 a[172:175], v27 offset:61440
    v_mfma_f32_16x16x32_bf16 v[232:235], a[176:179], v[96:99], v[232:235]
    v_exp_f32 v63, v63
    v_mfma_f32_16x16x32_bf16 v[236:239], a[176:179], v[104:107], v[236:239]
    v_cvt_pk_bf16_f32 v58, v60, v61
    v_mfma_f32_16x16x32_bf16 a[128:131], a[144:147], v[80:83], a[128:131]
    v_exp_f32 v64, v64
    v_mfma_f32_16x16x32_bf16 a[132:135], a[144:147], v[88:91], a[132:135]
    v_exp_f32 v65, v65
    v_mfma_f32_16x16x32_bf16 a[136:139], a[144:147], v[96:99], a[136:139]
    v_cvt_pk_bf16_f32 v59, v62, v63
    s_lshl_b32 s41, s2, 2
    v_mfma_f32_16x16x32_bf16 a[140:143], a[144:147], v[104:107], a[140:143]
    s_add_u32 s41, s41, s3
    s_waitcnt lgkmcnt(3)
    v_mfma_f32_16x16x32_bf16 v[80:83], a[148:151], a[64:67], v[32:35]
    ds_read_b128 a[176:179], v27 offset:63488
    s_lshl_b32 s41, s41, 2
    v_mfma_f32_16x16x32_bf16 v[88:91], a[148:151], a[80:83], v[36:39]
    v_exp_f32 v66, v66
    v_mfma_f32_16x16x32_bf16 v[96:99], a[148:151], a[96:99], v[40:43]
    v_exp_f32 v67, v67
    v_mfma_f32_16x16x32_bf16 v[104:107], a[148:151], a[112:115], v[44:47]
    s_waitcnt vmcnt(20)
    s_barrier
    v_mfma_f32_16x16x32_bf16 v[84:87], a[152:155], a[64:67], v[32:35]
    ds_read_b64_tr_b16 a[148:149], v12 offset:0
    ds_read_b64_tr_b16 a[150:151], v12 offset:2048
    v_mfma_f32_16x16x32_bf16 v[92:95], a[152:155], a[80:83], v[36:39]
    s_add_u32 s41, s41, 737280
    s_waitcnt vmcnt(8)
    v_mfma_f32_16x16x32_bf16 v[100:103], a[152:155], a[96:99], v[40:43]
    buffer_store_dword v0, v28, s[16:19], s41 offen sc1
    v_mfma_f32_16x16x32_bf16 v[108:111], a[152:155], a[112:115], v[44:47]
    v_cvt_pk_bf16_f32 v64, v64, v65
    v_mfma_f32_16x16x32_bf16 v[80:83], a[156:159], a[68:71], v[80:83]
    v_exp_f32 v68, v68
    v_mfma_f32_16x16x32_bf16 v[88:91], a[156:159], a[84:87], v[88:91]
    ds_read_b64_tr_b16 a[152:153], v13 offset:0
    ds_read_b64_tr_b16 a[154:155], v13 offset:2048
    v_mfma_f32_16x16x32_bf16 v[96:99], a[156:159], a[100:103], v[96:99]
    v_exp_f32 v69, v69
    v_mfma_f32_16x16x32_bf16 v[104:107], a[156:159], a[116:119], v[104:107]
    v_cvt_pk_bf16_f32 v65, v66, v67
    v_mfma_f32_16x16x32_bf16 v[84:87], a[160:163], a[68:71], v[84:87]
    v_exp_f32 v70, v70
    v_mfma_f32_16x16x32_bf16 v[92:95], a[160:163], a[84:87], v[92:95]
    ds_read_b64_tr_b16 a[156:157], v14 offset:0
    ds_read_b64_tr_b16 a[158:159], v14 offset:2048
    v_mfma_f32_16x16x32_bf16 v[100:103], a[160:163], a[100:103], v[100:103]
    v_exp_f32 v71, v71
    v_mfma_f32_16x16x32_bf16 v[108:111], a[160:163], a[116:119], v[108:111]
    v_cvt_pk_bf16_f32 v66, v68, v69
    s_waitcnt lgkmcnt(6)
    v_mfma_f32_16x16x32_bf16 v[80:83], a[164:167], a[72:75], v[80:83]
    v_exp_f32 v72, v72
    v_mfma_f32_16x16x32_bf16 v[88:91], a[164:167], a[88:91], v[88:91]
    ds_read_b64_tr_b16 a[160:161], v15 offset:0
    ds_read_b64_tr_b16 a[162:163], v15 offset:2048
    v_mfma_f32_16x16x32_bf16 v[96:99], a[164:167], a[104:107], v[96:99]
    v_exp_f32 v73, v73
    v_mfma_f32_16x16x32_bf16 v[104:107], a[164:167], a[120:123], v[104:107]
    v_cvt_pk_bf16_f32 v67, v70, v71
    v_mfma_f32_16x16x32_bf16 v[84:87], a[168:171], a[72:75], v[84:87]
    v_exp_f32 v74, v74
    v_mfma_f32_16x16x32_bf16 v[92:95], a[168:171], a[88:91], v[92:95]
    ds_read_b64_tr_b16 a[164:165], v12 offset:8192
    ds_read_b64_tr_b16 a[166:167], v12 offset:10240
    v_mfma_f32_16x16x32_bf16 v[100:103], a[168:171], a[104:107], v[100:103]
    v_exp_f32 v75, v75
    v_mfma_f32_16x16x32_bf16 v[108:111], a[168:171], a[120:123], v[108:111]
    v_cvt_pk_bf16_f32 v72, v72, v73
    v_mfma_f32_16x16x32_bf16 v[80:83], a[172:175], a[76:79], v[80:83]
    v_exp_f32 v76, v76
    v_mfma_f32_16x16x32_bf16 v[88:91], a[172:175], a[92:95], v[88:91]
    ds_read_b64_tr_b16 a[168:169], v13 offset:8192
    ds_read_b64_tr_b16 a[170:171], v13 offset:10240
    v_mfma_f32_16x16x32_bf16 v[96:99], a[172:175], a[108:111], v[96:99]
    v_exp_f32 v77, v77
    v_mfma_f32_16x16x32_bf16 v[104:107], a[172:175], a[124:127], v[104:107]
    v_cvt_pk_bf16_f32 v73, v74, v75
    v_mfma_f32_16x16x32_bf16 v[84:87], a[176:179], a[76:79], v[84:87]
    v_exp_f32 v78, v78
    v_mfma_f32_16x16x32_bf16 v[92:95], a[176:179], a[92:95], v[92:95]
    v_exp_f32 v79, v79
    v_cvt_pk_bf16_f32 v74, v76, v77
    v_mfma_f32_16x16x32_bf16 v[100:103], a[176:179], a[108:111], v[100:103]
    v_cvt_pk_bf16_f32 v75, v78, v79
    ds_read_b64_tr_b16 a[172:173], v14 offset:8192
    v_mfma_f32_16x16x32_bf16 v[108:111], a[176:179], a[124:127], v[108:111]
    ds_read_b64_tr_b16 a[174:175], v14 offset:10240
    s_load_dwordx2 s[56:57], s[0:1], 0
    s_waitcnt lgkmcnt(6)
    v_mfma_f32_16x16x32_bf16 v[112:115], a[148:151], v[48:51], v[112:115]
    ds_read_b64_tr_b16 a[176:177], v15 offset:8192
    ds_read_b64_tr_b16 a[178:179], v15 offset:10240
    v_mfma_f32_16x16x32_bf16 v[116:119], a[148:151], v[56:59], v[116:119]
    v_exp_f32 v80, v80
    v_mfma_f32_16x16x32_bf16 v[120:123], a[148:151], v[64:67], v[120:123]
    v_exp_f32 v81, v81
    v_mfma_f32_16x16x32_bf16 v[124:127], a[148:151], v[72:75], v[124:127]
    s_add_u32 m0, s37, s35
    v_mfma_f32_16x16x32_bf16 v[128:131], a[152:155], v[48:51], v[128:131]
    ds_read_b128 a[148:151], v24 offset:16384
    v_mfma_f32_16x16x32_bf16 v[132:135], a[152:155], v[56:59], v[132:135]
    v_exp_f32 v82, v82
    v_mfma_f32_16x16x32_bf16 v[136:139], a[152:155], v[64:67], v[136:139]
    buffer_load_dwordx4 v4, s[8:11], s32 offen offset:0 nt lds
    v_mfma_f32_16x16x32_bf16 v[140:143], a[152:155], v[72:75], v[140:143]
    v_exp_f32 v83, v83
    v_mfma_f32_16x16x32_bf16 v[144:147], a[156:159], v[48:51], v[144:147]
    ds_read_b128 a[152:155], v24 offset:18432
    v_cvt_pk_bf16_f32 v80, v80, v81
    v_mfma_f32_16x16x32_bf16 v[148:151], a[156:159], v[56:59], v[148:151]
    v_exp_f32 v84, v84
    v_mfma_f32_16x16x32_bf16 v[152:155], a[156:159], v[64:67], v[152:155]
    v_exp_f32 v85, v85
    v_mfma_f32_16x16x32_bf16 v[156:159], a[156:159], v[72:75], v[156:159]
    buffer_load_dwordx4 v5, s[8:11], s32 offen offset:1024 nt lds
    v_mfma_f32_16x16x32_bf16 v[160:163], a[160:163], v[48:51], v[160:163]
    ds_read_b128 a[156:159], v25 offset:16384
    v_cvt_pk_bf16_f32 v81, v82, v83
    v_mfma_f32_16x16x32_bf16 v[164:167], a[160:163], v[56:59], v[164:167]
    v_exp_f32 v86, v86
    v_mfma_f32_16x16x32_bf16 v[168:171], a[160:163], v[64:67], v[168:171]
    v_exp_f32 v87, v87
    v_mfma_f32_16x16x32_bf16 v[172:175], a[160:163], v[72:75], v[172:175]
    v_cvt_pk_bf16_f32 v82, v84, v85
    s_waitcnt lgkmcnt(3)
    v_mfma_f32_16x16x32_bf16 v[176:179], a[164:167], v[48:51], v[176:179]
    ds_read_b128 a[160:163], v25 offset:18432
    v_mfma_f32_16x16x32_bf16 v[180:183], a[164:167], v[56:59], v[180:183]
    v_exp_f32 v88, v88
    v_mfma_f32_16x16x32_bf16 v[184:187], a[164:167], v[64:67], v[184:187]
    buffer_load_dwordx4 v6, s[8:11], s32 offen offset:2048 nt lds
    v_mfma_f32_16x16x32_bf16 v[188:191], a[164:167], v[72:75], v[188:191]
    v_exp_f32 v89, v89
    v_mfma_f32_16x16x32_bf16 v[192:195], a[168:171], v[48:51], v[192:195]
    ds_read_b128 a[164:167], v24 offset:24576
    v_cvt_pk_bf16_f32 v83, v86, v87
    v_mfma_f32_16x16x32_bf16 v[196:199], a[168:171], v[56:59], v[196:199]
    v_exp_f32 v90, v90
    v_mfma_f32_16x16x32_bf16 v[200:203], a[168:171], v[64:67], v[200:203]
    v_exp_f32 v91, v91
    v_mfma_f32_16x16x32_bf16 v[204:207], a[168:171], v[72:75], v[204:207]
    buffer_load_dwordx4 v7, s[8:11], s32 offen offset:3072 nt lds
    v_mfma_f32_16x16x32_bf16 v[208:211], a[172:175], v[48:51], v[208:211]
    ds_read_b128 a[168:171], v24 offset:26624
    v_cvt_pk_bf16_f32 v88, v88, v89
    v_mfma_f32_16x16x32_bf16 v[212:215], a[172:175], v[56:59], v[212:215]
    v_exp_f32 v92, v92
    v_mfma_f32_16x16x32_bf16 v[216:219], a[172:175], v[64:67], v[216:219]
    v_exp_f32 v93, v93
    v_mfma_f32_16x16x32_bf16 v[220:223], a[172:175], v[72:75], v[220:223]
    v_cvt_pk_bf16_f32 v89, v90, v91
    s_add_u32 m0, s37, s36
    v_mfma_f32_16x16x32_bf16 v[224:227], a[176:179], v[48:51], v[224:227]
    v_exp_f32 v94, v94
    v_mfma_f32_16x16x32_bf16 v[228:231], a[176:179], v[56:59], v[228:231]
    buffer_load_dwordx4 v8, s[12:15], s33 offen offset:0 nt lds
    v_mfma_f32_16x16x32_bf16 v[232:235], a[176:179], v[64:67], v[232:235]
    ds_read_b128 a[172:175], v25 offset:24576
    v_mfma_f32_16x16x32_bf16 v[236:239], a[176:179], v[72:75], v[236:239]
    v_exp_f32 v95, v95
    v_mfma_f32_16x16x32_bf16 a[128:131], a[144:147], v[48:51], a[128:131]
    v_cvt_pk_bf16_f32 v90, v92, v93
    v_mfma_f32_16x16x32_bf16 a[132:135], a[144:147], v[56:59], a[132:135]
    v_exp_f32 v96, v96
    v_mfma_f32_16x16x32_bf16 a[136:139], a[144:147], v[64:67], a[136:139]
    v_exp_f32 v97, v97
    v_mfma_f32_16x16x32_bf16 a[140:143], a[144:147], v[72:75], a[140:143]
    v_cvt_pk_bf16_f32 v91, v94, v95
    s_waitcnt lgkmcnt(3)
    v_mfma_f32_16x16x32_bf16 v[48:51], a[148:151], a[64:67], v[32:35]
    ds_read_b128 a[176:179], v25 offset:26624
    v_mfma_f32_16x16x32_bf16 v[56:59], a[148:151], a[80:83], v[36:39]
    buffer_load_dwordx4 v9, s[12:15], s33 offen offset:1024 nt lds
    v_mfma_f32_16x16x32_bf16 v[64:67], a[148:151], a[96:99], v[40:43]
    v_exp_f32 v98, v98
    v_mfma_f32_16x16x32_bf16 v[72:75], a[148:151], a[112:115], v[44:47]
    v_exp_f32 v99, v99
    v_mfma_f32_16x16x32_bf16 v[52:55], a[152:155], a[64:67], v[32:35]
    ds_read_b64_tr_b16 a[148:149], v12 offset:4096
    ds_read_b64_tr_b16 a[150:151], v12 offset:6144
    v_mfma_f32_16x16x32_bf16 v[60:63], a[152:155], a[80:83], v[36:39]
    v_cvt_pk_bf16_f32 v96, v96, v97
    v_mfma_f32_16x16x32_bf16 v[68:71], a[152:155], a[96:99], v[40:43]
    buffer_load_dwordx4 v10, s[12:15], s33 offen offset:2048 nt lds
    v_mfma_f32_16x16x32_bf16 v[76:79], a[152:155], a[112:115], v[44:47]
    v_exp_f32 v100, v100
    v_mfma_f32_16x16x32_bf16 v[48:51], a[156:159], a[68:71], v[48:51]
    ds_read_b64_tr_b16 a[152:153], v13 offset:4096
    ds_read_b64_tr_b16 a[154:155], v13 offset:6144
    v_mfma_f32_16x16x32_bf16 v[56:59], a[156:159], a[84:87], v[56:59]
    v_exp_f32 v101, v101
    v_mfma_f32_16x16x32_bf16 v[64:67], a[156:159], a[100:103], v[64:67]
    v_cvt_pk_bf16_f32 v97, v98, v99
    v_mfma_f32_16x16x32_bf16 v[72:75], a[156:159], a[116:119], v[72:75]
    v_exp_f32 v102, v102
    v_mfma_f32_16x16x32_bf16 v[52:55], a[160:163], a[68:71], v[52:55]
    ds_read_b64_tr_b16 a[156:157], v14 offset:4096
    ds_read_b64_tr_b16 a[158:159], v14 offset:6144
    v_mfma_f32_16x16x32_bf16 v[60:63], a[160:163], a[84:87], v[60:63]
    buffer_load_dwordx4 v11, s[12:15], s33 offen offset:3072 nt lds
    v_mfma_f32_16x16x32_bf16 v[68:71], a[160:163], a[100:103], v[68:71]
    v_exp_f32 v103, v103
    v_mfma_f32_16x16x32_bf16 v[76:79], a[160:163], a[116:119], v[76:79]
    v_cvt_pk_bf16_f32 v98, v100, v101
    s_waitcnt lgkmcnt(6)
    v_mfma_f32_16x16x32_bf16 v[48:51], a[164:167], a[72:75], v[48:51]
    v_exp_f32 v104, v104
    v_mfma_f32_16x16x32_bf16 v[56:59], a[164:167], a[88:91], v[56:59]
    ds_read_b64_tr_b16 a[160:161], v15 offset:4096
    ds_read_b64_tr_b16 a[162:163], v15 offset:6144
    v_mfma_f32_16x16x32_bf16 v[64:67], a[164:167], a[104:107], v[64:67]
    v_exp_f32 v105, v105
    v_mfma_f32_16x16x32_bf16 v[72:75], a[164:167], a[120:123], v[72:75]
    v_cvt_pk_bf16_f32 v99, v102, v103
    s_add_u32 s32, s32, s34
    v_mfma_f32_16x16x32_bf16 v[52:55], a[168:171], a[72:75], v[52:55]
    s_waitcnt vmcnt(25)
    ds_read_b64_tr_b16 a[164:165], v12 offset:12288
    v_mfma_f32_16x16x32_bf16 v[60:63], a[168:171], a[88:91], v[60:63]
    v_exp_f32 v106, v106
    v_mfma_f32_16x16x32_bf16 v[68:71], a[168:171], a[104:107], v[68:71]
    ds_read_b64_tr_b16 a[166:167], v12 offset:14336
    ds_read_b64_tr_b16 a[0:1], v16 offset:0
    v_mfma_f32_16x16x32_bf16 v[76:79], a[168:171], a[120:123], v[76:79]
    v_exp_f32 v107, v107
    v_mfma_f32_16x16x32_bf16 v[48:51], a[172:175], a[76:79], v[48:51]
    ds_read_b64_tr_b16 a[2:3], v16 offset:2048
    v_cvt_pk_bf16_f32 v104, v104, v105
    v_mfma_f32_16x16x32_bf16 v[56:59], a[172:175], a[92:95], v[56:59]
    ds_read_b64_tr_b16 a[4:5], v17 offset:0
    ds_read_b64_tr_b16 a[168:169], v13 offset:12288
    v_mfma_f32_16x16x32_bf16 v[64:67], a[172:175], a[108:111], v[64:67]
    v_exp_f32 v108, v108
    v_mfma_f32_16x16x32_bf16 v[72:75], a[172:175], a[124:127], v[72:75]
    ds_read_b64_tr_b16 a[170:171], v13 offset:14336
    ds_read_b64_tr_b16 a[6:7], v17 offset:2048
    v_mfma_f32_16x16x32_bf16 v[52:55], a[176:179], a[76:79], v[52:55]
    ds_read_b64_tr_b16 a[8:9], v18 offset:0
    v_exp_f32 v109, v109
    v_mfma_f32_16x16x32_bf16 v[60:63], a[176:179], a[92:95], v[60:63]
    ds_read_b64_tr_b16 a[10:11], v18 offset:2048
    v_cvt_pk_bf16_f32 v105, v106, v107
    v_exp_f32 v110, v110
    v_exp_f32 v111, v111
    v_cvt_pk_bf16_f32 v106, v108, v109
    v_mfma_f32_16x16x32_bf16 v[68:71], a[176:179], a[108:111], v[68:71]
    ds_read_b64_tr_b16 a[12:13], v19 offset:0
    v_cvt_pk_bf16_f32 v107, v110, v111
    v_mfma_f32_16x16x32_bf16 v[76:79], a[176:179], a[124:127], v[76:79]
    ds_read_b64_tr_b16 a[172:173], v14 offset:12288
    ds_read_b64_tr_b16 a[174:175], v14 offset:14336
    ds_read_b64_tr_b16 a[14:15], v19 offset:2048
    s_waitcnt lgkmcnt(14)
    v_mfma_f32_16x16x32_bf16 v[112:115], a[148:151], v[80:83], v[112:115]
    s_add_u32 s33, s33, s34
    s_add_u32 s37, s37, 0x8000
    v_mfma_f32_16x16x32_bf16 v[116:119], a[148:151], v[88:91], v[116:119]
    s_and_b32 s37, s37, 0x1ffff
    ds_read_b64_tr_b16 a[176:177], v15 offset:12288
    v_mfma_f32_16x16x32_bf16 v[120:123], a[148:151], v[96:99], v[120:123]
    ds_read_b64_tr_b16 a[178:179], v15 offset:14336
    v_mfma_f32_16x16x32_bf16 v[124:127], a[148:151], v[104:107], v[124:127]
    v_exp_f32 v48, v48
    v_mfma_f32_16x16x32_bf16 v[128:131], a[152:155], v[80:83], v[128:131]
    ds_read_b128 a[148:151], v24 offset:20480
    v_mfma_f32_16x16x32_bf16 v[132:135], a[152:155], v[88:91], v[132:135]
    v_exp_f32 v49, v49
    v_mfma_f32_16x16x32_bf16 v[136:139], a[152:155], v[96:99], v[136:139]
    v_exp_f32 v50, v50
    v_mfma_f32_16x16x32_bf16 v[140:143], a[152:155], v[104:107], v[140:143]
    v_exp_f32 v51, v51
    v_mfma_f32_16x16x32_bf16 v[144:147], a[156:159], v[80:83], v[144:147]
    s_waitcnt lgkmcnt(3)
    ds_read_b128 a[152:155], v24 offset:22528
    v_mfma_f32_16x16x32_bf16 v[148:151], a[156:159], v[88:91], v[148:151]
    buffer_store_dwordx4 a[0:3], v2, s[16:19], s50 offen sc1
    v_mfma_f32_16x16x32_bf16 v[152:155], a[156:159], v[96:99], v[152:155]
    s_add_u32 s50, s50, 2048
    v_cvt_pk_bf16_f32 v48, v48, v49
    v_mfma_f32_16x16x32_bf16 v[156:159], a[156:159], v[104:107], v[156:159]
    v_mfma_f32_16x16x32_bf16 v[240:243], a[0:3], a[252:255], 0
    v_mfma_f32_16x16x32_bf16 v[160:163], a[160:163], v[80:83], v[160:163]
    v_exp_f32 v52, v52
    v_mfma_f32_16x16x32_bf16 v[164:167], a[160:163], v[88:91], v[164:167]
    v_exp_f32 v53, v53
    v_mfma_f32_16x16x32_bf16 v[168:171], a[160:163], v[96:99], v[168:171]
    ds_read_b128 a[156:159], v25 offset:20480
    v_cvt_pk_bf16_f32 v49, v50, v51
    v_mfma_f32_16x16x32_bf16 v[172:175], a[160:163], v[104:107], v[172:175]
    buffer_store_dwordx4 a[4:7], v2, s[16:19], s50 offen sc1
    s_add_u32 s50, s50, 2048
    v_mfma_f32_16x16x32_bf16 v[244:247], a[4:7], a[252:255], 0
    s_waitcnt lgkmcnt(3)
    v_mfma_f32_16x16x32_bf16 v[176:179], a[164:167], v[80:83], v[176:179]
    v_exp_f32 v54, v54
    v_mfma_f32_16x16x32_bf16 v[180:183], a[164:167], v[88:91], v[180:183]
    ds_read_b128 a[160:163], v25 offset:22528
    v_mfma_f32_16x16x32_bf16 v[184:187], a[164:167], v[96:99], v[184:187]
    buffer_store_dwordx4 a[8:11], v2, s[16:19], s50 offen sc1
    v_mfma_f32_16x16x32_bf16 v[188:191], a[164:167], v[104:107], v[188:191]
    s_add_u32 s50, s50, 2048
    v_mfma_f32_16x16x32_bf16 v[248:251], a[8:11], a[252:255], 0
    v_exp_f32 v55, v55
    v_mfma_f32_16x16x32_bf16 v[192:195], a[168:171], v[80:83], v[192:195]
    v_cvt_pk_bf16_f32 v50, v52, v53
    ds_read_b128 a[164:167], v24 offset:28672
    v_mfma_f32_16x16x32_bf16 v[196:199], a[168:171], v[88:91], v[196:199]
    v_exp_f32 v56, v56
    v_mfma_f32_16x16x32_bf16 v[200:203], a[168:171], v[96:99], v[200:203]
    buffer_store_dwordx4 a[12:15], v2, s[16:19], s50 offen sc1
    v_mfma_f32_16x16x32_bf16 v[204:207], a[168:171], v[104:107], v[204:207]
    v_exp_f32 v57, v57
    v_mfma_f32_16x16x32_bf16 v[208:211], a[172:175], v[80:83], v[208:211]
    v_cvt_pk_bf16_f32 v51, v54, v55
    ds_read_b128 a[168:171], v24 offset:30720
    v_mfma_f32_16x16x32_bf16 v[212:215], a[172:175], v[88:91], v[212:215]
    v_exp_f32 v58, v58
    v_mfma_f32_16x16x32_bf16 v[216:219], a[172:175], v[96:99], v[216:219]
    v_exp_f32 v59, v59
    v_mfma_f32_16x16x32_bf16 v[220:223], a[172:175], v[104:107], v[220:223]
    v_cvt_pk_bf16_f32 v56, v56, v57
    v_mfma_f32_16x16x32_bf16 v[224:227], a[176:179], v[80:83], v[224:227]
    v_exp_f32 v60, v60
    v_mfma_f32_16x16x32_bf16 v[228:231], a[176:179], v[88:91], v[228:231]
    v_exp_f32 v61, v61
    v_mfma_f32_16x16x32_bf16 v[232:235], a[176:179], v[96:99], v[232:235]
    buffer_store_dwordx4 v[240:243], v255, s[16:19], s53 offen offset:0 sc1
    v_mfma_f32_16x16x32_bf16 v[236:239], a[176:179], v[104:107], v[236:239]
    v_cvt_pk_bf16_f32 v57, v58, v59
    ds_read_b128 a[172:175], v25 offset:28672
    v_mfma_f32_16x16x32_bf16 a[128:131], a[144:147], v[80:83], a[128:131]
    v_mfma_f32_16x16x32_bf16 v[240:243], a[12:15], a[252:255], 0
    v_mfma_f32_16x16x32_bf16 a[132:135], a[144:147], v[88:91], a[132:135]
    v_exp_f32 v62, v62
    v_mfma_f32_16x16x32_bf16 a[136:139], a[144:147], v[96:99], a[136:139]
    buffer_store_dwordx4 v[244:247], v255, s[16:19], s53 offen offset:256 sc1
    v_mfma_f32_16x16x32_bf16 a[140:143], a[144:147], v[104:107], a[140:143]
    v_exp_f32 v63, v63
    s_waitcnt lgkmcnt(3)
    v_mfma_f32_16x16x32_bf16 v[80:83], a[148:151], a[64:67], v[32:35]
    v_cvt_pk_bf16_f32 v58, v60, v61
    ds_read_b128 a[176:179], v25 offset:30720
    v_mfma_f32_16x16x32_bf16 v[88:91], a[148:151], a[80:83], v[36:39]
    buffer_store_dwordx4 v[248:251], v255, s[16:19], s53 offen offset:512 sc1
    v_mfma_f32_16x16x32_bf16 v[96:99], a[148:151], a[96:99], v[40:43]
    v_exp_f32 v64, v64
    v_mfma_f32_16x16x32_bf16 v[104:107], a[148:151], a[112:115], v[44:47]
    v_exp_f32 v65, v65
    s_waitcnt vmcnt(16)
    s_barrier
    v_mfma_f32_16x16x32_bf16 v[84:87], a[152:155], a[64:67], v[32:35]
    v_cvt_pk_bf16_f32 v59, v62, v63
    ds_read_b64_tr_b16 a[148:149], v12 offset:32768
    v_mfma_f32_16x16x32_bf16 v[92:95], a[152:155], a[80:83], v[36:39]
    v_exp_f32 v66, v66
    v_mfma_f32_16x16x32_bf16 v[100:103], a[152:155], a[96:99], v[40:43]
    ds_read_b64_tr_b16 a[150:151], v12 offset:34816
    v_mfma_f32_16x16x32_bf16 v[108:111], a[152:155], a[112:115], v[44:47]
    v_exp_f32 v67, v67
    v_mfma_f32_16x16x32_bf16 v[80:83], a[156:159], a[68:71], v[80:83]
    buffer_store_dwordx4 v[240:243], v255, s[16:19], s53 offen offset:768 sc1
    v_mfma_f32_16x16x32_bf16 v[88:91], a[156:159], a[84:87], v[88:91]
    v_cvt_pk_bf16_f32 v64, v64, v65
    ds_read_b64_tr_b16 a[152:153], v13 offset:32768
    v_mfma_f32_16x16x32_bf16 v[96:99], a[156:159], a[100:103], v[96:99]
    v_exp_f32 v68, v68
    v_mfma_f32_16x16x32_bf16 v[104:107], a[156:159], a[116:119], v[104:107]
    ds_read_b64_tr_b16 a[154:155], v13 offset:34816
    v_exp_f32 v69, v69
    v_mfma_f32_16x16x32_bf16 v[84:87], a[160:163], a[68:71], v[84:87]
    v_cvt_pk_bf16_f32 v65, v66, v67
    ds_read_b64_tr_b16 a[156:157], v14 offset:32768
    v_mfma_f32_16x16x32_bf16 v[92:95], a[160:163], a[84:87], v[92:95]
    v_exp_f32 v70, v70
    v_mfma_f32_16x16x32_bf16 v[100:103], a[160:163], a[100:103], v[100:103]
    ds_read_b64_tr_b16 a[158:159], v14 offset:34816
    v_mfma_f32_16x16x32_bf16 v[108:111], a[160:163], a[116:119], v[108:111]
    s_waitcnt lgkmcnt(6)
    v_mfma_f32_16x16x32_bf16 v[80:83], a[164:167], a[72:75], v[80:83]
    v_exp_f32 v71, v71
    v_mfma_f32_16x16x32_bf16 v[88:91], a[164:167], a[88:91], v[88:91]
    v_cvt_pk_bf16_f32 v66, v68, v69
    ds_read_b64_tr_b16 a[160:161], v15 offset:32768
    v_mfma_f32_16x16x32_bf16 v[96:99], a[164:167], a[104:107], v[96:99]
    v_exp_f32 v72, v72
    v_mfma_f32_16x16x32_bf16 v[104:107], a[164:167], a[120:123], v[104:107]
    ds_read_b64_tr_b16 a[162:163], v15 offset:34816
    v_mfma_f32_16x16x32_bf16 v[84:87], a[168:171], a[72:75], v[84:87]
    v_exp_f32 v73, v73
    v_mfma_f32_16x16x32_bf16 v[92:95], a[168:171], a[88:91], v[92:95]
    v_cvt_pk_bf16_f32 v67, v70, v71
    ds_read_b64_tr_b16 a[164:165], v12 offset:40960
    v_mfma_f32_16x16x32_bf16 v[100:103], a[168:171], a[104:107], v[100:103]
    v_exp_f32 v74, v74
    v_mfma_f32_16x16x32_bf16 v[108:111], a[168:171], a[120:123], v[108:111]
    ds_read_b64_tr_b16 a[166:167], v12 offset:43008
    v_mfma_f32_16x16x32_bf16 v[80:83], a[172:175], a[76:79], v[80:83]
    v_exp_f32 v75, v75
    v_mfma_f32_16x16x32_bf16 v[88:91], a[172:175], a[92:95], v[88:91]
    v_cvt_pk_bf16_f32 v72, v72, v73
    ds_read_b64_tr_b16 a[168:169], v13 offset:40960
    v_mfma_f32_16x16x32_bf16 v[96:99], a[172:175], a[108:111], v[96:99]
    v_exp_f32 v76, v76
    v_mfma_f32_16x16x32_bf16 v[104:107], a[172:175], a[124:127], v[104:107]
    ds_read_b64_tr_b16 a[170:171], v13 offset:43008
    v_mfma_f32_16x16x32_bf16 v[84:87], a[176:179], a[76:79], v[84:87]
    v_exp_f32 v77, v77
    v_mfma_f32_16x16x32_bf16 v[92:95], a[176:179], a[92:95], v[92:95]
    v_cvt_pk_bf16_f32 v73, v74, v75
    v_exp_f32 v78, v78
    v_exp_f32 v79, v79
    v_cvt_pk_bf16_f32 v74, v76, v77
    v_mfma_f32_16x16x32_bf16 v[100:103], a[176:179], a[108:111], v[100:103]
    v_cvt_pk_bf16_f32 v75, v78, v79
    ds_read_b64_tr_b16 a[172:173], v14 offset:40960
    v_mfma_f32_16x16x32_bf16 v[108:111], a[176:179], a[124:127], v[108:111]
    ds_read_b64_tr_b16 a[174:175], v14 offset:43008
    s_waitcnt lgkmcnt(0)
    s_getpc_b64 s[68:69]
K1_PC:
    s_add_u32 s68, s68, (K1_EXIT-K1_PC)&0xffffffff
    s_addc_u32 s69, s69, ((K1_EXIT-K1_PC)>>32)&0xffffffff
    s_mov_b32 s70, K1_SLOW-K1_EXIT
    s_mov_b32 s71, 0x20000
    s_waitcnt lgkmcnt(6)
    v_mfma_f32_16x16x32_bf16 v[112:115], a[148:151], v[48:51], v[112:115]
    ds_read_b64_tr_b16 a[176:177], v15 offset:40960
    ds_read_b64_tr_b16 a[178:179], v15 offset:43008
    v_mfma_f32_16x16x32_bf16 v[116:119], a[148:151], v[56:59], v[116:119]
    v_exp_f32 v80, v80
    v_mfma_f32_16x16x32_bf16 v[120:123], a[148:151], v[64:67], v[120:123]
    v_exp_f32 v81, v81
    v_mfma_f32_16x16x32_bf16 v[124:127], a[148:151], v[72:75], v[124:127]
    s_add_u32 m0, s37, s35
    s_lshr_b32 s41, s2, 3
    v_mfma_f32_16x16x32_bf16 v[128:131], a[152:155], v[48:51], v[128:131]
    ds_read_b128 a[148:151], v24 offset:49152
    s_lshl_b32 s41, s41, 2
    v_mfma_f32_16x16x32_bf16 v[132:135], a[152:155], v[56:59], v[132:135]
    v_exp_f32 v82, v82
    v_mfma_f32_16x16x32_bf16 v[136:139], a[152:155], v[64:67], v[136:139]
    buffer_load_dwordx4 v4, s[8:11], s32 offen offset:0 nt lds
    v_mfma_f32_16x16x32_bf16 v[140:143], a[152:155], v[72:75], v[140:143]
    v_exp_f32 v83, v83
    v_mfma_f32_16x16x32_bf16 v[144:147], a[156:159], v[48:51], v[144:147]
    ds_read_b128 a[152:155], v24 offset:51200
    v_cvt_pk_bf16_f32 v80, v80, v81
    v_mfma_f32_16x16x32_bf16 v[148:151], a[156:159], v[56:59], v[148:151]
    v_exp_f32 v84, v84
    v_mfma_f32_16x16x32_bf16 v[152:155], a[156:159], v[64:67], v[152:155]
    v_exp_f32 v85, v85
    v_mfma_f32_16x16x32_bf16 v[156:159], a[156:159], v[72:75], v[156:159]
    buffer_load_dwordx4 v5, s[8:11], s32 offen offset:1024 nt lds
    v_mfma_f32_16x16x32_bf16 v[160:163], a[160:163], v[48:51], v[160:163]
    ds_read_b128 a[156:159], v25 offset:49152
    v_cvt_pk_bf16_f32 v81, v82, v83
    v_mfma_f32_16x16x32_bf16 v[164:167], a[160:163], v[56:59], v[164:167]
    v_exp_f32 v86, v86
    v_mfma_f32_16x16x32_bf16 v[168:171], a[160:163], v[64:67], v[168:171]
    v_exp_f32 v87, v87
    v_mfma_f32_16x16x32_bf16 v[172:175], a[160:163], v[72:75], v[172:175]
    s_add_u32 s41, s41, s3
    s_waitcnt lgkmcnt(3)
    v_mfma_f32_16x16x32_bf16 v[176:179], a[164:167], v[48:51], v[176:179]
    ds_read_b128 a[160:163], v25 offset:51200
    s_lshl_b32 s41, s41, 10
    v_mfma_f32_16x16x32_bf16 v[180:183], a[164:167], v[56:59], v[180:183]
    buffer_load_dwordx4 a[60:63], v2, s[68:71], s41 offen
    v_mfma_f32_16x16x32_bf16 v[184:187], a[164:167], v[64:67], v[184:187]
    v_cvt_pk_bf16_f32 v82, v84, v85
    v_mfma_f32_16x16x32_bf16 v[188:191], a[164:167], v[72:75], v[188:191]
    v_exp_f32 v88, v88
    v_mfma_f32_16x16x32_bf16 v[192:195], a[168:171], v[48:51], v[192:195]
    buffer_load_dwordx4 v6, s[8:11], s32 offen offset:2048 nt lds
    v_mfma_f32_16x16x32_bf16 v[196:199], a[168:171], v[56:59], v[196:199]
    ds_read_b128 a[164:167], v24 offset:57344
    v_mfma_f32_16x16x32_bf16 v[200:203], a[168:171], v[64:67], v[200:203]
    v_exp_f32 v89, v89
    v_mfma_f32_16x16x32_bf16 v[204:207], a[168:171], v[72:75], v[204:207]
    v_cvt_pk_bf16_f32 v83, v86, v87
    v_mfma_f32_16x16x32_bf16 v[208:211], a[172:175], v[48:51], v[208:211]
    v_exp_f32 v90, v90
    v_mfma_f32_16x16x32_bf16 v[212:215], a[172:175], v[56:59], v[212:215]
    ds_read_b128 a[168:171], v24 offset:59392
    s_mov_b32 s58, 2621440
    v_mfma_f32_16x16x32_bf16 v[216:219], a[172:175], v[64:67], v[216:219]
    v_exp_f32 v91, v91
    v_mfma_f32_16x16x32_bf16 v[220:223], a[172:175], v[72:75], v[220:223]
    buffer_load_dwordx4 v7, s[8:11], s32 offen offset:3072 nt lds
    v_mfma_f32_16x16x32_bf16 v[224:227], a[176:179], v[48:51], v[224:227]
    v_cvt_pk_bf16_f32 v88, v88, v89
    ds_read_b128 a[172:175], v25 offset:57344
    v_mfma_f32_16x16x32_bf16 v[228:231], a[176:179], v[56:59], v[228:231]
    v_exp_f32 v92, v92
    v_mfma_f32_16x16x32_bf16 v[232:235], a[176:179], v[64:67], v[232:235]
    v_exp_f32 v93, v93
    v_mfma_f32_16x16x32_bf16 v[236:239], a[176:179], v[72:75], v[236:239]
    v_cvt_pk_bf16_f32 v89, v90, v91
    s_mov_b32 s41, 737280
    v_mfma_f32_16x16x32_bf16 a[128:131], a[144:147], v[48:51], a[128:131]
    v_exp_f32 v94, v94
    v_mfma_f32_16x16x32_bf16 a[132:135], a[144:147], v[56:59], a[132:135]
    v_exp_f32 v95, v95
    v_mfma_f32_16x16x32_bf16 a[136:139], a[144:147], v[64:67], a[136:139]
    v_cvt_pk_bf16_f32 v90, v92, v93
    s_mov_b32 s59, 0x20000
    v_mfma_f32_16x16x32_bf16 a[140:143], a[144:147], v[72:75], a[140:143]
    s_bfe_u32 s60, s2, 0x20001
    s_waitcnt lgkmcnt(3)
    v_mfma_f32_16x16x32_bf16 v[48:51], a[148:151], a[64:67], v[32:35]
    v_exp_f32 v96, v96
    v_mfma_f32_16x16x32_bf16 v[56:59], a[148:151], a[80:83], v[36:39]
    ds_read_b128 a[176:179], v25 offset:59392
    s_lshl_b32 s60, s60, 3
    v_mfma_f32_16x16x32_bf16 v[64:67], a[148:151], a[96:99], v[40:43]
    v_exp_f32 v97, v97
    v_mfma_f32_16x16x32_bf16 v[72:75], a[148:151], a[112:115], v[44:47]
    buffer_load_dwordx4 v[240:243], v2, s[16:19], s41 offen offset:0 sc1
    v_mfma_f32_16x16x32_bf16 v[52:55], a[152:155], a[64:67], v[32:35]
    v_cvt_pk_bf16_f32 v91, v94, v95
    ds_read_b64_tr_b16 a[148:149], v12 offset:36864
    v_mfma_f32_16x16x32_bf16 v[60:63], a[152:155], a[80:83], v[36:39]
    v_exp_f32 v98, v98
    v_mfma_f32_16x16x32_bf16 v[68:71], a[152:155], a[96:99], v[40:43]
    ds_read_b64_tr_b16 a[150:151], v12 offset:38912
    s_bfe_u32 s61, s2, 0x30003
    v_mfma_f32_16x16x32_bf16 v[76:79], a[152:155], a[112:115], v[44:47]
    v_exp_f32 v99, v99
    v_mfma_f32_16x16x32_bf16 v[48:51], a[156:159], a[68:71], v[48:51]
    buffer_load_dwordx4 v[244:247], v2, s[16:19], s41 offen offset:1024 sc1
    v_mfma_f32_16x16x32_bf16 v[56:59], a[156:159], a[84:87], v[56:59]
    v_cvt_pk_bf16_f32 v96, v96, v97
    ds_read_b64_tr_b16 a[152:153], v13 offset:36864
    v_mfma_f32_16x16x32_bf16 v[64:67], a[156:159], a[100:103], v[64:67]
    v_exp_f32 v100, v100
    v_mfma_f32_16x16x32_bf16 v[72:75], a[156:159], a[116:119], v[72:75]
    ds_read_b64_tr_b16 a[154:155], v13 offset:38912
    v_exp_f32 v101, v101
    v_mfma_f32_16x16x32_bf16 v[52:55], a[160:163], a[68:71], v[52:55]
    buffer_load_dwordx4 v[248:251], v2, s[16:19], s41 offen offset:2048 sc1
    v_mfma_f32_16x16x32_bf16 v[60:63], a[160:163], a[84:87], v[60:63]
    v_cvt_pk_bf16_f32 v97, v98, v99
    ds_read_b64_tr_b16 a[156:157], v14 offset:36864
    v_mfma_f32_16x16x32_bf16 v[68:71], a[160:163], a[100:103], v[68:71]
    v_exp_f32 v102, v102
    v_mfma_f32_16x16x32_bf16 v[76:79], a[160:163], a[116:119], v[76:79]
    ds_read_b64_tr_b16 a[158:159], v14 offset:38912
    s_waitcnt lgkmcnt(6)
    v_mfma_f32_16x16x32_bf16 v[48:51], a[164:167], a[72:75], v[48:51]
    buffer_load_dwordx4 v[252:255], v2, s[16:19], s41 offen offset:3072 sc1
    v_exp_f32 v103, v103
    v_mfma_f32_16x16x32_bf16 v[56:59], a[164:167], a[88:91], v[56:59]
    v_cvt_pk_bf16_f32 v98, v100, v101
    ds_read_b64_tr_b16 a[160:161], v15 offset:36864
    v_mfma_f32_16x16x32_bf16 v[64:67], a[164:167], a[104:107], v[64:67]
    v_exp_f32 v104, v104
    v_mfma_f32_16x16x32_bf16 v[72:75], a[164:167], a[120:123], v[72:75]
    ds_read_b64_tr_b16 a[162:163], v15 offset:38912
    s_add_u32 s32, s32, s34
    v_mfma_f32_16x16x32_bf16 v[52:55], a[168:171], a[72:75], v[52:55]
    v_exp_f32 v105, v105
    v_mfma_f32_16x16x32_bf16 v[60:63], a[168:171], a[88:91], v[60:63]
    v_cvt_pk_bf16_f32 v99, v102, v103
    ds_read_b64_tr_b16 a[164:165], v12 offset:45056
    v_mfma_f32_16x16x32_bf16 v[68:71], a[168:171], a[104:107], v[68:71]
    v_exp_f32 v106, v106
    v_mfma_f32_16x16x32_bf16 v[76:79], a[168:171], a[120:123], v[76:79]
    ds_read_b64_tr_b16 a[166:167], v12 offset:47104
    s_add_u32 s33, s33, s34
    v_mfma_f32_16x16x32_bf16 v[48:51], a[172:175], a[76:79], v[48:51]
    v_exp_f32 v107, v107
    v_mfma_f32_16x16x32_bf16 v[56:59], a[172:175], a[92:95], v[56:59]
    v_cvt_pk_bf16_f32 v104, v104, v105
    ds_read_b64_tr_b16 a[168:169], v13 offset:45056
    v_mfma_f32_16x16x32_bf16 v[64:67], a[172:175], a[108:111], v[64:67]
    v_exp_f32 v108, v108
    v_mfma_f32_16x16x32_bf16 v[72:75], a[172:175], a[124:127], v[72:75]
    ds_read_b64_tr_b16 a[170:171], v13 offset:47104
    s_add_u32 s37, s37, 0x8000
    v_mfma_f32_16x16x32_bf16 v[52:55], a[176:179], a[76:79], v[52:55]
    v_exp_f32 v109, v109
    v_mfma_f32_16x16x32_bf16 v[60:63], a[176:179], a[92:95], v[60:63]
    v_cvt_pk_bf16_f32 v105, v106, v107
    v_exp_f32 v110, v110
    v_exp_f32 v111, v111
    v_cvt_pk_bf16_f32 v106, v108, v109
    v_mfma_f32_16x16x32_bf16 v[68:71], a[176:179], a[108:111], v[68:71]
    v_cvt_pk_bf16_f32 v107, v110, v111
    ds_read_b64_tr_b16 a[172:173], v14 offset:45056
    v_mfma_f32_16x16x32_bf16 v[76:79], a[176:179], a[124:127], v[76:79]
    ds_read_b64_tr_b16 a[174:175], v14 offset:47104
    s_waitcnt lgkmcnt(6)
    v_mfma_f32_16x16x32_bf16 v[112:115], a[148:151], v[80:83], v[112:115]
    s_and_b32 s37, s37, 0x1ffff
    ds_read_b64_tr_b16 a[176:177], v15 offset:45056
    v_mfma_f32_16x16x32_bf16 v[116:119], a[148:151], v[88:91], v[116:119]
    ds_read_b64_tr_b16 a[178:179], v15 offset:47104
    s_add_u32 s60, s60, s61
    v_mfma_f32_16x16x32_bf16 v[120:123], a[148:151], v[96:99], v[120:123]
    v_exp_f32 v48, v48
    v_mfma_f32_16x16x32_bf16 v[124:127], a[148:151], v[104:107], v[124:127]
    v_exp_f32 v49, v49
    v_mfma_f32_16x16x32_bf16 v[128:131], a[152:155], v[80:83], v[128:131]
    ds_read_b128 a[148:151], v24 offset:53248
    s_lshl_b32 s60, s60, 2
    v_mfma_f32_16x16x32_bf16 v[132:135], a[152:155], v[88:91], v[132:135]
    v_exp_f32 v50, v50
    v_mfma_f32_16x16x32_bf16 v[136:139], a[152:155], v[96:99], v[136:139]
    v_exp_f32 v51, v51
    v_mfma_f32_16x16x32_bf16 v[140:143], a[152:155], v[104:107], v[140:143]
    v_cvt_pk_bf16_f32 v48, v48, v49
    s_add_u32 s60, s60, s3
    v_mfma_f32_16x16x32_bf16 v[144:147], a[156:159], v[80:83], v[144:147]
    ds_read_b128 a[152:155], v24 offset:55296
    s_mul_i32 s60, s60, 20480
    v_mfma_f32_16x16x32_bf16 v[148:151], a[156:159], v[88:91], v[148:151]
    v_exp_f32 v52, v52
    v_mfma_f32_16x16x32_bf16 v[152:155], a[156:159], v[96:99], v[152:155]
    v_exp_f32 v53, v53
    v_mfma_f32_16x16x32_bf16 v[156:159], a[156:159], v[104:107], v[156:159]
    v_cvt_pk_bf16_f32 v49, v50, v51
    s_and_b32 s61, s2, 1
    v_mfma_f32_16x16x32_bf16 v[160:163], a[160:163], v[80:83], v[160:163]
    ds_read_b128 a[156:159], v25 offset:53248
    s_lshl_b32 s61, s61, 2
    v_mfma_f32_16x16x32_bf16 v[164:167], a[160:163], v[88:91], v[164:167]
    v_exp_f32 v54, v54
    v_mfma_f32_16x16x32_bf16 v[168:171], a[160:163], v[96:99], v[168:171]
    v_exp_f32 v55, v55
    v_mfma_f32_16x16x32_bf16 v[172:175], a[160:163], v[104:107], v[172:175]
    v_cvt_pk_bf16_f32 v50, v52, v53
    s_waitcnt lgkmcnt(3)
    v_mfma_f32_16x16x32_bf16 v[176:179], a[164:167], v[80:83], v[176:179]
    ds_read_b128 a[160:163], v25 offset:55296
    s_lshr_b32 s62, s2, 6
    v_mfma_f32_16x16x32_bf16 v[180:183], a[164:167], v[88:91], v[180:183]
    v_exp_f32 v56, v56
    v_mfma_f32_16x16x32_bf16 v[184:187], a[164:167], v[96:99], v[184:187]
    s_add_u32 s61, s61, s62
    s_mul_i32 s62, s61, 160
    v_mfma_f32_16x16x32_bf16 v[188:191], a[164:167], v[104:107], v[188:191]
    s_add_u32 s60, s60, s62
    s_and_b32 s61, s61, 1
    v_mfma_f32_16x16x32_bf16 v[192:195], a[168:171], v[80:83], v[192:195]
    s_lshl_b32 s62, s61, 5
    s_add_u32 s60, s60, s62
    v_mfma_f32_16x16x32_bf16 v[196:199], a[168:171], v[88:91], v[196:199]
    s_mul_i32 s61, s61, -160
    s_add_u32 s61, s61, s60
    v_mfma_f32_16x16x32_bf16 v[200:203], a[168:171], v[96:99], v[200:203]
    v_and_b32 v29, 15, v1
    v_mul_u32_u24 v29, 1280, v29
    v_lshrrev_b32 v30, 4, v1
    v_lshl_add_u32 v29, v30, 3, v29
    buffer_load_dwordx2 a[240:241], v29, s[56:59], s60 offen offset:0 nt
    buffer_load_dwordx2 a[242:243], v29, s[56:59], s60 offen offset:32 nt
    buffer_load_dwordx2 a[244:245], v29, s[56:59], s60 offen offset:64 nt
    buffer_load_dwordx2 a[246:247], v29, s[56:59], s60 offen offset:96 nt
    buffer_load_dwordx2 a[248:249], v29, s[56:59], s61 offen offset:128 nt
    v_mfma_f32_16x16x32_bf16 v[204:207], a[168:171], v[104:107], v[204:207]
    ds_read_b128 a[164:167], v24 offset:61440
    v_exp_f32 v57, v57
    v_mfma_f32_16x16x32_bf16 v[208:211], a[172:175], v[80:83], v[208:211]
    v_cvt_pk_bf16_f32 v51, v54, v55
    ds_read_b128 a[168:171], v24 offset:63488
    v_mfma_f32_16x16x32_bf16 v[212:215], a[172:175], v[88:91], v[212:215]
    v_exp_f32 v58, v58
    v_mfma_f32_16x16x32_bf16 v[216:219], a[172:175], v[96:99], v[216:219]
    v_exp_f32 v59, v59
    v_mfma_f32_16x16x32_bf16 v[220:223], a[172:175], v[104:107], v[220:223]
    v_cvt_pk_bf16_f32 v56, v56, v57
    v_mfma_f32_16x16x32_bf16 v[224:227], a[176:179], v[80:83], v[224:227]
    v_exp_f32 v60, v60
    v_mfma_f32_16x16x32_bf16 v[228:231], a[176:179], v[88:91], v[228:231]
    v_exp_f32 v61, v61
    v_mfma_f32_16x16x32_bf16 v[232:235], a[176:179], v[96:99], v[232:235]
    v_cvt_pk_bf16_f32 v57, v58, v59
    ds_read_b128 a[172:175], v25 offset:61440
    v_mfma_f32_16x16x32_bf16 v[236:239], a[176:179], v[104:107], v[236:239]
    v_exp_f32 v62, v62
    v_mfma_f32_16x16x32_bf16 a[128:131], a[144:147], v[80:83], a[128:131]
    v_exp_f32 v63, v63
    v_mfma_f32_16x16x32_bf16 a[132:135], a[144:147], v[88:91], a[132:135]
    s_waitcnt vmcnt(5)
    v_cvt_pk_bf16_f32 v58, v60, v61
    v_mfma_f32_16x16x32_bf16 a[136:139], a[144:147], v[96:99], a[136:139]
    v_exp_f32 v64, v64
    v_mfma_f32_16x16x32_bf16 a[140:143], a[144:147], v[104:107], a[140:143]
    v_xor_b32 v240, v0, v240
    s_waitcnt lgkmcnt(3)
    v_mfma_f32_16x16x32_bf16 v[80:83], a[148:151], a[64:67], v[32:35]
    ds_read_b128 a[176:179], v25 offset:63488
    v_xor_b32 v241, v0, v241
    v_mfma_f32_16x16x32_bf16 v[88:91], a[148:151], a[80:83], v[36:39]
    v_exp_f32 v65, v65
    v_mfma_f32_16x16x32_bf16 v[96:99], a[148:151], a[96:99], v[40:43]
    v_cvt_pk_bf16_f32 v59, v62, v63
    v_xor_b32 v242, v0, v242
    v_mfma_f32_16x16x32_bf16 v[104:107], a[148:151], a[112:115], v[44:47]
    s_waitcnt vmcnt(22)
    s_barrier
    v_mfma_f32_16x16x32_bf16 v[84:87], a[152:155], a[64:67], v[32:35]
    v_exp_f32 v66, v66
    v_mfma_f32_16x16x32_bf16 v[92:95], a[152:155], a[80:83], v[36:39]
    ds_read_b64_tr_b16 a[148:149], v20 offset:0
    ds_read_b64_tr_b16 a[150:151], v20 offset:2048
    v_mfma_f32_16x16x32_bf16 v[100:103], a[152:155], a[96:99], v[40:43]
    v_exp_f32 v67, v67
    v_mfma_f32_16x16x32_bf16 v[108:111], a[152:155], a[112:115], v[44:47]
    v_xor_b32 v243, v0, v243
    v_cvt_pk_bf16_f32 v64, v64, v65
    v_mfma_f32_16x16x32_bf16 v[80:83], a[156:159], a[68:71], v[80:83]
    v_xor_b32 v244, v0, v244
    ds_read_b64_tr_b16 a[152:153], v21 offset:0
    v_mfma_f32_16x16x32_bf16 v[88:91], a[156:159], a[84:87], v[88:91]
    v_exp_f32 v68, v68
    v_mfma_f32_16x16x32_bf16 v[96:99], a[156:159], a[100:103], v[96:99]
    ds_read_b64_tr_b16 a[154:155], v21 offset:2048
    v_xor_b32 v245, v0, v245
    v_mfma_f32_16x16x32_bf16 v[104:107], a[156:159], a[116:119], v[104:107]
    v_exp_f32 v69, v69
    v_mfma_f32_16x16x32_bf16 v[84:87], a[160:163], a[68:71], v[84:87]
    v_xor_b32 v246, v0, v246
    v_xor_b32 v247, v0, v247
    v_mfma_f32_16x16x32_bf16 v[92:95], a[160:163], a[84:87], v[92:95]
    v_cvt_pk_bf16_f32 v65, v66, v67
    v_xor_b32 v248, v0, v248
    v_mfma_f32_16x16x32_bf16 v[100:103], a[160:163], a[100:103], v[100:103]
    v_exp_f32 v70, v70
    v_mfma_f32_16x16x32_bf16 v[108:111], a[160:163], a[116:119], v[108:111]
    ds_read_b64_tr_b16 a[156:157], v22 offset:0
    ds_read_b64_tr_b16 a[158:159], v22 offset:2048
    v_xor_b32 v249, v0, v249
    s_waitcnt lgkmcnt(6)
    v_mfma_f32_16x16x32_bf16 v[80:83], a[164:167], a[72:75], v[80:83]
    v_xor_b32 v250, v0, v250
    v_exp_f32 v71, v71
    v_mfma_f32_16x16x32_bf16 v[88:91], a[164:167], a[88:91], v[88:91]
    v_xor_b32 v251, v0, v251
    v_cvt_pk_bf16_f32 v66, v68, v69
    v_mfma_f32_16x16x32_bf16 v[96:99], a[164:167], a[104:107], v[96:99]
    v_xor_b32 v252, v0, v252
    v_exp_f32 v72, v72
    v_mfma_f32_16x16x32_bf16 v[104:107], a[164:167], a[120:123], v[104:107]
    ds_read_b64_tr_b16 a[160:161], v23 offset:0
    ds_read_b64_tr_b16 a[162:163], v23 offset:2048
    v_xor_b32 v253, v0, v253
    v_mfma_f32_16x16x32_bf16 v[84:87], a[168:171], a[72:75], v[84:87]
    v_xor_b32 v254, v0, v254
    v_exp_f32 v73, v73
    v_mfma_f32_16x16x32_bf16 v[92:95], a[168:171], a[88:91], v[92:95]
    v_xor_b32 v255, v0, v255
    v_cvt_pk_bf16_f32 v67, v70, v71
    v_mfma_f32_16x16x32_bf16 v[100:103], a[168:171], a[104:107], v[100:103]
    v_or3_b32 v3, v240, v241, v242
    v_exp_f32 v74, v74
    v_mfma_f32_16x16x32_bf16 v[108:111], a[168:171], a[120:123], v[108:111]
    ds_read_b64_tr_b16 a[164:165], v20 offset:8192
    ds_read_b64_tr_b16 a[166:167], v20 offset:10240
    v_or3_b32 v3, v3, v243, v244
    v_mfma_f32_16x16x32_bf16 v[80:83], a[172:175], a[76:79], v[80:83]
    v_or3_b32 v3, v3, v245, v246
    v_exp_f32 v75, v75
    v_mfma_f32_16x16x32_bf16 v[88:91], a[172:175], a[92:95], v[88:91]
    v_or3_b32 v3, v3, v247, v248
    v_cvt_pk_bf16_f32 v72, v72, v73
    v_mfma_f32_16x16x32_bf16 v[96:99], a[172:175], a[108:111], v[96:99]
    v_or3_b32 v3, v3, v249, v250
    v_exp_f32 v76, v76
    v_mfma_f32_16x16x32_bf16 v[104:107], a[172:175], a[124:127], v[104:107]
    ds_read_b64_tr_b16 a[168:169], v21 offset:8192
    ds_read_b64_tr_b16 a[170:171], v21 offset:10240
    v_or3_b32 v3, v3, v251, v252
    v_mfma_f32_16x16x32_bf16 v[84:87], a[176:179], a[76:79], v[84:87]
    v_or3_b32 v3, v3, v253, v254
    v_exp_f32 v77, v77
    v_mfma_f32_16x16x32_bf16 v[92:95], a[176:179], a[92:95], v[92:95]
    v_or_b32 v3, v3, v255
    v_cvt_pk_bf16_f32 v73, v74, v75
    v_exp_f32 v78, v78
    v_exp_f32 v79, v79
    v_cvt_pk_bf16_f32 v74, v76, v77
    v_mfma_f32_16x16x32_bf16 v[100:103], a[176:179], a[108:111], v[100:103]
    v_cvt_pk_bf16_f32 v75, v78, v79
    ds_read_b64_tr_b16 a[172:173], v22 offset:8192
    v_mfma_f32_16x16x32_bf16 v[108:111], a[176:179], a[124:127], v[108:111]
    ds_read_b64_tr_b16 a[174:175], v22 offset:10240
    s_lshl_b32 s38, s2, 2
    s_add_u32 s38, s38, 741376
    s_cmp_eq_u32 s3, 0
    s_cselect_b32 s38, s38, 0x70000000
    s_waitcnt lgkmcnt(6)
    v_mfma_f32_16x16x32_bf16 v[112:115], a[148:151], v[48:51], v[112:115]
    ds_read_b64_tr_b16 a[176:177], v23 offset:8192
    ds_read_b64_tr_b16 a[178:179], v23 offset:10240
    v_mfma_f32_16x16x32_bf16 v[116:119], a[148:151], v[56:59], v[116:119]
    v_exp_f32 v80, v80
    v_mfma_f32_16x16x32_bf16 v[120:123], a[148:151], v[64:67], v[120:123]
    v_exp_f32 v81, v81
    v_mfma_f32_16x16x32_bf16 v[124:127], a[148:151], v[72:75], v[124:127]
    v_exp_f32 v82, v82
    v_mfma_f32_16x16x32_bf16 v[128:131], a[152:155], v[48:51], v[128:131]
    ds_read_b128 a[148:151], v26 offset:16384
    s_and_b32 s41, s2, 1
    v_mfma_f32_16x16x32_bf16 v[132:135], a[152:155], v[56:59], v[132:135]
    v_exp_f32 v83, v83
    v_mfma_f32_16x16x32_bf16 v[136:139], a[152:155], v[64:67], v[136:139]
    v_cvt_pk_bf16_f32 v80, v80, v81
    s_lshl_b32 s41, s41, 2
    v_mfma_f32_16x16x32_bf16 v[140:143], a[152:155], v[72:75], v[140:143]
    v_exp_f32 v84, v84
    v_mfma_f32_16x16x32_bf16 v[144:147], a[156:159], v[48:51], v[144:147]
    ds_read_b128 a[152:155], v26 offset:18432
    s_lshr_b32 s42, s2, 6
    v_mfma_f32_16x16x32_bf16 v[148:151], a[156:159], v[56:59], v[148:151]
    v_exp_f32 v85, v85
    v_mfma_f32_16x16x32_bf16 v[152:155], a[156:159], v[64:67], v[152:155]
    s_add_u32 s41, s41, s42
    s_and_b32 s42, s41, 1
    v_mfma_f32_16x16x32_bf16 v[156:159], a[156:159], v[72:75], v[156:159]
    s_mul_i32 s6, s41, 655360
    s_lshl_b32 s41, s3, 15
    v_mfma_f32_16x16x32_bf16 v[160:163], a[160:163], v[48:51], v[160:163]
    ds_read_b128 a[156:159], v27 offset:16384
    s_add_u32 s6, s6, s41
    v_mfma_f32_16x16x32_bf16 v[164:167], a[160:163], v[56:59], v[164:167]
    s_add_u32 s6, s6, 13500416
    s_mul_i32 s41, s42, 131072
    v_mfma_f32_16x16x32_bf16 v[168:171], a[160:163], v[64:67], v[168:171]
    v_add_u32 v240, s41, v2
    s_mul_i32 s41, s42, -524288
    v_mfma_f32_16x16x32_bf16 v[172:175], a[160:163], v[72:75], v[172:175]
    s_add_u32 s41, s41, 524288
    s_waitcnt lgkmcnt(3)
    v_mfma_f32_16x16x32_bf16 v[176:179], a[164:167], v[48:51], v[176:179]
    v_add_u32 v244, s41, v2
    v_add_u32 v241, 131072, v240
    v_add_u32 v242, 262144, v240
    v_add_u32 v243, 393216, v240
    v_cmp_ne_u32 vcc, 0, v3
    s_nop 0
    s_cmp_eq_u64 vcc, 0
    s_cselect_b32 s6, s6, 0x70000000
    s_add_u32 s7, s6, 4096
    v_cvt_pk_bf16_f32 v81, v82, v83
    v_mfma_f32_16x16x32_bf16 v[180:183], a[164:167], v[56:59], v[180:183]
    v_exp_f32 v86, v86
    v_mfma_f32_16x16x32_bf16 v[184:187], a[164:167], v[64:67], v[184:187]
    ds_read_b128 a[160:163], v27 offset:18432
    v_mfma_f32_16x16x32_bf16 v[188:191], a[164:167], v[72:75], v[188:191]
    v_exp_f32 v87, v87
    v_mfma_f32_16x16x32_bf16 v[192:195], a[168:171], v[48:51], v[192:195]
    v_cvt_pk_bf16_f32 v82, v84, v85
    ds_read_b128 a[164:167], v26 offset:24576
    v_mfma_f32_16x16x32_bf16 v[196:199], a[168:171], v[56:59], v[196:199]
    v_exp_f32 v88, v88
    v_mfma_f32_16x16x32_bf16 v[200:203], a[168:171], v[64:67], v[200:203]
    buffer_load_dwordx4 a[0:3], v240, s[16:19], s6 offen offset:0 sc1
    v_mfma_f32_16x16x32_bf16 v[204:207], a[168:171], v[72:75], v[204:207]
    v_exp_f32 v89, v89
    v_mfma_f32_16x16x32_bf16 v[208:211], a[172:175], v[48:51], v[208:211]
    v_cvt_pk_bf16_f32 v83, v86, v87
    ds_read_b128 a[168:171], v26 offset:26624
    v_mfma_f32_16x16x32_bf16 v[212:215], a[172:175], v[56:59], v[212:215]
    buffer_load_dwordx4 a[4:7], v241, s[16:19], s6 offen offset:0 sc1
    v_exp_f32 v90, v90
    v_mfma_f32_16x16x32_bf16 v[216:219], a[172:175], v[64:67], v[216:219]
    v_exp_f32 v91, v91
    v_mfma_f32_16x16x32_bf16 v[220:223], a[172:175], v[72:75], v[220:223]
    buffer_load_dwordx4 a[8:11], v242, s[16:19], s6 offen offset:0 sc1
    v_mfma_f32_16x16x32_bf16 v[224:227], a[176:179], v[48:51], v[224:227]
    v_cvt_pk_bf16_f32 v88, v88, v89
    ds_read_b128 a[172:175], v27 offset:24576
    v_mfma_f32_16x16x32_bf16 v[228:231], a[176:179], v[56:59], v[228:231]
    v_exp_f32 v92, v92
    v_mfma_f32_16x16x32_bf16 v[232:235], a[176:179], v[64:67], v[232:235]
    buffer_load_dwordx4 a[12:15], v243, s[16:19], s6 offen offset:0 sc1
    v_mfma_f32_16x16x32_bf16 v[236:239], a[176:179], v[72:75], v[236:239]
    v_exp_f32 v93, v93
    v_mfma_f32_16x16x32_bf16 a[128:131], a[144:147], v[48:51], a[128:131]
    v_cvt_pk_bf16_f32 v89, v90, v91
    v_mfma_f32_16x16x32_bf16 a[132:135], a[144:147], v[56:59], a[132:135]
    v_exp_f32 v94, v94
    v_mfma_f32_16x16x32_bf16 a[136:139], a[144:147], v[64:67], a[136:139]
    buffer_load_dwordx4 a[16:19], v244, s[16:19], s6 offen offset:0 sc1
    v_mfma_f32_16x16x32_bf16 a[140:143], a[144:147], v[72:75], a[140:143]
    v_exp_f32 v95, v95
    s_waitcnt lgkmcnt(3)
    v_mfma_f32_16x16x32_bf16 v[48:51], a[148:151], a[64:67], v[32:35]
    v_cvt_pk_bf16_f32 v90, v92, v93
    ds_read_b128 a[176:179], v27 offset:26624
    v_mfma_f32_16x16x32_bf16 v[56:59], a[148:151], a[80:83], v[36:39]
    buffer_load_dwordx4 a[20:23], v240, s[16:19], s6 offen offset:1024 sc1
    v_mfma_f32_16x16x32_bf16 v[64:67], a[148:151], a[96:99], v[40:43]
    v_exp_f32 v96, v96
    v_mfma_f32_16x16x32_bf16 v[72:75], a[148:151], a[112:115], v[44:47]
    v_exp_f32 v97, v97
    v_mfma_f32_16x16x32_bf16 v[52:55], a[152:155], a[64:67], v[32:35]
    buffer_load_dwordx4 a[24:27], v241, s[16:19], s6 offen offset:1024 sc1
    v_cvt_pk_bf16_f32 v91, v94, v95
    v_mfma_f32_16x16x32_bf16 v[60:63], a[152:155], a[80:83], v[36:39]
    v_exp_f32 v98, v98
    v_mfma_f32_16x16x32_bf16 v[68:71], a[152:155], a[96:99], v[40:43]
    ds_read_b64_tr_b16 a[148:149], v20 offset:4096
    ds_read_b64_tr_b16 a[150:151], v20 offset:6144
    v_mfma_f32_16x16x32_bf16 v[76:79], a[152:155], a[112:115], v[44:47]
    buffer_load_dwordx4 a[28:31], v242, s[16:19], s6 offen offset:1024 sc1
    v_exp_f32 v99, v99
    v_mfma_f32_16x16x32_bf16 v[48:51], a[156:159], a[68:71], v[48:51]
    v_cvt_pk_bf16_f32 v96, v96, v97
    ds_read_b64_tr_b16 a[152:153], v21 offset:4096
    v_mfma_f32_16x16x32_bf16 v[56:59], a[156:159], a[84:87], v[56:59]
    buffer_load_dwordx4 a[32:35], v243, s[16:19], s6 offen offset:1024 sc1
    v_mfma_f32_16x16x32_bf16 v[64:67], a[156:159], a[100:103], v[64:67]
    v_exp_f32 v100, v100
    v_mfma_f32_16x16x32_bf16 v[72:75], a[156:159], a[116:119], v[72:75]
    ds_read_b64_tr_b16 a[154:155], v21 offset:6144
    v_exp_f32 v101, v101
    v_mfma_f32_16x16x32_bf16 v[52:55], a[160:163], a[68:71], v[52:55]
    buffer_load_dwordx4 a[36:39], v244, s[16:19], s6 offen offset:1024 sc1
    v_mfma_f32_16x16x32_bf16 v[60:63], a[160:163], a[84:87], v[60:63]
    v_cvt_pk_bf16_f32 v97, v98, v99
    ds_read_b64_tr_b16 a[156:157], v22 offset:4096
    v_mfma_f32_16x16x32_bf16 v[68:71], a[160:163], a[100:103], v[68:71]
    v_exp_f32 v102, v102
    v_mfma_f32_16x16x32_bf16 v[76:79], a[160:163], a[116:119], v[76:79]
    ds_read_b64_tr_b16 a[158:159], v22 offset:6144
    s_waitcnt lgkmcnt(6)
    v_mfma_f32_16x16x32_bf16 v[48:51], a[164:167], a[72:75], v[48:51]
    buffer_load_dwordx4 a[40:43], v240, s[16:19], s6 offen offset:2048 sc1
    v_exp_f32 v103, v103
    v_mfma_f32_16x16x32_bf16 v[56:59], a[164:167], a[88:91], v[56:59]
    v_cvt_pk_bf16_f32 v98, v100, v101
    ds_read_b64_tr_b16 a[160:161], v23 offset:4096
    v_mfma_f32_16x16x32_bf16 v[64:67], a[164:167], a[104:107], v[64:67]
    v_exp_f32 v104, v104
    v_mfma_f32_16x16x32_bf16 v[72:75], a[164:167], a[120:123], v[72:75]
    ds_read_b64_tr_b16 a[162:163], v23 offset:6144
    buffer_load_dwordx4 a[44:47], v241, s[16:19], s6 offen offset:2048 sc1
    v_mfma_f32_16x16x32_bf16 v[52:55], a[168:171], a[72:75], v[52:55]
    v_exp_f32 v105, v105
    v_mfma_f32_16x16x32_bf16 v[60:63], a[168:171], a[88:91], v[60:63]
    v_cvt_pk_bf16_f32 v99, v102, v103
    ds_read_b64_tr_b16 a[164:165], v20 offset:12288
    v_mfma_f32_16x16x32_bf16 v[68:71], a[168:171], a[104:107], v[68:71]
    buffer_load_dwordx4 a[48:51], v242, s[16:19], s6 offen offset:2048 sc1
    v_exp_f32 v106, v106
    v_mfma_f32_16x16x32_bf16 v[76:79], a[168:171], a[120:123], v[76:79]
    ds_read_b64_tr_b16 a[166:167], v20 offset:14336
    v_mfma_f32_16x16x32_bf16 v[48:51], a[172:175], a[76:79], v[48:51]
    v_exp_f32 v107, v107
    v_mfma_f32_16x16x32_bf16 v[56:59], a[172:175], a[92:95], v[56:59]
    buffer_load_dwordx4 a[52:55], v243, s[16:19], s6 offen offset:2048 sc1
    v_cvt_pk_bf16_f32 v104, v104, v105
    v_mfma_f32_16x16x32_bf16 v[64:67], a[172:175], a[108:111], v[64:67]
    v_exp_f32 v108, v108
    v_mfma_f32_16x16x32_bf16 v[72:75], a[172:175], a[124:127], v[72:75]
    ds_read_b64_tr_b16 a[168:169], v21 offset:12288
    ds_read_b64_tr_b16 a[170:171], v21 offset:14336
    v_mfma_f32_16x16x32_bf16 v[52:55], a[176:179], a[76:79], v[52:55]
    buffer_load_dwordx4 a[56:59], v244, s[16:19], s6 offen offset:2048 sc1
    v_exp_f32 v109, v109
    v_mfma_f32_16x16x32_bf16 v[60:63], a[176:179], a[92:95], v[60:63]
    v_cvt_pk_bf16_f32 v105, v106, v107
    v_exp_f32 v110, v110
    v_exp_f32 v111, v111
    v_cvt_pk_bf16_f32 v106, v108, v109
    v_mfma_f32_16x16x32_bf16 v[68:71], a[176:179], a[108:111], v[68:71]
    v_cvt_pk_bf16_f32 v107, v110, v111
    ds_read_b64_tr_b16 a[172:173], v22 offset:12288
    v_mfma_f32_16x16x32_bf16 v[76:79], a[176:179], a[124:127], v[76:79]
    ds_read_b64_tr_b16 a[174:175], v22 offset:14336
    buffer_load_dwordx4 a[180:183], v240, s[16:19], s6 offen offset:3072 sc1
    s_waitcnt lgkmcnt(6)
    v_mfma_f32_16x16x32_bf16 v[112:115], a[148:151], v[80:83], v[112:115]
    buffer_load_dwordx4 a[184:187], v241, s[16:19], s6 offen offset:3072 sc1
    v_mfma_f32_16x16x32_bf16 v[116:119], a[148:151], v[88:91], v[116:119]
    ds_read_b64_tr_b16 a[176:177], v23 offset:12288
    ds_read_b64_tr_b16 a[178:179], v23 offset:14336
    v_mfma_f32_16x16x32_bf16 v[120:123], a[148:151], v[96:99], v[120:123]
    buffer_load_dwordx4 a[188:191], v242, s[16:19], s6 offen offset:3072 sc1
    v_mfma_f32_16x16x32_bf16 v[124:127], a[148:151], v[104:107], v[124:127]
    v_exp_f32 v48, v48
    v_mfma_f32_16x16x32_bf16 v[128:131], a[152:155], v[80:83], v[128:131]
    ds_read_b128 a[148:151], v26 offset:20480
    v_mfma_f32_16x16x32_bf16 v[132:135], a[152:155], v[88:91], v[132:135]
    v_exp_f32 v49, v49
    v_mfma_f32_16x16x32_bf16 v[136:139], a[152:155], v[96:99], v[136:139]
    buffer_load_dwordx4 a[192:195], v243, s[16:19], s6 offen offset:3072 sc1
    v_mfma_f32_16x16x32_bf16 v[140:143], a[152:155], v[104:107], v[140:143]
    v_exp_f32 v50, v50
    v_mfma_f32_16x16x32_bf16 v[144:147], a[156:159], v[80:83], v[144:147]
    v_exp_f32 v51, v51
    v_mfma_f32_16x16x32_bf16 v[148:151], a[156:159], v[88:91], v[148:151]
    ds_read_b128 a[152:155], v26 offset:22528
    v_cvt_pk_bf16_f32 v48, v48, v49
    v_mfma_f32_16x16x32_bf16 v[152:155], a[156:159], v[96:99], v[152:155]
    buffer_load_dwordx4 a[196:199], v244, s[16:19], s6 offen offset:3072 sc1
    v_mfma_f32_16x16x32_bf16 v[156:159], a[156:159], v[104:107], v[156:159]
    v_exp_f32 v52, v52
    v_mfma_f32_16x16x32_bf16 v[160:163], a[160:163], v[80:83], v[160:163]
    buffer_load_dwordx4 a[200:203], v240, s[16:19], s7 offen offset:0 sc1
    v_mfma_f32_16x16x32_bf16 v[164:167], a[160:163], v[88:91], v[164:167]
    v_exp_f32 v53, v53
    v_mfma_f32_16x16x32_bf16 v[168:171], a[160:163], v[96:99], v[168:171]
    ds_read_b128 a[156:159], v27 offset:20480
    v_cvt_pk_bf16_f32 v49, v50, v51
    v_mfma_f32_16x16x32_bf16 v[172:175], a[160:163], v[104:107], v[172:175]
    s_waitcnt lgkmcnt(3)
    v_mfma_f32_16x16x32_bf16 v[176:179], a[164:167], v[80:83], v[176:179]
    buffer_load_dwordx4 a[204:207], v241, s[16:19], s7 offen offset:0 sc1
    v_mfma_f32_16x16x32_bf16 v[180:183], a[164:167], v[88:91], v[180:183]
    v_exp_f32 v54, v54
    v_mfma_f32_16x16x32_bf16 v[184:187], a[164:167], v[96:99], v[184:187]
    ds_read_b128 a[160:163], v27 offset:22528
    v_mfma_f32_16x16x32_bf16 v[188:191], a[164:167], v[104:107], v[188:191]
    v_exp_f32 v55, v55
    v_mfma_f32_16x16x32_bf16 v[192:195], a[168:171], v[80:83], v[192:195]
    buffer_load_dwordx4 a[208:211], v242, s[16:19], s7 offen offset:0 sc1
    v_cvt_pk_bf16_f32 v50, v52, v53
    v_mfma_f32_16x16x32_bf16 v[196:199], a[168:171], v[88:91], v[196:199]
    v_exp_f32 v56, v56
    v_mfma_f32_16x16x32_bf16 v[200:203], a[168:171], v[96:99], v[200:203]
    ds_read_b128 a[164:167], v26 offset:28672
    v_mfma_f32_16x16x32_bf16 v[204:207], a[168:171], v[104:107], v[204:207]
    buffer_load_dwordx4 a[212:215], v243, s[16:19], s7 offen offset:0 sc1
    v_exp_f32 v57, v57
    v_mfma_f32_16x16x32_bf16 v[208:211], a[172:175], v[80:83], v[208:211]
    v_cvt_pk_bf16_f32 v51, v54, v55
    ds_read_b128 a[168:171], v26 offset:30720
    v_mfma_f32_16x16x32_bf16 v[212:215], a[172:175], v[88:91], v[212:215]
    v_exp_f32 v58, v58
    v_mfma_f32_16x16x32_bf16 v[216:219], a[172:175], v[96:99], v[216:219]
    buffer_load_dwordx4 a[216:219], v244, s[16:19], s7 offen offset:0 sc1
    v_mfma_f32_16x16x32_bf16 v[220:223], a[172:175], v[104:107], v[220:223]
    v_exp_f32 v59, v59
    v_mfma_f32_16x16x32_bf16 v[224:227], a[176:179], v[80:83], v[224:227]
    v_cvt_pk_bf16_f32 v56, v56, v57
    ds_read_b128 a[172:175], v27 offset:28672
    v_mfma_f32_16x16x32_bf16 v[228:231], a[176:179], v[88:91], v[228:231]
    buffer_load_dwordx4 a[220:223], v240, s[16:19], s7 offen offset:1024 sc1
    v_exp_f32 v60, v60
    v_mfma_f32_16x16x32_bf16 v[232:235], a[176:179], v[96:99], v[232:235]
    v_exp_f32 v61, v61
    v_mfma_f32_16x16x32_bf16 v[236:239], a[176:179], v[104:107], v[236:239]
    buffer_load_dwordx4 a[224:227], v241, s[16:19], s7 offen offset:1024 sc1
    v_mfma_f32_16x16x32_bf16 a[128:131], a[144:147], v[80:83], a[128:131]
    v_cvt_pk_bf16_f32 v57, v58, v59
    v_mfma_f32_16x16x32_bf16 a[132:135], a[144:147], v[88:91], a[132:135]
    v_exp_f32 v62, v62
    v_mfma_f32_16x16x32_bf16 a[136:139], a[144:147], v[96:99], a[136:139]
    buffer_load_dwordx4 a[228:231], v242, s[16:19], s7 offen offset:1024 sc1
    v_mfma_f32_16x16x32_bf16 a[140:143], a[144:147], v[104:107], a[140:143]
    v_exp_f32 v63, v63
    s_waitcnt lgkmcnt(3)
    v_mfma_f32_16x16x32_bf16 v[80:83], a[148:151], a[64:67], v[32:35]
    v_cvt_pk_bf16_f32 v58, v60, v61
    ds_read_b128 a[176:179], v27 offset:30720
    v_mfma_f32_16x16x32_bf16 v[88:91], a[148:151], a[80:83], v[36:39]
    buffer_load_dwordx4 a[232:235], v243, s[16:19], s7 offen offset:1024 sc1
    v_mfma_f32_16x16x32_bf16 v[96:99], a[148:151], a[96:99], v[40:43]
    v_exp_f32 v64, v64
    v_mfma_f32_16x16x32_bf16 v[104:107], a[148:151], a[112:115], v[44:47]
    v_exp_f32 v65, v65
    s_waitcnt vmcnt(38)
    s_barrier
    v_mfma_f32_16x16x32_bf16 v[84:87], a[152:155], a[64:67], v[32:35]
    v_cvt_pk_bf16_f32 v59, v62, v63
    ds_read_b64_tr_b16 a[148:149], v20 offset:32768
    v_mfma_f32_16x16x32_bf16 v[92:95], a[152:155], a[80:83], v[36:39]
    buffer_load_dwordx4 a[236:239], v244, s[16:19], s7 offen offset:1024 sc1
    v_mfma_f32_16x16x32_bf16 v[100:103], a[152:155], a[96:99], v[40:43]
    v_exp_f32 v66, v66
    v_mfma_f32_16x16x32_bf16 v[108:111], a[152:155], a[112:115], v[44:47]
    ds_read_b64_tr_b16 a[150:151], v20 offset:34816
    v_exp_f32 v67, v67
    v_mfma_f32_16x16x32_bf16 v[80:83], a[156:159], a[68:71], v[80:83]
    v_cvt_pk_bf16_f32 v64, v64, v65
    ds_read_b64_tr_b16 a[152:153], v21 offset:32768
    v_mfma_f32_16x16x32_bf16 v[88:91], a[156:159], a[84:87], v[88:91]
    v_exp_f32 v68, v68
    v_mfma_f32_16x16x32_bf16 v[96:99], a[156:159], a[100:103], v[96:99]
    ds_read_b64_tr_b16 a[154:155], v21 offset:34816
    v_mfma_f32_16x16x32_bf16 v[104:107], a[156:159], a[116:119], v[104:107]
    v_exp_f32 v69, v69
    v_mfma_f32_16x16x32_bf16 v[84:87], a[160:163], a[68:71], v[84:87]
    v_cvt_pk_bf16_f32 v65, v66, v67
    ds_read_b64_tr_b16 a[156:157], v22 offset:32768
    v_mfma_f32_16x16x32_bf16 v[92:95], a[160:163], a[84:87], v[92:95]
    v_exp_f32 v70, v70
    v_mfma_f32_16x16x32_bf16 v[100:103], a[160:163], a[100:103], v[100:103]
    ds_read_b64_tr_b16 a[158:159], v22 offset:34816
    v_mfma_f32_16x16x32_bf16 v[108:111], a[160:163], a[116:119], v[108:111]
    s_waitcnt lgkmcnt(6)
    v_mfma_f32_16x16x32_bf16 v[80:83], a[164:167], a[72:75], v[80:83]
    v_exp_f32 v71, v71
    v_mfma_f32_16x16x32_bf16 v[88:91], a[164:167], a[88:91], v[88:91]
    v_cvt_pk_bf16_f32 v66, v68, v69
    ds_read_b64_tr_b16 a[160:161], v23 offset:32768
    v_mfma_f32_16x16x32_bf16 v[96:99], a[164:167], a[104:107], v[96:99]
    v_exp_f32 v72, v72
    v_mfma_f32_16x16x32_bf16 v[104:107], a[164:167], a[120:123], v[104:107]
    ds_read_b64_tr_b16 a[162:163], v23 offset:34816
    v_mfma_f32_16x16x32_bf16 v[84:87], a[168:171], a[72:75], v[84:87]
    v_exp_f32 v73, v73
    v_mfma_f32_16x16x32_bf16 v[92:95], a[168:171], a[88:91], v[92:95]
    v_cvt_pk_bf16_f32 v67, v70, v71
    ds_read_b64_tr_b16 a[164:165], v20 offset:40960
    v_mfma_f32_16x16x32_bf16 v[100:103], a[168:171], a[104:107], v[100:103]
    v_exp_f32 v74, v74
    v_mfma_f32_16x16x32_bf16 v[108:111], a[168:171], a[120:123], v[108:111]
    ds_read_b64_tr_b16 a[166:167], v20 offset:43008
    v_mfma_f32_16x16x32_bf16 v[80:83], a[172:175], a[76:79], v[80:83]
    v_exp_f32 v75, v75
    v_mfma_f32_16x16x32_bf16 v[88:91], a[172:175], a[92:95], v[88:91]
    v_cvt_pk_bf16_f32 v72, v72, v73
    ds_read_b64_tr_b16 a[168:169], v21 offset:40960
    v_mfma_f32_16x16x32_bf16 v[96:99], a[172:175], a[108:111], v[96:99]
    v_exp_f32 v76, v76
    v_mfma_f32_16x16x32_bf16 v[104:107], a[172:175], a[124:127], v[104:107]
    ds_read_b64_tr_b16 a[170:171], v21 offset:43008
    v_mfma_f32_16x16x32_bf16 v[84:87], a[176:179], a[76:79], v[84:87]
    v_exp_f32 v77, v77
    v_mfma_f32_16x16x32_bf16 v[92:95], a[176:179], a[92:95], v[92:95]
    v_cvt_pk_bf16_f32 v73, v74, v75
    v_exp_f32 v78, v78
    v_exp_f32 v79, v79
    v_cvt_pk_bf16_f32 v74, v76, v77
    v_mfma_f32_16x16x32_bf16 v[100:103], a[176:179], a[108:111], v[100:103]
    v_cvt_pk_bf16_f32 v75, v78, v79
    ds_read_b64_tr_b16 a[172:173], v22 offset:40960
    v_mfma_f32_16x16x32_bf16 v[108:111], a[176:179], a[124:127], v[108:111]
    ds_read_b64_tr_b16 a[174:175], v22 offset:43008
    buffer_store_dword v0, v28, s[16:19], s38 offen sc1
    v_add_u32 v12, 0x8000, v20
    v_add_u32 v13, 0x8000, v21
    v_add_u32 v14, 0x8000, v22
    v_add_u32 v15, 0x8000, v23
    s_waitcnt lgkmcnt(10)
    s_mul_i32 s41, s5, 131072
    s_lshl_b32 s42, s4, 12
    s_add_u32 s48, s41, s42
    s_add_u32 s49, s48, 131072
    s_add_u32 s50, s48, 262144
    s_add_u32 s51, s48, 393216
    s_waitcnt lgkmcnt(6)
    v_mfma_f32_16x16x32_bf16 v[112:115], a[148:151], v[48:51], v[112:115]
    ds_read_b64_tr_b16 a[176:177], v15 offset:8192
    ds_read_b64_tr_b16 a[178:179], v15 offset:10240
    v_mfma_f32_16x16x32_bf16 v[116:119], a[148:151], v[56:59], v[116:119]
    v_exp_f32 v80, v80
    v_mfma_f32_16x16x32_bf16 v[120:123], a[148:151], v[64:67], v[120:123]
    v_exp_f32 v81, v81
    v_mfma_f32_16x16x32_bf16 v[124:127], a[148:151], v[72:75], v[124:127]
    v_exp_f32 v82, v82
    v_mfma_f32_16x16x32_bf16 v[128:131], a[152:155], v[48:51], v[128:131]
    v_exp_f32 v83, v83
    v_mfma_f32_16x16x32_bf16 v[132:135], a[152:155], v[56:59], v[132:135]
    v_cvt_pk_bf16_f32 v80, v80, v81
    ds_read_b64_tr_b16 a[148:149], v12 offset:4096
    v_mfma_f32_16x16x32_bf16 v[136:139], a[152:155], v[64:67], v[136:139]
    ds_read_b64_tr_b16 a[150:151], v12 offset:6144
    v_mfma_f32_16x16x32_bf16 v[140:143], a[152:155], v[72:75], v[140:143]
    v_exp_f32 v84, v84
    v_mfma_f32_16x16x32_bf16 v[144:147], a[156:159], v[48:51], v[144:147]
    v_exp_f32 v85, v85
    v_mfma_f32_16x16x32_bf16 v[148:151], a[156:159], v[56:59], v[148:151]
    v_cvt_pk_bf16_f32 v81, v82, v83
    ds_read_b64_tr_b16 a[152:153], v13 offset:4096
    v_mfma_f32_16x16x32_bf16 v[152:155], a[156:159], v[64:67], v[152:155]
    v_exp_f32 v86, v86
    v_mfma_f32_16x16x32_bf16 v[156:159], a[156:159], v[72:75], v[156:159]
    v_exp_f32 v87, v87
    v_cvt_pk_bf16_f32 v82, v84, v85
    ds_read_b64_tr_b16 a[154:155], v13 offset:6144
    v_mfma_f32_16x16x32_bf16 v[160:163], a[160:163], v[48:51], v[160:163]
    v_exp_f32 v88, v88
    v_mfma_f32_16x16x32_bf16 v[164:167], a[160:163], v[56:59], v[164:167]
    v_exp_f32 v89, v89
    v_cvt_pk_bf16_f32 v83, v86, v87
    v_mfma_f32_16x16x32_bf16 v[168:171], a[160:163], v[64:67], v[168:171]
    v_exp_f32 v90, v90
    v_mfma_f32_16x16x32_bf16 v[172:175], a[160:163], v[72:75], v[172:175]
    v_exp_f32 v91, v91
    v_cvt_pk_bf16_f32 v88, v88, v89
    ds_read_b64_tr_b16 a[156:157], v14 offset:4096
    ds_read_b64_tr_b16 a[158:159], v14 offset:6144
    s_waitcnt lgkmcnt(6)
    v_mfma_f32_16x16x32_bf16 v[176:179], a[164:167], v[48:51], v[176:179]
    v_exp_f32 v92, v92
    v_mfma_f32_16x16x32_bf16 v[180:183], a[164:167], v[56:59], v[180:183]
    v_exp_f32 v93, v93
    v_mfma_f32_16x16x32_bf16 v[184:187], a[164:167], v[64:67], v[184:187]
    v_cvt_pk_bf16_f32 v89, v90, v91
    v_exp_f32 v94, v94
    v_mfma_f32_16x16x32_bf16 v[188:191], a[164:167], v[72:75], v[188:191]
    v_exp_f32 v95, v95
    ds_read_b64_tr_b16 a[160:161], v15 offset:4096
    ds_read_b64_tr_b16 a[162:163], v15 offset:6144
    v_mfma_f32_16x16x32_bf16 v[192:195], a[168:171], v[48:51], v[192:195]
    v_cvt_pk_bf16_f32 v90, v92, v93
    v_exp_f32 v96, v96
    v_mfma_f32_16x16x32_bf16 v[196:199], a[168:171], v[56:59], v[196:199]
    v_exp_f32 v97, v97
    v_mfma_f32_16x16x32_bf16 v[200:203], a[168:171], v[64:67], v[200:203]
    v_cvt_pk_bf16_f32 v91, v94, v95
    v_exp_f32 v98, v98
    v_mfma_f32_16x16x32_bf16 v[204:207], a[168:171], v[72:75], v[204:207]
    v_exp_f32 v99, v99
    ds_read_b64_tr_b16 a[164:165], v12 offset:12288
    ds_read_b64_tr_b16 a[166:167], v12 offset:14336
    v_mfma_f32_16x16x32_bf16 v[208:211], a[172:175], v[48:51], v[208:211]
    v_cvt_pk_bf16_f32 v96, v96, v97
    v_exp_f32 v100, v100
    v_mfma_f32_16x16x32_bf16 v[212:215], a[172:175], v[56:59], v[212:215]
    v_exp_f32 v101, v101
    v_mfma_f32_16x16x32_bf16 v[216:219], a[172:175], v[64:67], v[216:219]
    v_cvt_pk_bf16_f32 v97, v98, v99
    ds_read_b64_tr_b16 a[168:169], v13 offset:12288
    v_mfma_f32_16x16x32_bf16 v[220:223], a[172:175], v[72:75], v[220:223]
    v_exp_f32 v102, v102
    v_exp_f32 v103, v103
    ds_read_b64_tr_b16 a[170:171], v13 offset:14336
    v_mfma_f32_16x16x32_bf16 v[224:227], a[176:179], v[48:51], v[224:227]
    v_cvt_pk_bf16_f32 v98, v100, v101
    ds_read_b64_tr_b16 a[172:173], v14 offset:12288
    v_mfma_f32_16x16x32_bf16 v[228:231], a[176:179], v[56:59], v[228:231]
    v_exp_f32 v104, v104
    v_mfma_f32_16x16x32_bf16 v[232:235], a[176:179], v[64:67], v[232:235]
    v_exp_f32 v105, v105
    v_cvt_pk_bf16_f32 v99, v102, v103
    v_mfma_f32_16x16x32_bf16 v[236:239], a[176:179], v[72:75], v[236:239]
    v_exp_f32 v106, v106
    v_mfma_f32_16x16x32_bf16 a[128:131], a[144:147], v[48:51], a[128:131]
    v_exp_f32 v107, v107
    v_cvt_pk_bf16_f32 v104, v104, v105
    v_mfma_f32_16x16x32_bf16 a[132:135], a[144:147], v[56:59], a[132:135]
    v_exp_f32 v108, v108
    v_mfma_f32_16x16x32_bf16 a[136:139], a[144:147], v[64:67], a[136:139]
    v_exp_f32 v109, v109
    v_cvt_pk_bf16_f32 v105, v106, v107
    v_exp_f32 v110, v110
    v_exp_f32 v111, v111
    v_cvt_pk_bf16_f32 v106, v108, v109
    s_nop 0
    v_cvt_pk_bf16_f32 v107, v110, v111
    v_mfma_f32_16x16x32_bf16 a[140:143], a[144:147], v[72:75], a[140:143]
    ds_read_b64_tr_b16 a[174:175], v14 offset:14336
    v_mfma_f32_16x16x32_bf16 a[128:131], a[144:147], v[80:83], a[128:131]
    v_mfma_f32_16x16x32_bf16 a[132:135], a[144:147], v[88:91], a[132:135]
    v_mfma_f32_16x16x32_bf16 a[136:139], a[144:147], v[96:99], a[136:139]
    v_mfma_f32_16x16x32_bf16 a[140:143], a[144:147], v[104:107], a[140:143]
    s_waitcnt lgkmcnt(6)
    v_mfma_f32_16x16x32_bf16 v[112:115], a[148:151], v[80:83], v[112:115]
    ds_read_b64_tr_b16 a[176:177], v15 offset:12288
    ds_read_b64_tr_b16 a[178:179], v15 offset:14336
    v_mfma_f32_16x16x32_bf16 v[116:119], a[148:151], v[88:91], v[116:119]
    v_mfma_f32_16x16x32_bf16 v[120:123], a[148:151], v[96:99], v[120:123]
    v_mfma_f32_16x16x32_bf16 v[124:127], a[148:151], v[104:107], v[124:127]
    v_mfma_f32_16x16x32_bf16 v[128:131], a[152:155], v[80:83], v[128:131]
    v_mfma_f32_16x16x32_bf16 v[132:135], a[152:155], v[88:91], v[132:135]
    v_accvgpr_read_b32 v248, a128
    v_accvgpr_read_b32 v250, a132
    v_mfma_f32_16x16x32_bf16 v[136:139], a[152:155], v[96:99], v[136:139]
    v_accvgpr_read_b32 v252, a136
    v_accvgpr_read_b32 v254, a140
    v_mfma_f32_16x16x32_bf16 v[140:143], a[152:155], v[104:107], v[140:143]
    v_add_f32 v249, v248, v250
    v_add_f32 v251, v252, v254
    v_mfma_f32_16x16x32_bf16 v[144:147], a[156:159], v[80:83], v[144:147]
    v_rcp_f32 v248, v248
    v_mfma_f32_16x16x32_bf16 v[148:151], a[156:159], v[88:91], v[148:151]
    v_rcp_f32 v250, v250
    v_rcp_f32 v252, v252
    v_rcp_f32 v254, v254
    v_add_f32 v249, v249, v251
    v_mfma_f32_16x16x32_bf16 v[152:155], a[156:159], v[96:99], v[152:155]
    v_mfma_f32_16x16x32_bf16 v[156:159], a[156:159], v[104:107], v[156:159]
    v_mfma_f32_16x16x32_bf16 v[160:163], a[160:163], v[80:83], v[160:163]
    v_mfma_f32_16x16x32_bf16 v[164:167], a[160:163], v[88:91], v[164:167]
    v_mfma_f32_16x16x32_bf16 v[168:171], a[160:163], v[96:99], v[168:171]
    v_pk_mul_f32 v[112:113], v[112:113], v[248:249] op_sel_hi:[1,0]
    v_pk_mul_f32 v[114:115], v[114:115], v[248:249] op_sel_hi:[1,0]
    v_mfma_f32_16x16x32_bf16 v[172:175], a[160:163], v[104:107], v[172:175]
    v_pk_mul_f32 v[128:129], v[128:129], v[248:249] op_sel_hi:[1,0]
    s_waitcnt lgkmcnt(0)
    v_mfma_f32_16x16x32_bf16 v[176:179], a[164:167], v[80:83], v[176:179]
    v_pk_mul_f32 v[130:131], v[130:131], v[248:249] op_sel_hi:[1,0]
    v_cvt_pk_bf16_f32 v48, v112, v113
    v_mfma_f32_16x16x32_bf16 v[180:183], a[164:167], v[88:91], v[180:183]
    v_cvt_pk_bf16_f32 v49, v114, v115
    v_cvt_pk_bf16_f32 v50, v128, v129
    v_mfma_f32_16x16x32_bf16 v[184:187], a[164:167], v[96:99], v[184:187]
    v_cvt_pk_bf16_f32 v51, v130, v131
    v_mfma_f32_16x16x32_bf16 v[188:191], a[164:167], v[104:107], v[188:191]
    buffer_store_dwordx4 v[48:51], v2, s[20:23], s48 offen offset:0 sc1
    v_pk_mul_f32 v[116:117], v[116:117], v[250:251] op_sel_hi:[1,0]
    v_mfma_f32_16x16x32_bf16 v[192:195], a[168:171], v[80:83], v[192:195]
    v_pk_mul_f32 v[118:119], v[118:119], v[250:251] op_sel_hi:[1,0]
    v_pk_mul_f32 v[132:133], v[132:133], v[250:251] op_sel_hi:[1,0]
    v_pk_mul_f32 v[134:135], v[134:135], v[250:251] op_sel_hi:[1,0]
    v_cvt_pk_bf16_f32 v52, v116, v117
    v_cvt_pk_bf16_f32 v53, v118, v119
    v_cvt_pk_bf16_f32 v54, v132, v133
    v_mfma_f32_16x16x32_bf16 v[196:199], a[168:171], v[88:91], v[196:199]
    v_cvt_pk_bf16_f32 v55, v134, v135
    buffer_store_dwordx4 v[52:55], v2, s[20:23], s49 offen offset:0 sc1
    v_pk_mul_f32 v[120:121], v[120:121], v[252:253] op_sel_hi:[1,0]
    v_pk_mul_f32 v[122:123], v[122:123], v[252:253] op_sel_hi:[1,0]
    v_pk_mul_f32 v[136:137], v[136:137], v[252:253] op_sel_hi:[1,0]
    v_pk_mul_f32 v[138:139], v[138:139], v[252:253] op_sel_hi:[1,0]
    v_cvt_pk_bf16_f32 v56, v120, v121
    v_cvt_pk_bf16_f32 v57, v122, v123
    v_cvt_pk_bf16_f32 v58, v136, v137
    v_cvt_pk_bf16_f32 v59, v138, v139
    buffer_store_dwordx4 v[56:59], v2, s[20:23], s50 offen offset:0 sc1
    v_pk_mul_f32 v[124:125], v[124:125], v[254:255] op_sel_hi:[1,0]
    v_pk_mul_f32 v[126:127], v[126:127], v[254:255] op_sel_hi:[1,0]
    v_pk_mul_f32 v[140:141], v[140:141], v[254:255] op_sel_hi:[1,0]
    v_pk_mul_f32 v[142:143], v[142:143], v[254:255] op_sel_hi:[1,0]
    v_cvt_pk_bf16_f32 v60, v124, v125
    v_cvt_pk_bf16_f32 v61, v126, v127
    v_cvt_pk_bf16_f32 v62, v140, v141
    v_cvt_pk_bf16_f32 v63, v142, v143
    buffer_store_dwordx4 v[60:63], v2, s[20:23], s51 offen offset:0 sc1
    v_mfma_f32_16x16x32_bf16 v[200:203], a[168:171], v[96:99], v[200:203]
    v_pk_mul_f32 v[144:145], v[144:145], v[248:249] op_sel_hi:[1,0]
    v_pk_mul_f32 v[146:147], v[146:147], v[248:249] op_sel_hi:[1,0]
    v_mfma_f32_16x16x32_bf16 v[204:207], a[168:171], v[104:107], v[204:207]
    v_pk_mul_f32 v[160:161], v[160:161], v[248:249] op_sel_hi:[1,0]
    v_pk_mul_f32 v[162:163], v[162:163], v[248:249] op_sel_hi:[1,0]
    v_mfma_f32_16x16x32_bf16 v[208:211], a[172:175], v[80:83], v[208:211]
    v_cvt_pk_bf16_f32 v64, v144, v145
    v_cvt_pk_bf16_f32 v65, v146, v147
    v_mfma_f32_16x16x32_bf16 v[212:215], a[172:175], v[88:91], v[212:215]
    v_cvt_pk_bf16_f32 v66, v160, v161
    v_cvt_pk_bf16_f32 v67, v162, v163
    v_mfma_f32_16x16x32_bf16 v[216:219], a[172:175], v[96:99], v[216:219]
    buffer_store_dwordx4 v[64:67], v2, s[20:23], s48 offen offset:1024 sc1
    v_mfma_f32_16x16x32_bf16 v[220:223], a[172:175], v[104:107], v[220:223]
    v_pk_mul_f32 v[148:149], v[148:149], v[250:251] op_sel_hi:[1,0]
    v_pk_mul_f32 v[150:151], v[150:151], v[250:251] op_sel_hi:[1,0]
    v_mfma_f32_16x16x32_bf16 v[224:227], a[176:179], v[80:83], v[224:227]
    v_pk_mul_f32 v[164:165], v[164:165], v[250:251] op_sel_hi:[1,0]
    v_pk_mul_f32 v[166:167], v[166:167], v[250:251] op_sel_hi:[1,0]
    v_cvt_pk_bf16_f32 v68, v148, v149
    v_cvt_pk_bf16_f32 v69, v150, v151
    v_cvt_pk_bf16_f32 v70, v164, v165
    v_mfma_f32_16x16x32_bf16 v[228:231], a[176:179], v[88:91], v[228:231]
    v_cvt_pk_bf16_f32 v71, v166, v167
    buffer_store_dwordx4 v[68:71], v2, s[20:23], s49 offen offset:1024 sc1
    v_pk_mul_f32 v[152:153], v[152:153], v[252:253] op_sel_hi:[1,0]
    v_pk_mul_f32 v[154:155], v[154:155], v[252:253] op_sel_hi:[1,0]
    v_pk_mul_f32 v[168:169], v[168:169], v[252:253] op_sel_hi:[1,0]
    v_pk_mul_f32 v[170:171], v[170:171], v[252:253] op_sel_hi:[1,0]
    v_cvt_pk_bf16_f32 v72, v152, v153
    v_cvt_pk_bf16_f32 v73, v154, v155
    v_cvt_pk_bf16_f32 v74, v168, v169
    v_cvt_pk_bf16_f32 v75, v170, v171
    buffer_store_dwordx4 v[72:75], v2, s[20:23], s50 offen offset:1024 sc1
    v_pk_mul_f32 v[156:157], v[156:157], v[254:255] op_sel_hi:[1,0]
    v_pk_mul_f32 v[158:159], v[158:159], v[254:255] op_sel_hi:[1,0]
    v_pk_mul_f32 v[172:173], v[172:173], v[254:255] op_sel_hi:[1,0]
    v_pk_mul_f32 v[174:175], v[174:175], v[254:255] op_sel_hi:[1,0]
    v_cvt_pk_bf16_f32 v76, v156, v157
    v_cvt_pk_bf16_f32 v77, v158, v159
    v_cvt_pk_bf16_f32 v78, v172, v173
    v_cvt_pk_bf16_f32 v79, v174, v175
    buffer_store_dwordx4 v[76:79], v2, s[20:23], s51 offen offset:1024 sc1
    v_mfma_f32_16x16x32_bf16 v[232:235], a[176:179], v[96:99], v[232:235]
    v_mfma_f32_16x16x32_bf16 v[236:239], a[176:179], v[104:107], v[236:239]
    v_pk_mul_f32 v[176:177], v[176:177], v[248:249] op_sel_hi:[1,0]
    v_pk_mul_f32 v[178:179], v[178:179], v[248:249] op_sel_hi:[1,0]
    v_pk_mul_f32 v[192:193], v[192:193], v[248:249] op_sel_hi:[1,0]
    v_pk_mul_f32 v[194:195], v[194:195], v[248:249] op_sel_hi:[1,0]
    v_cvt_pk_bf16_f32 v48, v176, v177
    v_cvt_pk_bf16_f32 v49, v178, v179
    v_cvt_pk_bf16_f32 v50, v192, v193
    v_cvt_pk_bf16_f32 v51, v194, v195
    buffer_store_dwordx4 v[48:51], v2, s[20:23], s48 offen offset:2048 sc1
    v_pk_mul_f32 v[180:181], v[180:181], v[250:251] op_sel_hi:[1,0]
    v_pk_mul_f32 v[182:183], v[182:183], v[250:251] op_sel_hi:[1,0]
    v_pk_mul_f32 v[196:197], v[196:197], v[250:251] op_sel_hi:[1,0]
    v_pk_mul_f32 v[198:199], v[198:199], v[250:251] op_sel_hi:[1,0]
    v_cvt_pk_bf16_f32 v52, v180, v181
    v_cvt_pk_bf16_f32 v53, v182, v183
    v_cvt_pk_bf16_f32 v54, v196, v197
    v_cvt_pk_bf16_f32 v55, v198, v199
    buffer_store_dwordx4 v[52:55], v2, s[20:23], s49 offen offset:2048 sc1
    v_pk_mul_f32 v[184:185], v[184:185], v[252:253] op_sel_hi:[1,0]
    v_pk_mul_f32 v[186:187], v[186:187], v[252:253] op_sel_hi:[1,0]
    v_pk_mul_f32 v[200:201], v[200:201], v[252:253] op_sel_hi:[1,0]
    v_pk_mul_f32 v[202:203], v[202:203], v[252:253] op_sel_hi:[1,0]
    v_cvt_pk_bf16_f32 v56, v184, v185
    v_cvt_pk_bf16_f32 v57, v186, v187
    v_cvt_pk_bf16_f32 v58, v200, v201
    v_cvt_pk_bf16_f32 v59, v202, v203
    buffer_store_dwordx4 v[56:59], v2, s[20:23], s50 offen offset:2048 sc1
    v_pk_mul_f32 v[188:189], v[188:189], v[254:255] op_sel_hi:[1,0]
    v_pk_mul_f32 v[190:191], v[190:191], v[254:255] op_sel_hi:[1,0]
    v_pk_mul_f32 v[204:205], v[204:205], v[254:255] op_sel_hi:[1,0]
    v_pk_mul_f32 v[206:207], v[206:207], v[254:255] op_sel_hi:[1,0]
    v_cvt_pk_bf16_f32 v60, v188, v189
    v_cvt_pk_bf16_f32 v61, v190, v191
    v_cvt_pk_bf16_f32 v62, v204, v205
    v_cvt_pk_bf16_f32 v63, v206, v207
    buffer_store_dwordx4 v[60:63], v2, s[20:23], s51 offen offset:2048 sc1
    v_pk_mul_f32 v[208:209], v[208:209], v[248:249] op_sel_hi:[1,0]
    v_pk_mul_f32 v[210:211], v[210:211], v[248:249] op_sel_hi:[1,0]
    v_pk_mul_f32 v[224:225], v[224:225], v[248:249] op_sel_hi:[1,0]
    v_pk_mul_f32 v[226:227], v[226:227], v[248:249] op_sel_hi:[1,0]
    v_cvt_pk_bf16_f32 v64, v208, v209
    v_cvt_pk_bf16_f32 v65, v210, v211
    v_cvt_pk_bf16_f32 v66, v224, v225
    v_cvt_pk_bf16_f32 v67, v226, v227
    buffer_store_dwordx4 v[64:67], v2, s[20:23], s48 offen offset:3072 sc1
    v_pk_mul_f32 v[212:213], v[212:213], v[250:251] op_sel_hi:[1,0]
    v_pk_mul_f32 v[214:215], v[214:215], v[250:251] op_sel_hi:[1,0]
    v_pk_mul_f32 v[228:229], v[228:229], v[250:251] op_sel_hi:[1,0]
    v_pk_mul_f32 v[230:231], v[230:231], v[250:251] op_sel_hi:[1,0]
    v_cvt_pk_bf16_f32 v68, v212, v213
    v_cvt_pk_bf16_f32 v69, v214, v215
    v_cvt_pk_bf16_f32 v70, v228, v229
    v_cvt_pk_bf16_f32 v71, v230, v231
    buffer_store_dwordx4 v[68:71], v2, s[20:23], s49 offen offset:3072 sc1
    v_pk_mul_f32 v[216:217], v[216:217], v[252:253] op_sel_hi:[1,0]
    v_pk_mul_f32 v[218:219], v[218:219], v[252:253] op_sel_hi:[1,0]
    v_pk_mul_f32 v[232:233], v[232:233], v[252:253] op_sel_hi:[1,0]
    v_pk_mul_f32 v[234:235], v[234:235], v[252:253] op_sel_hi:[1,0]
    v_cvt_pk_bf16_f32 v72, v216, v217
    v_cvt_pk_bf16_f32 v73, v218, v219
    v_cvt_pk_bf16_f32 v74, v232, v233
    v_cvt_pk_bf16_f32 v75, v234, v235
    buffer_store_dwordx4 v[72:75], v2, s[20:23], s50 offen offset:3072 sc1
    v_pk_mul_f32 v[220:221], v[220:221], v[254:255] op_sel_hi:[1,0]
    v_pk_mul_f32 v[222:223], v[222:223], v[254:255] op_sel_hi:[1,0]
    v_pk_mul_f32 v[236:237], v[236:237], v[254:255] op_sel_hi:[1,0]
    v_pk_mul_f32 v[238:239], v[238:239], v[254:255] op_sel_hi:[1,0]
    v_cvt_pk_bf16_f32 v76, v220, v221
    v_cvt_pk_bf16_f32 v77, v222, v223
    v_cvt_pk_bf16_f32 v78, v236, v237
    v_cvt_pk_bf16_f32 v79, v238, v239
    buffer_store_dwordx4 v[76:79], v2, s[20:23], s51 offen offset:3072 sc1
    s_mov_b32 s41, 0x5d800000
    v_cmp_ngt_f32 vcc, s41, v249
    s_cbranch_vccnz K1_SLOW
K1_EXIT:
    s_load_dwordx2 s[64:65], s[0:1], 104
    s_load_dwordx2 s[66:67], s[0:1], 0
    s_lshr_b32 s61, s5, 2
    s_lshl_b32 s61, s61, 7
    s_lshl_b32 s62, s4, 2
    s_add_u32 s61, s61, s62
    s_add_u32 s61, s61, 143360
    s_bfe_u32 s4, s2, 0x20001
    s_lshl_b32 s4, s4, 3
    s_bfe_u32 s37, s2, 0x30003
    s_add_u32 s4, s4, s37
    s_and_b32 s5, s2, 1
    s_lshl_b32 s5, s5, 2
    s_lshr_b32 s37, s2, 6
    s_add_u32 s5, s5, s37
    v_lshlrev_b32 v2, 4, v1
    v_add_u32 v4, 0, v2
    v_add_u32 v5, 131072, v2
    v_add_u32 v6, 262144, v2
    v_add_u32 v7, 393216, v2
    s_and_b32 s70, s5, 1
    s_mul_i32 s37, s70, 131072
    v_add_u32 v8, s37, v2
    s_mul_i32 s37, s70, -524288
    s_add_u32 s37, s37, 524288
    v_add_u32 v12, s37, v2
    v_add_u32 v9, 131072, v8
    v_add_u32 v10, 262144, v8
    v_add_u32 v11, 393216, v8
    s_lshl_b32 s37, s3, 15
    s_mul_i32 s32, s4, 524288
    s_lshl_b32 s33, s37, 0
    s_add_u32 s32, s32, s33
    s_mul_i32 s33, s5, 655360
    s_add_u32 s33, s33, s37
    s_mov_b32 s36, 0
    s_waitcnt lgkmcnt(0)
    s_add_u32 s8, s64, 0x187c000
    s_addc_u32 s9, s65, 0
    s_mov_b32 s10, 0x1000000
    s_mov_b32 s11, 0x20000
    s_add_u32 s12, s64, 0xd00000
    s_addc_u32 s13, s65, 0
    s_mov_b32 s14, 0x500000
    s_mov_b32 s15, 0x20000
    s_add_u32 s28, s64, 0xb0000
    s_addc_u32 s29, s65, 0
    s_mov_b32 s30, 0x30000
    s_mov_b32 s31, 0x20000
    v_lshlrev_b32 v141, 7, v1
    v_mov_b32 v142, 0
    s_mov_b32 s62, 147456
    s_mul_i32 s71, s3, 40960
    s_lshl_b32 s68, s3, 13
    s_lshl_b32 s69, s3, 14
    s_barrier
    s_cmp_lg_u32 s6, 0x70000000
    s_cbranch_scc1 TW_OK
    s_mov_b32 s37, 0
TW_POLL:
    buffer_load_dwordx4 v[200:203], v2, s[28:31], s62 offen offset:0 sc1
    buffer_load_dwordx4 v[204:207], v2, s[28:31], s62 offen offset:1024 sc1
    buffer_load_dwordx4 v[208:211], v2, s[28:31], s62 offen offset:2048 sc1
    buffer_load_dwordx4 v[212:215], v2, s[28:31], s62 offen offset:3072 sc1
    s_add_u32 s37, s37, 1
    s_waitcnt vmcnt(0)
    v_xor_b32 v200, v0, v200
    v_xor_b32 v201, v0, v201
    v_xor_b32 v202, v0, v202
    v_xor_b32 v203, v0, v203
    v_xor_b32 v204, v0, v204
    v_xor_b32 v205, v0, v205
    v_xor_b32 v206, v0, v206
    v_xor_b32 v207, v0, v207
    v_xor_b32 v208, v0, v208
    v_xor_b32 v209, v0, v209
    v_xor_b32 v210, v0, v210
    v_xor_b32 v211, v0, v211
    v_xor_b32 v212, v0, v212
    v_xor_b32 v213, v0, v213
    v_xor_b32 v214, v0, v214
    v_xor_b32 v215, v0, v215
    v_or3_b32 v200, v200, v201, v202
    v_or3_b32 v200, v200, v203, v204
    v_or3_b32 v200, v200, v205, v206
    v_or3_b32 v200, v200, v207, v208
    v_or3_b32 v200, v200, v209, v210
    v_or3_b32 v200, v200, v211, v212
    v_or3_b32 v200, v200, v213, v214
    v_or_b32 v200, v200, v215
    v_cmp_ne_u32 vcc, 0, v200
    s_cbranch_vccz TW_GO
    s_sleep 2
    s_cmp_lt_u32 s37, 0x80000
    s_cbranch_scc1 TW_POLL
TW_GO:
    s_mov_b32 s62, s33
    s_add_u32 s63, s33, 4096
    buffer_load_dwordx4 a[0:3], v8, s[12:15], s62 offen offset:0 sc1
    buffer_load_dwordx4 a[4:7], v9, s[12:15], s62 offen offset:0 sc1
    buffer_load_dwordx4 a[8:11], v10, s[12:15], s62 offen offset:0 sc1
    buffer_load_dwordx4 a[12:15], v11, s[12:15], s62 offen offset:0 sc1
    buffer_load_dwordx4 a[16:19], v12, s[12:15], s62 offen offset:0 sc1
    buffer_load_dwordx4 a[20:23], v8, s[12:15], s62 offen offset:1024 sc1
    buffer_load_dwordx4 a[24:27], v9, s[12:15], s62 offen offset:1024 sc1
    buffer_load_dwordx4 a[28:31], v10, s[12:15], s62 offen offset:1024 sc1
    buffer_load_dwordx4 a[32:35], v11, s[12:15], s62 offen offset:1024 sc1
    buffer_load_dwordx4 a[36:39], v12, s[12:15], s62 offen offset:1024 sc1
    buffer_load_dwordx4 a[40:43], v8, s[12:15], s62 offen offset:2048 sc1
    buffer_load_dwordx4 a[44:47], v9, s[12:15], s62 offen offset:2048 sc1
    buffer_load_dwordx4 a[48:51], v10, s[12:15], s62 offen offset:2048 sc1
    buffer_load_dwordx4 a[52:55], v11, s[12:15], s62 offen offset:2048 sc1
    buffer_load_dwordx4 a[56:59], v12, s[12:15], s62 offen offset:2048 sc1
    buffer_load_dwordx4 a[180:183], v8, s[12:15], s62 offen offset:3072 sc1
    buffer_load_dwordx4 a[184:187], v9, s[12:15], s62 offen offset:3072 sc1
    buffer_load_dwordx4 a[188:191], v10, s[12:15], s62 offen offset:3072 sc1
    buffer_load_dwordx4 a[192:195], v11, s[12:15], s62 offen offset:3072 sc1
    buffer_load_dwordx4 a[196:199], v12, s[12:15], s62 offen offset:3072 sc1
    buffer_load_dwordx4 a[200:203], v8, s[12:15], s63 offen offset:0 sc1
    buffer_load_dwordx4 a[204:207], v9, s[12:15], s63 offen offset:0 sc1
    buffer_load_dwordx4 a[208:211], v10, s[12:15], s63 offen offset:0 sc1
    buffer_load_dwordx4 a[212:215], v11, s[12:15], s63 offen offset:0 sc1
    buffer_load_dwordx4 a[216:219], v12, s[12:15], s63 offen offset:0 sc1
    buffer_load_dwordx4 a[220:223], v8, s[12:15], s63 offen offset:1024 sc1
    buffer_load_dwordx4 a[224:227], v9, s[12:15], s63 offen offset:1024 sc1
    buffer_load_dwordx4 a[228:231], v10, s[12:15], s63 offen offset:1024 sc1
    buffer_load_dwordx4 a[232:235], v11, s[12:15], s63 offen offset:1024 sc1
    buffer_load_dwordx4 a[236:239], v12, s[12:15], s63 offen offset:1024 sc1
TW_OK:
    s_add_u32 m0, s71, 0
    s_add_u32 s37, s33, 6144
    buffer_load_dwordx4 v8, s[12:15], s37 offen offset:0 sc1 lds
    buffer_load_dwordx4 v8, s[12:15], s37 offen offset:1024 sc1 lds
    buffer_load_dwordx4 v8, s[12:15], s37 offen offset:2048 sc1 lds
    buffer_load_dwordx4 v8, s[12:15], s37 offen offset:3072 sc1 lds
    s_add_u32 m0, s71, 4096
    s_add_u32 s37, s33, 10240
    buffer_load_dwordx4 v8, s[12:15], s37 offen offset:0 sc1 lds
    buffer_load_dwordx4 v8, s[12:15], s37 offen offset:1024 sc1 lds
    buffer_load_dwordx4 v8, s[12:15], s37 offen offset:2048 sc1 lds
    buffer_load_dwordx4 v8, s[12:15], s37 offen offset:3072 sc1 lds
    s_add_u32 m0, s71, 8192
    s_add_u32 s37, s33, 6144
    buffer_load_dwordx4 v9, s[12:15], s37 offen offset:0 sc1 lds
    buffer_load_dwordx4 v9, s[12:15], s37 offen offset:1024 sc1 lds
    buffer_load_dwordx4 v9, s[12:15], s37 offen offset:2048 sc1 lds
    buffer_load_dwordx4 v9, s[12:15], s37 offen offset:3072 sc1 lds
    s_add_u32 m0, s71, 12288
    s_add_u32 s37, s33, 10240
    buffer_load_dwordx4 v9, s[12:15], s37 offen offset:0 sc1 lds
    buffer_load_dwordx4 v9, s[12:15], s37 offen offset:1024 sc1 lds
    buffer_load_dwordx4 v9, s[12:15], s37 offen offset:2048 sc1 lds
    buffer_load_dwordx4 v9, s[12:15], s37 offen offset:3072 sc1 lds
    s_mov_b64 exec, 1
    s_waitcnt vmcnt(16)
    buffer_store_dword v0, v142, s[28:31], s61 offen sc1
    s_mov_b64 exec, -1
    s_add_u32 m0, s71, 16384
    s_add_u32 s37, s33, 6144
    buffer_load_dwordx4 v10, s[12:15], s37 offen offset:0 sc1 lds
    buffer_load_dwordx4 v10, s[12:15], s37 offen offset:1024 sc1 lds
    buffer_load_dwordx4 v10, s[12:15], s37 offen offset:2048 sc1 lds
    buffer_load_dwordx4 v10, s[12:15], s37 offen offset:3072 sc1 lds
    s_add_u32 m0, s71, 20480
    s_add_u32 s37, s33, 10240
    buffer_load_dwordx4 v10, s[12:15], s37 offen offset:0 sc1 lds
    buffer_load_dwordx4 v10, s[12:15], s37 offen offset:1024 sc1 lds
    buffer_load_dwordx4 v10, s[12:15], s37 offen offset:2048 sc1 lds
    buffer_load_dwordx4 v10, s[12:15], s37 offen offset:3072 sc1 lds
    s_add_u32 m0, s71, 24576
    s_add_u32 s37, s33, 6144
    buffer_load_dwordx4 v11, s[12:15], s37 offen offset:0 sc1 lds
    buffer_load_dwordx4 v11, s[12:15], s37 offen offset:1024 sc1 lds
    buffer_load_dwordx4 v11, s[12:15], s37 offen offset:2048 sc1 lds
    buffer_load_dwordx4 v11, s[12:15], s37 offen offset:3072 sc1 lds
    s_add_u32 m0, s71, 28672
    s_add_u32 s37, s33, 10240
    buffer_load_dwordx4 v11, s[12:15], s37 offen offset:0 sc1 lds
    buffer_load_dwordx4 v11, s[12:15], s37 offen offset:1024 sc1 lds
    buffer_load_dwordx4 v11, s[12:15], s37 offen offset:2048 sc1 lds
    buffer_load_dwordx4 v11, s[12:15], s37 offen offset:3072 sc1 lds
    s_add_u32 m0, s71, 32768
    s_add_u32 s37, s33, 6144
    buffer_load_dwordx4 v12, s[12:15], s37 offen offset:0 sc1 lds
    buffer_load_dwordx4 v12, s[12:15], s37 offen offset:1024 sc1 lds
    buffer_load_dwordx4 v12, s[12:15], s37 offen offset:2048 sc1 lds
    buffer_load_dwordx4 v12, s[12:15], s37 offen offset:3072 sc1 lds
    s_add_u32 m0, s71, 36864
    s_add_u32 s37, s33, 10240
    buffer_load_dwordx4 v12, s[12:15], s37 offen offset:0 sc1 lds
    buffer_load_dwordx4 v12, s[12:15], s37 offen offset:1024 sc1 lds
    buffer_load_dwordx4 v12, s[12:15], s37 offen offset:2048 sc1 lds
    buffer_load_dwordx4 v12, s[12:15], s37 offen offset:3072 sc1 lds
    s_add_u32 s63, s33, 12288
    s_mov_b32 s20, s64
    s_mov_b32 s21, s65
    s_mov_b32 s22, 0x3c00
    s_mov_b32 s23, 0x20000
    s_mov_b32 s16, s66
    s_mov_b32 s17, s67
    s_mov_b32 s18, 0x280000
    s_mov_b32 s19, 0x20000
    s_add_u32 s24, s64, 0x380000
    s_addc_u32 s25, s65, 0
    s_mov_b32 s26, 0x280000
    s_mov_b32 s27, 0x20000
    s_lshl_b32 s35, s4, 7
    s_lshl_b32 s34, s3, 5
    s_add_u32 s35, s35, s34
    s_add_u32 s35, s35, 143360
    v_and_b32 v128, 15, v1
    v_lshrrev_b32 v129, 4, v1
    s_lshl_b32 s37, s4, 2
    s_add_u32 s4, s37, s3
    v_mul_u32_u24 v130, 1280, v128
    v_lshl_add_u32 v130, v129, 3, v130
    v_lshlrev_b32 v131, 4, v129
    s_mul_i32 s50, s4, 20480
    s_mul_i32 s37, s5, 160
    s_add_u32 s50, s50, s37
    s_mul_i32 s51, s5, 320
    s_add_u32 s51, s51, 5120
    s_add_u32 s52, s51, 5120
    s_lshl_b32 s37, s70, 5
    s_add_u32 s50, s50, s37
    s_mul_i32 s54, s70, -160
    s_add_u32 s54, s54, s50
    s_lshl_b32 s37, s70, 6
    s_add_u32 s51, s51, s37
    s_add_u32 s52, s52, s37
    s_mul_i32 s37, s70, -320
    s_add_u32 s55, s51, s37
    s_add_u32 s56, s52, s37
    s_mul_i32 s53, s4, 20480
    s_mul_i32 s37, s5, 5
    s_add_u32 s37, s37, s70
    s_lshl_b32 s37, s37, 9
    s_add_u32 s57, s53, s37
    s_mul_i32 s37, s70, -2560
    s_add_u32 s58, s57, s37
    s_add_u32 s58, s58, 2048
    s_lshl_b32 s59, s4, 10
    s_lshl_b32 s38, s5, 7
    s_add_u32 s59, s59, s38
    s_lshr_b32 s60, s4, 1
    s_lshl_b32 s60, s60, 7
    s_and_b32 s37, s4, 1
    s_lshl_b32 s37, s37, 5
    s_add_u32 s60, s60, s37
    s_lshl_b32 s37, s5, 2
    s_add_u32 s60, s60, s37
    s_add_u32 s60, s60, 131072
    s_mul_i32 s37, s3, 5120
    s_add_u32 s37, s37, 61440
    v_add_u32 v132, s37, v2
    v_add_u32 v133, 40960, v132
    s_mul_i32 s37, s3, 20480
    s_add_u32 s37, s37, 61440
    v_add_u32 v134, s37, v2
    v_lshlrev_b32 v135, 3, v1
    s_and_b32 s47, s2, 1
    s_lshl_b32 s47, s47, 3
    s_bfe_u32 s46, s2, 0x30003
    s_add_u32 s47, s47, s46
    s_bfe_u32 s48, s2, 0x20001
    s_lshl_b32 s48, s48, 2
    s_lshr_b32 s46, s2, 6
    s_add_u32 s48, s48, s46
    s_mul_i32 s44, s3, 7168
    s_mul_i32 s45, s48, 14336
    s_and_b32 s46, s3, 1
    s_mul_i32 s46, s46, 7168
    s_add_u32 s45, s45, s46
    s_lshr_b32 s46, s3, 1
    s_mul_i32 s46, s46, 229376
    s_add_u32 s45, s45, s46
    s_add_u32 s40, s64, 0x141c000
    s_addc_u32 s41, s65, 0
    s_mov_b32 s42, 0x460000
    s_mov_b32 s43, 0x20000
    v_lshlrev_b32 v141, 2, v1
    v_add_u32 v136, s71, v2
    s_mov_b32 s37, 0
TA_POLL:
    buffer_load_dword v250, v141, s[28:31], s35 offen sc1
    s_add_u32 s37, s37, 1
    s_waitcnt vmcnt(0)
    v_cmp_eq_u32 vcc, v0, v250
    s_and_b32 s38, vcc_lo, 0xff
    s_cmp_eq_u32 s38, 0xff
    s_cbranch_scc1 TA_GO
    s_sleep 1
    s_cmp_lt_u32 s37, 0x80000
    s_cbranch_scc1 TA_POLL
TA_GO:
    buffer_load_dwordx4 a[64:67], v4, s[8:11], s32 offen offset:0 sc1
    buffer_load_dwordx4 a[68:71], v5, s[8:11], s32 offen offset:0 sc1
    buffer_load_dwordx4 a[72:75], v6, s[8:11], s32 offen offset:0 sc1
    buffer_load_dwordx4 a[76:79], v7, s[8:11], s32 offen offset:0 sc1
    buffer_load_dwordx4 a[80:83], v4, s[8:11], s32 offen offset:1024 sc1
    buffer_load_dwordx4 a[84:87], v5, s[8:11], s32 offen offset:1024 sc1
    buffer_load_dwordx4 a[88:91], v6, s[8:11], s32 offen offset:1024 sc1
    buffer_load_dwordx4 a[92:95], v7, s[8:11], s32 offen offset:1024 sc1
    buffer_load_dwordx4 a[96:99], v4, s[8:11], s32 offen offset:2048 sc1
    buffer_load_dwordx4 a[100:103], v5, s[8:11], s32 offen offset:2048 sc1
    buffer_load_dwordx4 a[104:107], v6, s[8:11], s32 offen offset:2048 sc1
    buffer_load_dwordx4 a[108:111], v7, s[8:11], s32 offen offset:2048 sc1
    v_accvgpr_read_b32 v96, a240
    v_accvgpr_read_b32 v97, a241
    v_accvgpr_read_b32 v98, a242
    v_accvgpr_read_b32 v99, a243
    v_accvgpr_read_b32 v100, a244
    v_accvgpr_read_b32 v101, a245
    v_accvgpr_read_b32 v102, a246
    v_accvgpr_read_b32 v103, a247
    v_accvgpr_read_b32 v104, a248
    v_accvgpr_read_b32 v105, a249
    s_waitcnt vmcnt(8)
    v_mfma_f32_16x16x32_bf16 v[16:19], a[0:3], a[64:67], 0
    buffer_load_dwordx4 a[112:115], v4, s[8:11], s32 offen offset:3072 sc1
    v_mfma_f32_16x16x32_bf16 v[36:39], a[0:3], a[68:71], 0
    v_mfma_f32_16x16x32_bf16 v[56:59], a[0:3], a[72:75], 0
    v_mfma_f32_16x16x32_bf16 v[76:79], a[0:3], a[76:79], 0
    v_mfma_f32_16x16x32_bf16 v[20:23], a[4:7], a[64:67], 0
    buffer_load_dwordx4 a[116:119], v5, s[8:11], s32 offen offset:3072 sc1
    v_mfma_f32_16x16x32_bf16 v[40:43], a[4:7], a[68:71], 0
    v_mfma_f32_16x16x32_bf16 v[60:63], a[4:7], a[72:75], 0
    v_mfma_f32_16x16x32_bf16 v[80:83], a[4:7], a[76:79], 0
    v_mfma_f32_16x16x32_bf16 v[24:27], a[8:11], a[64:67], 0
    v_mfma_f32_16x16x32_bf16 v[44:47], a[8:11], a[68:71], 0
    buffer_load_dwordx4 a[120:123], v6, s[8:11], s32 offen offset:3072 sc1
    v_mfma_f32_16x16x32_bf16 v[64:67], a[8:11], a[72:75], 0
    v_mfma_f32_16x16x32_bf16 v[84:87], a[8:11], a[76:79], 0
    v_mfma_f32_16x16x32_bf16 v[28:31], a[12:15], a[64:67], 0
    v_mfma_f32_16x16x32_bf16 v[48:51], a[12:15], a[68:71], 0
    buffer_load_dwordx4 a[124:127], v7, s[8:11], s32 offen offset:3072 sc1
    v_mfma_f32_16x16x32_bf16 v[68:71], a[12:15], a[72:75], 0
    v_mfma_f32_16x16x32_bf16 v[88:91], a[12:15], a[76:79], 0
    v_mfma_f32_16x16x32_bf16 v[32:35], a[16:19], a[64:67], 0
    v_mfma_f32_16x16x32_bf16 v[52:55], a[16:19], a[68:71], 0
    v_mfma_f32_16x16x32_bf16 v[72:75], a[16:19], a[72:75], 0
    v_mfma_f32_16x16x32_bf16 v[92:95], a[16:19], a[76:79], 0
    s_waitcnt vmcnt(8)
    v_mfma_f32_16x16x32_bf16 v[16:19], a[20:23], a[80:83], v[16:19]
    s_add_u32 s32, s32, 4096
    v_mfma_f32_16x16x32_bf16 v[36:39], a[20:23], a[84:87], v[36:39]
    v_mfma_f32_16x16x32_bf16 v[56:59], a[20:23], a[88:91], v[56:59]
    buffer_load_dwordx4 a[64:67], v4, s[8:11], s32 offen offset:0 sc1
    v_mfma_f32_16x16x32_bf16 v[76:79], a[20:23], a[92:95], v[76:79]
    v_mfma_f32_16x16x32_bf16 v[20:23], a[24:27], a[80:83], v[20:23]
    v_mfma_f32_16x16x32_bf16 v[40:43], a[24:27], a[84:87], v[40:43]
    buffer_load_dwordx4 a[68:71], v5, s[8:11], s32 offen offset:0 sc1
    v_mfma_f32_16x16x32_bf16 v[60:63], a[24:27], a[88:91], v[60:63]
    v_mfma_f32_16x16x32_bf16 v[80:83], a[24:27], a[92:95], v[80:83]
    buffer_load_dwordx4 a[72:75], v6, s[8:11], s32 offen offset:0 sc1
    v_mfma_f32_16x16x32_bf16 v[24:27], a[28:31], a[80:83], v[24:27]
    v_mfma_f32_16x16x32_bf16 v[44:47], a[28:31], a[84:87], v[44:47]
    v_mfma_f32_16x16x32_bf16 v[64:67], a[28:31], a[88:91], v[64:67]
    buffer_load_dwordx4 a[76:79], v7, s[8:11], s32 offen offset:0 sc1
    v_mfma_f32_16x16x32_bf16 v[84:87], a[28:31], a[92:95], v[84:87]
    v_mfma_f32_16x16x32_bf16 v[28:31], a[32:35], a[80:83], v[28:31]
    buffer_load_dwordx4 v[144:147], v131, s[20:23], s52 offen offset:0 sc1
    v_mfma_f32_16x16x32_bf16 v[48:51], a[32:35], a[84:87], v[48:51]
    v_mfma_f32_16x16x32_bf16 v[68:71], a[32:35], a[88:91], v[68:71]
    v_mfma_f32_16x16x32_bf16 v[88:91], a[32:35], a[92:95], v[88:91]
    buffer_load_dwordx4 v[108:111], v131, s[20:23], s51 offen offset:0 sc1
    v_mfma_f32_16x16x32_bf16 v[32:35], a[36:39], a[80:83], v[32:35]
    v_mfma_f32_16x16x32_bf16 v[52:55], a[36:39], a[84:87], v[52:55]
    v_mfma_f32_16x16x32_bf16 v[72:75], a[36:39], a[88:91], v[72:75]
    v_mfma_f32_16x16x32_bf16 v[92:95], a[36:39], a[92:95], v[92:95]
    s_waitcnt vmcnt(10)
    v_mfma_f32_16x16x32_bf16 v[16:19], a[40:43], a[96:99], v[16:19]
    buffer_load_dwordx4 a[80:83], v4, s[8:11], s32 offen offset:1024 sc1
    v_mfma_f32_16x16x32_bf16 v[36:39], a[40:43], a[100:103], v[36:39]
    v_mfma_f32_16x16x32_bf16 v[56:59], a[40:43], a[104:107], v[56:59]
    v_mfma_f32_16x16x32_bf16 v[76:79], a[40:43], a[108:111], v[76:79]
    buffer_load_dwordx4 a[84:87], v5, s[8:11], s32 offen offset:1024 sc1
    v_mfma_f32_16x16x32_bf16 v[20:23], a[44:47], a[96:99], v[20:23]
    v_mfma_f32_16x16x32_bf16 v[40:43], a[44:47], a[100:103], v[40:43]
    v_mfma_f32_16x16x32_bf16 v[60:63], a[44:47], a[104:107], v[60:63]
    buffer_load_dwordx4 a[88:91], v6, s[8:11], s32 offen offset:1024 sc1
    v_mfma_f32_16x16x32_bf16 v[80:83], a[44:47], a[108:111], v[80:83]
    v_mfma_f32_16x16x32_bf16 v[24:27], a[48:51], a[96:99], v[24:27]
    v_mfma_f32_16x16x32_bf16 v[44:47], a[48:51], a[100:103], v[44:47]
    buffer_load_dwordx4 a[92:95], v7, s[8:11], s32 offen offset:1024 sc1
    v_mfma_f32_16x16x32_bf16 v[64:67], a[48:51], a[104:107], v[64:67]
    v_mfma_f32_16x16x32_bf16 v[84:87], a[48:51], a[108:111], v[84:87]
    v_mfma_f32_16x16x32_bf16 v[28:31], a[52:55], a[96:99], v[28:31]
    buffer_load_dwordx4 v[148:151], v131, s[20:23], s52 offen offset:64 sc1
    v_mfma_f32_16x16x32_bf16 v[48:51], a[52:55], a[100:103], v[48:51]
    v_mfma_f32_16x16x32_bf16 v[68:71], a[52:55], a[104:107], v[68:71]
    v_mfma_f32_16x16x32_bf16 v[88:91], a[52:55], a[108:111], v[88:91]
    buffer_load_dwordx4 v[112:115], v131, s[20:23], s51 offen offset:64 sc1
    v_mfma_f32_16x16x32_bf16 v[32:35], a[56:59], a[96:99], v[32:35]
    v_mfma_f32_16x16x32_bf16 v[52:55], a[56:59], a[100:103], v[52:55]
    v_mfma_f32_16x16x32_bf16 v[72:75], a[56:59], a[104:107], v[72:75]
    v_mfma_f32_16x16x32_bf16 v[92:95], a[56:59], a[108:111], v[92:95]
    s_waitcnt vmcnt(12)
    v_mfma_f32_16x16x32_bf16 v[16:19], a[180:183], a[112:115], v[16:19]
    buffer_load_dwordx4 a[96:99], v4, s[8:11], s32 offen offset:2048 sc1
    v_mfma_f32_16x16x32_bf16 v[36:39], a[180:183], a[116:119], v[36:39]
    v_mfma_f32_16x16x32_bf16 v[56:59], a[180:183], a[120:123], v[56:59]
    v_mfma_f32_16x16x32_bf16 v[76:79], a[180:183], a[124:127], v[76:79]
    buffer_load_dwordx4 a[100:103], v5, s[8:11], s32 offen offset:2048 sc1
    v_mfma_f32_16x16x32_bf16 v[20:23], a[184:187], a[112:115], v[20:23]
    v_mfma_f32_16x16x32_bf16 v[40:43], a[184:187], a[116:119], v[40:43]
    v_mfma_f32_16x16x32_bf16 v[60:63], a[184:187], a[120:123], v[60:63]
    buffer_load_dwordx4 a[104:107], v6, s[8:11], s32 offen offset:2048 sc1
    v_mfma_f32_16x16x32_bf16 v[80:83], a[184:187], a[124:127], v[80:83]
    v_mfma_f32_16x16x32_bf16 v[24:27], a[188:191], a[112:115], v[24:27]
    v_mfma_f32_16x16x32_bf16 v[44:47], a[188:191], a[116:119], v[44:47]
    buffer_load_dwordx4 a[108:111], v7, s[8:11], s32 offen offset:2048 sc1
    v_mfma_f32_16x16x32_bf16 v[64:67], a[188:191], a[120:123], v[64:67]
    v_mfma_f32_16x16x32_bf16 v[84:87], a[188:191], a[124:127], v[84:87]
    v_mfma_f32_16x16x32_bf16 v[28:31], a[192:195], a[112:115], v[28:31]
    buffer_load_dwordx4 v[152:155], v131, s[20:23], s52 offen offset:128 sc1
    v_mfma_f32_16x16x32_bf16 v[48:51], a[192:195], a[116:119], v[48:51]
    v_mfma_f32_16x16x32_bf16 v[68:71], a[192:195], a[120:123], v[68:71]
    v_mfma_f32_16x16x32_bf16 v[88:91], a[192:195], a[124:127], v[88:91]
    buffer_load_dwordx4 v[116:119], v131, s[20:23], s51 offen offset:128 sc1
    v_mfma_f32_16x16x32_bf16 v[32:35], a[196:199], a[112:115], v[32:35]
    v_mfma_f32_16x16x32_bf16 v[52:55], a[196:199], a[116:119], v[52:55]
    v_mfma_f32_16x16x32_bf16 v[72:75], a[196:199], a[120:123], v[72:75]
    v_mfma_f32_16x16x32_bf16 v[92:95], a[196:199], a[124:127], v[92:95]
    s_waitcnt vmcnt(14)
    v_mfma_f32_16x16x32_bf16 v[16:19], a[200:203], a[64:67], v[16:19]
    buffer_load_dwordx4 a[112:115], v4, s[8:11], s32 offen offset:3072 sc1
    v_mfma_f32_16x16x32_bf16 v[36:39], a[200:203], a[68:71], v[36:39]
    v_mfma_f32_16x16x32_bf16 v[56:59], a[200:203], a[72:75], v[56:59]
    v_mfma_f32_16x16x32_bf16 v[76:79], a[200:203], a[76:79], v[76:79]
    buffer_load_dwordx4 a[116:119], v5, s[8:11], s32 offen offset:3072 sc1
    v_mfma_f32_16x16x32_bf16 v[20:23], a[204:207], a[64:67], v[20:23]
    v_mfma_f32_16x16x32_bf16 v[40:43], a[204:207], a[68:71], v[40:43]
    v_mfma_f32_16x16x32_bf16 v[60:63], a[204:207], a[72:75], v[60:63]
    buffer_load_dwordx4 a[120:123], v6, s[8:11], s32 offen offset:3072 sc1
    v_mfma_f32_16x16x32_bf16 v[80:83], a[204:207], a[76:79], v[80:83]
    v_mfma_f32_16x16x32_bf16 v[24:27], a[208:211], a[64:67], v[24:27]
    v_mfma_f32_16x16x32_bf16 v[44:47], a[208:211], a[68:71], v[44:47]
    buffer_load_dwordx4 a[124:127], v7, s[8:11], s32 offen offset:3072 sc1
    v_mfma_f32_16x16x32_bf16 v[64:67], a[208:211], a[72:75], v[64:67]
    v_mfma_f32_16x16x32_bf16 v[84:87], a[208:211], a[76:79], v[84:87]
    v_mfma_f32_16x16x32_bf16 v[28:31], a[212:215], a[64:67], v[28:31]
    buffer_load_dwordx4 v[156:159], v131, s[20:23], s52 offen offset:192 sc1
    v_mfma_f32_16x16x32_bf16 v[48:51], a[212:215], a[68:71], v[48:51]
    v_mfma_f32_16x16x32_bf16 v[68:71], a[212:215], a[72:75], v[68:71]
    v_mfma_f32_16x16x32_bf16 v[88:91], a[212:215], a[76:79], v[88:91]
    buffer_load_dwordx4 v[120:123], v131, s[20:23], s51 offen offset:192 sc1
    v_mfma_f32_16x16x32_bf16 v[32:35], a[216:219], a[64:67], v[32:35]
    v_mfma_f32_16x16x32_bf16 v[52:55], a[216:219], a[68:71], v[52:55]
    v_mfma_f32_16x16x32_bf16 v[72:75], a[216:219], a[72:75], v[72:75]
    v_mfma_f32_16x16x32_bf16 v[92:95], a[216:219], a[76:79], v[92:95]
    s_waitcnt vmcnt(14)
    v_mfma_f32_16x16x32_bf16 v[16:19], a[220:223], a[80:83], v[16:19]
    s_add_u32 s32, s32, 4096
    v_mfma_f32_16x16x32_bf16 v[36:39], a[220:223], a[84:87], v[36:39]
    v_mfma_f32_16x16x32_bf16 v[56:59], a[220:223], a[88:91], v[56:59]
    buffer_load_dwordx4 a[64:67], v4, s[8:11], s32 offen offset:0 sc1
    ds_read_b128 a[128:131], v136 offset:0
    v_mfma_f32_16x16x32_bf16 v[76:79], a[220:223], a[92:95], v[76:79]
    v_mfma_f32_16x16x32_bf16 v[20:23], a[224:227], a[80:83], v[20:23]
    v_mfma_f32_16x16x32_bf16 v[40:43], a[224:227], a[84:87], v[40:43]
    buffer_load_dwordx4 a[68:71], v5, s[8:11], s32 offen offset:0 sc1
    v_mfma_f32_16x16x32_bf16 v[60:63], a[224:227], a[88:91], v[60:63]
    ds_read_b128 a[132:135], v136 offset:8192
    v_mfma_f32_16x16x32_bf16 v[80:83], a[224:227], a[92:95], v[80:83]
    buffer_load_dwordx4 a[72:75], v6, s[8:11], s32 offen offset:0 sc1
    v_mfma_f32_16x16x32_bf16 v[24:27], a[228:231], a[80:83], v[24:27]
    v_mfma_f32_16x16x32_bf16 v[44:47], a[228:231], a[84:87], v[44:47]
    v_mfma_f32_16x16x32_bf16 v[64:67], a[228:231], a[88:91], v[64:67]
    buffer_load_dwordx4 a[76:79], v7, s[8:11], s32 offen offset:0 sc1
    ds_read_b128 a[136:139], v136 offset:16384
    v_mfma_f32_16x16x32_bf16 v[84:87], a[228:231], a[92:95], v[84:87]
    v_mfma_f32_16x16x32_bf16 v[28:31], a[232:235], a[80:83], v[28:31]
    buffer_load_dwordx4 v[160:163], v131, s[20:23], s56 offen offset:256 sc1
    v_mfma_f32_16x16x32_bf16 v[48:51], a[232:235], a[84:87], v[48:51]
    v_mfma_f32_16x16x32_bf16 v[68:71], a[232:235], a[88:91], v[68:71]
    ds_read_b128 a[140:143], v136 offset:24576
    v_mfma_f32_16x16x32_bf16 v[88:91], a[232:235], a[92:95], v[88:91]
    buffer_load_dwordx4 v[124:127], v131, s[20:23], s55 offen offset:256 sc1
    v_mfma_f32_16x16x32_bf16 v[32:35], a[236:239], a[80:83], v[32:35]
    v_mfma_f32_16x16x32_bf16 v[52:55], a[236:239], a[84:87], v[52:55]
    v_mfma_f32_16x16x32_bf16 v[72:75], a[236:239], a[88:91], v[72:75]
    ds_read_b128 a[144:147], v136 offset:32768
    v_mfma_f32_16x16x32_bf16 v[92:95], a[236:239], a[92:95], v[92:95]
    s_waitcnt lgkmcnt(0)
    s_waitcnt vmcnt(14)
    v_mfma_f32_16x16x32_bf16 v[16:19], a[128:131], a[96:99], v[16:19]
    buffer_load_dwordx4 a[80:83], v4, s[8:11], s32 offen offset:1024 sc1
    v_mfma_f32_16x16x32_bf16 v[36:39], a[128:131], a[100:103], v[36:39]
    v_mfma_f32_16x16x32_bf16 v[56:59], a[128:131], a[104:107], v[56:59]
    ds_read_b128 a[148:151], v136 offset:1024
    v_mfma_f32_16x16x32_bf16 v[76:79], a[128:131], a[108:111], v[76:79]
    v_mfma_f32_16x16x32_bf16 v[20:23], a[132:135], a[96:99], v[20:23]
    buffer_load_dwordx4 a[84:87], v5, s[8:11], s32 offen offset:1024 sc1
    v_mfma_f32_16x16x32_bf16 v[40:43], a[132:135], a[100:103], v[40:43]
    v_mfma_f32_16x16x32_bf16 v[60:63], a[132:135], a[104:107], v[60:63]
    ds_read_b128 a[152:155], v136 offset:9216
    v_mfma_f32_16x16x32_bf16 v[80:83], a[132:135], a[108:111], v[80:83]
    v_mfma_f32_16x16x32_bf16 v[24:27], a[136:139], a[96:99], v[24:27]
    v_mfma_f32_16x16x32_bf16 v[44:47], a[136:139], a[100:103], v[44:47]
    buffer_load_dwordx4 a[88:91], v6, s[8:11], s32 offen offset:1024 sc1
    v_mfma_f32_16x16x32_bf16 v[64:67], a[136:139], a[104:107], v[64:67]
    ds_read_b128 a[156:159], v136 offset:17408
    v_mfma_f32_16x16x32_bf16 v[84:87], a[136:139], a[108:111], v[84:87]
    v_mfma_f32_16x16x32_bf16 v[28:31], a[140:143], a[96:99], v[28:31]
    v_mfma_f32_16x16x32_bf16 v[48:51], a[140:143], a[100:103], v[48:51]
    buffer_load_dwordx4 a[92:95], v7, s[8:11], s32 offen offset:1024 sc1
    v_mfma_f32_16x16x32_bf16 v[68:71], a[140:143], a[104:107], v[68:71]
    ds_read_b128 a[160:163], v136 offset:25600
    v_mfma_f32_16x16x32_bf16 v[88:91], a[140:143], a[108:111], v[88:91]
    v_mfma_f32_16x16x32_bf16 v[32:35], a[144:147], a[96:99], v[32:35]
    v_mfma_f32_16x16x32_bf16 v[52:55], a[144:147], a[100:103], v[52:55]
    v_mfma_f32_16x16x32_bf16 v[72:75], a[144:147], a[104:107], v[72:75]
    ds_read_b128 a[164:167], v136 offset:33792
    v_mfma_f32_16x16x32_bf16 v[92:95], a[144:147], a[108:111], v[92:95]
    s_waitcnt lgkmcnt(0)
    s_waitcnt vmcnt(12)
    v_mfma_f32_16x16x32_bf16 v[16:19], a[148:151], a[112:115], v[16:19]
    buffer_load_dwordx4 a[96:99], v4, s[8:11], s32 offen offset:2048 sc1
    v_mfma_f32_16x16x32_bf16 v[36:39], a[148:151], a[116:119], v[36:39]
    v_mfma_f32_16x16x32_bf16 v[56:59], a[148:151], a[120:123], v[56:59]
    ds_read_b128 a[128:131], v136 offset:2048
    v_mfma_f32_16x16x32_bf16 v[76:79], a[148:151], a[124:127], v[76:79]
    v_mfma_f32_16x16x32_bf16 v[20:23], a[152:155], a[112:115], v[20:23]
    buffer_load_dwordx4 a[100:103], v5, s[8:11], s32 offen offset:2048 sc1
    v_mfma_f32_16x16x32_bf16 v[40:43], a[152:155], a[116:119], v[40:43]
    v_mfma_f32_16x16x32_bf16 v[60:63], a[152:155], a[120:123], v[60:63]
    ds_read_b128 a[132:135], v136 offset:10240
    v_mfma_f32_16x16x32_bf16 v[80:83], a[152:155], a[124:127], v[80:83]
    v_mfma_f32_16x16x32_bf16 v[24:27], a[156:159], a[112:115], v[24:27]
    v_mfma_f32_16x16x32_bf16 v[44:47], a[156:159], a[116:119], v[44:47]
    buffer_load_dwordx4 a[104:107], v6, s[8:11], s32 offen offset:2048 sc1
    v_mfma_f32_16x16x32_bf16 v[64:67], a[156:159], a[120:123], v[64:67]
    ds_read_b128 a[136:139], v136 offset:18432
    v_mfma_f32_16x16x32_bf16 v[84:87], a[156:159], a[124:127], v[84:87]
    v_mfma_f32_16x16x32_bf16 v[28:31], a[160:163], a[112:115], v[28:31]
    v_mfma_f32_16x16x32_bf16 v[48:51], a[160:163], a[116:119], v[48:51]
    buffer_load_dwordx4 a[108:111], v7, s[8:11], s32 offen offset:2048 sc1
    v_mfma_f32_16x16x32_bf16 v[68:71], a[160:163], a[120:123], v[68:71]
    ds_read_b128 a[140:143], v136 offset:26624
    v_mfma_f32_16x16x32_bf16 v[88:91], a[160:163], a[124:127], v[88:91]
    v_mfma_f32_16x16x32_bf16 v[32:35], a[164:167], a[112:115], v[32:35]
    v_mfma_f32_16x16x32_bf16 v[52:55], a[164:167], a[116:119], v[52:55]
    v_mfma_f32_16x16x32_bf16 v[72:75], a[164:167], a[120:123], v[72:75]
    ds_read_b128 a[144:147], v136 offset:34816
    v_mfma_f32_16x16x32_bf16 v[92:95], a[164:167], a[124:127], v[92:95]
    s_waitcnt lgkmcnt(0)
    s_waitcnt vmcnt(10)
    v_mfma_f32_16x16x32_bf16 v[16:19], a[128:131], a[64:67], v[16:19]
    buffer_load_dwordx4 a[112:115], v4, s[8:11], s32 offen offset:3072 sc1
    v_mfma_f32_16x16x32_bf16 v[36:39], a[128:131], a[68:71], v[36:39]
    v_mfma_f32_16x16x32_bf16 v[56:59], a[128:131], a[72:75], v[56:59]
    ds_read_b128 a[148:151], v136 offset:3072
    v_mfma_f32_16x16x32_bf16 v[76:79], a[128:131], a[76:79], v[76:79]
    v_mfma_f32_16x16x32_bf16 v[20:23], a[132:135], a[64:67], v[20:23]
    buffer_load_dwordx4 a[116:119], v5, s[8:11], s32 offen offset:3072 sc1
    v_mfma_f32_16x16x32_bf16 v[40:43], a[132:135], a[68:71], v[40:43]
    v_mfma_f32_16x16x32_bf16 v[60:63], a[132:135], a[72:75], v[60:63]
    ds_read_b128 a[152:155], v136 offset:11264
    v_mfma_f32_16x16x32_bf16 v[80:83], a[132:135], a[76:79], v[80:83]
    v_mfma_f32_16x16x32_bf16 v[24:27], a[136:139], a[64:67], v[24:27]
    v_mfma_f32_16x16x32_bf16 v[44:47], a[136:139], a[68:71], v[44:47]
    buffer_load_dwordx4 a[120:123], v6, s[8:11], s32 offen offset:3072 sc1
    v_mfma_f32_16x16x32_bf16 v[64:67], a[136:139], a[72:75], v[64:67]
    ds_read_b128 a[156:159], v136 offset:19456
    v_mfma_f32_16x16x32_bf16 v[84:87], a[136:139], a[76:79], v[84:87]
    v_mfma_f32_16x16x32_bf16 v[28:31], a[140:143], a[64:67], v[28:31]
    v_mfma_f32_16x16x32_bf16 v[48:51], a[140:143], a[68:71], v[48:51]
    buffer_load_dwordx4 a[124:127], v7, s[8:11], s32 offen offset:3072 sc1
    v_mfma_f32_16x16x32_bf16 v[68:71], a[140:143], a[72:75], v[68:71]
    ds_read_b128 a[160:163], v136 offset:27648
    v_mfma_f32_16x16x32_bf16 v[88:91], a[140:143], a[76:79], v[88:91]
    v_mfma_f32_16x16x32_bf16 v[32:35], a[144:147], a[64:67], v[32:35]
    v_mfma_f32_16x16x32_bf16 v[52:55], a[144:147], a[68:71], v[52:55]
    v_mfma_f32_16x16x32_bf16 v[72:75], a[144:147], a[72:75], v[72:75]
    ds_read_b128 a[164:167], v136 offset:35840
    v_mfma_f32_16x16x32_bf16 v[92:95], a[144:147], a[76:79], v[92:95]
    s_waitcnt lgkmcnt(0)
    s_waitcnt vmcnt(8)
    v_mfma_f32_16x16x32_bf16 v[16:19], a[148:151], a[80:83], v[16:19]
    s_add_u32 s32, s32, 4096
    v_mfma_f32_16x16x32_bf16 v[36:39], a[148:151], a[84:87], v[36:39]
    buffer_load_dwordx4 a[64:67], v4, s[8:11], s32 offen offset:0 sc1
    v_mfma_f32_16x16x32_bf16 v[56:59], a[148:151], a[88:91], v[56:59]
    ds_read_b128 a[128:131], v136 offset:4096
    v_mfma_f32_16x16x32_bf16 v[76:79], a[148:151], a[92:95], v[76:79]
    buffer_load_dwordx4 a[68:71], v5, s[8:11], s32 offen offset:0 sc1
    v_mfma_f32_16x16x32_bf16 v[20:23], a[152:155], a[80:83], v[20:23]
    v_mfma_f32_16x16x32_bf16 v[40:43], a[152:155], a[84:87], v[40:43]
    buffer_load_dwordx4 a[72:75], v6, s[8:11], s32 offen offset:0 sc1
    v_mfma_f32_16x16x32_bf16 v[60:63], a[152:155], a[88:91], v[60:63]
    ds_read_b128 a[132:135], v136 offset:12288
    v_mfma_f32_16x16x32_bf16 v[80:83], a[152:155], a[92:95], v[80:83]
    buffer_load_dwordx4 a[76:79], v7, s[8:11], s32 offen offset:0 sc1
    v_mfma_f32_16x16x32_bf16 v[24:27], a[156:159], a[80:83], v[24:27]
    v_mfma_f32_16x16x32_bf16 v[44:47], a[156:159], a[84:87], v[44:47]
    buffer_load_dwordx4 a[0:3], v8, s[12:15], s63 offen offset:2048 sc1
    v_mfma_f32_16x16x32_bf16 v[64:67], a[156:159], a[88:91], v[64:67]
    buffer_load_dwordx4 a[4:7], v9, s[12:15], s63 offen offset:2048 sc1
    ds_read_b128 a[136:139], v136 offset:20480
    v_mfma_f32_16x16x32_bf16 v[84:87], a[156:159], a[92:95], v[84:87]
    v_mfma_f32_16x16x32_bf16 v[28:31], a[160:163], a[80:83], v[28:31]
    buffer_load_dwordx4 a[8:11], v10, s[12:15], s63 offen offset:2048 sc1
    v_mfma_f32_16x16x32_bf16 v[48:51], a[160:163], a[84:87], v[48:51]
    v_mfma_f32_16x16x32_bf16 v[68:71], a[160:163], a[88:91], v[68:71]
    buffer_load_dwordx4 a[12:15], v11, s[12:15], s63 offen offset:2048 sc1
    ds_read_b128 a[140:143], v136 offset:28672
    v_mfma_f32_16x16x32_bf16 v[88:91], a[160:163], a[92:95], v[88:91]
    v_mfma_f32_16x16x32_bf16 v[32:35], a[164:167], a[80:83], v[32:35]
    buffer_load_dwordx4 a[16:19], v12, s[12:15], s63 offen offset:2048 sc1
    v_mfma_f32_16x16x32_bf16 v[52:55], a[164:167], a[84:87], v[52:55]
    v_mfma_f32_16x16x32_bf16 v[72:75], a[164:167], a[88:91], v[72:75]
    ds_read_b128 a[144:147], v136 offset:36864
    v_mfma_f32_16x16x32_bf16 v[92:95], a[164:167], a[92:95], v[92:95]
    s_waitcnt lgkmcnt(0)
    s_waitcnt vmcnt(13)
    v_mfma_f32_16x16x32_bf16 v[16:19], a[128:131], a[96:99], v[16:19]
    buffer_load_dwordx4 a[80:83], v4, s[8:11], s32 offen offset:1024 sc1
    v_mfma_f32_16x16x32_bf16 v[36:39], a[128:131], a[100:103], v[36:39]
    v_mfma_f32_16x16x32_bf16 v[56:59], a[128:131], a[104:107], v[56:59]
    buffer_load_dwordx4 a[84:87], v5, s[8:11], s32 offen offset:1024 sc1
    ds_read_b128 a[148:151], v136 offset:5120
    v_mfma_f32_16x16x32_bf16 v[76:79], a[128:131], a[108:111], v[76:79]
    v_mfma_f32_16x16x32_bf16 v[20:23], a[132:135], a[96:99], v[20:23]
    buffer_load_dwordx4 a[88:91], v6, s[8:11], s32 offen offset:1024 sc1
    v_mfma_f32_16x16x32_bf16 v[40:43], a[132:135], a[100:103], v[40:43]
    v_mfma_f32_16x16x32_bf16 v[60:63], a[132:135], a[104:107], v[60:63]
    buffer_load_dwordx4 a[92:95], v7, s[8:11], s32 offen offset:1024 sc1
    ds_read_b128 a[152:155], v136 offset:13312
    v_mfma_f32_16x16x32_bf16 v[80:83], a[132:135], a[108:111], v[80:83]
    v_mfma_f32_16x16x32_bf16 v[24:27], a[136:139], a[96:99], v[24:27]
    buffer_load_dwordx4 a[20:23], v8, s[12:15], s63 offen offset:3072 sc1
    v_mfma_f32_16x16x32_bf16 v[44:47], a[136:139], a[100:103], v[44:47]
    v_mfma_f32_16x16x32_bf16 v[64:67], a[136:139], a[104:107], v[64:67]
    buffer_load_dwordx4 a[24:27], v9, s[12:15], s63 offen offset:3072 sc1
    ds_read_b128 a[156:159], v136 offset:21504
    v_mfma_f32_16x16x32_bf16 v[84:87], a[136:139], a[108:111], v[84:87]
    v_mfma_f32_16x16x32_bf16 v[28:31], a[140:143], a[96:99], v[28:31]
    buffer_load_dwordx4 a[28:31], v10, s[12:15], s63 offen offset:3072 sc1
    v_mfma_f32_16x16x32_bf16 v[48:51], a[140:143], a[100:103], v[48:51]
    v_mfma_f32_16x16x32_bf16 v[68:71], a[140:143], a[104:107], v[68:71]
    buffer_load_dwordx4 a[32:35], v11, s[12:15], s63 offen offset:3072 sc1
    ds_read_b128 a[160:163], v136 offset:29696
    v_mfma_f32_16x16x32_bf16 v[88:91], a[140:143], a[108:111], v[88:91]
    v_mfma_f32_16x16x32_bf16 v[32:35], a[144:147], a[96:99], v[32:35]
    buffer_load_dwordx4 a[36:39], v12, s[12:15], s63 offen offset:3072 sc1
    v_mfma_f32_16x16x32_bf16 v[52:55], a[144:147], a[100:103], v[52:55]
    v_mfma_f32_16x16x32_bf16 v[72:75], a[144:147], a[104:107], v[72:75]
    ds_read_b128 a[164:167], v136 offset:37888
    v_mfma_f32_16x16x32_bf16 v[92:95], a[144:147], a[108:111], v[92:95]
    s_waitcnt lgkmcnt(0)
    s_waitcnt vmcnt(18)
    v_mfma_f32_16x16x32_bf16 v[16:19], a[148:151], a[112:115], v[16:19]
    buffer_load_dwordx4 a[96:99], v4, s[8:11], s32 offen offset:2048 sc1
    v_mfma_f32_16x16x32_bf16 v[36:39], a[148:151], a[116:119], v[36:39]
    buffer_load_dwordx4 a[100:103], v5, s[8:11], s32 offen offset:2048 sc1
    v_mfma_f32_16x16x32_bf16 v[56:59], a[148:151], a[120:123], v[56:59]
    ds_read_b128 a[128:131], v136 offset:6144
    v_mfma_f32_16x16x32_bf16 v[76:79], a[148:151], a[124:127], v[76:79]
    buffer_load_dwordx4 a[104:107], v6, s[8:11], s32 offen offset:2048 sc1
    v_mfma_f32_16x16x32_bf16 v[20:23], a[152:155], a[112:115], v[20:23]
    v_mfma_f32_16x16x32_bf16 v[40:43], a[152:155], a[116:119], v[40:43]
    buffer_load_dwordx4 a[108:111], v7, s[8:11], s32 offen offset:2048 sc1
    v_mfma_f32_16x16x32_bf16 v[60:63], a[152:155], a[120:123], v[60:63]
    ds_read_b128 a[132:135], v136 offset:14336
    v_mfma_f32_16x16x32_bf16 v[80:83], a[152:155], a[124:127], v[80:83]
    s_add_u32 s62, s33, 16384
    v_mfma_f32_16x16x32_bf16 v[24:27], a[156:159], a[112:115], v[24:27]
    v_mfma_f32_16x16x32_bf16 v[44:47], a[156:159], a[116:119], v[44:47]
    buffer_load_dwordx4 a[40:43], v8, s[12:15], s62 offen offset:0 sc1
    v_mfma_f32_16x16x32_bf16 v[64:67], a[156:159], a[120:123], v[64:67]
    buffer_load_dwordx4 a[44:47], v9, s[12:15], s62 offen offset:0 sc1
    ds_read_b128 a[136:139], v136 offset:22528
    v_mfma_f32_16x16x32_bf16 v[84:87], a[156:159], a[124:127], v[84:87]
    v_mfma_f32_16x16x32_bf16 v[28:31], a[160:163], a[112:115], v[28:31]
    buffer_load_dwordx4 a[48:51], v10, s[12:15], s62 offen offset:0 sc1
    v_mfma_f32_16x16x32_bf16 v[48:51], a[160:163], a[116:119], v[48:51]
    v_mfma_f32_16x16x32_bf16 v[68:71], a[160:163], a[120:123], v[68:71]
    buffer_load_dwordx4 a[52:55], v11, s[12:15], s62 offen offset:0 sc1
    ds_read_b128 a[140:143], v136 offset:30720
    v_mfma_f32_16x16x32_bf16 v[88:91], a[160:163], a[124:127], v[88:91]
    v_mfma_f32_16x16x32_bf16 v[32:35], a[164:167], a[112:115], v[32:35]
    buffer_load_dwordx4 a[56:59], v12, s[12:15], s62 offen offset:0 sc1
    v_mfma_f32_16x16x32_bf16 v[52:55], a[164:167], a[116:119], v[52:55]
    v_mfma_f32_16x16x32_bf16 v[72:75], a[164:167], a[120:123], v[72:75]
    ds_read_b128 a[144:147], v136 offset:38912
    v_mfma_f32_16x16x32_bf16 v[92:95], a[164:167], a[124:127], v[92:95]
    s_waitcnt lgkmcnt(0)
    s_waitcnt vmcnt(23)
    v_mfma_f32_16x16x32_bf16 v[16:19], a[128:131], a[64:67], v[16:19]
    buffer_load_dwordx4 a[112:115], v4, s[8:11], s32 offen offset:3072 sc1
    v_mfma_f32_16x16x32_bf16 v[36:39], a[128:131], a[68:71], v[36:39]
    v_mfma_f32_16x16x32_bf16 v[56:59], a[128:131], a[72:75], v[56:59]
    buffer_load_dwordx4 a[116:119], v5, s[8:11], s32 offen offset:3072 sc1
    ds_read_b128 a[148:151], v136 offset:7168
    v_mfma_f32_16x16x32_bf16 v[76:79], a[128:131], a[76:79], v[76:79]
    v_mfma_f32_16x16x32_bf16 v[20:23], a[132:135], a[64:67], v[20:23]
    buffer_load_dwordx4 a[120:123], v6, s[8:11], s32 offen offset:3072 sc1
    v_mfma_f32_16x16x32_bf16 v[40:43], a[132:135], a[68:71], v[40:43]
    v_mfma_f32_16x16x32_bf16 v[60:63], a[132:135], a[72:75], v[60:63]
    buffer_load_dwordx4 a[124:127], v7, s[8:11], s32 offen offset:3072 sc1
    ds_read_b128 a[152:155], v136 offset:15360
    v_mfma_f32_16x16x32_bf16 v[80:83], a[132:135], a[76:79], v[80:83]
    v_mfma_f32_16x16x32_bf16 v[24:27], a[136:139], a[64:67], v[24:27]
    buffer_load_dwordx4 a[180:183], v8, s[12:15], s62 offen offset:1024 sc1
    v_mfma_f32_16x16x32_bf16 v[44:47], a[136:139], a[68:71], v[44:47]
    v_mfma_f32_16x16x32_bf16 v[64:67], a[136:139], a[72:75], v[64:67]
    buffer_load_dwordx4 a[184:187], v9, s[12:15], s62 offen offset:1024 sc1
    ds_read_b128 a[156:159], v136 offset:23552
    v_mfma_f32_16x16x32_bf16 v[84:87], a[136:139], a[76:79], v[84:87]
    v_mfma_f32_16x16x32_bf16 v[28:31], a[140:143], a[64:67], v[28:31]
    buffer_load_dwordx4 a[188:191], v10, s[12:15], s62 offen offset:1024 sc1
    v_mfma_f32_16x16x32_bf16 v[48:51], a[140:143], a[68:71], v[48:51]
    v_mfma_f32_16x16x32_bf16 v[68:71], a[140:143], a[72:75], v[68:71]
    buffer_load_dwordx4 a[192:195], v11, s[12:15], s62 offen offset:1024 sc1
    ds_read_b128 a[160:163], v136 offset:31744
    v_mfma_f32_16x16x32_bf16 v[88:91], a[140:143], a[76:79], v[88:91]
    v_mfma_f32_16x16x32_bf16 v[32:35], a[144:147], a[64:67], v[32:35]
    buffer_load_dwordx4 a[196:199], v12, s[12:15], s62 offen offset:1024 sc1
    v_mfma_f32_16x16x32_bf16 v[52:55], a[144:147], a[68:71], v[52:55]
    v_mfma_f32_16x16x32_bf16 v[72:75], a[144:147], a[72:75], v[72:75]
    ds_read_b128 a[164:167], v136 offset:39936
    v_mfma_f32_16x16x32_bf16 v[92:95], a[144:147], a[76:79], v[92:95]
    s_waitcnt lgkmcnt(0)
    s_waitcnt vmcnt(23)
    v_mfma_f32_16x16x32_bf16 v[16:19], a[148:151], a[80:83], v[16:19]
    s_add_u32 s32, s32, 4096
    v_mfma_f32_16x16x32_bf16 v[36:39], a[148:151], a[84:87], v[36:39]
    buffer_load_dwordx4 a[64:67], v4, s[8:11], s32 offen offset:0 sc1
    v_mfma_f32_16x16x32_bf16 v[56:59], a[148:151], a[88:91], v[56:59]
    v_mfma_f32_16x16x32_bf16 v[76:79], a[148:151], a[92:95], v[76:79]
    buffer_load_dwordx4 a[68:71], v5, s[8:11], s32 offen offset:0 sc1
    v_mfma_f32_16x16x32_bf16 v[20:23], a[152:155], a[80:83], v[20:23]
    v_mfma_f32_16x16x32_bf16 v[40:43], a[152:155], a[84:87], v[40:43]
    buffer_load_dwordx4 a[72:75], v6, s[8:11], s32 offen offset:0 sc1
    v_mfma_f32_16x16x32_bf16 v[60:63], a[152:155], a[88:91], v[60:63]
    v_mfma_f32_16x16x32_bf16 v[80:83], a[152:155], a[92:95], v[80:83]
    buffer_load_dwordx4 a[76:79], v7, s[8:11], s32 offen offset:0 sc1
    v_mfma_f32_16x16x32_bf16 v[24:27], a[156:159], a[80:83], v[24:27]
    v_mfma_f32_16x16x32_bf16 v[44:47], a[156:159], a[84:87], v[44:47]
    buffer_load_dwordx4 a[200:203], v8, s[12:15], s62 offen offset:2048 sc1
    v_mfma_f32_16x16x32_bf16 v[64:67], a[156:159], a[88:91], v[64:67]
    buffer_load_dwordx4 a[204:207], v9, s[12:15], s62 offen offset:2048 sc1
    v_mfma_f32_16x16x32_bf16 v[84:87], a[156:159], a[92:95], v[84:87]
    v_mfma_f32_16x16x32_bf16 v[28:31], a[160:163], a[80:83], v[28:31]
    buffer_load_dwordx4 a[208:211], v10, s[12:15], s62 offen offset:2048 sc1
    v_mfma_f32_16x16x32_bf16 v[48:51], a[160:163], a[84:87], v[48:51]
    v_mfma_f32_16x16x32_bf16 v[68:71], a[160:163], a[88:91], v[68:71]
    buffer_load_dwordx4 a[212:215], v11, s[12:15], s62 offen offset:2048 sc1
    v_mfma_f32_16x16x32_bf16 v[88:91], a[160:163], a[92:95], v[88:91]
    v_mfma_f32_16x16x32_bf16 v[32:35], a[164:167], a[80:83], v[32:35]
    buffer_load_dwordx4 a[216:219], v12, s[12:15], s62 offen offset:2048 sc1
    v_mfma_f32_16x16x32_bf16 v[52:55], a[164:167], a[84:87], v[52:55]
    v_mfma_f32_16x16x32_bf16 v[72:75], a[164:167], a[88:91], v[72:75]
    v_mfma_f32_16x16x32_bf16 v[92:95], a[164:167], a[92:95], v[92:95]
    s_waitcnt vmcnt(23)
    v_mfma_f32_16x16x32_bf16 v[16:19], a[0:3], a[96:99], v[16:19]
    buffer_load_dwordx4 a[80:83], v4, s[8:11], s32 offen offset:1024 sc1
    v_mfma_f32_16x16x32_bf16 v[36:39], a[0:3], a[100:103], v[36:39]
    v_mfma_f32_16x16x32_bf16 v[56:59], a[0:3], a[104:107], v[56:59]
    buffer_load_dwordx4 a[84:87], v5, s[8:11], s32 offen offset:1024 sc1
    v_mfma_f32_16x16x32_bf16 v[76:79], a[0:3], a[108:111], v[76:79]
    v_mfma_f32_16x16x32_bf16 v[20:23], a[4:7], a[96:99], v[20:23]
    buffer_load_dwordx4 a[88:91], v6, s[8:11], s32 offen offset:1024 sc1
    v_mfma_f32_16x16x32_bf16 v[40:43], a[4:7], a[100:103], v[40:43]
    v_mfma_f32_16x16x32_bf16 v[60:63], a[4:7], a[104:107], v[60:63]
    buffer_load_dwordx4 a[92:95], v7, s[8:11], s32 offen offset:1024 sc1
    v_mfma_f32_16x16x32_bf16 v[80:83], a[4:7], a[108:111], v[80:83]
    v_mfma_f32_16x16x32_bf16 v[24:27], a[8:11], a[96:99], v[24:27]
    buffer_load_dwordx4 a[220:223], v8, s[12:15], s62 offen offset:3072 sc1
    v_mfma_f32_16x16x32_bf16 v[44:47], a[8:11], a[100:103], v[44:47]
    v_mfma_f32_16x16x32_bf16 v[64:67], a[8:11], a[104:107], v[64:67]
    buffer_load_dwordx4 a[224:227], v9, s[12:15], s62 offen offset:3072 sc1
    v_mfma_f32_16x16x32_bf16 v[84:87], a[8:11], a[108:111], v[84:87]
    v_mfma_f32_16x16x32_bf16 v[28:31], a[12:15], a[96:99], v[28:31]
    buffer_load_dwordx4 a[228:231], v10, s[12:15], s62 offen offset:3072 sc1
    v_mfma_f32_16x16x32_bf16 v[48:51], a[12:15], a[100:103], v[48:51]
    v_mfma_f32_16x16x32_bf16 v[68:71], a[12:15], a[104:107], v[68:71]
    buffer_load_dwordx4 a[232:235], v11, s[12:15], s62 offen offset:3072 sc1
    v_mfma_f32_16x16x32_bf16 v[88:91], a[12:15], a[108:111], v[88:91]
    v_mfma_f32_16x16x32_bf16 v[32:35], a[16:19], a[96:99], v[32:35]
    buffer_load_dwordx4 a[236:239], v12, s[12:15], s62 offen offset:3072 sc1
    v_mfma_f32_16x16x32_bf16 v[52:55], a[16:19], a[100:103], v[52:55]
    v_mfma_f32_16x16x32_bf16 v[72:75], a[16:19], a[104:107], v[72:75]
    v_mfma_f32_16x16x32_bf16 v[92:95], a[16:19], a[108:111], v[92:95]
    s_waitcnt vmcnt(23)
    v_mfma_f32_16x16x32_bf16 v[16:19], a[20:23], a[112:115], v[16:19]
    buffer_load_dwordx4 a[96:99], v4, s[8:11], s32 offen offset:2048 sc1
    v_mfma_f32_16x16x32_bf16 v[36:39], a[20:23], a[116:119], v[36:39]
    buffer_load_dwordx4 a[100:103], v5, s[8:11], s32 offen offset:2048 sc1
    v_mfma_f32_16x16x32_bf16 v[56:59], a[20:23], a[120:123], v[56:59]
    v_mfma_f32_16x16x32_bf16 v[76:79], a[20:23], a[124:127], v[76:79]
    buffer_load_dwordx4 a[104:107], v6, s[8:11], s32 offen offset:2048 sc1
    v_mfma_f32_16x16x32_bf16 v[20:23], a[24:27], a[112:115], v[20:23]
    v_mfma_f32_16x16x32_bf16 v[40:43], a[24:27], a[116:119], v[40:43]
    buffer_load_dwordx4 a[108:111], v7, s[8:11], s32 offen offset:2048 sc1
    v_mfma_f32_16x16x32_bf16 v[60:63], a[24:27], a[120:123], v[60:63]
    v_mfma_f32_16x16x32_bf16 v[80:83], a[24:27], a[124:127], v[80:83]
    s_add_u32 s63, s33, 20480
    v_mfma_f32_16x16x32_bf16 v[24:27], a[28:31], a[112:115], v[24:27]
    v_mfma_f32_16x16x32_bf16 v[44:47], a[28:31], a[116:119], v[44:47]
    buffer_load_dwordx4 a[0:3], v8, s[12:15], s63 offen offset:0 sc1
    v_mfma_f32_16x16x32_bf16 v[64:67], a[28:31], a[120:123], v[64:67]
    buffer_load_dwordx4 a[4:7], v9, s[12:15], s63 offen offset:0 sc1
    v_mfma_f32_16x16x32_bf16 v[84:87], a[28:31], a[124:127], v[84:87]
    v_mfma_f32_16x16x32_bf16 v[28:31], a[32:35], a[112:115], v[28:31]
    buffer_load_dwordx4 a[8:11], v10, s[12:15], s63 offen offset:0 sc1
    v_mfma_f32_16x16x32_bf16 v[48:51], a[32:35], a[116:119], v[48:51]
    v_mfma_f32_16x16x32_bf16 v[68:71], a[32:35], a[120:123], v[68:71]
    buffer_load_dwordx4 a[12:15], v11, s[12:15], s63 offen offset:0 sc1
    v_mfma_f32_16x16x32_bf16 v[88:91], a[32:35], a[124:127], v[88:91]
    v_mfma_f32_16x16x32_bf16 v[32:35], a[36:39], a[112:115], v[32:35]
    buffer_load_dwordx4 a[16:19], v12, s[12:15], s63 offen offset:0 sc1
    v_mfma_f32_16x16x32_bf16 v[52:55], a[36:39], a[116:119], v[52:55]
    v_mfma_f32_16x16x32_bf16 v[72:75], a[36:39], a[120:123], v[72:75]
    v_mfma_f32_16x16x32_bf16 v[92:95], a[36:39], a[124:127], v[92:95]
    s_waitcnt vmcnt(23)
    v_mfma_f32_16x16x32_bf16 v[16:19], a[40:43], a[64:67], v[16:19]
    buffer_load_dwordx4 a[112:115], v4, s[8:11], s32 offen offset:3072 sc1
    v_mfma_f32_16x16x32_bf16 v[36:39], a[40:43], a[68:71], v[36:39]
    v_mfma_f32_16x16x32_bf16 v[56:59], a[40:43], a[72:75], v[56:59]
    buffer_load_dwordx4 a[116:119], v5, s[8:11], s32 offen offset:3072 sc1
    v_mfma_f32_16x16x32_bf16 v[76:79], a[40:43], a[76:79], v[76:79]
    v_mfma_f32_16x16x32_bf16 v[20:23], a[44:47], a[64:67], v[20:23]
    buffer_load_dwordx4 a[120:123], v6, s[8:11], s32 offen offset:3072 sc1
    v_mfma_f32_16x16x32_bf16 v[40:43], a[44:47], a[68:71], v[40:43]
    v_mfma_f32_16x16x32_bf16 v[60:63], a[44:47], a[72:75], v[60:63]
    buffer_load_dwordx4 a[124:127], v7, s[8:11], s32 offen offset:3072 sc1
    v_mfma_f32_16x16x32_bf16 v[80:83], a[44:47], a[76:79], v[80:83]
    v_mfma_f32_16x16x32_bf16 v[24:27], a[48:51], a[64:67], v[24:27]
    buffer_load_dwordx4 a[20:23], v8, s[12:15], s63 offen offset:1024 sc1
    v_mfma_f32_16x16x32_bf16 v[44:47], a[48:51], a[68:71], v[44:47]
    v_mfma_f32_16x16x32_bf16 v[64:67], a[48:51], a[72:75], v[64:67]
    buffer_load_dwordx4 a[24:27], v9, s[12:15], s63 offen offset:1024 sc1
    v_mfma_f32_16x16x32_bf16 v[84:87], a[48:51], a[76:79], v[84:87]
    v_mfma_f32_16x16x32_bf16 v[28:31], a[52:55], a[64:67], v[28:31]
    buffer_load_dwordx4 a[28:31], v10, s[12:15], s63 offen offset:1024 sc1
    v_mfma_f32_16x16x32_bf16 v[48:51], a[52:55], a[68:71], v[48:51]
    v_mfma_f32_16x16x32_bf16 v[68:71], a[52:55], a[72:75], v[68:71]
    buffer_load_dwordx4 a[32:35], v11, s[12:15], s63 offen offset:1024 sc1
    v_mfma_f32_16x16x32_bf16 v[88:91], a[52:55], a[76:79], v[88:91]
    v_mfma_f32_16x16x32_bf16 v[32:35], a[56:59], a[64:67], v[32:35]
    buffer_load_dwordx4 a[36:39], v12, s[12:15], s63 offen offset:1024 sc1
    v_mfma_f32_16x16x32_bf16 v[52:55], a[56:59], a[68:71], v[52:55]
    v_mfma_f32_16x16x32_bf16 v[72:75], a[56:59], a[72:75], v[72:75]
    v_mfma_f32_16x16x32_bf16 v[92:95], a[56:59], a[76:79], v[92:95]
    s_waitcnt vmcnt(23)
    v_mfma_f32_16x16x32_bf16 v[16:19], a[180:183], a[80:83], v[16:19]
    s_add_u32 s32, s32, 4096
    v_mfma_f32_16x16x32_bf16 v[36:39], a[180:183], a[84:87], v[36:39]
    buffer_load_dwordx4 a[64:67], v4, s[8:11], s32 offen offset:0 sc1
    v_mfma_f32_16x16x32_bf16 v[56:59], a[180:183], a[88:91], v[56:59]
    v_mfma_f32_16x16x32_bf16 v[76:79], a[180:183], a[92:95], v[76:79]
    buffer_load_dwordx4 a[68:71], v5, s[8:11], s32 offen offset:0 sc1
    v_mfma_f32_16x16x32_bf16 v[20:23], a[184:187], a[80:83], v[20:23]
    v_mfma_f32_16x16x32_bf16 v[40:43], a[184:187], a[84:87], v[40:43]
    buffer_load_dwordx4 a[72:75], v6, s[8:11], s32 offen offset:0 sc1
    v_mfma_f32_16x16x32_bf16 v[60:63], a[184:187], a[88:91], v[60:63]
    v_mfma_f32_16x16x32_bf16 v[80:83], a[184:187], a[92:95], v[80:83]
    buffer_load_dwordx4 a[76:79], v7, s[8:11], s32 offen offset:0 sc1
    v_mfma_f32_16x16x32_bf16 v[24:27], a[188:191], a[80:83], v[24:27]
    v_mfma_f32_16x16x32_bf16 v[44:47], a[188:191], a[84:87], v[44:47]
    buffer_load_dwordx4 a[40:43], v8, s[12:15], s63 offen offset:2048 sc1
    v_mfma_f32_16x16x32_bf16 v[64:67], a[188:191], a[88:91], v[64:67]
    buffer_load_dwordx4 a[44:47], v9, s[12:15], s63 offen offset:2048 sc1
    v_mfma_f32_16x16x32_bf16 v[84:87], a[188:191], a[92:95], v[84:87]
    v_mfma_f32_16x16x32_bf16 v[28:31], a[192:195], a[80:83], v[28:31]
    buffer_load_dwordx4 a[48:51], v10, s[12:15], s63 offen offset:2048 sc1
    v_mfma_f32_16x16x32_bf16 v[48:51], a[192:195], a[84:87], v[48:51]
    v_mfma_f32_16x16x32_bf16 v[68:71], a[192:195], a[88:91], v[68:71]
    buffer_load_dwordx4 a[52:55], v11, s[12:15], s63 offen offset:2048 sc1
    v_mfma_f32_16x16x32_bf16 v[88:91], a[192:195], a[92:95], v[88:91]
    v_mfma_f32_16x16x32_bf16 v[32:35], a[196:199], a[80:83], v[32:35]
    buffer_load_dwordx4 a[56:59], v12, s[12:15], s63 offen offset:2048 sc1
    v_mfma_f32_16x16x32_bf16 v[52:55], a[196:199], a[84:87], v[52:55]
    v_mfma_f32_16x16x32_bf16 v[72:75], a[196:199], a[88:91], v[72:75]
    v_mfma_f32_16x16x32_bf16 v[92:95], a[196:199], a[92:95], v[92:95]
    s_waitcnt vmcnt(23)
    v_mfma_f32_16x16x32_bf16 v[16:19], a[200:203], a[96:99], v[16:19]
    buffer_load_dwordx4 a[80:83], v4, s[8:11], s32 offen offset:1024 sc1
    v_mfma_f32_16x16x32_bf16 v[36:39], a[200:203], a[100:103], v[36:39]
    v_mfma_f32_16x16x32_bf16 v[56:59], a[200:203], a[104:107], v[56:59]
    buffer_load_dwordx4 a[84:87], v5, s[8:11], s32 offen offset:1024 sc1
    v_mfma_f32_16x16x32_bf16 v[76:79], a[200:203], a[108:111], v[76:79]
    v_mfma_f32_16x16x32_bf16 v[20:23], a[204:207], a[96:99], v[20:23]
    buffer_load_dwordx4 a[88:91], v6, s[8:11], s32 offen offset:1024 sc1
    v_mfma_f32_16x16x32_bf16 v[40:43], a[204:207], a[100:103], v[40:43]
    v_mfma_f32_16x16x32_bf16 v[60:63], a[204:207], a[104:107], v[60:63]
    buffer_load_dwordx4 a[92:95], v7, s[8:11], s32 offen offset:1024 sc1
    v_mfma_f32_16x16x32_bf16 v[80:83], a[204:207], a[108:111], v[80:83]
    v_mfma_f32_16x16x32_bf16 v[24:27], a[208:211], a[96:99], v[24:27]
    buffer_load_dwordx4 a[180:183], v8, s[12:15], s63 offen offset:3072 sc1
    v_mfma_f32_16x16x32_bf16 v[44:47], a[208:211], a[100:103], v[44:47]
    v_mfma_f32_16x16x32_bf16 v[64:67], a[208:211], a[104:107], v[64:67]
    buffer_load_dwordx4 a[184:187], v9, s[12:15], s63 offen offset:3072 sc1
    v_mfma_f32_16x16x32_bf16 v[84:87], a[208:211], a[108:111], v[84:87]
    v_mfma_f32_16x16x32_bf16 v[28:31], a[212:215], a[96:99], v[28:31]
    buffer_load_dwordx4 a[188:191], v10, s[12:15], s63 offen offset:3072 sc1
    v_mfma_f32_16x16x32_bf16 v[48:51], a[212:215], a[100:103], v[48:51]
    v_mfma_f32_16x16x32_bf16 v[68:71], a[212:215], a[104:107], v[68:71]
    buffer_load_dwordx4 a[192:195], v11, s[12:15], s63 offen offset:3072 sc1
    v_mfma_f32_16x16x32_bf16 v[88:91], a[212:215], a[108:111], v[88:91]
    v_mfma_f32_16x16x32_bf16 v[32:35], a[216:219], a[96:99], v[32:35]
    buffer_load_dwordx4 a[196:199], v12, s[12:15], s63 offen offset:3072 sc1
    v_mfma_f32_16x16x32_bf16 v[52:55], a[216:219], a[100:103], v[52:55]
    v_mfma_f32_16x16x32_bf16 v[72:75], a[216:219], a[104:107], v[72:75]
    v_mfma_f32_16x16x32_bf16 v[92:95], a[216:219], a[108:111], v[92:95]
    s_waitcnt vmcnt(23)
    v_mfma_f32_16x16x32_bf16 v[16:19], a[220:223], a[112:115], v[16:19]
    buffer_load_dwordx4 a[96:99], v4, s[8:11], s32 offen offset:2048 sc1
    v_mfma_f32_16x16x32_bf16 v[36:39], a[220:223], a[116:119], v[36:39]
    buffer_load_dwordx4 a[100:103], v5, s[8:11], s32 offen offset:2048 sc1
    v_mfma_f32_16x16x32_bf16 v[56:59], a[220:223], a[120:123], v[56:59]
    v_mfma_f32_16x16x32_bf16 v[76:79], a[220:223], a[124:127], v[76:79]
    buffer_load_dwordx4 a[104:107], v6, s[8:11], s32 offen offset:2048 sc1
    v_mfma_f32_16x16x32_bf16 v[20:23], a[224:227], a[112:115], v[20:23]
    v_mfma_f32_16x16x32_bf16 v[40:43], a[224:227], a[116:119], v[40:43]
    buffer_load_dwordx4 a[108:111], v7, s[8:11], s32 offen offset:2048 sc1
    v_mfma_f32_16x16x32_bf16 v[60:63], a[224:227], a[120:123], v[60:63]
    v_mfma_f32_16x16x32_bf16 v[80:83], a[224:227], a[124:127], v[80:83]
    s_add_u32 s62, s33, 24576
    v_mfma_f32_16x16x32_bf16 v[24:27], a[228:231], a[112:115], v[24:27]
    v_mfma_f32_16x16x32_bf16 v[44:47], a[228:231], a[116:119], v[44:47]
    buffer_load_dwordx4 a[200:203], v8, s[12:15], s62 offen offset:0 sc1
    v_mfma_f32_16x16x32_bf16 v[64:67], a[228:231], a[120:123], v[64:67]
    buffer_load_dwordx4 a[204:207], v9, s[12:15], s62 offen offset:0 sc1
    v_mfma_f32_16x16x32_bf16 v[84:87], a[228:231], a[124:127], v[84:87]
    v_mfma_f32_16x16x32_bf16 v[28:31], a[232:235], a[112:115], v[28:31]
    buffer_load_dwordx4 a[208:211], v10, s[12:15], s62 offen offset:0 sc1
    v_mfma_f32_16x16x32_bf16 v[48:51], a[232:235], a[116:119], v[48:51]
    v_mfma_f32_16x16x32_bf16 v[68:71], a[232:235], a[120:123], v[68:71]
    buffer_load_dwordx4 a[212:215], v11, s[12:15], s62 offen offset:0 sc1
    v_mfma_f32_16x16x32_bf16 v[88:91], a[232:235], a[124:127], v[88:91]
    v_mfma_f32_16x16x32_bf16 v[32:35], a[236:239], a[112:115], v[32:35]
    buffer_load_dwordx4 a[216:219], v12, s[12:15], s62 offen offset:0 sc1
    v_mfma_f32_16x16x32_bf16 v[52:55], a[236:239], a[116:119], v[52:55]
    v_mfma_f32_16x16x32_bf16 v[72:75], a[236:239], a[120:123], v[72:75]
    v_mfma_f32_16x16x32_bf16 v[92:95], a[236:239], a[124:127], v[92:95]
    s_waitcnt vmcnt(23)
    v_mfma_f32_16x16x32_bf16 v[16:19], a[0:3], a[64:67], v[16:19]
    buffer_load_dwordx4 a[112:115], v4, s[8:11], s32 offen offset:3072 sc1
    v_mfma_f32_16x16x32_bf16 v[36:39], a[0:3], a[68:71], v[36:39]
    v_mfma_f32_16x16x32_bf16 v[56:59], a[0:3], a[72:75], v[56:59]
    buffer_load_dwordx4 a[116:119], v5, s[8:11], s32 offen offset:3072 sc1
    v_mfma_f32_16x16x32_bf16 v[76:79], a[0:3], a[76:79], v[76:79]
    v_mfma_f32_16x16x32_bf16 v[20:23], a[4:7], a[64:67], v[20:23]
    buffer_load_dwordx4 a[120:123], v6, s[8:11], s32 offen offset:3072 sc1
    v_mfma_f32_16x16x32_bf16 v[40:43], a[4:7], a[68:71], v[40:43]
    v_mfma_f32_16x16x32_bf16 v[60:63], a[4:7], a[72:75], v[60:63]
    buffer_load_dwordx4 a[124:127], v7, s[8:11], s32 offen offset:3072 sc1
    v_mfma_f32_16x16x32_bf16 v[80:83], a[4:7], a[76:79], v[80:83]
    v_mfma_f32_16x16x32_bf16 v[24:27], a[8:11], a[64:67], v[24:27]
    buffer_load_dwordx4 a[220:223], v8, s[12:15], s62 offen offset:1024 sc1
    v_mfma_f32_16x16x32_bf16 v[44:47], a[8:11], a[68:71], v[44:47]
    v_mfma_f32_16x16x32_bf16 v[64:67], a[8:11], a[72:75], v[64:67]
    buffer_load_dwordx4 a[224:227], v9, s[12:15], s62 offen offset:1024 sc1
    v_mfma_f32_16x16x32_bf16 v[84:87], a[8:11], a[76:79], v[84:87]
    v_mfma_f32_16x16x32_bf16 v[28:31], a[12:15], a[64:67], v[28:31]
    buffer_load_dwordx4 a[228:231], v10, s[12:15], s62 offen offset:1024 sc1
    v_mfma_f32_16x16x32_bf16 v[48:51], a[12:15], a[68:71], v[48:51]
    v_mfma_f32_16x16x32_bf16 v[68:71], a[12:15], a[72:75], v[68:71]
    buffer_load_dwordx4 a[232:235], v11, s[12:15], s62 offen offset:1024 sc1
    v_mfma_f32_16x16x32_bf16 v[88:91], a[12:15], a[76:79], v[88:91]
    v_mfma_f32_16x16x32_bf16 v[32:35], a[16:19], a[64:67], v[32:35]
    buffer_load_dwordx4 a[236:239], v12, s[12:15], s62 offen offset:1024 sc1
    v_mfma_f32_16x16x32_bf16 v[52:55], a[16:19], a[68:71], v[52:55]
    v_mfma_f32_16x16x32_bf16 v[72:75], a[16:19], a[72:75], v[72:75]
    v_mfma_f32_16x16x32_bf16 v[92:95], a[16:19], a[76:79], v[92:95]
    s_waitcnt vmcnt(23)
    v_mfma_f32_16x16x32_bf16 v[16:19], a[20:23], a[80:83], v[16:19]
    s_add_u32 s32, s32, 4096
    v_mfma_f32_16x16x32_bf16 v[36:39], a[20:23], a[84:87], v[36:39]
    buffer_load_dwordx4 a[64:67], v4, s[8:11], s32 offen offset:0 sc1
    v_mfma_f32_16x16x32_bf16 v[56:59], a[20:23], a[88:91], v[56:59]
    v_mfma_f32_16x16x32_bf16 v[76:79], a[20:23], a[92:95], v[76:79]
    buffer_load_dwordx4 a[68:71], v5, s[8:11], s32 offen offset:0 sc1
    v_mfma_f32_16x16x32_bf16 v[20:23], a[24:27], a[80:83], v[20:23]
    v_mfma_f32_16x16x32_bf16 v[40:43], a[24:27], a[84:87], v[40:43]
    buffer_load_dwordx4 a[72:75], v6, s[8:11], s32 offen offset:0 sc1
    v_mfma_f32_16x16x32_bf16 v[60:63], a[24:27], a[88:91], v[60:63]
    v_mfma_f32_16x16x32_bf16 v[80:83], a[24:27], a[92:95], v[80:83]
    buffer_load_dwordx4 a[76:79], v7, s[8:11], s32 offen offset:0 sc1
    v_mfma_f32_16x16x32_bf16 v[24:27], a[28:31], a[80:83], v[24:27]
    v_mfma_f32_16x16x32_bf16 v[44:47], a[28:31], a[84:87], v[44:47]
    buffer_load_dwordx4 a[0:3], v8, s[12:15], s62 offen offset:2048 sc1
    v_mfma_f32_16x16x32_bf16 v[64:67], a[28:31], a[88:91], v[64:67]
    buffer_load_dwordx4 a[4:7], v9, s[12:15], s62 offen offset:2048 sc1
    v_mfma_f32_16x16x32_bf16 v[84:87], a[28:31], a[92:95], v[84:87]
    v_mfma_f32_16x16x32_bf16 v[28:31], a[32:35], a[80:83], v[28:31]
    buffer_load_dwordx4 a[8:11], v10, s[12:15], s62 offen offset:2048 sc1
    v_mfma_f32_16x16x32_bf16 v[48:51], a[32:35], a[84:87], v[48:51]
    v_mfma_f32_16x16x32_bf16 v[68:71], a[32:35], a[88:91], v[68:71]
    buffer_load_dwordx4 a[12:15], v11, s[12:15], s62 offen offset:2048 sc1
    v_mfma_f32_16x16x32_bf16 v[88:91], a[32:35], a[92:95], v[88:91]
    v_mfma_f32_16x16x32_bf16 v[32:35], a[36:39], a[80:83], v[32:35]
    buffer_load_dwordx4 a[16:19], v12, s[12:15], s62 offen offset:2048 sc1
    v_mfma_f32_16x16x32_bf16 v[52:55], a[36:39], a[84:87], v[52:55]
    v_mfma_f32_16x16x32_bf16 v[72:75], a[36:39], a[88:91], v[72:75]
    v_mfma_f32_16x16x32_bf16 v[92:95], a[36:39], a[92:95], v[92:95]
    s_waitcnt vmcnt(23)
    v_mfma_f32_16x16x32_bf16 v[16:19], a[40:43], a[96:99], v[16:19]
    buffer_load_dwordx4 a[80:83], v4, s[8:11], s32 offen offset:1024 sc1
    v_mfma_f32_16x16x32_bf16 v[36:39], a[40:43], a[100:103], v[36:39]
    v_mfma_f32_16x16x32_bf16 v[56:59], a[40:43], a[104:107], v[56:59]
    buffer_load_dwordx4 a[84:87], v5, s[8:11], s32 offen offset:1024 sc1
    v_mfma_f32_16x16x32_bf16 v[76:79], a[40:43], a[108:111], v[76:79]
    v_mfma_f32_16x16x32_bf16 v[20:23], a[44:47], a[96:99], v[20:23]
    buffer_load_dwordx4 a[88:91], v6, s[8:11], s32 offen offset:1024 sc1
    v_mfma_f32_16x16x32_bf16 v[40:43], a[44:47], a[100:103], v[40:43]
    v_mfma_f32_16x16x32_bf16 v[60:63], a[44:47], a[104:107], v[60:63]
    buffer_load_dwordx4 a[92:95], v7, s[8:11], s32 offen offset:1024 sc1
    v_mfma_f32_16x16x32_bf16 v[80:83], a[44:47], a[108:111], v[80:83]
    v_mfma_f32_16x16x32_bf16 v[24:27], a[48:51], a[96:99], v[24:27]
    buffer_load_dwordx4 a[20:23], v8, s[12:15], s62 offen offset:3072 sc1
    v_mfma_f32_16x16x32_bf16 v[44:47], a[48:51], a[100:103], v[44:47]
    v_mfma_f32_16x16x32_bf16 v[64:67], a[48:51], a[104:107], v[64:67]
    buffer_load_dwordx4 a[24:27], v9, s[12:15], s62 offen offset:3072 sc1
    v_mfma_f32_16x16x32_bf16 v[84:87], a[48:51], a[108:111], v[84:87]
    v_mfma_f32_16x16x32_bf16 v[28:31], a[52:55], a[96:99], v[28:31]
    buffer_load_dwordx4 a[28:31], v10, s[12:15], s62 offen offset:3072 sc1
    v_mfma_f32_16x16x32_bf16 v[48:51], a[52:55], a[100:103], v[48:51]
    v_mfma_f32_16x16x32_bf16 v[68:71], a[52:55], a[104:107], v[68:71]
    buffer_load_dwordx4 a[32:35], v11, s[12:15], s62 offen offset:3072 sc1
    v_mfma_f32_16x16x32_bf16 v[88:91], a[52:55], a[108:111], v[88:91]
    v_mfma_f32_16x16x32_bf16 v[32:35], a[56:59], a[96:99], v[32:35]
    buffer_load_dwordx4 a[36:39], v12, s[12:15], s62 offen offset:3072 sc1
    v_mfma_f32_16x16x32_bf16 v[52:55], a[56:59], a[100:103], v[52:55]
    v_mfma_f32_16x16x32_bf16 v[72:75], a[56:59], a[104:107], v[72:75]
    v_mfma_f32_16x16x32_bf16 v[92:95], a[56:59], a[108:111], v[92:95]
    s_waitcnt vmcnt(23)
    v_mfma_f32_16x16x32_bf16 v[16:19], a[180:183], a[112:115], v[16:19]
    buffer_load_dwordx4 a[96:99], v4, s[8:11], s32 offen offset:2048 sc1
    v_mfma_f32_16x16x32_bf16 v[36:39], a[180:183], a[116:119], v[36:39]
    buffer_load_dwordx4 a[100:103], v5, s[8:11], s32 offen offset:2048 sc1
    v_mfma_f32_16x16x32_bf16 v[56:59], a[180:183], a[120:123], v[56:59]
    v_mfma_f32_16x16x32_bf16 v[76:79], a[180:183], a[124:127], v[76:79]
    buffer_load_dwordx4 a[104:107], v6, s[8:11], s32 offen offset:2048 sc1
    v_mfma_f32_16x16x32_bf16 v[20:23], a[184:187], a[112:115], v[20:23]
    v_mfma_f32_16x16x32_bf16 v[40:43], a[184:187], a[116:119], v[40:43]
    buffer_load_dwordx4 a[108:111], v7, s[8:11], s32 offen offset:2048 sc1
    v_mfma_f32_16x16x32_bf16 v[60:63], a[184:187], a[120:123], v[60:63]
    v_mfma_f32_16x16x32_bf16 v[80:83], a[184:187], a[124:127], v[80:83]
    s_add_u32 s63, s33, 28672
    v_mfma_f32_16x16x32_bf16 v[24:27], a[188:191], a[112:115], v[24:27]
    v_mfma_f32_16x16x32_bf16 v[44:47], a[188:191], a[116:119], v[44:47]
    buffer_load_dwordx4 a[40:43], v8, s[12:15], s63 offen offset:0 sc1
    v_mfma_f32_16x16x32_bf16 v[64:67], a[188:191], a[120:123], v[64:67]
    buffer_load_dwordx4 a[44:47], v9, s[12:15], s63 offen offset:0 sc1
    v_mfma_f32_16x16x32_bf16 v[84:87], a[188:191], a[124:127], v[84:87]
    v_mfma_f32_16x16x32_bf16 v[28:31], a[192:195], a[112:115], v[28:31]
    buffer_load_dwordx4 a[48:51], v10, s[12:15], s63 offen offset:0 sc1
    v_mfma_f32_16x16x32_bf16 v[48:51], a[192:195], a[116:119], v[48:51]
    v_mfma_f32_16x16x32_bf16 v[68:71], a[192:195], a[120:123], v[68:71]
    buffer_load_dwordx4 a[52:55], v11, s[12:15], s63 offen offset:0 sc1
    v_mfma_f32_16x16x32_bf16 v[88:91], a[192:195], a[124:127], v[88:91]
    v_mfma_f32_16x16x32_bf16 v[32:35], a[196:199], a[112:115], v[32:35]
    buffer_load_dwordx4 a[56:59], v12, s[12:15], s63 offen offset:0 sc1
    v_mfma_f32_16x16x32_bf16 v[52:55], a[196:199], a[116:119], v[52:55]
    v_mfma_f32_16x16x32_bf16 v[72:75], a[196:199], a[120:123], v[72:75]
    v_mfma_f32_16x16x32_bf16 v[92:95], a[196:199], a[124:127], v[92:95]
    s_waitcnt vmcnt(23)
    v_mfma_f32_16x16x32_bf16 v[16:19], a[200:203], a[64:67], v[16:19]
    buffer_load_dwordx4 a[112:115], v4, s[8:11], s32 offen offset:3072 sc1
    v_mfma_f32_16x16x32_bf16 v[36:39], a[200:203], a[68:71], v[36:39]
    v_mfma_f32_16x16x32_bf16 v[56:59], a[200:203], a[72:75], v[56:59]
    buffer_load_dwordx4 a[116:119], v5, s[8:11], s32 offen offset:3072 sc1
    v_mfma_f32_16x16x32_bf16 v[76:79], a[200:203], a[76:79], v[76:79]
    v_mfma_f32_16x16x32_bf16 v[20:23], a[204:207], a[64:67], v[20:23]
    buffer_load_dwordx4 a[120:123], v6, s[8:11], s32 offen offset:3072 sc1
    v_mfma_f32_16x16x32_bf16 v[40:43], a[204:207], a[68:71], v[40:43]
    v_mfma_f32_16x16x32_bf16 v[60:63], a[204:207], a[72:75], v[60:63]
    buffer_load_dwordx4 a[124:127], v7, s[8:11], s32 offen offset:3072 sc1
    v_mfma_f32_16x16x32_bf16 v[80:83], a[204:207], a[76:79], v[80:83]
    v_mfma_f32_16x16x32_bf16 v[24:27], a[208:211], a[64:67], v[24:27]
    buffer_load_dwordx4 a[180:183], v8, s[12:15], s63 offen offset:1024 sc1
    v_mfma_f32_16x16x32_bf16 v[44:47], a[208:211], a[68:71], v[44:47]
    v_mfma_f32_16x16x32_bf16 v[64:67], a[208:211], a[72:75], v[64:67]
    buffer_load_dwordx4 a[184:187], v9, s[12:15], s63 offen offset:1024 sc1
    v_mfma_f32_16x16x32_bf16 v[84:87], a[208:211], a[76:79], v[84:87]
    v_mfma_f32_16x16x32_bf16 v[28:31], a[212:215], a[64:67], v[28:31]
    buffer_load_dwordx4 a[188:191], v10, s[12:15], s63 offen offset:1024 sc1
    v_mfma_f32_16x16x32_bf16 v[48:51], a[212:215], a[68:71], v[48:51]
    v_mfma_f32_16x16x32_bf16 v[68:71], a[212:215], a[72:75], v[68:71]
    buffer_load_dwordx4 a[192:195], v11, s[12:15], s63 offen offset:1024 sc1
    v_mfma_f32_16x16x32_bf16 v[88:91], a[212:215], a[76:79], v[88:91]
    v_mfma_f32_16x16x32_bf16 v[32:35], a[216:219], a[64:67], v[32:35]
    buffer_load_dwordx4 a[196:199], v12, s[12:15], s63 offen offset:1024 sc1
    v_mfma_f32_16x16x32_bf16 v[52:55], a[216:219], a[68:71], v[52:55]
    v_mfma_f32_16x16x32_bf16 v[72:75], a[216:219], a[72:75], v[72:75]
    v_mfma_f32_16x16x32_bf16 v[92:95], a[216:219], a[76:79], v[92:95]
    s_waitcnt vmcnt(23)
    v_mfma_f32_16x16x32_bf16 v[16:19], a[220:223], a[80:83], v[16:19]
    s_add_u32 s32, s32, 4096
    v_mfma_f32_16x16x32_bf16 v[36:39], a[220:223], a[84:87], v[36:39]
    buffer_load_dwordx4 a[64:67], v4, s[8:11], s32 offen offset:0 sc1
    v_mfma_f32_16x16x32_bf16 v[56:59], a[220:223], a[88:91], v[56:59]
    v_mfma_f32_16x16x32_bf16 v[76:79], a[220:223], a[92:95], v[76:79]
    buffer_load_dwordx4 a[68:71], v5, s[8:11], s32 offen offset:0 sc1
    v_mfma_f32_16x16x32_bf16 v[20:23], a[224:227], a[80:83], v[20:23]
    v_mfma_f32_16x16x32_bf16 v[40:43], a[224:227], a[84:87], v[40:43]
    buffer_load_dwordx4 a[72:75], v6, s[8:11], s32 offen offset:0 sc1
    v_mfma_f32_16x16x32_bf16 v[60:63], a[224:227], a[88:91], v[60:63]
    v_mfma_f32_16x16x32_bf16 v[80:83], a[224:227], a[92:95], v[80:83]
    buffer_load_dwordx4 a[76:79], v7, s[8:11], s32 offen offset:0 sc1
    v_mfma_f32_16x16x32_bf16 v[24:27], a[228:231], a[80:83], v[24:27]
    v_mfma_f32_16x16x32_bf16 v[44:47], a[228:231], a[84:87], v[44:47]
    buffer_load_dwordx4 a[200:203], v8, s[12:15], s63 offen offset:2048 sc1
    v_mfma_f32_16x16x32_bf16 v[64:67], a[228:231], a[88:91], v[64:67]
    buffer_load_dwordx4 a[204:207], v9, s[12:15], s63 offen offset:2048 sc1
    v_mfma_f32_16x16x32_bf16 v[84:87], a[228:231], a[92:95], v[84:87]
    v_mfma_f32_16x16x32_bf16 v[28:31], a[232:235], a[80:83], v[28:31]
    buffer_load_dwordx4 a[208:211], v10, s[12:15], s63 offen offset:2048 sc1
    v_mfma_f32_16x16x32_bf16 v[48:51], a[232:235], a[84:87], v[48:51]
    v_mfma_f32_16x16x32_bf16 v[68:71], a[232:235], a[88:91], v[68:71]
    buffer_load_dwordx4 a[212:215], v11, s[12:15], s63 offen offset:2048 sc1
    v_mfma_f32_16x16x32_bf16 v[88:91], a[232:235], a[92:95], v[88:91]
    v_mfma_f32_16x16x32_bf16 v[32:35], a[236:239], a[80:83], v[32:35]
    buffer_load_dwordx4 a[216:219], v12, s[12:15], s63 offen offset:2048 sc1
    v_mfma_f32_16x16x32_bf16 v[52:55], a[236:239], a[84:87], v[52:55]
    v_mfma_f32_16x16x32_bf16 v[72:75], a[236:239], a[88:91], v[72:75]
    v_mfma_f32_16x16x32_bf16 v[92:95], a[236:239], a[92:95], v[92:95]
    s_waitcnt vmcnt(23)
    v_mfma_f32_16x16x32_bf16 v[16:19], a[0:3], a[96:99], v[16:19]
    buffer_load_dwordx4 a[80:83], v4, s[8:11], s32 offen offset:1024 sc1
    v_mfma_f32_16x16x32_bf16 v[36:39], a[0:3], a[100:103], v[36:39]
    v_mfma_f32_16x16x32_bf16 v[56:59], a[0:3], a[104:107], v[56:59]
    buffer_load_dwordx4 a[84:87], v5, s[8:11], s32 offen offset:1024 sc1
    v_mfma_f32_16x16x32_bf16 v[76:79], a[0:3], a[108:111], v[76:79]
    v_mfma_f32_16x16x32_bf16 v[20:23], a[4:7], a[96:99], v[20:23]
    buffer_load_dwordx4 a[88:91], v6, s[8:11], s32 offen offset:1024 sc1
    v_mfma_f32_16x16x32_bf16 v[40:43], a[4:7], a[100:103], v[40:43]
    v_mfma_f32_16x16x32_bf16 v[60:63], a[4:7], a[104:107], v[60:63]
    buffer_load_dwordx4 a[92:95], v7, s[8:11], s32 offen offset:1024 sc1
    v_mfma_f32_16x16x32_bf16 v[80:83], a[4:7], a[108:111], v[80:83]
    v_mfma_f32_16x16x32_bf16 v[24:27], a[8:11], a[96:99], v[24:27]
    buffer_load_dwordx4 a[220:223], v8, s[12:15], s63 offen offset:3072 sc1
    v_mfma_f32_16x16x32_bf16 v[44:47], a[8:11], a[100:103], v[44:47]
    v_mfma_f32_16x16x32_bf16 v[64:67], a[8:11], a[104:107], v[64:67]
    buffer_load_dwordx4 a[224:227], v9, s[12:15], s63 offen offset:3072 sc1
    v_mfma_f32_16x16x32_bf16 v[84:87], a[8:11], a[108:111], v[84:87]
    v_mfma_f32_16x16x32_bf16 v[28:31], a[12:15], a[96:99], v[28:31]
    buffer_load_dwordx4 a[228:231], v10, s[12:15], s63 offen offset:3072 sc1
    v_mfma_f32_16x16x32_bf16 v[48:51], a[12:15], a[100:103], v[48:51]
    v_mfma_f32_16x16x32_bf16 v[68:71], a[12:15], a[104:107], v[68:71]
    buffer_load_dwordx4 a[232:235], v11, s[12:15], s63 offen offset:3072 sc1
    v_mfma_f32_16x16x32_bf16 v[88:91], a[12:15], a[108:111], v[88:91]
    v_mfma_f32_16x16x32_bf16 v[32:35], a[16:19], a[96:99], v[32:35]
    buffer_load_dwordx4 a[236:239], v12, s[12:15], s63 offen offset:3072 sc1
    v_mfma_f32_16x16x32_bf16 v[52:55], a[16:19], a[100:103], v[52:55]
    v_mfma_f32_16x16x32_bf16 v[72:75], a[16:19], a[104:107], v[72:75]
    v_mfma_f32_16x16x32_bf16 v[92:95], a[16:19], a[108:111], v[92:95]
    s_waitcnt vmcnt(23)
    v_mfma_f32_16x16x32_bf16 v[16:19], a[20:23], a[112:115], v[16:19]
    buffer_load_dwordx4 a[96:99], v4, s[8:11], s32 offen offset:2048 sc1
    v_mfma_f32_16x16x32_bf16 v[36:39], a[20:23], a[116:119], v[36:39]
    v_mfma_f32_16x16x32_bf16 v[56:59], a[20:23], a[120:123], v[56:59]
    v_mfma_f32_16x16x32_bf16 v[76:79], a[20:23], a[124:127], v[76:79]
    v_mfma_f32_16x16x32_bf16 v[20:23], a[24:27], a[112:115], v[20:23]
    buffer_load_dwordx4 a[100:103], v5, s[8:11], s32 offen offset:2048 sc1
    v_mfma_f32_16x16x32_bf16 v[40:43], a[24:27], a[116:119], v[40:43]
    v_mfma_f32_16x16x32_bf16 v[60:63], a[24:27], a[120:123], v[60:63]
    v_mfma_f32_16x16x32_bf16 v[80:83], a[24:27], a[124:127], v[80:83]
    v_mfma_f32_16x16x32_bf16 v[24:27], a[28:31], a[112:115], v[24:27]
    v_mfma_f32_16x16x32_bf16 v[44:47], a[28:31], a[116:119], v[44:47]
    buffer_load_dwordx4 a[104:107], v6, s[8:11], s32 offen offset:2048 sc1
    v_mfma_f32_16x16x32_bf16 v[64:67], a[28:31], a[120:123], v[64:67]
    v_mfma_f32_16x16x32_bf16 v[84:87], a[28:31], a[124:127], v[84:87]
    v_mfma_f32_16x16x32_bf16 v[28:31], a[32:35], a[112:115], v[28:31]
    v_mfma_f32_16x16x32_bf16 v[48:51], a[32:35], a[116:119], v[48:51]
    buffer_load_dwordx4 a[108:111], v7, s[8:11], s32 offen offset:2048 sc1
    v_mfma_f32_16x16x32_bf16 v[68:71], a[32:35], a[120:123], v[68:71]
    v_mfma_f32_16x16x32_bf16 v[88:91], a[32:35], a[124:127], v[88:91]
    v_mfma_f32_16x16x32_bf16 v[32:35], a[36:39], a[112:115], v[32:35]
    v_mfma_f32_16x16x32_bf16 v[52:55], a[36:39], a[116:119], v[52:55]
    v_mfma_f32_16x16x32_bf16 v[72:75], a[36:39], a[120:123], v[72:75]
    v_mfma_f32_16x16x32_bf16 v[92:95], a[36:39], a[124:127], v[92:95]
    s_waitcnt vmcnt(18)
    v_mfma_f32_16x16x32_bf16 v[16:19], a[40:43], a[64:67], v[16:19]
    buffer_load_dwordx4 a[112:115], v4, s[8:11], s32 offen offset:3072 sc1
    v_mfma_f32_16x16x32_bf16 v[36:39], a[40:43], a[68:71], v[36:39]
    v_mfma_f32_16x16x32_bf16 v[56:59], a[40:43], a[72:75], v[56:59]
    v_mfma_f32_16x16x32_bf16 v[76:79], a[40:43], a[76:79], v[76:79]
    v_mfma_f32_16x16x32_bf16 v[20:23], a[44:47], a[64:67], v[20:23]
    buffer_load_dwordx4 a[116:119], v5, s[8:11], s32 offen offset:3072 sc1
    v_mfma_f32_16x16x32_bf16 v[40:43], a[44:47], a[68:71], v[40:43]
    v_mfma_f32_16x16x32_bf16 v[60:63], a[44:47], a[72:75], v[60:63]
    v_mfma_f32_16x16x32_bf16 v[80:83], a[44:47], a[76:79], v[80:83]
    v_mfma_f32_16x16x32_bf16 v[24:27], a[48:51], a[64:67], v[24:27]
    v_mfma_f32_16x16x32_bf16 v[44:47], a[48:51], a[68:71], v[44:47]
    buffer_load_dwordx4 a[120:123], v6, s[8:11], s32 offen offset:3072 sc1
    v_mfma_f32_16x16x32_bf16 v[64:67], a[48:51], a[72:75], v[64:67]
    v_mfma_f32_16x16x32_bf16 v[84:87], a[48:51], a[76:79], v[84:87]
    v_mfma_f32_16x16x32_bf16 v[28:31], a[52:55], a[64:67], v[28:31]
    v_mfma_f32_16x16x32_bf16 v[48:51], a[52:55], a[68:71], v[48:51]
    buffer_load_dwordx4 a[124:127], v7, s[8:11], s32 offen offset:3072 sc1
    v_mfma_f32_16x16x32_bf16 v[68:71], a[52:55], a[72:75], v[68:71]
    v_mfma_f32_16x16x32_bf16 v[88:91], a[52:55], a[76:79], v[88:91]
    v_mfma_f32_16x16x32_bf16 v[32:35], a[56:59], a[64:67], v[32:35]
    v_mfma_f32_16x16x32_bf16 v[52:55], a[56:59], a[68:71], v[52:55]
    v_mfma_f32_16x16x32_bf16 v[72:75], a[56:59], a[72:75], v[72:75]
    v_mfma_f32_16x16x32_bf16 v[92:95], a[56:59], a[76:79], v[92:95]
    s_waitcnt vmcnt(13)
    v_mfma_f32_16x16x32_bf16 v[16:19], a[180:183], a[80:83], v[16:19]
    v_mfma_f32_16x16x32_bf16 v[36:39], a[180:183], a[84:87], v[36:39]
    v_mfma_f32_16x16x32_bf16 v[56:59], a[180:183], a[88:91], v[56:59]
    v_mfma_f32_16x16x32_bf16 v[76:79], a[180:183], a[92:95], v[76:79]
    v_mfma_f32_16x16x32_bf16 v[20:23], a[184:187], a[80:83], v[20:23]
    v_mfma_f32_16x16x32_bf16 v[40:43], a[184:187], a[84:87], v[40:43]
    v_mfma_f32_16x16x32_bf16 v[60:63], a[184:187], a[88:91], v[60:63]
    v_mfma_f32_16x16x32_bf16 v[80:83], a[184:187], a[92:95], v[80:83]
    v_mfma_f32_16x16x32_bf16 v[24:27], a[188:191], a[80:83], v[24:27]
    v_mfma_f32_16x16x32_bf16 v[44:47], a[188:191], a[84:87], v[44:47]
    v_mfma_f32_16x16x32_bf16 v[64:67], a[188:191], a[88:91], v[64:67]
    v_mfma_f32_16x16x32_bf16 v[84:87], a[188:191], a[92:95], v[84:87]
    v_mfma_f32_16x16x32_bf16 v[28:31], a[192:195], a[80:83], v[28:31]
    v_mfma_f32_16x16x32_bf16 v[48:51], a[192:195], a[84:87], v[48:51]
    v_mfma_f32_16x16x32_bf16 v[68:71], a[192:195], a[88:91], v[68:71]
    v_mfma_f32_16x16x32_bf16 v[88:91], a[192:195], a[92:95], v[88:91]
    v_mfma_f32_16x16x32_bf16 v[32:35], a[196:199], a[80:83], v[32:35]
    v_mfma_f32_16x16x32_bf16 v[52:55], a[196:199], a[84:87], v[52:55]
    v_mfma_f32_16x16x32_bf16 v[72:75], a[196:199], a[88:91], v[72:75]
    v_mfma_f32_16x16x32_bf16 v[92:95], a[196:199], a[92:95], v[92:95]
    s_waitcnt vmcnt(4)
    v_mfma_f32_16x16x32_bf16 v[16:19], a[200:203], a[96:99], v[16:19]
    s_mov_b32 s62, 151552
    v_mfma_f32_16x16x32_bf16 v[36:39], a[200:203], a[100:103], v[36:39]
    v_mfma_f32_16x16x32_bf16 v[56:59], a[200:203], a[104:107], v[56:59]
    v_mfma_f32_16x16x32_bf16 v[76:79], a[200:203], a[108:111], v[76:79]
    v_mfma_f32_16x16x32_bf16 v[20:23], a[204:207], a[96:99], v[20:23]
    v_mfma_f32_16x16x32_bf16 v[40:43], a[204:207], a[100:103], v[40:43]
    v_mfma_f32_16x16x32_bf16 v[60:63], a[204:207], a[104:107], v[60:63]
    v_mfma_f32_16x16x32_bf16 v[80:83], a[204:207], a[108:111], v[80:83]
    v_mfma_f32_16x16x32_bf16 v[24:27], a[208:211], a[96:99], v[24:27]
    v_mfma_f32_16x16x32_bf16 v[44:47], a[208:211], a[100:103], v[44:47]
    buffer_load_dwordx4 v[164:167], v2, s[28:31], s62 offen sc1
    v_mfma_f32_16x16x32_bf16 v[64:67], a[208:211], a[104:107], v[64:67]
    v_mfma_f32_16x16x32_bf16 v[84:87], a[208:211], a[108:111], v[84:87]
    v_mfma_f32_16x16x32_bf16 v[28:31], a[212:215], a[96:99], v[28:31]
    v_mfma_f32_16x16x32_bf16 v[48:51], a[212:215], a[100:103], v[48:51]
    v_mfma_f32_16x16x32_bf16 v[68:71], a[212:215], a[104:107], v[68:71]
    v_mfma_f32_16x16x32_bf16 v[88:91], a[212:215], a[108:111], v[88:91]
    v_mfma_f32_16x16x32_bf16 v[32:35], a[216:219], a[96:99], v[32:35]
    v_mfma_f32_16x16x32_bf16 v[52:55], a[216:219], a[100:103], v[52:55]
    v_mfma_f32_16x16x32_bf16 v[72:75], a[216:219], a[104:107], v[72:75]
    v_mfma_f32_16x16x32_bf16 v[92:95], a[216:219], a[108:111], v[92:95]
    s_waitcnt vmcnt(0)
    v_xor_b32 v164, v0, v164
    v_xor_b32 v165, v0, v165
    v_xor_b32 v166, v0, v166
    v_xor_b32 v167, v0, v167
    v_or3_b32 v164, v164, v165, v166
    v_or_b32 v164, v164, v167
    v_cmp_ne_u32 vcc, 0, v164
    s_cbranch_vccz TS_GO
    s_mov_b32 s37, 0
TS_POLL:
    buffer_load_dwordx4 v[164:167], v2, s[28:31], s62 offen offset:0 sc1
    s_add_u32 s37, s37, 1
    s_waitcnt vmcnt(0)
    v_xor_b32 v164, v0, v164
    v_xor_b32 v165, v0, v165
    v_xor_b32 v166, v0, v166
    v_xor_b32 v167, v0, v167
    v_or3_b32 v164, v164, v165, v166
    v_or_b32 v164, v164, v167
    v_cmp_ne_u32 vcc, 0, v164
    s_cbranch_vccz TS_GO
    s_sleep 2
    s_cmp_lt_u32 s37, 0x80000
    s_cbranch_scc1 TS_POLL
TS_GO:
    s_barrier
    s_nop 0
    v_mfma_f32_16x16x32_bf16 v[16:19], a[220:223], a[112:115], v[16:19]
    s_add_u32 m0, s44, 0
    s_add_u32 s46, s45, 0
    buffer_load_dwordx4 v2, s[40:43], s46 offen offset:0 sc1 lds
    v_mfma_f32_16x16x32_bf16 v[36:39], a[220:223], a[116:119], v[36:39]
    buffer_load_dwordx4 v2, s[40:43], s46 offen offset:1024 sc1 lds
    v_mfma_f32_16x16x32_bf16 v[56:59], a[220:223], a[120:123], v[56:59]
    buffer_load_dwordx4 v2, s[40:43], s46 offen offset:2048 sc1 lds
    v_mfma_f32_16x16x32_bf16 v[76:79], a[220:223], a[124:127], v[76:79]
    buffer_load_dwordx4 v2, s[40:43], s46 offen offset:3072 sc1 lds
    v_mfma_f32_16x16x32_bf16 v[20:23], a[224:227], a[112:115], v[20:23]
    s_add_u32 m0, s44, 4096
    s_add_u32 s46, s45, 4096
    buffer_load_dwordx4 v2, s[40:43], s46 offen offset:0 sc1 lds
    v_mfma_f32_16x16x32_bf16 v[40:43], a[224:227], a[116:119], v[40:43]
    buffer_load_dwordx4 v2, s[40:43], s46 offen offset:1024 sc1 lds
    v_mfma_f32_16x16x32_bf16 v[60:63], a[224:227], a[120:123], v[60:63]
    buffer_load_dwordx4 v2, s[40:43], s46 offen offset:2048 sc1 lds
    v_mfma_f32_16x16x32_bf16 v[80:83], a[224:227], a[124:127], v[80:83]
    s_add_u32 m0, s44, 28672
    s_add_u32 s46, s45, 458752
    buffer_load_dwordx4 v2, s[40:43], s46 offen offset:0 sc1 lds
    v_mfma_f32_16x16x32_bf16 v[24:27], a[228:231], a[112:115], v[24:27]
    buffer_load_dwordx4 v2, s[40:43], s46 offen offset:1024 sc1 lds
    ds_write_b128 v132, v[16:19] offset:0
    v_mfma_f32_16x16x32_bf16 v[44:47], a[228:231], a[116:119], v[44:47]
    buffer_load_dwordx4 v2, s[40:43], s46 offen offset:2048 sc1 lds
    ds_write_b128 v132, v[36:39] offset:20480
    v_mfma_f32_16x16x32_bf16 v[64:67], a[228:231], a[120:123], v[64:67]
    buffer_load_dwordx4 v2, s[40:43], s46 offen offset:3072 sc1 lds
    ds_write_b128 v133, v[56:59] offset:0
    v_mfma_f32_16x16x32_bf16 v[84:87], a[228:231], a[124:127], v[84:87]
    s_add_u32 m0, s44, 32768
    s_add_u32 s46, s45, 462848
    buffer_load_dwordx4 v2, s[40:43], s46 offen offset:0 sc1 lds
    ds_write_b128 v133, v[76:79] offset:20480
    v_mfma_f32_16x16x32_bf16 v[28:31], a[232:235], a[112:115], v[28:31]
    buffer_load_dwordx4 v2, s[40:43], s46 offen offset:1024 sc1 lds
    ds_write_b128 v132, v[20:23] offset:1024
    v_mfma_f32_16x16x32_bf16 v[48:51], a[232:235], a[116:119], v[48:51]
    buffer_load_dwordx4 v2, s[40:43], s46 offen offset:2048 sc1 lds
    ds_write_b128 v132, v[40:43] offset:21504
    v_mfma_f32_16x16x32_bf16 v[68:71], a[232:235], a[120:123], v[68:71]
    ds_write_b128 v133, v[60:63] offset:1024
    v_mfma_f32_16x16x32_bf16 v[88:91], a[232:235], a[124:127], v[88:91]
    ds_write_b128 v133, v[80:83] offset:21504
    v_mfma_f32_16x16x32_bf16 v[32:35], a[236:239], a[112:115], v[32:35]
    ds_write_b128 v132, v[24:27] offset:2048
    v_mfma_f32_16x16x32_bf16 v[52:55], a[236:239], a[116:119], v[52:55]
    ds_write_b128 v132, v[44:47] offset:22528
    v_mfma_f32_16x16x32_bf16 v[72:75], a[236:239], a[120:123], v[72:75]
    ds_write_b128 v133, v[64:67] offset:2048
    v_mfma_f32_16x16x32_bf16 v[92:95], a[236:239], a[124:127], v[92:95]
    ds_write_b128 v133, v[84:87] offset:22528
    ds_write_b128 v132, v[28:31] offset:3072
    ds_write_b128 v132, v[48:51] offset:23552
    ds_write_b128 v133, v[68:71] offset:3072
    ds_write_b128 v133, v[88:91] offset:23552
    s_nop 3
    ds_write_b128 v132, v[32:35] offset:4096
    ds_write_b128 v132, v[52:55] offset:24576
    ds_write_b128 v133, v[72:75] offset:4096
    ds_write_b128 v133, v[92:95] offset:24576
    s_waitcnt lgkmcnt(0)
    s_barrier
    ds_read_b128 v[16:19], v134 offset:0
    ds_read_b128 v[20:23], v134 offset:1024
    ds_read_b128 v[24:27], v134 offset:2048
    ds_read_b128 v[28:31], v134 offset:3072
    ds_read_b128 v[32:35], v134 offset:4096
    ds_read_b128 v[36:39], v134 offset:5120
    ds_read_b128 v[40:43], v134 offset:6144
    ds_read_b128 v[44:47], v134 offset:7168
    ds_read_b128 v[48:51], v134 offset:8192
    ds_read_b128 v[52:55], v134 offset:9216
    ds_read_b128 v[56:59], v134 offset:10240
    ds_read_b128 v[60:63], v134 offset:11264
    ds_read_b128 v[64:67], v134 offset:12288
    ds_read_b128 v[68:71], v134 offset:13312
    ds_read_b128 v[72:75], v134 offset:14336
    ds_read_b128 v[76:79], v134 offset:15360
    ds_read_b128 v[80:83], v134 offset:16384
    ds_read_b128 v[84:87], v134 offset:17408
    ds_read_b128 v[88:91], v134 offset:18432
    ds_read_b128 v[92:95], v134 offset:19456
    s_waitcnt vmcnt(63)
    v_lshlrev_b32 v176, 16, v96
    v_and_b32 v177, 0xffff0000, v96
    v_lshlrev_b32 v178, 16, v97
    v_and_b32 v179, 0xffff0000, v97
    v_lshlrev_b32 v180, 16, v98
    v_and_b32 v181, 0xffff0000, v98
    v_lshlrev_b32 v182, 16, v99
    v_and_b32 v183, 0xffff0000, v99
    v_lshlrev_b32 v184, 16, v100
    v_and_b32 v185, 0xffff0000, v100
    v_lshlrev_b32 v186, 16, v101
    v_and_b32 v187, 0xffff0000, v101
    v_lshlrev_b32 v188, 16, v102
    v_and_b32 v189, 0xffff0000, v102
    v_lshlrev_b32 v190, 16, v103
    v_and_b32 v191, 0xffff0000, v103
    v_lshlrev_b32 v192, 16, v104
    v_and_b32 v193, 0xffff0000, v104
    v_lshlrev_b32 v194, 16, v105
    v_and_b32 v195, 0xffff0000, v105
    s_waitcnt lgkmcnt(10)
    v_pk_add_f32 v[16:17], v[16:17], v[36:37]
    v_pk_add_f32 v[18:19], v[18:19], v[38:39]
    v_pk_add_f32 v[20:21], v[20:21], v[40:41]
    v_pk_add_f32 v[22:23], v[22:23], v[42:43]
    v_pk_add_f32 v[24:25], v[24:25], v[44:45]
    v_pk_add_f32 v[26:27], v[26:27], v[46:47]
    v_pk_add_f32 v[28:29], v[28:29], v[48:49]
    v_pk_add_f32 v[30:31], v[30:31], v[50:51]
    v_pk_add_f32 v[32:33], v[32:33], v[52:53]
    v_pk_add_f32 v[34:35], v[34:35], v[54:55]
    s_waitcnt lgkmcnt(5)
    v_pk_add_f32 v[16:17], v[16:17], v[56:57]
    v_pk_add_f32 v[18:19], v[18:19], v[58:59]
    v_pk_add_f32 v[20:21], v[20:21], v[60:61]
    v_pk_add_f32 v[22:23], v[22:23], v[62:63]
    v_pk_add_f32 v[24:25], v[24:25], v[64:65]
    v_pk_add_f32 v[26:27], v[26:27], v[66:67]
    v_pk_add_f32 v[28:29], v[28:29], v[68:69]
    v_pk_add_f32 v[30:31], v[30:31], v[70:71]
    v_pk_add_f32 v[32:33], v[32:33], v[72:73]
    v_pk_add_f32 v[34:35], v[34:35], v[74:75]
    s_waitcnt lgkmcnt(0)
    v_pk_add_f32 v[16:17], v[16:17], v[76:77]
    v_pk_add_f32 v[18:19], v[18:19], v[78:79]
    v_pk_add_f32 v[20:21], v[20:21], v[80:81]
    v_pk_add_f32 v[22:23], v[22:23], v[82:83]
    v_pk_add_f32 v[24:25], v[24:25], v[84:85]
    v_pk_add_f32 v[26:27], v[26:27], v[86:87]
    v_pk_add_f32 v[28:29], v[28:29], v[88:89]
    v_pk_add_f32 v[30:31], v[30:31], v[90:91]
    v_pk_add_f32 v[32:33], v[32:33], v[92:93]
    v_pk_add_f32 v[34:35], v[34:35], v[94:95]
    s_barrier
    v_pk_fma_f32 v[176:177], v[108:109], v[16:17], v[176:177]
    v_pk_fma_f32 v[178:179], v[110:111], v[18:19], v[178:179]
    v_cvt_pk_bf16_f32 v96, v176, v177
    v_cvt_pk_bf16_f32 v97, v178, v179
    v_lshlrev_b32 v176, 16, v96
    v_and_b32 v177, 0xffff0000, v96
    v_lshlrev_b32 v178, 16, v97
    v_and_b32 v179, 0xffff0000, v97
    v_pk_mul_f32 v[144:145], v[144:145], v[176:177]
    v_pk_mul_f32 v[146:147], v[146:147], v[178:179]
    v_cvt_pk_bf16_f32 v108, v144, v145
    v_cvt_pk_bf16_f32 v109, v146, v147
    v_pk_fma_f32 v[180:181], v[112:113], v[20:21], v[180:181]
    v_pk_fma_f32 v[182:183], v[114:115], v[22:23], v[182:183]
    v_cvt_pk_bf16_f32 v98, v180, v181
    v_cvt_pk_bf16_f32 v99, v182, v183
    v_lshlrev_b32 v180, 16, v98
    v_and_b32 v181, 0xffff0000, v98
    v_lshlrev_b32 v182, 16, v99
    v_and_b32 v183, 0xffff0000, v99
    v_pk_mul_f32 v[148:149], v[148:149], v[180:181]
    v_pk_mul_f32 v[150:151], v[150:151], v[182:183]
    v_cvt_pk_bf16_f32 v110, v148, v149
    v_cvt_pk_bf16_f32 v111, v150, v151
    buffer_store_dwordx4 v[108:111], v2, s[24:27], s57 offen offset:0 sc1
    v_pk_fma_f32 v[184:185], v[116:117], v[24:25], v[184:185]
    v_pk_fma_f32 v[186:187], v[118:119], v[26:27], v[186:187]
    v_cvt_pk_bf16_f32 v100, v184, v185
    v_cvt_pk_bf16_f32 v101, v186, v187
    v_lshlrev_b32 v184, 16, v100
    v_and_b32 v185, 0xffff0000, v100
    v_lshlrev_b32 v186, 16, v101
    v_and_b32 v187, 0xffff0000, v101
    v_pk_mul_f32 v[152:153], v[152:153], v[184:185]
    v_pk_mul_f32 v[154:155], v[154:155], v[186:187]
    v_cvt_pk_bf16_f32 v112, v152, v153
    v_cvt_pk_bf16_f32 v113, v154, v155
    v_pk_fma_f32 v[188:189], v[120:121], v[28:29], v[188:189]
    v_pk_fma_f32 v[190:191], v[122:123], v[30:31], v[190:191]
    v_cvt_pk_bf16_f32 v102, v188, v189
    v_cvt_pk_bf16_f32 v103, v190, v191
    v_lshlrev_b32 v188, 16, v102
    v_and_b32 v189, 0xffff0000, v102
    v_lshlrev_b32 v190, 16, v103
    v_and_b32 v191, 0xffff0000, v103
    v_pk_mul_f32 v[156:157], v[156:157], v[188:189]
    v_pk_mul_f32 v[158:159], v[158:159], v[190:191]
    v_cvt_pk_bf16_f32 v114, v156, v157
    v_cvt_pk_bf16_f32 v115, v158, v159
    buffer_store_dwordx4 v[112:115], v2, s[24:27], s57 offen offset:1024 sc1
    v_pk_fma_f32 v[192:193], v[124:125], v[32:33], v[192:193]
    v_pk_fma_f32 v[194:195], v[126:127], v[34:35], v[194:195]
    v_cvt_pk_bf16_f32 v104, v192, v193
    v_cvt_pk_bf16_f32 v105, v194, v195
    v_lshlrev_b32 v192, 16, v104
    v_and_b32 v193, 0xffff0000, v104
    v_lshlrev_b32 v194, 16, v105
    v_and_b32 v195, 0xffff0000, v105
    v_pk_mul_f32 v[160:161], v[160:161], v[192:193]
    v_pk_mul_f32 v[162:163], v[162:163], v[194:195]
    v_cvt_pk_bf16_f32 v116, v160, v161
    v_cvt_pk_bf16_f32 v117, v162, v163
    buffer_store_dwordx2 v[116:117], v135, s[24:27], s58 offen sc1
    v_pk_add_f32 v[136:137], v[176:177], v[178:179]
    v_pk_add_f32 v[136:137], v[136:137], v[180:181]
    v_pk_add_f32 v[136:137], v[136:137], v[182:183]
    v_pk_add_f32 v[136:137], v[136:137], v[184:185]
    v_pk_add_f32 v[136:137], v[136:137], v[186:187]
    v_pk_add_f32 v[136:137], v[136:137], v[188:189]
    v_pk_add_f32 v[136:137], v[136:137], v[190:191]
    v_pk_add_f32 v[136:137], v[136:137], v[192:193]
    v_pk_add_f32 v[136:137], v[136:137], v[194:195]
    v_add_f32 v136, v136, v137
    v_mov_b32 v138, v136
    s_nop 1
    v_permlane16_swap_b32 v136, v138
    s_nop 1
    v_add_f32 v136, v136, v138
    v_mov_b32 v138, v136
    s_nop 1
    v_permlane32_swap_b32 v136, v138
    s_nop 1
    v_add_f32 v136, v136, v138
    v_mul_f32 v138, 0xbc4ccccd, v136
    v_pk_add_f32 v[176:177], v[176:177], v[138:139] op_sel_hi:[1,0]
    v_pk_add_f32 v[178:179], v[178:179], v[138:139] op_sel_hi:[1,0]
    v_pk_add_f32 v[180:181], v[180:181], v[138:139] op_sel_hi:[1,0]
    v_pk_add_f32 v[182:183], v[182:183], v[138:139] op_sel_hi:[1,0]
    v_pk_add_f32 v[184:185], v[184:185], v[138:139] op_sel_hi:[1,0]
    v_pk_add_f32 v[186:187], v[186:187], v[138:139] op_sel_hi:[1,0]
    v_pk_add_f32 v[188:189], v[188:189], v[138:139] op_sel_hi:[1,0]
    v_pk_add_f32 v[190:191], v[190:191], v[138:139] op_sel_hi:[1,0]
    v_pk_add_f32 v[192:193], v[192:193], v[138:139] op_sel_hi:[1,0]
    v_pk_add_f32 v[194:195], v[194:195], v[138:139] op_sel_hi:[1,0]
    v_pk_mul_f32 v[138:139], v[176:177], v[176:177]
    v_pk_fma_f32 v[138:139], v[178:179], v[178:179], v[138:139]
    v_pk_fma_f32 v[138:139], v[180:181], v[180:181], v[138:139]
    v_pk_fma_f32 v[138:139], v[182:183], v[182:183], v[138:139]
    v_pk_fma_f32 v[138:139], v[184:185], v[184:185], v[138:139]
    v_pk_fma_f32 v[138:139], v[186:187], v[186:187], v[138:139]
    v_pk_fma_f32 v[138:139], v[188:189], v[188:189], v[138:139]
    v_pk_fma_f32 v[138:139], v[190:191], v[190:191], v[138:139]
    v_pk_fma_f32 v[138:139], v[192:193], v[192:193], v[138:139]
    v_pk_fma_f32 v[138:139], v[194:195], v[194:195], v[138:139]
    v_add_f32 v137, v138, v139
    v_mov_b32 v138, v137
    s_nop 1
    v_permlane16_swap_b32 v137, v138
    s_nop 1
    v_add_f32 v137, v137, v138
    v_mov_b32 v138, v137
    s_nop 1
    v_permlane32_swap_b32 v137, v138
    s_nop 1
    v_add_f32 v137, v137, v138
    s_mov_b64 exec, 0xffff
    buffer_store_dwordx2 v[136:137], v135, s[28:31], s59 offen sc1
    s_mov_b64 exec, -1
    v_accvgpr_write_b32 a240, v96
    v_accvgpr_write_b32 a241, v97
    v_accvgpr_write_b32 a242, v98
    v_accvgpr_write_b32 a243, v99
    v_accvgpr_write_b32 a244, v100
    v_accvgpr_write_b32 a245, v101
    v_accvgpr_write_b32 a246, v102
    v_accvgpr_write_b32 a247, v103
    v_accvgpr_write_b32 a248, v104
    v_accvgpr_write_b32 a249, v105
    s_load_dwordx2 s[66:67], s[0:1], 88
    s_add_u32 s16, s64, 0x20000
    s_addc_u32 s17, s65, 0
    s_mov_b32 s18, 0x8c000
    s_mov_b32 s19, 0x20000
    s_mul_i32 s35, s48, 1792
    s_mul_i32 s33, s3, 448
    s_add_u32 s35, s35, s33
    v_mov_b32 v141, 0x70000000
    v_cmp_gt_u32 vcc, 28, v1
    s_add_u32 s36, s33, 143360
    v_add_u32 v139, s36, v2
    v_cndmask_b32 v140, v141, v2, vcc
    buffer_load_dwordx4 v[144:147], v140, s[16:19], s35 offen sc1
    s_add_u32 s35, s35, 28672
    buffer_load_dwordx4 v[148:151], v140, s[16:19], s35 offen sc1
    s_add_u32 s35, s35, 28672
    buffer_load_dwordx4 v[152:155], v140, s[16:19], s35 offen sc1
    s_add_u32 s35, s35, 28672
    buffer_load_dwordx4 v[156:159], v140, s[16:19], s35 offen sc1
    s_add_u32 s35, s35, 28672
    buffer_load_dwordx4 v[160:163], v140, s[16:19], s35 offen sc1
    s_add_u32 s35, s35, 28672
    buffer_load_dwordx4 v[164:167], v140, s[16:19], s35 offen sc1
    s_add_u32 s35, s35, 28672
    buffer_load_dwordx4 v[168:171], v140, s[16:19], s35 offen sc1
    s_add_u32 s35, s35, 28672
    buffer_load_dwordx4 v[172:175], v140, s[16:19], s35 offen sc1
    s_add_u32 s35, s35, 28672
    buffer_load_dwordx4 v[176:179], v140, s[16:19], s35 offen sc1
    s_add_u32 s35, s35, 28672
    buffer_load_dwordx4 v[180:183], v140, s[16:19], s35 offen sc1
    s_add_u32 s35, s35, 28672
    buffer_load_dwordx4 v[184:187], v140, s[16:19], s35 offen sc1
    s_add_u32 s35, s35, 28672
    buffer_load_dwordx4 v[188:191], v140, s[16:19], s35 offen sc1
    s_add_u32 s35, s35, 28672
    buffer_load_dwordx4 v[192:195], v140, s[16:19], s35 offen sc1
    s_add_u32 s35, s35, 28672
    buffer_load_dwordx4 v[196:199], v140, s[16:19], s35 offen sc1
    s_add_u32 s35, s35, 28672
    buffer_load_dwordx4 v[200:203], v140, s[16:19], s35 offen sc1
    s_add_u32 s35, s35, 28672
    buffer_load_dwordx4 v[204:207], v140, s[16:19], s35 offen sc1
    s_add_u32 s35, s35, 28672
    buffer_load_dwordx4 v[208:211], v140, s[16:19], s35 offen sc1
    s_add_u32 s35, s35, 28672
    buffer_load_dwordx4 v[212:215], v140, s[16:19], s35 offen sc1
    s_add_u32 s35, s35, 28672
    buffer_load_dwordx4 v[216:219], v140, s[16:19], s35 offen sc1
    s_add_u32 s35, s35, 28672
    buffer_load_dwordx4 v[220:223], v140, s[16:19], s35 offen sc1
    s_add_u32 s35, s35, 28672
    v_mov_b32 v142, 0
    s_mov_b64 exec, 1
    s_waitcnt vmcnt(20)
    buffer_store_dword v0, v142, s[28:31], s60 offen sc1
    s_mov_b64 exec, -1
    s_add_u32 m0, s44, 57344
    s_add_u32 s46, s45, 917504
    buffer_load_dwordx4 v2, s[40:43], s46 offen offset:0 sc1 lds
    buffer_load_dwordx4 v2, s[40:43], s46 offen offset:1024 sc1 lds
    buffer_load_dwordx4 v2, s[40:43], s46 offen offset:2048 sc1 lds
    buffer_load_dwordx4 v2, s[40:43], s46 offen offset:3072 sc1 lds
    s_add_u32 m0, s44, 61440
    s_add_u32 s46, s45, 921600
    buffer_load_dwordx4 v2, s[40:43], s46 offen offset:0 sc1 lds
    buffer_load_dwordx4 v2, s[40:43], s46 offen offset:1024 sc1 lds
    buffer_load_dwordx4 v2, s[40:43], s46 offen offset:2048 sc1 lds
    s_add_u32 m0, s44, 86016
    s_add_u32 s46, s45, 1376256
    buffer_load_dwordx4 v2, s[40:43], s46 offen offset:0 sc1 lds
    buffer_load_dwordx4 v2, s[40:43], s46 offen offset:1024 sc1 lds
    buffer_load_dwordx4 v2, s[40:43], s46 offen offset:2048 sc1 lds
    buffer_load_dwordx4 v2, s[40:43], s46 offen offset:3072 sc1 lds
    s_add_u32 m0, s44, 90112
    s_add_u32 s46, s45, 1380352
    buffer_load_dwordx4 v2, s[40:43], s46 offen offset:0 sc1 lds
    buffer_load_dwordx4 v2, s[40:43], s46 offen offset:1024 sc1 lds
    buffer_load_dwordx4 v2, s[40:43], s46 offen offset:2048 sc1 lds
    s_add_u32 m0, s44, 114688
    s_add_u32 s46, s45, 1835008
    buffer_load_dwordx4 v2, s[40:43], s46 offen offset:0 sc1 lds
    buffer_load_dwordx4 v2, s[40:43], s46 offen offset:1024 sc1 lds
    buffer_load_dwordx4 v2, s[40:43], s46 offen offset:2048 sc1 lds
    buffer_load_dwordx4 v2, s[40:43], s46 offen offset:3072 sc1 lds
    s_add_u32 m0, s44, 118784
    s_add_u32 s46, s45, 1839104
    buffer_load_dwordx4 v2, s[40:43], s46 offen offset:0 sc1 lds
    buffer_load_dwordx4 v2, s[40:43], s46 offen offset:1024 sc1 lds
    buffer_load_dwordx4 v2, s[40:43], s46 offen offset:2048 sc1 lds
    s_add_u32 s12, s64, 0x380000
    s_addc_u32 s13, s65, 0
    s_mov_b32 s14, 0x280000
    s_mov_b32 s15, 0x20000
    s_add_u32 s24, s64, 0x600000
    s_addc_u32 s25, s65, 0
    s_mov_b32 s26, 0x700000
    s_mov_b32 s27, 0x20000
    s_lshl_b32 s47, s47, 3
    s_lshl_b32 s33, s3, 1
    s_add_u32 s47, s47, s33
    s_mul_i32 s7, s47, 20480
    s_lshl_b32 s61, s47, 6
    s_add_u32 s61, s61, 131072
    v_mov_b32 v10, v2
    v_add_u32 v11, 20480, v2
    s_and_b32 s33, s48, 1
    s_lshl_b32 s4, s33, 11
    s_mul_i32 s5, s33, -12288
    v_add_u32 v4, s4, v2
    v_add_u32 v5, 57344, v4
    v_add_u32 v6, 114688, v4
    v_add_u32 v7, s5, v2
    v_add_u32 v8, 57344, v7
    v_add_u32 v9, 114688, v7
    s_lshl_b32 s49, s47, 10
    v_lshrrev_b32 v128, 4, v1
    v_lshlrev_b32 v128, 4, v128
    v_add_u32 v128, 143360, v128
    s_lshr_b32 s4, s4, 3
    s_ashr_i32 s5, s5, 3
    v_add_u32 v129, s5, v128
    v_add_u32 v128, s4, v128
    s_mul_i32 s33, s48, 7
    s_and_b32 s34, s48, 1
    s_add_u32 s36, s33, s34
    s_lshr_b32 s36, s36, 1
    s_lshr_b32 s37, s48, 2
    s_lshl_b32 s37, s37, 31
    s_lshl_b32 s36, s36, 10
    s_mul_i32 s37, s47, 57344
    s_add_u32 s36, s36, s37
    s_add_u32 s38, s36, 3072
    s_sub_u32 s39, s36, 512
    s_cmp_eq_u32 s34, 1
    s_cselect_b32 s38, s39, s38
    v_add_u32 v138, 57344, v2
    s_mov_b32 s6, 0x3c4ccccd
    s_lshr_b32 s60, s47, 2
    s_lshl_b32 s60, s60, 7
    s_lshl_b32 s33, s48, 3
    s_add_u32 s60, s60, s33
    s_and_b32 s33, s3, 1
    s_lshl_b32 s33, s33, 2
    s_add_u32 s60, s60, s33
    s_add_u32 s60, s60, 139264
    v_lshlrev_b32 v141, 2, v1
    s_waitcnt vmcnt(22)
    v_pk_add_f32 v[144:145], v[144:145], v[148:149]
    v_pk_add_f32 v[146:147], v[146:147], v[150:151]
    v_pk_add_f32 v[144:145], v[144:145], v[152:153]
    v_pk_add_f32 v[146:147], v[146:147], v[154:155]
    v_pk_add_f32 v[144:145], v[144:145], v[156:157]
    v_pk_add_f32 v[146:147], v[146:147], v[158:159]
    v_pk_add_f32 v[144:145], v[144:145], v[160:161]
    v_pk_add_f32 v[146:147], v[146:147], v[162:163]
    v_pk_add_f32 v[144:145], v[144:145], v[164:165]
    v_pk_add_f32 v[146:147], v[146:147], v[166:167]
    v_pk_add_f32 v[144:145], v[144:145], v[168:169]
    v_pk_add_f32 v[146:147], v[146:147], v[170:171]
    v_pk_add_f32 v[144:145], v[144:145], v[172:173]
    v_pk_add_f32 v[146:147], v[146:147], v[174:175]
    v_pk_add_f32 v[144:145], v[144:145], v[176:177]
    v_pk_add_f32 v[146:147], v[146:147], v[178:179]
    v_pk_add_f32 v[144:145], v[144:145], v[180:181]
    v_pk_add_f32 v[146:147], v[146:147], v[182:183]
    v_pk_add_f32 v[144:145], v[144:145], v[184:185]
    v_pk_add_f32 v[146:147], v[146:147], v[186:187]
    v_pk_add_f32 v[144:145], v[144:145], v[188:189]
    v_pk_add_f32 v[146:147], v[146:147], v[190:191]
    v_pk_add_f32 v[144:145], v[144:145], v[192:193]
    v_pk_add_f32 v[146:147], v[146:147], v[194:195]
    v_pk_add_f32 v[144:145], v[144:145], v[196:197]
    v_pk_add_f32 v[146:147], v[146:147], v[198:199]
    v_pk_add_f32 v[144:145], v[144:145], v[200:201]
    v_pk_add_f32 v[146:147], v[146:147], v[202:203]
    v_pk_add_f32 v[144:145], v[144:145], v[204:205]
    v_pk_add_f32 v[146:147], v[146:147], v[206:207]
    v_pk_add_f32 v[144:145], v[144:145], v[208:209]
    v_pk_add_f32 v[146:147], v[146:147], v[210:211]
    v_pk_add_f32 v[144:145], v[144:145], v[212:213]
    v_pk_add_f32 v[146:147], v[146:147], v[214:215]
    v_pk_add_f32 v[144:145], v[144:145], v[216:217]
    v_pk_add_f32 v[146:147], v[146:147], v[218:219]
    v_pk_add_f32 v[144:145], v[144:145], v[220:221]
    v_pk_add_f32 v[146:147], v[146:147], v[222:223]
    s_mov_b64 exec, 0xfffffff
    ds_write_b128 v139, v[144:147]
    s_mov_b64 exec, -1
    v_and_b32 v140, 15, v1
    v_lshlrev_b32 v140, 3, v140
    v_lshlrev_b32 v3, 3, v1
    v_add_u32 v12, 20480, v3
    s_mov_b32 s33, 0
TB_POLL:
    buffer_load_dword v13, v141, s[28:31], s61 offen sc1
    s_add_u32 s33, s33, 1
    s_waitcnt vmcnt(0)
    v_cmp_eq_u32 vcc, v0, v13
    s_and_b32 s34, vcc_lo, 0xffff
    s_cmp_eq_u32 s34, 0xffff
    s_cbranch_scc1 TB_GO
    s_sleep 1
    s_cmp_lt_u32 s33, 0x80000
    s_cbranch_scc1 TB_POLL
TB_GO:
    s_add_u32 s34, s7, 0
    buffer_load_dwordx4 a[0:3], v10, s[12:15], s34 offen offset:0 sc1
    buffer_load_dwordx4 a[4:7], v11, s[12:15], s34 offen offset:0 sc1
    buffer_load_dwordx4 a[8:11], v10, s[12:15], s34 offen offset:1024 sc1
    buffer_load_dwordx4 a[12:15], v11, s[12:15], s34 offen offset:1024 sc1
    s_add_u32 s34, s7, 2048
    buffer_load_dwordx2 a[16:17], v3, s[12:15], s34 offen offset:0 sc1
    buffer_load_dwordx2 a[18:19], v3, s[12:15], s34 offen offset:512 sc1
    buffer_load_dwordx2 a[20:21], v12, s[12:15], s34 offen offset:0 sc1
    buffer_load_dwordx2 a[22:23], v12, s[12:15], s34 offen offset:512 sc1
    buffer_load_dwordx4 a[24:27], v10, s[12:15], s34 offen offset:1024 sc1
    buffer_load_dwordx4 a[28:31], v11, s[12:15], s34 offen offset:1024 sc1
    s_add_u32 s34, s7, 4096
    buffer_load_dwordx4 a[32:35], v10, s[12:15], s34 offen offset:0 sc1
    buffer_load_dwordx4 a[36:39], v11, s[12:15], s34 offen offset:0 sc1
    buffer_load_dwordx4 a[40:43], v10, s[12:15], s34 offen offset:1024 sc1
    buffer_load_dwordx4 a[44:47], v11, s[12:15], s34 offen offset:1024 sc1
    s_add_u32 s34, s7, 6144
    buffer_load_dwordx4 a[48:51], v10, s[12:15], s34 offen offset:0 sc1
    buffer_load_dwordx4 a[52:55], v11, s[12:15], s34 offen offset:0 sc1
    buffer_load_dwordx2 a[56:57], v3, s[12:15], s34 offen offset:1024 sc1
    buffer_load_dwordx2 a[58:59], v3, s[12:15], s34 offen offset:1536 sc1
    buffer_load_dwordx2 a[60:61], v12, s[12:15], s34 offen offset:1024 sc1
    buffer_load_dwordx2 a[62:63], v12, s[12:15], s34 offen offset:1536 sc1
    s_lshl_b32 s39, s3, 11
    s_add_u32 s39, s39, 145408
    v_add_u32 v140, s39, v140
    s_waitcnt lgkmcnt(0)
    s_barrier
    ds_read_b128 a[64:67], v4 offset:0
    ds_read_b128 a[68:71], v4 offset:1024
    ds_read_b128 a[72:75], v4 offset:2048
    ds_read_b128 a[76:79], v4 offset:3072
    ds_read_b128 a[80:83], v4 offset:4096
    ds_read_b128 a[84:87], v4 offset:5120
    s_waitcnt vmcnt(16)
    s_waitcnt lgkmcnt(4)
    v_mfma_f32_16x16x32_bf16 v[16:19], a[64:67], a[0:3], 0
    ds_read_b128 a[88:91], v4 offset:6144
    s_mov_b32 m0, s39
    v_mfma_f32_16x16x32_bf16 v[20:23], a[64:67], a[4:7], 0
    buffer_load_dwordx4 v2, s[28:31], s49 offen sc1 lds
    v_mfma_f32_16x16x32_bf16 v[24:27], a[68:71], a[0:3], 0
    ds_read_b128 a[92:95], v4 offset:7168
    v_mfma_f32_16x16x32_bf16 v[28:31], a[68:71], a[4:7], 0
    s_waitcnt lgkmcnt(4)
    v_mfma_f32_16x16x32_bf16 v[32:35], a[72:75], a[0:3], 0
    ds_read_b128 a[64:67], v4 offset:8192
    v_mfma_f32_16x16x32_bf16 v[36:39], a[72:75], a[4:7], 0
    v_mfma_f32_16x16x32_bf16 v[40:43], a[76:79], a[0:3], 0
    ds_read_b128 a[68:71], v4 offset:9216
    v_mfma_f32_16x16x32_bf16 v[44:47], a[76:79], a[4:7], 0
    s_waitcnt lgkmcnt(4)
    v_mfma_f32_16x16x32_bf16 v[48:51], a[80:83], a[0:3], 0
    ds_read_b128 a[72:75], v4 offset:10240
    v_mfma_f32_16x16x32_bf16 v[52:55], a[80:83], a[4:7], 0
    v_mfma_f32_16x16x32_bf16 v[56:59], a[84:87], a[0:3], 0
    ds_read_b128 a[76:79], v4 offset:11264
    v_mfma_f32_16x16x32_bf16 v[60:63], a[84:87], a[4:7], 0
    s_waitcnt lgkmcnt(4)
    v_mfma_f32_16x16x32_bf16 v[64:67], a[88:91], a[0:3], 0
    ds_read_b128 a[80:83], v7 offset:12288
    v_mfma_f32_16x16x32_bf16 v[68:71], a[88:91], a[4:7], 0
    v_mfma_f32_16x16x32_bf16 v[72:75], a[92:95], a[0:3], 0
    ds_read_b128 a[84:87], v7 offset:13312
    v_mfma_f32_16x16x32_bf16 v[76:79], a[92:95], a[4:7], 0
    s_waitcnt lgkmcnt(4)
    v_mfma_f32_16x16x32_bf16 v[80:83], a[64:67], a[0:3], 0
    ds_read_b128 a[88:91], v4 offset:14336
    v_mfma_f32_16x16x32_bf16 v[84:87], a[64:67], a[4:7], 0
    v_mfma_f32_16x16x32_bf16 v[88:91], a[68:71], a[0:3], 0
    ds_read_b128 a[92:95], v4 offset:15360
    v_mfma_f32_16x16x32_bf16 v[92:95], a[68:71], a[4:7], 0
    s_waitcnt lgkmcnt(4)
    v_mfma_f32_16x16x32_bf16 v[96:99], a[72:75], a[0:3], 0
    ds_read_b128 a[64:67], v4 offset:16384
    v_mfma_f32_16x16x32_bf16 v[100:103], a[72:75], a[4:7], 0
    buffer_load_dwordx4 v2, s[28:31], s49 offen offset:1024 sc1 lds
    v_mfma_f32_16x16x32_bf16 v[104:107], a[76:79], a[0:3], 0
    ds_read_b128 a[68:71], v4 offset:17408
    v_mfma_f32_16x16x32_bf16 v[108:111], a[76:79], a[4:7], 0
    s_waitcnt lgkmcnt(4)
    v_mfma_f32_16x16x32_bf16 v[112:115], a[80:83], a[0:3], 0
    ds_read_b128 a[72:75], v4 offset:18432
    v_mfma_f32_16x16x32_bf16 v[116:119], a[80:83], a[4:7], 0
    v_mfma_f32_16x16x32_bf16 v[120:123], a[84:87], a[0:3], 0
    ds_read_b128 a[76:79], v4 offset:19456
    v_mfma_f32_16x16x32_bf16 v[124:127], a[84:87], a[4:7], 0
    s_waitcnt lgkmcnt(4)
    v_mfma_f32_16x16x32_bf16 v[16:19], a[88:91], a[8:11], v[16:19]
    ds_read_b128 a[80:83], v4 offset:20480
    v_mfma_f32_16x16x32_bf16 v[20:23], a[88:91], a[12:15], v[20:23]
    v_mfma_f32_16x16x32_bf16 v[24:27], a[92:95], a[8:11], v[24:27]
    ds_read_b128 a[84:87], v4 offset:21504
    v_mfma_f32_16x16x32_bf16 v[28:31], a[92:95], a[12:15], v[28:31]
    s_waitcnt lgkmcnt(4)
    v_mfma_f32_16x16x32_bf16 v[32:35], a[64:67], a[8:11], v[32:35]
    ds_read_b128 a[88:91], v4 offset:22528
    v_mfma_f32_16x16x32_bf16 v[36:39], a[64:67], a[12:15], v[36:39]
    v_mfma_f32_16x16x32_bf16 v[40:43], a[68:71], a[8:11], v[40:43]
    ds_read_b128 a[92:95], v4 offset:23552
    v_mfma_f32_16x16x32_bf16 v[44:47], a[68:71], a[12:15], v[44:47]
    s_waitcnt lgkmcnt(4)
    v_mfma_f32_16x16x32_bf16 v[48:51], a[72:75], a[8:11], v[48:51]
    ds_read_b128 a[64:67], v4 offset:24576
    v_mfma_f32_16x16x32_bf16 v[52:55], a[72:75], a[12:15], v[52:55]
    v_mfma_f32_16x16x32_bf16 v[56:59], a[76:79], a[8:11], v[56:59]
    ds_read_b128 a[68:71], v4 offset:25600
    v_mfma_f32_16x16x32_bf16 v[60:63], a[76:79], a[12:15], v[60:63]
    s_waitcnt lgkmcnt(4)
    v_mfma_f32_16x16x32_bf16 v[64:67], a[80:83], a[8:11], v[64:67]
    ds_read_b128 a[72:75], v7 offset:26624
    v_mfma_f32_16x16x32_bf16 v[68:71], a[80:83], a[12:15], v[68:71]
    v_mfma_f32_16x16x32_bf16 v[72:75], a[84:87], a[8:11], v[72:75]
    ds_read_b128 a[76:79], v7 offset:27648
    v_mfma_f32_16x16x32_bf16 v[76:79], a[84:87], a[12:15], v[76:79]
    s_barrier
    s_waitcnt lgkmcnt(4)
    v_mfma_f32_16x16x32_bf16 v[80:83], a[88:91], a[8:11], v[80:83]
    ds_read_b128 a[80:83], v4 offset:28672
    v_mfma_f32_16x16x32_bf16 v[84:87], a[88:91], a[12:15], v[84:87]
    v_mfma_f32_16x16x32_bf16 v[88:91], a[92:95], a[8:11], v[88:91]
    ds_read_b128 a[84:87], v4 offset:29696
    v_mfma_f32_16x16x32_bf16 v[92:95], a[92:95], a[12:15], v[92:95]
    s_waitcnt lgkmcnt(4)
    v_mfma_f32_16x16x32_bf16 v[96:99], a[64:67], a[8:11], v[96:99]
    ds_read_b128 a[88:91], v4 offset:30720
    v_mfma_f32_16x16x32_bf16 v[100:103], a[64:67], a[12:15], v[100:103]
    v_mfma_f32_16x16x32_bf16 v[104:107], a[68:71], a[8:11], v[104:107]
    ds_read_b128 a[92:95], v4 offset:31744
    v_mfma_f32_16x16x32_bf16 v[108:111], a[68:71], a[12:15], v[108:111]
    s_waitcnt lgkmcnt(4)
    v_mfma_f32_16x16x32_bf16 v[112:115], a[72:75], a[8:11], v[112:115]
    ds_read_b128 a[64:67], v4 offset:32768
    v_mfma_f32_16x16x32_bf16 v[116:119], a[72:75], a[12:15], v[116:119]
    v_mfma_f32_16x16x32_bf16 v[120:123], a[76:79], a[8:11], v[120:123]
    ds_read_b128 a[68:71], v4 offset:33792
    v_mfma_f32_16x16x32_bf16 v[124:127], a[76:79], a[12:15], v[124:127]
    s_waitcnt vmcnt(12)
    s_waitcnt lgkmcnt(4)
    v_mfma_f32_16x16x32_bf16 v[16:19], a[80:83], a[16:19], v[16:19]
    ds_read_b128 a[72:75], v4 offset:34816
    s_add_u32 s34, s7, 8192
    v_mfma_f32_16x16x32_bf16 v[20:23], a[80:83], a[20:23], v[20:23]
    buffer_load_dwordx4 a[0:3], v10, s[12:15], s34 offen offset:0 sc1
    v_mfma_f32_16x16x32_bf16 v[24:27], a[84:87], a[16:19], v[24:27]
    ds_read_b128 a[76:79], v4 offset:35840
    v_mfma_f32_16x16x32_bf16 v[28:31], a[84:87], a[20:23], v[28:31]
    s_waitcnt lgkmcnt(4)
    v_mfma_f32_16x16x32_bf16 v[32:35], a[88:91], a[16:19], v[32:35]
    ds_read_b128 a[80:83], v4 offset:36864
    v_mfma_f32_16x16x32_bf16 v[36:39], a[88:91], a[20:23], v[36:39]
    v_mfma_f32_16x16x32_bf16 v[40:43], a[92:95], a[16:19], v[40:43]
    ds_read_b128 a[84:87], v4 offset:37888
    v_mfma_f32_16x16x32_bf16 v[44:47], a[92:95], a[20:23], v[44:47]
    s_waitcnt lgkmcnt(4)
    v_mfma_f32_16x16x32_bf16 v[48:51], a[64:67], a[16:19], v[48:51]
    ds_read_b128 a[88:91], v4 offset:38912
    v_mfma_f32_16x16x32_bf16 v[52:55], a[64:67], a[20:23], v[52:55]
    buffer_load_dwordx4 a[4:7], v11, s[12:15], s34 offen offset:0 sc1
    v_mfma_f32_16x16x32_bf16 v[56:59], a[68:71], a[16:19], v[56:59]
    ds_read_b128 a[92:95], v4 offset:39936
    v_mfma_f32_16x16x32_bf16 v[60:63], a[68:71], a[20:23], v[60:63]
    s_waitcnt lgkmcnt(4)
    v_mfma_f32_16x16x32_bf16 v[64:67], a[72:75], a[16:19], v[64:67]
    ds_read_b128 a[64:67], v7 offset:40960
    v_mfma_f32_16x16x32_bf16 v[68:71], a[72:75], a[20:23], v[68:71]
    v_mfma_f32_16x16x32_bf16 v[72:75], a[76:79], a[16:19], v[72:75]
    ds_read_b128 a[68:71], v7 offset:41984
    v_mfma_f32_16x16x32_bf16 v[76:79], a[76:79], a[20:23], v[76:79]
    s_waitcnt lgkmcnt(4)
    v_mfma_f32_16x16x32_bf16 v[80:83], a[80:83], a[16:19], v[80:83]
    ds_read_b128 a[72:75], v4 offset:43008
    v_mfma_f32_16x16x32_bf16 v[84:87], a[80:83], a[20:23], v[84:87]
    v_mfma_f32_16x16x32_bf16 v[88:91], a[84:87], a[16:19], v[88:91]
    ds_read_b128 a[76:79], v4 offset:44032
    v_mfma_f32_16x16x32_bf16 v[92:95], a[84:87], a[20:23], v[92:95]
    s_waitcnt lgkmcnt(4)
    v_mfma_f32_16x16x32_bf16 v[96:99], a[88:91], a[16:19], v[96:99]
    ds_read_b128 a[80:83], v4 offset:45056
    v_mfma_f32_16x16x32_bf16 v[100:103], a[88:91], a[20:23], v[100:103]
    buffer_load_dwordx4 a[8:11], v10, s[12:15], s34 offen offset:1024 sc1
    v_mfma_f32_16x16x32_bf16 v[104:107], a[92:95], a[16:19], v[104:107]
    ds_read_b128 a[84:87], v4 offset:46080
    v_mfma_f32_16x16x32_bf16 v[108:111], a[92:95], a[20:23], v[108:111]
    s_waitcnt lgkmcnt(4)
    v_mfma_f32_16x16x32_bf16 v[112:115], a[64:67], a[16:19], v[112:115]
    ds_read_b128 a[88:91], v4 offset:47104
    v_mfma_f32_16x16x32_bf16 v[116:119], a[64:67], a[20:23], v[116:119]
    v_mfma_f32_16x16x32_bf16 v[120:123], a[68:71], a[16:19], v[120:123]
    ds_read_b128 a[92:95], v4 offset:48128
    v_mfma_f32_16x16x32_bf16 v[124:127], a[68:71], a[20:23], v[124:127]
    s_waitcnt lgkmcnt(4)
    v_mfma_f32_16x16x32_bf16 v[16:19], a[72:75], a[24:27], v[16:19]
    ds_read_b128 a[64:67], v4 offset:49152
    v_mfma_f32_16x16x32_bf16 v[20:23], a[72:75], a[28:31], v[20:23]
    buffer_load_dwordx4 a[12:15], v11, s[12:15], s34 offen offset:1024 sc1
    v_mfma_f32_16x16x32_bf16 v[24:27], a[76:79], a[24:27], v[24:27]
    ds_read_b128 a[68:71], v4 offset:50176
    v_mfma_f32_16x16x32_bf16 v[28:31], a[76:79], a[28:31], v[28:31]
    s_waitcnt lgkmcnt(4)
    v_mfma_f32_16x16x32_bf16 v[32:35], a[80:83], a[24:27], v[32:35]
    ds_read_b128 a[72:75], v4 offset:51200
    v_mfma_f32_16x16x32_bf16 v[36:39], a[80:83], a[28:31], v[36:39]
    v_mfma_f32_16x16x32_bf16 v[40:43], a[84:87], a[24:27], v[40:43]
    ds_read_b128 a[76:79], v4 offset:52224
    v_mfma_f32_16x16x32_bf16 v[44:47], a[84:87], a[28:31], v[44:47]
    s_waitcnt lgkmcnt(4)
    v_mfma_f32_16x16x32_bf16 v[48:51], a[88:91], a[24:27], v[48:51]
    ds_read_b128 a[80:83], v4 offset:53248
    v_mfma_f32_16x16x32_bf16 v[52:55], a[88:91], a[28:31], v[52:55]
    v_mfma_f32_16x16x32_bf16 v[56:59], a[92:95], a[24:27], v[56:59]
    ds_read_b128 a[84:87], v4 offset:54272
    v_mfma_f32_16x16x32_bf16 v[60:63], a[92:95], a[28:31], v[60:63]
    s_waitcnt lgkmcnt(4)
    v_mfma_f32_16x16x32_bf16 v[64:67], a[64:67], a[24:27], v[64:67]
    ds_read_b128 a[88:91], v7 offset:55296
    v_mfma_f32_16x16x32_bf16 v[68:71], a[64:67], a[28:31], v[68:71]
    v_mfma_f32_16x16x32_bf16 v[72:75], a[68:71], a[24:27], v[72:75]
    ds_read_b128 a[92:95], v7 offset:56320
    v_mfma_f32_16x16x32_bf16 v[76:79], a[68:71], a[28:31], v[76:79]
    s_barrier
    s_waitcnt lgkmcnt(4)
    v_mfma_f32_16x16x32_bf16 v[80:83], a[72:75], a[24:27], v[80:83]
    ds_read_b128 a[64:67], v5 offset:0
    v_mfma_f32_16x16x32_bf16 v[84:87], a[72:75], a[28:31], v[84:87]
    v_mfma_f32_16x16x32_bf16 v[88:91], a[76:79], a[24:27], v[88:91]
    ds_read_b128 a[68:71], v5 offset:1024
    v_mfma_f32_16x16x32_bf16 v[92:95], a[76:79], a[28:31], v[92:95]
    s_waitcnt lgkmcnt(4)
    v_mfma_f32_16x16x32_bf16 v[96:99], a[80:83], a[24:27], v[96:99]
    ds_read_b128 a[72:75], v5 offset:2048
    v_mfma_f32_16x16x32_bf16 v[100:103], a[80:83], a[28:31], v[100:103]
    v_mfma_f32_16x16x32_bf16 v[104:107], a[84:87], a[24:27], v[104:107]
    ds_read_b128 a[76:79], v5 offset:3072
    v_mfma_f32_16x16x32_bf16 v[108:111], a[84:87], a[28:31], v[108:111]
    s_waitcnt lgkmcnt(4)
    v_mfma_f32_16x16x32_bf16 v[112:115], a[88:91], a[24:27], v[112:115]
    ds_read_b128 a[80:83], v5 offset:4096
    v_mfma_f32_16x16x32_bf16 v[116:119], a[88:91], a[28:31], v[116:119]
    v_mfma_f32_16x16x32_bf16 v[120:123], a[92:95], a[24:27], v[120:123]
    ds_read_b128 a[84:87], v5 offset:5120
    v_mfma_f32_16x16x32_bf16 v[124:127], a[92:95], a[28:31], v[124:127]
    s_waitcnt vmcnt(12)
    s_waitcnt lgkmcnt(4)
    v_mfma_f32_16x16x32_bf16 v[16:19], a[64:67], a[32:35], v[16:19]
    ds_read_b128 a[88:91], v5 offset:6144
    s_add_u32 m0, s44, 0
    v_mfma_f32_16x16x32_bf16 v[20:23], a[64:67], a[36:39], v[20:23]
    s_add_u32 s46, s45, 2293760
    v_mfma_f32_16x16x32_bf16 v[24:27], a[68:71], a[32:35], v[24:27]
    ds_read_b128 a[92:95], v5 offset:7168
    v_mfma_f32_16x16x32_bf16 v[28:31], a[68:71], a[36:39], v[28:31]
    s_waitcnt lgkmcnt(4)
    v_mfma_f32_16x16x32_bf16 v[32:35], a[72:75], a[32:35], v[32:35]
    ds_read_b128 a[64:67], v5 offset:8192
    v_mfma_f32_16x16x32_bf16 v[36:39], a[72:75], a[36:39], v[36:39]
    buffer_load_dwordx4 v2, s[40:43], s46 offen offset:0 sc1 lds
    v_mfma_f32_16x16x32_bf16 v[40:43], a[76:79], a[32:35], v[40:43]
    ds_read_b128 a[68:71], v5 offset:9216
    v_mfma_f32_16x16x32_bf16 v[44:47], a[76:79], a[36:39], v[44:47]
    s_waitcnt lgkmcnt(4)
    v_mfma_f32_16x16x32_bf16 v[48:51], a[80:83], a[32:35], v[48:51]
    ds_read_b128 a[72:75], v5 offset:10240
    v_mfma_f32_16x16x32_bf16 v[52:55], a[80:83], a[36:39], v[52:55]
    buffer_load_dwordx4 v2, s[40:43], s46 offen offset:1024 sc1 lds
    v_mfma_f32_16x16x32_bf16 v[56:59], a[84:87], a[32:35], v[56:59]
    ds_read_b128 a[76:79], v5 offset:11264
    v_mfma_f32_16x16x32_bf16 v[60:63], a[84:87], a[36:39], v[60:63]
    s_waitcnt lgkmcnt(4)
    v_mfma_f32_16x16x32_bf16 v[64:67], a[88:91], a[32:35], v[64:67]
    ds_read_b128 a[80:83], v8 offset:12288
    v_mfma_f32_16x16x32_bf16 v[68:71], a[88:91], a[36:39], v[68:71]
    buffer_load_dwordx4 v2, s[40:43], s46 offen offset:2048 sc1 lds
    v_mfma_f32_16x16x32_bf16 v[72:75], a[92:95], a[32:35], v[72:75]
    ds_read_b128 a[84:87], v8 offset:13312
    v_mfma_f32_16x16x32_bf16 v[76:79], a[92:95], a[36:39], v[76:79]
    s_waitcnt lgkmcnt(4)
    v_mfma_f32_16x16x32_bf16 v[80:83], a[64:67], a[32:35], v[80:83]
    ds_read_b128 a[88:91], v5 offset:14336
    v_mfma_f32_16x16x32_bf16 v[84:87], a[64:67], a[36:39], v[84:87]
    buffer_load_dwordx4 v2, s[40:43], s46 offen offset:3072 sc1 lds
    v_mfma_f32_16x16x32_bf16 v[88:91], a[68:71], a[32:35], v[88:91]
    ds_read_b128 a[92:95], v5 offset:15360
    s_add_u32 m0, s44, 4096
    v_mfma_f32_16x16x32_bf16 v[92:95], a[68:71], a[36:39], v[92:95]
    s_add_u32 s46, s45, 2297856
    s_waitcnt lgkmcnt(4)
    v_mfma_f32_16x16x32_bf16 v[96:99], a[72:75], a[32:35], v[96:99]
    buffer_load_dwordx4 v2, s[40:43], s46 offen offset:0 sc1 lds
    v_mfma_f32_16x16x32_bf16 v[100:103], a[72:75], a[36:39], v[100:103]
    ds_read_b128 a[64:67], v5 offset:16384
    v_mfma_f32_16x16x32_bf16 v[104:107], a[76:79], a[32:35], v[104:107]
    ds_read_b128 a[68:71], v5 offset:17408
    v_mfma_f32_16x16x32_bf16 v[108:111], a[76:79], a[36:39], v[108:111]
    s_waitcnt lgkmcnt(4)
    v_mfma_f32_16x16x32_bf16 v[112:115], a[80:83], a[32:35], v[112:115]
    buffer_load_dwordx4 v2, s[40:43], s46 offen offset:1024 sc1 lds
    v_mfma_f32_16x16x32_bf16 v[116:119], a[80:83], a[36:39], v[116:119]
    ds_read_b128 a[72:75], v5 offset:18432
    v_mfma_f32_16x16x32_bf16 v[120:123], a[84:87], a[32:35], v[120:123]
    ds_read_b128 a[76:79], v5 offset:19456
    v_mfma_f32_16x16x32_bf16 v[124:127], a[84:87], a[36:39], v[124:127]
    s_waitcnt lgkmcnt(4)
    v_mfma_f32_16x16x32_bf16 v[16:19], a[88:91], a[40:43], v[16:19]
    buffer_load_dwordx4 v2, s[40:43], s46 offen offset:2048 sc1 lds
    v_mfma_f32_16x16x32_bf16 v[20:23], a[88:91], a[44:47], v[20:23]
    ds_read_b128 a[80:83], v5 offset:20480
    s_add_u32 s34, s7, 10240
    v_mfma_f32_16x16x32_bf16 v[24:27], a[92:95], a[40:43], v[24:27]
    ds_read_b128 a[84:87], v5 offset:21504
    v_mfma_f32_16x16x32_bf16 v[28:31], a[92:95], a[44:47], v[28:31]
    s_waitcnt lgkmcnt(4)
    v_mfma_f32_16x16x32_bf16 v[32:35], a[64:67], a[40:43], v[32:35]
    buffer_load_dwordx4 a[16:19], v10, s[12:15], s34 offen offset:0 sc1
    v_mfma_f32_16x16x32_bf16 v[36:39], a[64:67], a[44:47], v[36:39]
    ds_read_b128 a[88:91], v5 offset:22528
    v_mfma_f32_16x16x32_bf16 v[40:43], a[68:71], a[40:43], v[40:43]
    buffer_load_dwordx4 a[20:23], v11, s[12:15], s34 offen offset:0 sc1
    v_mfma_f32_16x16x32_bf16 v[44:47], a[68:71], a[44:47], v[44:47]
    ds_read_b128 a[92:95], v5 offset:23552
    s_waitcnt lgkmcnt(4)
    v_mfma_f32_16x16x32_bf16 v[48:51], a[72:75], a[40:43], v[48:51]
    ds_read_b128 a[64:67], v5 offset:24576
    v_mfma_f32_16x16x32_bf16 v[52:55], a[72:75], a[44:47], v[52:55]
    buffer_load_dwordx4 a[24:27], v10, s[12:15], s34 offen offset:1024 sc1
    v_mfma_f32_16x16x32_bf16 v[56:59], a[76:79], a[40:43], v[56:59]
    ds_read_b128 a[68:71], v5 offset:25600
    v_mfma_f32_16x16x32_bf16 v[60:63], a[76:79], a[44:47], v[60:63]
    s_waitcnt lgkmcnt(4)
    v_mfma_f32_16x16x32_bf16 v[64:67], a[80:83], a[40:43], v[64:67]
    ds_read_b128 a[72:75], v8 offset:26624
    v_mfma_f32_16x16x32_bf16 v[68:71], a[80:83], a[44:47], v[68:71]
    buffer_load_dwordx4 a[28:31], v11, s[12:15], s34 offen offset:1024 sc1
    v_mfma_f32_16x16x32_bf16 v[72:75], a[84:87], a[40:43], v[72:75]
    ds_read_b128 a[76:79], v8 offset:27648
    v_mfma_f32_16x16x32_bf16 v[76:79], a[84:87], a[44:47], v[76:79]
    s_barrier
    s_waitcnt lgkmcnt(4)
    v_mfma_f32_16x16x32_bf16 v[80:83], a[88:91], a[40:43], v[80:83]
    ds_read_b128 a[80:83], v5 offset:28672
    v_mfma_f32_16x16x32_bf16 v[84:87], a[88:91], a[44:47], v[84:87]
    v_mfma_f32_16x16x32_bf16 v[88:91], a[92:95], a[40:43], v[88:91]
    ds_read_b128 a[84:87], v5 offset:29696
    v_mfma_f32_16x16x32_bf16 v[92:95], a[92:95], a[44:47], v[92:95]
    s_waitcnt lgkmcnt(4)
    v_mfma_f32_16x16x32_bf16 v[96:99], a[64:67], a[40:43], v[96:99]
    ds_read_b128 a[88:91], v5 offset:30720
    v_mfma_f32_16x16x32_bf16 v[100:103], a[64:67], a[44:47], v[100:103]
    v_mfma_f32_16x16x32_bf16 v[104:107], a[68:71], a[40:43], v[104:107]
    ds_read_b128 a[92:95], v5 offset:31744
    v_mfma_f32_16x16x32_bf16 v[108:111], a[68:71], a[44:47], v[108:111]
    s_waitcnt lgkmcnt(4)
    v_mfma_f32_16x16x32_bf16 v[112:115], a[72:75], a[40:43], v[112:115]
    ds_read_b128 a[64:67], v5 offset:32768
    v_mfma_f32_16x16x32_bf16 v[116:119], a[72:75], a[44:47], v[116:119]
    v_mfma_f32_16x16x32_bf16 v[120:123], a[76:79], a[40:43], v[120:123]
    ds_read_b128 a[68:71], v5 offset:33792
    v_mfma_f32_16x16x32_bf16 v[124:127], a[76:79], a[44:47], v[124:127]
    s_waitcnt vmcnt(17)
    s_waitcnt lgkmcnt(4)
    v_mfma_f32_16x16x32_bf16 v[16:19], a[80:83], a[48:51], v[16:19]
    ds_read_b128 a[72:75], v5 offset:34816
    s_add_u32 m0, s44, 28672
    v_mfma_f32_16x16x32_bf16 v[20:23], a[80:83], a[52:55], v[20:23]
    s_add_u32 s46, s45, 2752512
    v_mfma_f32_16x16x32_bf16 v[24:27], a[84:87], a[48:51], v[24:27]
    ds_read_b128 a[76:79], v5 offset:35840
    v_mfma_f32_16x16x32_bf16 v[28:31], a[84:87], a[52:55], v[28:31]
    s_waitcnt lgkmcnt(4)
    v_mfma_f32_16x16x32_bf16 v[32:35], a[88:91], a[48:51], v[32:35]
    ds_read_b128 a[80:83], v5 offset:36864
    v_mfma_f32_16x16x32_bf16 v[36:39], a[88:91], a[52:55], v[36:39]
    buffer_load_dwordx4 v2, s[40:43], s46 offen offset:0 sc1 lds
    v_mfma_f32_16x16x32_bf16 v[40:43], a[92:95], a[48:51], v[40:43]
    ds_read_b128 a[84:87], v5 offset:37888
    v_mfma_f32_16x16x32_bf16 v[44:47], a[92:95], a[52:55], v[44:47]
    s_waitcnt lgkmcnt(4)
    v_mfma_f32_16x16x32_bf16 v[48:51], a[64:67], a[48:51], v[48:51]
    ds_read_b128 a[88:91], v5 offset:38912
    v_mfma_f32_16x16x32_bf16 v[52:55], a[64:67], a[52:55], v[52:55]
    buffer_load_dwordx4 v2, s[40:43], s46 offen offset:1024 sc1 lds
    v_mfma_f32_16x16x32_bf16 v[56:59], a[68:71], a[48:51], v[56:59]
    ds_read_b128 a[92:95], v5 offset:39936
    v_mfma_f32_16x16x32_bf16 v[60:63], a[68:71], a[52:55], v[60:63]
    s_waitcnt lgkmcnt(4)
    v_mfma_f32_16x16x32_bf16 v[64:67], a[72:75], a[48:51], v[64:67]
    buffer_load_dwordx4 v2, s[40:43], s46 offen offset:2048 sc1 lds
    v_mfma_f32_16x16x32_bf16 v[68:71], a[72:75], a[52:55], v[68:71]
    ds_read_b128 a[64:67], v8 offset:40960
    v_mfma_f32_16x16x32_bf16 v[72:75], a[76:79], a[48:51], v[72:75]
    ds_read_b128 a[68:71], v8 offset:41984
    v_mfma_f32_16x16x32_bf16 v[76:79], a[76:79], a[52:55], v[76:79]
    s_waitcnt lgkmcnt(4)
    v_mfma_f32_16x16x32_bf16 v[80:83], a[80:83], a[48:51], v[80:83]
    buffer_load_dwordx4 v2, s[40:43], s46 offen offset:3072 sc1 lds
    v_mfma_f32_16x16x32_bf16 v[84:87], a[80:83], a[52:55], v[84:87]
    ds_read_b128 a[72:75], v5 offset:43008
    s_add_u32 m0, s44, 32768
    v_mfma_f32_16x16x32_bf16 v[88:91], a[84:87], a[48:51], v[88:91]
    s_add_u32 s46, s45, 2756608
    buffer_load_dwordx4 v2, s[40:43], s46 offen offset:0 sc1 lds
    v_mfma_f32_16x16x32_bf16 v[92:95], a[84:87], a[52:55], v[92:95]
    ds_read_b128 a[76:79], v5 offset:44032
    s_waitcnt lgkmcnt(4)
    v_mfma_f32_16x16x32_bf16 v[96:99], a[88:91], a[48:51], v[96:99]
    ds_read_b128 a[80:83], v5 offset:45056
    v_mfma_f32_16x16x32_bf16 v[100:103], a[88:91], a[52:55], v[100:103]
    buffer_load_dwordx4 v2, s[40:43], s46 offen offset:1024 sc1 lds
    v_mfma_f32_16x16x32_bf16 v[104:107], a[92:95], a[48:51], v[104:107]
    ds_read_b128 a[84:87], v5 offset:46080
    v_mfma_f32_16x16x32_bf16 v[108:111], a[92:95], a[52:55], v[108:111]
    s_waitcnt lgkmcnt(4)
    v_mfma_f32_16x16x32_bf16 v[112:115], a[64:67], a[48:51], v[112:115]
    buffer_load_dwordx4 v2, s[40:43], s46 offen offset:2048 sc1 lds
    v_mfma_f32_16x16x32_bf16 v[116:119], a[64:67], a[52:55], v[116:119]
    ds_read_b128 a[88:91], v5 offset:47104
    s_add_u32 s34, s7, 12288
    v_mfma_f32_16x16x32_bf16 v[120:123], a[68:71], a[48:51], v[120:123]
    ds_read_b128 a[92:95], v5 offset:48128
    v_mfma_f32_16x16x32_bf16 v[124:127], a[68:71], a[52:55], v[124:127]
    s_waitcnt lgkmcnt(4)
    v_mfma_f32_16x16x32_bf16 v[16:19], a[72:75], a[56:59], v[16:19]
    buffer_load_dwordx2 a[32:33], v3, s[12:15], s34 offen offset:0 sc1
    v_mfma_f32_16x16x32_bf16 v[20:23], a[72:75], a[60:63], v[20:23]
    ds_read_b128 a[64:67], v5 offset:49152
    v_mfma_f32_16x16x32_bf16 v[24:27], a[76:79], a[56:59], v[24:27]
    buffer_load_dwordx2 a[34:35], v3, s[12:15], s34 offen offset:512 sc1
    v_mfma_f32_16x16x32_bf16 v[28:31], a[76:79], a[60:63], v[28:31]
    ds_read_b128 a[68:71], v5 offset:50176
    s_waitcnt lgkmcnt(4)
    v_mfma_f32_16x16x32_bf16 v[32:35], a[80:83], a[56:59], v[32:35]
    ds_read_b128 a[72:75], v5 offset:51200
    v_mfma_f32_16x16x32_bf16 v[36:39], a[80:83], a[60:63], v[36:39]
    buffer_load_dwordx2 a[36:37], v12, s[12:15], s34 offen offset:0 sc1
    v_mfma_f32_16x16x32_bf16 v[40:43], a[84:87], a[56:59], v[40:43]
    ds_read_b128 a[76:79], v5 offset:52224
    v_mfma_f32_16x16x32_bf16 v[44:47], a[84:87], a[60:63], v[44:47]
    s_waitcnt lgkmcnt(4)
    v_mfma_f32_16x16x32_bf16 v[48:51], a[88:91], a[56:59], v[48:51]
    buffer_load_dwordx2 a[38:39], v12, s[12:15], s34 offen offset:512 sc1
    v_mfma_f32_16x16x32_bf16 v[52:55], a[88:91], a[60:63], v[52:55]
    ds_read_b128 a[80:83], v5 offset:53248
    v_mfma_f32_16x16x32_bf16 v[56:59], a[92:95], a[56:59], v[56:59]
    ds_read_b128 a[84:87], v5 offset:54272
    v_mfma_f32_16x16x32_bf16 v[60:63], a[92:95], a[60:63], v[60:63]
    s_waitcnt lgkmcnt(4)
    v_mfma_f32_16x16x32_bf16 v[64:67], a[64:67], a[56:59], v[64:67]
    buffer_load_dwordx4 a[40:43], v10, s[12:15], s34 offen offset:1024 sc1
    v_mfma_f32_16x16x32_bf16 v[68:71], a[64:67], a[60:63], v[68:71]
    ds_read_b128 a[88:91], v8 offset:55296
    v_mfma_f32_16x16x32_bf16 v[72:75], a[68:71], a[56:59], v[72:75]
    buffer_load_dwordx4 a[44:47], v11, s[12:15], s34 offen offset:1024 sc1
    v_mfma_f32_16x16x32_bf16 v[76:79], a[68:71], a[60:63], v[76:79]
    ds_read_b128 a[92:95], v8 offset:56320
    s_barrier
    s_waitcnt lgkmcnt(4)
    v_mfma_f32_16x16x32_bf16 v[80:83], a[72:75], a[56:59], v[80:83]
    ds_read_b128 a[64:67], v6 offset:0
    v_mfma_f32_16x16x32_bf16 v[84:87], a[72:75], a[60:63], v[84:87]
    v_mfma_f32_16x16x32_bf16 v[88:91], a[76:79], a[56:59], v[88:91]
    ds_read_b128 a[68:71], v6 offset:1024
    v_mfma_f32_16x16x32_bf16 v[92:95], a[76:79], a[60:63], v[92:95]
    s_waitcnt lgkmcnt(4)
    v_mfma_f32_16x16x32_bf16 v[96:99], a[80:83], a[56:59], v[96:99]
    ds_read_b128 a[72:75], v6 offset:2048
    v_mfma_f32_16x16x32_bf16 v[100:103], a[80:83], a[60:63], v[100:103]
    v_mfma_f32_16x16x32_bf16 v[104:107], a[84:87], a[56:59], v[104:107]
    ds_read_b128 a[76:79], v6 offset:3072
    v_mfma_f32_16x16x32_bf16 v[108:111], a[84:87], a[60:63], v[108:111]
    s_waitcnt lgkmcnt(4)
    v_mfma_f32_16x16x32_bf16 v[112:115], a[88:91], a[56:59], v[112:115]
    ds_read_b128 a[80:83], v6 offset:4096
    v_mfma_f32_16x16x32_bf16 v[116:119], a[88:91], a[60:63], v[116:119]
    v_mfma_f32_16x16x32_bf16 v[120:123], a[92:95], a[56:59], v[120:123]
    ds_read_b128 a[84:87], v6 offset:5120
    v_mfma_f32_16x16x32_bf16 v[124:127], a[92:95], a[60:63], v[124:127]
    s_waitcnt vmcnt(24)
    s_waitcnt lgkmcnt(4)
    v_mfma_f32_16x16x32_bf16 v[16:19], a[64:67], a[0:3], v[16:19]
    ds_read_b128 a[88:91], v6 offset:6144
    s_add_u32 m0, s44, 57344
    v_mfma_f32_16x16x32_bf16 v[20:23], a[64:67], a[4:7], v[20:23]
    s_add_u32 s46, s45, 3211264
    v_mfma_f32_16x16x32_bf16 v[24:27], a[68:71], a[0:3], v[24:27]
    ds_read_b128 a[92:95], v6 offset:7168
    v_mfma_f32_16x16x32_bf16 v[28:31], a[68:71], a[4:7], v[28:31]
    s_waitcnt lgkmcnt(4)
    v_mfma_f32_16x16x32_bf16 v[32:35], a[72:75], a[0:3], v[32:35]
    ds_read_b128 a[64:67], v6 offset:8192
    s_waitcnt vmcnt(28)
    v_mfma_f32_16x16x32_bf16 v[36:39], a[72:75], a[4:7], v[36:39]
    buffer_load_dwordx4 v2, s[40:43], s46 offen offset:0 sc1 lds
    v_mfma_f32_16x16x32_bf16 v[40:43], a[76:79], a[0:3], v[40:43]
    ds_read_b128 a[68:71], v6 offset:9216
    v_mfma_f32_16x16x32_bf16 v[44:47], a[76:79], a[4:7], v[44:47]
    s_waitcnt lgkmcnt(4)
    v_mfma_f32_16x16x32_bf16 v[48:51], a[80:83], a[0:3], v[48:51]
    ds_read_b128 a[72:75], v6 offset:10240
    ds_read2_b64 v[144:147], v140 offset0:0 offset1:16
    v_mfma_f32_16x16x32_bf16 v[52:55], a[80:83], a[4:7], v[52:55]
    buffer_load_dwordx4 v2, s[40:43], s46 offen offset:1024 sc1 lds
    v_mfma_f32_16x16x32_bf16 v[56:59], a[84:87], a[0:3], v[56:59]
    ds_read_b128 a[76:79], v6 offset:11264
    v_mfma_f32_16x16x32_bf16 v[60:63], a[84:87], a[4:7], v[60:63]
    s_waitcnt lgkmcnt(5)
    v_mfma_f32_16x16x32_bf16 v[64:67], a[88:91], a[0:3], v[64:67]
    ds_read_b128 a[80:83], v9 offset:12288
    ds_read2_b64 v[148:151], v140 offset0:32 offset1:48
    v_mfma_f32_16x16x32_bf16 v[68:71], a[88:91], a[4:7], v[68:71]
    buffer_load_dwordx4 v2, s[40:43], s46 offen offset:2048 sc1 lds
    v_mfma_f32_16x16x32_bf16 v[72:75], a[92:95], a[0:3], v[72:75]
    ds_read_b128 a[84:87], v9 offset:13312
    v_mfma_f32_16x16x32_bf16 v[76:79], a[92:95], a[4:7], v[76:79]
    s_waitcnt lgkmcnt(6)
    v_mfma_f32_16x16x32_bf16 v[80:83], a[64:67], a[0:3], v[80:83]
    ds_read_b128 a[88:91], v6 offset:14336
    ds_read2_b64 v[152:155], v140 offset0:64 offset1:80
    v_mfma_f32_16x16x32_bf16 v[84:87], a[64:67], a[4:7], v[84:87]
    buffer_load_dwordx4 v2, s[40:43], s46 offen offset:3072 sc1 lds
    v_mfma_f32_16x16x32_bf16 v[88:91], a[68:71], a[0:3], v[88:91]
    ds_read_b128 a[92:95], v6 offset:15360
    s_add_u32 m0, s44, 61440
    v_mfma_f32_16x16x32_bf16 v[92:95], a[68:71], a[4:7], v[92:95]
    s_add_u32 s46, s45, 3215360
    s_waitcnt lgkmcnt(6)
    v_mfma_f32_16x16x32_bf16 v[96:99], a[72:75], a[0:3], v[96:99]
    buffer_load_dwordx4 v2, s[40:43], s46 offen offset:0 sc1 lds
    v_mfma_f32_16x16x32_bf16 v[100:103], a[72:75], a[4:7], v[100:103]
    ds_read_b128 a[64:67], v6 offset:16384
    ds_read2_b64 v[156:159], v140 offset0:96 offset1:112
    v_mfma_f32_16x16x32_bf16 v[104:107], a[76:79], a[0:3], v[104:107]
    ds_read_b128 a[68:71], v6 offset:17408
    v_mfma_f32_16x16x32_bf16 v[108:111], a[76:79], a[4:7], v[108:111]
    s_waitcnt lgkmcnt(6)
    v_mfma_f32_16x16x32_bf16 v[112:115], a[80:83], a[0:3], v[112:115]
    buffer_load_dwordx4 v2, s[40:43], s46 offen offset:1024 sc1 lds
    v_mfma_f32_16x16x32_bf16 v[116:119], a[80:83], a[4:7], v[116:119]
    ds_read_b128 a[72:75], v6 offset:18432
    ds_read2_b64 v[160:163], v140 offset0:128 offset1:144
    v_mfma_f32_16x16x32_bf16 v[120:123], a[84:87], a[0:3], v[120:123]
    ds_read_b128 a[76:79], v6 offset:19456
    v_mfma_f32_16x16x32_bf16 v[124:127], a[84:87], a[4:7], v[124:127]
    s_waitcnt lgkmcnt(6)
    v_mfma_f32_16x16x32_bf16 v[16:19], a[88:91], a[8:11], v[16:19]
    buffer_load_dwordx4 v2, s[40:43], s46 offen offset:2048 sc1 lds
    v_mfma_f32_16x16x32_bf16 v[20:23], a[88:91], a[12:15], v[20:23]
    ds_read_b128 a[80:83], v6 offset:20480
    s_add_u32 s34, s7, 14336
    v_mfma_f32_16x16x32_bf16 v[24:27], a[92:95], a[8:11], v[24:27]
    ds_read_b128 a[84:87], v6 offset:21504
    ds_read2_b64 v[164:167], v140 offset0:160 offset1:176
    v_mfma_f32_16x16x32_bf16 v[28:31], a[92:95], a[12:15], v[28:31]
    s_waitcnt lgkmcnt(6)
    v_mfma_f32_16x16x32_bf16 v[32:35], a[64:67], a[8:11], v[32:35]
    buffer_load_dwordx4 a[48:51], v10, s[12:15], s34 offen offset:0 sc1
    v_mfma_f32_16x16x32_bf16 v[36:39], a[64:67], a[12:15], v[36:39]
    ds_read_b128 a[88:91], v6 offset:22528
    ds_read2_b64 v[168:171], v140 offset0:192 offset1:208
    v_mfma_f32_16x16x32_bf16 v[40:43], a[68:71], a[8:11], v[40:43]
    buffer_load_dwordx4 a[52:55], v11, s[12:15], s34 offen offset:0 sc1
    v_mfma_f32_16x16x32_bf16 v[44:47], a[68:71], a[12:15], v[44:47]
    ds_read_b128 a[92:95], v6 offset:23552
    s_waitcnt lgkmcnt(6)
    v_mfma_f32_16x16x32_bf16 v[48:51], a[72:75], a[8:11], v[48:51]
    ds_read_b128 a[64:67], v6 offset:24576
    ds_read2_b64 v[172:175], v140 offset0:224 offset1:240
    v_mfma_f32_16x16x32_bf16 v[52:55], a[72:75], a[12:15], v[52:55]
    buffer_load_dwordx4 a[56:59], v10, s[12:15], s34 offen offset:1024 sc1
    v_mfma_f32_16x16x32_bf16 v[56:59], a[76:79], a[8:11], v[56:59]
    ds_read_b128 a[68:71], v6 offset:25600
    v_mfma_f32_16x16x32_bf16 v[60:63], a[76:79], a[12:15], v[60:63]
    s_waitcnt lgkmcnt(7)
    v_mfma_f32_16x16x32_bf16 v[64:67], a[80:83], a[8:11], v[64:67]
    ds_read_b128 a[72:75], v9 offset:26624
    v_mfma_f32_16x16x32_bf16 v[68:71], a[80:83], a[12:15], v[68:71]
    buffer_load_dwordx4 a[60:63], v11, s[12:15], s34 offen offset:1024 sc1
    v_mfma_f32_16x16x32_bf16 v[72:75], a[84:87], a[8:11], v[72:75]
    ds_read_b128 a[76:79], v9 offset:27648
    v_mfma_f32_16x16x32_bf16 v[76:79], a[84:87], a[12:15], v[76:79]
    s_waitcnt vmcnt(28)
    s_barrier
    s_waitcnt lgkmcnt(5)
    v_mfma_f32_16x16x32_bf16 v[80:83], a[88:91], a[8:11], v[80:83]
    ds_read_b128 a[80:83], v4 offset:0
    v_mfma_f32_16x16x32_bf16 v[84:87], a[88:91], a[12:15], v[84:87]
    v_mfma_f32_16x16x32_bf16 v[88:91], a[92:95], a[8:11], v[88:91]
    ds_read_b128 a[84:87], v4 offset:1024
    v_mfma_f32_16x16x32_bf16 v[92:95], a[92:95], a[12:15], v[92:95]
    s_waitcnt lgkmcnt(4)
    v_mfma_f32_16x16x32_bf16 v[96:99], a[64:67], a[8:11], v[96:99]
    ds_read_b128 a[88:91], v4 offset:2048
    v_mfma_f32_16x16x32_bf16 v[100:103], a[64:67], a[12:15], v[100:103]
    v_mfma_f32_16x16x32_bf16 v[104:107], a[68:71], a[8:11], v[104:107]
    ds_read_b128 a[92:95], v4 offset:3072
    v_mfma_f32_16x16x32_bf16 v[108:111], a[68:71], a[12:15], v[108:111]
    s_waitcnt lgkmcnt(4)
    v_mfma_f32_16x16x32_bf16 v[112:115], a[72:75], a[8:11], v[112:115]
    ds_read_b128 a[64:67], v4 offset:4096
    v_mfma_f32_16x16x32_bf16 v[116:119], a[72:75], a[12:15], v[116:119]
    v_mfma_f32_16x16x32_bf16 v[120:123], a[76:79], a[8:11], v[120:123]
    ds_read_b128 a[68:71], v4 offset:5120
    v_mfma_f32_16x16x32_bf16 v[124:127], a[76:79], a[12:15], v[124:127]
    s_waitcnt vmcnt(24)
    s_waitcnt lgkmcnt(4)
    v_mfma_f32_16x16x32_bf16 v[16:19], a[80:83], a[16:19], v[16:19]
    ds_read_b128 a[72:75], v4 offset:6144
    s_add_u32 m0, s44, 86016
    v_mfma_f32_16x16x32_bf16 v[20:23], a[80:83], a[20:23], v[20:23]
    s_add_u32 s46, s45, 3670016
    v_mfma_f32_16x16x32_bf16 v[24:27], a[84:87], a[16:19], v[24:27]
    ds_read_b128 a[76:79], v4 offset:7168
    v_add_f32 v141, v144, v146
    v_mfma_f32_16x16x32_bf16 v[28:31], a[84:87], a[20:23], v[28:31]
    v_add_f32 v142, v145, v147
    s_waitcnt lgkmcnt(4)
    v_mfma_f32_16x16x32_bf16 v[32:35], a[88:91], a[16:19], v[32:35]
    ds_read_b128 a[80:83], v4 offset:8192
    v_add_f32 v141, v141, v148
    v_mfma_f32_16x16x32_bf16 v[36:39], a[88:91], a[20:23], v[36:39]
    buffer_load_dwordx4 v2, s[40:43], s46 offen offset:0 sc1 lds
    v_mfma_f32_16x16x32_bf16 v[40:43], a[92:95], a[16:19], v[40:43]
    ds_read_b128 a[84:87], v4 offset:9216
    v_add_f32 v142, v142, v149
    v_mfma_f32_16x16x32_bf16 v[44:47], a[92:95], a[20:23], v[44:47]
    v_add_f32 v141, v141, v150
    s_waitcnt lgkmcnt(4)
    v_mfma_f32_16x16x32_bf16 v[48:51], a[64:67], a[16:19], v[48:51]
    ds_read_b128 a[88:91], v4 offset:10240
    v_add_f32 v142, v142, v151
    v_mfma_f32_16x16x32_bf16 v[52:55], a[64:67], a[20:23], v[52:55]
    buffer_load_dwordx4 v2, s[40:43], s46 offen offset:1024 sc1 lds
    v_mfma_f32_16x16x32_bf16 v[56:59], a[68:71], a[16:19], v[56:59]
    ds_read_b128 a[92:95], v4 offset:11264
    v_add_f32 v141, v141, v152
    v_mfma_f32_16x16x32_bf16 v[60:63], a[68:71], a[20:23], v[60:63]
    v_add_f32 v142, v142, v153
    s_waitcnt lgkmcnt(4)
    v_mfma_f32_16x16x32_bf16 v[64:67], a[72:75], a[16:19], v[64:67]
    buffer_load_dwordx4 v2, s[40:43], s46 offen offset:2048 sc1 lds
    v_mfma_f32_16x16x32_bf16 v[68:71], a[72:75], a[20:23], v[68:71]
    ds_read_b128 a[64:67], v7 offset:12288
    v_add_f32 v141, v141, v154
    v_mfma_f32_16x16x32_bf16 v[72:75], a[76:79], a[16:19], v[72:75]
    ds_read_b128 a[68:71], v7 offset:13312
    v_add_f32 v142, v142, v155
    v_mfma_f32_16x16x32_bf16 v[76:79], a[76:79], a[20:23], v[76:79]
    v_add_f32 v141, v141, v156
    s_waitcnt lgkmcnt(4)
    v_mfma_f32_16x16x32_bf16 v[80:83], a[80:83], a[16:19], v[80:83]
    buffer_load_dwordx4 v2, s[40:43], s46 offen offset:3072 sc1 lds
    v_mfma_f32_16x16x32_bf16 v[84:87], a[80:83], a[20:23], v[84:87]
    ds_read_b128 a[72:75], v4 offset:14336
    s_add_u32 m0, s44, 90112
    v_mfma_f32_16x16x32_bf16 v[88:91], a[84:87], a[16:19], v[88:91]
    s_add_u32 s46, s45, 3674112
    buffer_load_dwordx4 v2, s[40:43], s46 offen offset:0 sc1 lds
    v_mfma_f32_16x16x32_bf16 v[92:95], a[84:87], a[20:23], v[92:95]
    ds_read_b128 a[76:79], v4 offset:15360
    s_waitcnt lgkmcnt(4)
    v_mfma_f32_16x16x32_bf16 v[96:99], a[88:91], a[16:19], v[96:99]
    ds_read_b128 a[80:83], v4 offset:16384
    v_add_f32 v142, v142, v157
    v_mfma_f32_16x16x32_bf16 v[100:103], a[88:91], a[20:23], v[100:103]
    buffer_load_dwordx4 v2, s[40:43], s46 offen offset:1024 sc1 lds
    v_mfma_f32_16x16x32_bf16 v[104:107], a[92:95], a[16:19], v[104:107]
    ds_read_b128 a[84:87], v4 offset:17408
    v_add_f32 v141, v141, v158
    v_mfma_f32_16x16x32_bf16 v[108:111], a[92:95], a[20:23], v[108:111]
    v_add_f32 v142, v142, v159
    s_waitcnt lgkmcnt(4)
    v_mfma_f32_16x16x32_bf16 v[112:115], a[64:67], a[16:19], v[112:115]
    buffer_load_dwordx4 v2, s[40:43], s46 offen offset:2048 sc1 lds
    v_mfma_f32_16x16x32_bf16 v[116:119], a[64:67], a[20:23], v[116:119]
    ds_read_b128 a[88:91], v4 offset:18432
    v_mul_f32 v130, 0x3acccccd, v141
    v_mfma_f32_16x16x32_bf16 v[120:123], a[68:71], a[16:19], v[120:123]
    ds_read_b128 a[92:95], v4 offset:19456
    v_mov_b32 v141, 0
    v_mfma_f32_16x16x32_bf16 v[124:127], a[68:71], a[20:23], v[124:127]
    s_add_u32 s34, s7, 16384
    s_waitcnt lgkmcnt(4)
    v_mfma_f32_16x16x32_bf16 v[16:19], a[72:75], a[24:27], v[16:19]
    buffer_load_dwordx4 a[0:3], v10, s[12:15], s34 offen offset:0 sc1
    v_mfma_f32_16x16x32_bf16 v[20:23], a[72:75], a[28:31], v[20:23]
    v_fma_f32 v143, v144, s6, -v130
    ds_read_b128 a[64:67], v4 offset:20480
    v_mfma_f32_16x16x32_bf16 v[24:27], a[76:79], a[24:27], v[24:27]
    buffer_load_dwordx4 a[4:7], v11, s[12:15], s34 offen offset:0 sc1
    v_mfma_f32_16x16x32_bf16 v[28:31], a[76:79], a[28:31], v[28:31]
    v_fmac_f32 v141, v143, v143
    ds_read_b128 a[68:71], v4 offset:21504
    s_waitcnt lgkmcnt(4)
    v_mfma_f32_16x16x32_bf16 v[32:35], a[80:83], a[24:27], v[32:35]
    v_fma_f32 v143, v146, s6, -v130
    ds_read_b128 a[72:75], v4 offset:22528
    v_mfma_f32_16x16x32_bf16 v[36:39], a[80:83], a[28:31], v[36:39]
    v_fmac_f32 v141, v143, v143
    v_fma_f32 v143, v148, s6, -v130
    v_mfma_f32_16x16x32_bf16 v[40:43], a[84:87], a[24:27], v[40:43]
    buffer_load_dwordx2 a[8:9], v3, s[12:15], s34 offen offset:1024 sc1
    v_mfma_f32_16x16x32_bf16 v[44:47], a[84:87], a[28:31], v[44:47]
    ds_read_b128 a[76:79], v4 offset:23552
    s_waitcnt lgkmcnt(4)
    v_mfma_f32_16x16x32_bf16 v[48:51], a[88:91], a[24:27], v[48:51]
    buffer_load_dwordx2 a[10:11], v3, s[12:15], s34 offen offset:1536 sc1
    v_mfma_f32_16x16x32_bf16 v[52:55], a[88:91], a[28:31], v[52:55]
    v_fmac_f32 v141, v143, v143
    ds_read_b128 a[80:83], v4 offset:24576
    v_mfma_f32_16x16x32_bf16 v[56:59], a[92:95], a[24:27], v[56:59]
    v_fma_f32 v143, v150, s6, -v130
    ds_read_b128 a[84:87], v4 offset:25600
    v_mfma_f32_16x16x32_bf16 v[60:63], a[92:95], a[28:31], v[60:63]
    v_fmac_f32 v141, v143, v143
    s_waitcnt lgkmcnt(4)
    v_mfma_f32_16x16x32_bf16 v[64:67], a[64:67], a[24:27], v[64:67]
    buffer_load_dwordx2 a[12:13], v12, s[12:15], s34 offen offset:1024 sc1
    v_mfma_f32_16x16x32_bf16 v[68:71], a[64:67], a[28:31], v[68:71]
    v_fma_f32 v143, v152, s6, -v130
    ds_read_b128 a[88:91], v7 offset:26624
    v_mfma_f32_16x16x32_bf16 v[72:75], a[68:71], a[24:27], v[72:75]
    v_fmac_f32 v141, v143, v143
    buffer_load_dwordx2 a[14:15], v12, s[12:15], s34 offen offset:1536 sc1
    v_mfma_f32_16x16x32_bf16 v[76:79], a[68:71], a[28:31], v[76:79]
    ds_read_b128 a[92:95], v7 offset:27648
    s_waitcnt vmcnt(30)
    s_barrier
    s_waitcnt lgkmcnt(4)
    v_mfma_f32_16x16x32_bf16 v[80:83], a[72:75], a[24:27], v[80:83]
    v_fma_f32 v143, v154, s6, -v130
    v_fmac_f32 v141, v143, v143
    v_mfma_f32_16x16x32_bf16 v[84:87], a[72:75], a[28:31], v[84:87]
    ds_read_b128 a[64:67], v4 offset:28672
    v_fma_f32 v143, v156, s6, -v130
    v_mfma_f32_16x16x32_bf16 v[88:91], a[76:79], a[24:27], v[88:91]
    ds_read_b128 a[68:71], v4 offset:29696
    v_fmac_f32 v141, v143, v143
    v_mfma_f32_16x16x32_bf16 v[92:95], a[76:79], a[28:31], v[92:95]
    v_fma_f32 v143, v158, s6, -v130
    s_waitcnt lgkmcnt(4)
    v_mfma_f32_16x16x32_bf16 v[96:99], a[80:83], a[24:27], v[96:99]
    ds_read_b128 a[72:75], v4 offset:30720
    v_fmac_f32 v141, v143, v143
    v_mfma_f32_16x16x32_bf16 v[100:103], a[80:83], a[28:31], v[100:103]
    v_fmac_f32 v142, 0x42a00000, v141
    v_mov_b32 v141, 0x3727c5ac
    v_mfma_f32_16x16x32_bf16 v[104:107], a[84:87], a[24:27], v[104:107]
    ds_read_b128 a[76:79], v4 offset:31744
    v_fmac_f32 v141, 0x3acccccd, v142
    v_mfma_f32_16x16x32_bf16 v[108:111], a[84:87], a[28:31], v[108:111]
    s_waitcnt lgkmcnt(4)
    v_mfma_f32_16x16x32_bf16 v[112:115], a[88:91], a[24:27], v[112:115]
    ds_read_b128 a[80:83], v4 offset:32768
    v_mfma_f32_16x16x32_bf16 v[116:119], a[88:91], a[28:31], v[116:119]
    v_rsq_f32 v134, v141
    v_mfma_f32_16x16x32_bf16 v[120:123], a[92:95], a[24:27], v[120:123]
    ds_read_b128 a[84:87], v4 offset:33792
    s_nop 0
    v_mfma_f32_16x16x32_bf16 v[124:127], a[92:95], a[28:31], v[124:127]
    s_waitcnt vmcnt(24)
    s_waitcnt lgkmcnt(4)
    v_mfma_f32_16x16x32_bf16 v[16:19], a[64:67], a[32:35], v[16:19]
    ds_read_b128 a[88:91], v4 offset:34816
    v_add_f32 v141, v160, v162
    v_mfma_f32_16x16x32_bf16 v[20:23], a[64:67], a[36:39], v[20:23]
    v_add_f32 v142, v161, v163
    s_add_u32 m0, s44, 114688
    v_mfma_f32_16x16x32_bf16 v[24:27], a[68:71], a[32:35], v[24:27]
    ds_read_b128 a[92:95], v4 offset:35840
    v_add_f32 v141, v141, v164
    v_mfma_f32_16x16x32_bf16 v[28:31], a[68:71], a[36:39], v[28:31]
    s_add_u32 s46, s45, 4128768
    s_waitcnt lgkmcnt(4)
    v_mfma_f32_16x16x32_bf16 v[32:35], a[72:75], a[32:35], v[32:35]
    ds_read_b128 a[64:67], v4 offset:36864
    v_add_f32 v142, v142, v165
    v_mfma_f32_16x16x32_bf16 v[36:39], a[72:75], a[36:39], v[36:39]
    buffer_load_dwordx4 v2, s[40:43], s46 offen offset:0 sc1 lds
    v_mfma_f32_16x16x32_bf16 v[40:43], a[76:79], a[32:35], v[40:43]
    ds_read_b128 a[68:71], v4 offset:37888
    v_add_f32 v141, v141, v166
    v_mfma_f32_16x16x32_bf16 v[44:47], a[76:79], a[36:39], v[44:47]
    v_add_f32 v142, v142, v167
    s_waitcnt lgkmcnt(4)
    v_mfma_f32_16x16x32_bf16 v[48:51], a[80:83], a[32:35], v[48:51]
    ds_read_b128 a[72:75], v4 offset:38912
    v_add_f32 v141, v141, v168
    v_mfma_f32_16x16x32_bf16 v[52:55], a[80:83], a[36:39], v[52:55]
    buffer_load_dwordx4 v2, s[40:43], s46 offen offset:1024 sc1 lds
    v_mfma_f32_16x16x32_bf16 v[56:59], a[84:87], a[32:35], v[56:59]
    ds_read_b128 a[76:79], v4 offset:39936
    v_add_f32 v142, v142, v169
    v_mfma_f32_16x16x32_bf16 v[60:63], a[84:87], a[36:39], v[60:63]
    v_add_f32 v141, v141, v170
    s_waitcnt lgkmcnt(4)
    v_mfma_f32_16x16x32_bf16 v[64:67], a[88:91], a[32:35], v[64:67]
    ds_read_b128 a[80:83], v7 offset:40960
    v_add_f32 v142, v142, v171
    v_mfma_f32_16x16x32_bf16 v[68:71], a[88:91], a[36:39], v[68:71]
    buffer_load_dwordx4 v2, s[40:43], s46 offen offset:2048 sc1 lds
    v_mfma_f32_16x16x32_bf16 v[72:75], a[92:95], a[32:35], v[72:75]
    ds_read_b128 a[84:87], v7 offset:41984
    v_add_f32 v141, v141, v172
    v_mfma_f32_16x16x32_bf16 v[76:79], a[92:95], a[36:39], v[76:79]
    v_add_f32 v142, v142, v173
    s_waitcnt lgkmcnt(4)
    v_mfma_f32_16x16x32_bf16 v[80:83], a[64:67], a[32:35], v[80:83]
    ds_read_b128 a[88:91], v4 offset:43008
    v_add_f32 v141, v141, v174
    v_mfma_f32_16x16x32_bf16 v[84:87], a[64:67], a[36:39], v[84:87]
    buffer_load_dwordx4 v2, s[40:43], s46 offen offset:3072 sc1 lds
    v_mfma_f32_16x16x32_bf16 v[88:91], a[68:71], a[32:35], v[88:91]
    ds_read_b128 a[92:95], v4 offset:44032
    s_add_u32 m0, s44, 118784
    v_mfma_f32_16x16x32_bf16 v[92:95], a[68:71], a[36:39], v[92:95]
    s_add_u32 s46, s45, 4132864
    s_waitcnt lgkmcnt(4)
    v_mfma_f32_16x16x32_bf16 v[96:99], a[72:75], a[32:35], v[96:99]
    buffer_load_dwordx4 v2, s[40:43], s46 offen offset:0 sc1 lds
    v_mfma_f32_16x16x32_bf16 v[100:103], a[72:75], a[36:39], v[100:103]
    ds_read_b128 a[64:67], v4 offset:45056
    v_add_f32 v142, v142, v175
    v_mfma_f32_16x16x32_bf16 v[104:107], a[76:79], a[32:35], v[104:107]
    ds_read_b128 a[68:71], v4 offset:46080
    v_mul_f32 v132, 0x3acccccd, v141
    v_mfma_f32_16x16x32_bf16 v[108:111], a[76:79], a[36:39], v[108:111]
    v_mov_b32 v141, 0
    s_waitcnt lgkmcnt(4)
    v_mfma_f32_16x16x32_bf16 v[112:115], a[80:83], a[32:35], v[112:115]
    buffer_load_dwordx4 v2, s[40:43], s46 offen offset:1024 sc1 lds
    v_mfma_f32_16x16x32_bf16 v[116:119], a[80:83], a[36:39], v[116:119]
    ds_read_b128 a[72:75], v4 offset:47104
    v_fma_f32 v143, v160, s6, -v132
    v_mfma_f32_16x16x32_bf16 v[120:123], a[84:87], a[32:35], v[120:123]
    ds_read_b128 a[76:79], v4 offset:48128
    v_fmac_f32 v141, v143, v143
    v_mfma_f32_16x16x32_bf16 v[124:127], a[84:87], a[36:39], v[124:127]
    v_fma_f32 v143, v162, s6, -v132
    s_waitcnt lgkmcnt(4)
    v_mfma_f32_16x16x32_bf16 v[16:19], a[88:91], a[40:43], v[16:19]
    buffer_load_dwordx4 v2, s[40:43], s46 offen offset:2048 sc1 lds
    v_mfma_f32_16x16x32_bf16 v[20:23], a[88:91], a[44:47], v[20:23]
    ds_read_b128 a[80:83], v4 offset:49152
    s_add_u32 s34, s7, 18432
    v_mfma_f32_16x16x32_bf16 v[24:27], a[92:95], a[40:43], v[24:27]
    ds_read_b128 a[84:87], v4 offset:50176
    v_fmac_f32 v141, v143, v143
    v_mfma_f32_16x16x32_bf16 v[28:31], a[92:95], a[44:47], v[28:31]
    v_fma_f32 v143, v164, s6, -v132
    s_waitcnt lgkmcnt(4)
    v_mfma_f32_16x16x32_bf16 v[32:35], a[64:67], a[40:43], v[32:35]
    buffer_load_dwordx4 a[16:19], v10, s[12:15], s34 offen offset:0 sc1
    v_mfma_f32_16x16x32_bf16 v[36:39], a[64:67], a[44:47], v[36:39]
    ds_read_b128 a[88:91], v4 offset:51200
    v_fmac_f32 v141, v143, v143
    v_mfma_f32_16x16x32_bf16 v[40:43], a[68:71], a[40:43], v[40:43]
    buffer_load_dwordx4 a[20:23], v11, s[12:15], s34 offen offset:0 sc1
    v_mfma_f32_16x16x32_bf16 v[44:47], a[68:71], a[44:47], v[44:47]
    ds_read_b128 a[92:95], v4 offset:52224
    s_waitcnt lgkmcnt(4)
    v_mfma_f32_16x16x32_bf16 v[48:51], a[72:75], a[40:43], v[48:51]
    v_fma_f32 v143, v166, s6, -v132
    ds_read_b128 a[64:67], v4 offset:53248
    v_mfma_f32_16x16x32_bf16 v[52:55], a[72:75], a[44:47], v[52:55]
    buffer_load_dwordx4 a[24:27], v10, s[12:15], s34 offen offset:1024 sc1
    v_mfma_f32_16x16x32_bf16 v[56:59], a[76:79], a[40:43], v[56:59]
    v_fmac_f32 v141, v143, v143
    ds_read_b128 a[68:71], v4 offset:54272
    v_mfma_f32_16x16x32_bf16 v[60:63], a[76:79], a[44:47], v[60:63]
    v_fma_f32 v143, v168, s6, -v132
    s_waitcnt lgkmcnt(4)
    v_mfma_f32_16x16x32_bf16 v[64:67], a[80:83], a[40:43], v[64:67]
    v_fmac_f32 v141, v143, v143
    ds_read_b128 a[72:75], v7 offset:55296
    v_mfma_f32_16x16x32_bf16 v[68:71], a[80:83], a[44:47], v[68:71]
    buffer_load_dwordx4 a[28:31], v11, s[12:15], s34 offen offset:1024 sc1
    v_mfma_f32_16x16x32_bf16 v[72:75], a[84:87], a[40:43], v[72:75]
    v_fma_f32 v143, v170, s6, -v132
    ds_read_b128 a[76:79], v7 offset:56320
    v_mfma_f32_16x16x32_bf16 v[76:79], a[84:87], a[44:47], v[76:79]
    s_waitcnt vmcnt(28)
    s_barrier
    s_waitcnt lgkmcnt(4)
    v_mfma_f32_16x16x32_bf16 v[80:83], a[88:91], a[40:43], v[80:83]
    v_fmac_f32 v141, v143, v143
    ds_read_b128 a[80:83], v5 offset:0
    v_mfma_f32_16x16x32_bf16 v[84:87], a[88:91], a[44:47], v[84:87]
    v_fma_f32 v143, v172, s6, -v132
    v_fmac_f32 v141, v143, v143
    v_mfma_f32_16x16x32_bf16 v[88:91], a[92:95], a[40:43], v[88:91]
    ds_read_b128 a[84:87], v5 offset:1024
    v_fma_f32 v143, v174, s6, -v132
    v_mfma_f32_16x16x32_bf16 v[92:95], a[92:95], a[44:47], v[92:95]
    v_fmac_f32 v141, v143, v143
    s_waitcnt lgkmcnt(4)
    v_mfma_f32_16x16x32_bf16 v[96:99], a[64:67], a[40:43], v[96:99]
    ds_read_b128 a[88:91], v5 offset:2048
    v_fmac_f32 v142, 0x42a00000, v141
    v_mfma_f32_16x16x32_bf16 v[100:103], a[64:67], a[44:47], v[100:103]
    v_mov_b32 v141, 0x3727c5ac
    v_fmac_f32 v141, 0x3acccccd, v142
    v_mfma_f32_16x16x32_bf16 v[104:107], a[68:71], a[40:43], v[104:107]
    ds_read_b128 a[92:95], v5 offset:3072
    s_add_u32 s8, s64, 18874368
    v_mfma_f32_16x16x32_bf16 v[108:111], a[68:71], a[44:47], v[108:111]
    s_addc_u32 s9, s65, 0
    s_waitcnt lgkmcnt(4)
    v_mfma_f32_16x16x32_bf16 v[112:115], a[72:75], a[40:43], v[112:115]
    ds_read_b128 a[64:67], v5 offset:4096
    s_mov_b32 s10, 2211840
    v_mfma_f32_16x16x32_bf16 v[116:119], a[72:75], a[44:47], v[116:119]
    s_mov_b32 s11, 0x20000
    s_mul_i32 s63, s3, 14336
    v_mfma_f32_16x16x32_bf16 v[120:123], a[76:79], a[40:43], v[120:123]
    ds_read_b128 a[68:71], v5 offset:5120
    s_and_b32 s62, s2, 1
    v_mfma_f32_16x16x32_bf16 v[124:127], a[76:79], a[44:47], v[124:127]
    s_lshl_b32 s62, s62, 2
    s_lshr_b32 s71, s2, 6
    s_add_u32 s71, s71, s62
    s_mul_i32 s62, s71, 276480
    s_add_u32 s62, s62, s63
    s_mul_i32 s71, s70, 55296
    v_add_u32 v12, s71, v2
    s_mul_i32 s71, s70, -221184
    s_add_u32 s71, s71, 221184
    v_add_u32 v3, s71, v2
    v_add_u32 v13, 55296, v12
    v_add_u32 v14, 110592, v12
    v_add_u32 v15, 165888, v12
    s_mul_i32 s71, s3, 40960
    s_waitcnt vmcnt(24)
    s_waitcnt lgkmcnt(4)
    v_mfma_f32_16x16x32_bf16 v[16:19], a[80:83], a[48:51], v[16:19]
    v_rsq_f32 v136, v141
    s_nop 0
    v_mfma_f32_16x16x32_bf16 v[20:23], a[80:83], a[52:55], v[20:23]
    ds_read_b128 a[72:75], v5 offset:6144
    s_add_u32 s69, s62, 8192
    v_mfma_f32_16x16x32_bf16 v[24:27], a[84:87], a[48:51], v[24:27]
    ds_read_b128 a[76:79], v5 offset:7168
    v_mfma_f32_16x16x32_bf16 v[28:31], a[84:87], a[52:55], v[28:31]
    s_waitcnt lgkmcnt(4)
    v_mfma_f32_16x16x32_bf16 v[32:35], a[88:91], a[48:51], v[32:35]
    ds_read_b128 a[80:83], v5 offset:8192
    ds_read_b128 v[144:147], v128 offset:0
    v_mfma_f32_16x16x32_bf16 v[36:39], a[88:91], a[52:55], v[36:39]
    buffer_load_dwordx4 a[120:123], v12, s[8:11], s69 offen offset:0 sc1
    v_mfma_f32_16x16x32_bf16 v[40:43], a[92:95], a[48:51], v[40:43]
    ds_read_b128 a[84:87], v5 offset:9216
    v_mfma_f32_16x16x32_bf16 v[44:47], a[92:95], a[52:55], v[44:47]
    s_waitcnt lgkmcnt(5)
    v_mfma_f32_16x16x32_bf16 v[48:51], a[64:67], a[48:51], v[48:51]
    ds_read_b128 a[88:91], v5 offset:10240
    ds_read_b128 v[148:151], v128 offset:128
    v_mfma_f32_16x16x32_bf16 v[52:55], a[64:67], a[52:55], v[52:55]
    buffer_load_dwordx4 a[124:127], v13, s[8:11], s69 offen offset:0 sc1
    v_mfma_f32_16x16x32_bf16 v[56:59], a[68:71], a[48:51], v[56:59]
    ds_read_b128 a[92:95], v5 offset:11264
    v_mfma_f32_16x16x32_bf16 v[60:63], a[68:71], a[52:55], v[60:63]
    s_waitcnt lgkmcnt(6)
    v_mfma_f32_16x16x32_bf16 v[64:67], a[72:75], a[48:51], v[64:67]
    ds_read_b128 a[64:67], v8 offset:12288
    ds_read_b128 v[152:155], v128 offset:64
    v_mfma_f32_16x16x32_bf16 v[68:71], a[72:75], a[52:55], v[68:71]
    buffer_load_dwordx4 a[128:131], v14, s[8:11], s69 offen offset:0 sc1
    v_mfma_f32_16x16x32_bf16 v[72:75], a[76:79], a[48:51], v[72:75]
    ds_read_b128 a[68:71], v8 offset:13312
    v_mfma_f32_16x16x32_bf16 v[76:79], a[76:79], a[52:55], v[76:79]
    s_waitcnt lgkmcnt(6)
    v_mfma_f32_16x16x32_bf16 v[80:83], a[80:83], a[48:51], v[80:83]
    ds_read_b128 a[72:75], v5 offset:14336
    ds_read_b128 v[156:159], v128 offset:192
    v_mfma_f32_16x16x32_bf16 v[84:87], a[80:83], a[52:55], v[84:87]
    buffer_load_dwordx4 a[132:135], v15, s[8:11], s69 offen offset:0 sc1
    v_mfma_f32_16x16x32_bf16 v[88:91], a[84:87], a[48:51], v[88:91]
    ds_read_b128 a[76:79], v5 offset:15360
    v_mfma_f32_16x16x32_bf16 v[92:95], a[84:87], a[52:55], v[92:95]
    s_waitcnt lgkmcnt(6)
    v_mfma_f32_16x16x32_bf16 v[96:99], a[88:91], a[48:51], v[96:99]
    ds_read_b128 a[80:83], v5 offset:16384
    ds_read_b128 v[160:163], v128 offset:256
    v_mfma_f32_16x16x32_bf16 v[100:103], a[88:91], a[52:55], v[100:103]
    buffer_load_dwordx4 a[136:139], v3, s[8:11], s69 offen offset:0 sc1
    v_mfma_f32_16x16x32_bf16 v[104:107], a[92:95], a[48:51], v[104:107]
    ds_read_b128 a[84:87], v5 offset:17408
    v_mfma_f32_16x16x32_bf16 v[108:111], a[92:95], a[52:55], v[108:111]
    s_waitcnt lgkmcnt(6)
    v_mfma_f32_16x16x32_bf16 v[112:115], a[64:67], a[48:51], v[112:115]
    ds_read_b128 a[88:91], v5 offset:18432
    ds_read_b128 v[164:167], v128 offset:384
    v_mfma_f32_16x16x32_bf16 v[116:119], a[64:67], a[52:55], v[116:119]
    buffer_load_dwordx4 a[140:143], v12, s[8:11], s69 offen offset:1024 sc1
    v_mfma_f32_16x16x32_bf16 v[120:123], a[68:71], a[48:51], v[120:123]
    ds_read_b128 a[92:95], v5 offset:19456
    v_mfma_f32_16x16x32_bf16 v[124:127], a[68:71], a[52:55], v[124:127]
    s_waitcnt lgkmcnt(6)
    v_mfma_f32_16x16x32_bf16 v[16:19], a[72:75], a[56:59], v[16:19]
    ds_read_b128 a[64:67], v5 offset:20480
    ds_read_b128 v[168:171], v128 offset:320
    v_mfma_f32_16x16x32_bf16 v[20:23], a[72:75], a[60:63], v[20:23]
    buffer_load_dwordx4 a[144:147], v13, s[8:11], s69 offen offset:1024 sc1
    v_mfma_f32_16x16x32_bf16 v[24:27], a[76:79], a[56:59], v[24:27]
    ds_read_b128 a[68:71], v5 offset:21504
    v_mfma_f32_16x16x32_bf16 v[28:31], a[76:79], a[60:63], v[28:31]
    s_waitcnt lgkmcnt(6)
    v_mfma_f32_16x16x32_bf16 v[32:35], a[80:83], a[56:59], v[32:35]
    ds_read_b128 a[72:75], v5 offset:22528
    ds_read_b128 v[172:175], v128 offset:448
    v_mfma_f32_16x16x32_bf16 v[36:39], a[80:83], a[60:63], v[36:39]
    buffer_load_dwordx4 a[148:151], v14, s[8:11], s69 offen offset:1024 sc1
    v_mfma_f32_16x16x32_bf16 v[40:43], a[84:87], a[56:59], v[40:43]
    ds_read_b128 a[76:79], v5 offset:23552
    v_mfma_f32_16x16x32_bf16 v[44:47], a[84:87], a[60:63], v[44:47]
    s_waitcnt lgkmcnt(6)
    v_mfma_f32_16x16x32_bf16 v[48:51], a[88:91], a[56:59], v[48:51]
    ds_read_b128 a[80:83], v5 offset:24576
    ds_read_b128 v[176:179], v128 offset:512
    v_mfma_f32_16x16x32_bf16 v[52:55], a[88:91], a[60:63], v[52:55]
    buffer_load_dwordx4 a[152:155], v15, s[8:11], s69 offen offset:1024 sc1
    v_mfma_f32_16x16x32_bf16 v[56:59], a[92:95], a[56:59], v[56:59]
    ds_read_b128 a[84:87], v5 offset:25600
    v_mfma_f32_16x16x32_bf16 v[60:63], a[92:95], a[60:63], v[60:63]
    s_waitcnt lgkmcnt(6)
    v_mfma_f32_16x16x32_bf16 v[64:67], a[64:67], a[56:59], v[64:67]
    ds_read_b128 a[88:91], v8 offset:26624
    ds_read_b128 v[180:183], v128 offset:640
    v_mfma_f32_16x16x32_bf16 v[68:71], a[64:67], a[60:63], v[68:71]
    buffer_load_dwordx4 a[156:159], v3, s[8:11], s69 offen offset:1024 sc1
    v_mfma_f32_16x16x32_bf16 v[72:75], a[68:71], a[56:59], v[72:75]
    ds_read_b128 a[92:95], v8 offset:27648
    v_mfma_f32_16x16x32_bf16 v[76:79], a[68:71], a[60:63], v[76:79]
    s_waitcnt vmcnt(27)
    s_barrier
    s_waitcnt lgkmcnt(6)
    v_mfma_f32_16x16x32_bf16 v[80:83], a[72:75], a[56:59], v[80:83]
    ds_read_b128 a[64:67], v5 offset:28672
    ds_read_b128 v[184:187], v128 offset:576
    v_mfma_f32_16x16x32_bf16 v[84:87], a[72:75], a[60:63], v[84:87]
    v_mfma_f32_16x16x32_bf16 v[88:91], a[76:79], a[56:59], v[88:91]
    ds_read_b128 a[68:71], v5 offset:29696
    v_mfma_f32_16x16x32_bf16 v[92:95], a[76:79], a[60:63], v[92:95]
    s_waitcnt lgkmcnt(6)
    v_mfma_f32_16x16x32_bf16 v[96:99], a[80:83], a[56:59], v[96:99]
    ds_read_b128 a[72:75], v5 offset:30720
    ds_read_b128 v[188:191], v128 offset:704
    v_mfma_f32_16x16x32_bf16 v[100:103], a[80:83], a[60:63], v[100:103]
    v_mfma_f32_16x16x32_bf16 v[104:107], a[84:87], a[56:59], v[104:107]
    ds_read_b128 a[76:79], v5 offset:31744
    v_mfma_f32_16x16x32_bf16 v[108:111], a[84:87], a[60:63], v[108:111]
    s_waitcnt lgkmcnt(6)
    v_mfma_f32_16x16x32_bf16 v[112:115], a[88:91], a[56:59], v[112:115]
    ds_read_b128 a[80:83], v5 offset:32768
    ds_read_b128 v[192:195], v128 offset:768
    v_mfma_f32_16x16x32_bf16 v[116:119], a[88:91], a[60:63], v[116:119]
    v_mfma_f32_16x16x32_bf16 v[120:123], a[92:95], a[56:59], v[120:123]
    ds_read_b128 a[84:87], v5 offset:33792
    v_mfma_f32_16x16x32_bf16 v[124:127], a[92:95], a[60:63], v[124:127]
    s_waitcnt vmcnt(21)
    s_waitcnt lgkmcnt(6)
    v_mfma_f32_16x16x32_bf16 v[16:19], a[64:67], a[0:3], v[16:19]
    ds_read_b128 a[88:91], v5 offset:34816
    ds_read_b128 v[196:199], v128 offset:896
    v_mfma_f32_16x16x32_bf16 v[20:23], a[64:67], a[4:7], v[20:23]
    buffer_load_dwordx4 a[160:163], v12, s[8:11], s69 offen offset:2048 sc1
    v_mfma_f32_16x16x32_bf16 v[24:27], a[68:71], a[0:3], v[24:27]
    ds_read_b128 a[92:95], v5 offset:35840
    v_lshlrev_b32 v139, 3, v1
    v_mfma_f32_16x16x32_bf16 v[28:31], a[68:71], a[4:7], v[28:31]
    v_add_u32 v140, 57344, v139
    s_waitcnt lgkmcnt(6)
    v_mfma_f32_16x16x32_bf16 v[32:35], a[72:75], a[0:3], v[32:35]
    ds_read_b128 a[64:67], v5 offset:36864
    ds_read_b128 v[200:203], v128 offset:832
    v_mfma_f32_16x16x32_bf16 v[36:39], a[72:75], a[4:7], v[36:39]
    buffer_load_dwordx4 a[164:167], v13, s[8:11], s69 offen offset:2048 sc1
    v_mfma_f32_16x16x32_bf16 v[40:43], a[76:79], a[0:3], v[40:43]
    ds_read_b128 a[68:71], v5 offset:37888
    v_mfma_f32_16x16x32_bf16 v[44:47], a[76:79], a[4:7], v[44:47]
    s_waitcnt lgkmcnt(6)
    v_mfma_f32_16x16x32_bf16 v[48:51], a[80:83], a[0:3], v[48:51]
    ds_read_b128 a[72:75], v5 offset:38912
    ds_read_b128 v[204:207], v128 offset:960
    v_mfma_f32_16x16x32_bf16 v[52:55], a[80:83], a[4:7], v[52:55]
    buffer_load_dwordx4 a[168:171], v14, s[8:11], s69 offen offset:2048 sc1
    v_mfma_f32_16x16x32_bf16 v[56:59], a[84:87], a[0:3], v[56:59]
    ds_read_b128 a[76:79], v5 offset:39936
    v_mfma_f32_16x16x32_bf16 v[60:63], a[84:87], a[4:7], v[60:63]
    s_waitcnt lgkmcnt(6)
    v_mfma_f32_16x16x32_bf16 v[64:67], a[88:91], a[0:3], v[64:67]
    ds_read_b128 a[80:83], v8 offset:40960
    ds_read_b128 v[208:211], v128 offset:1024
    v_mfma_f32_16x16x32_bf16 v[68:71], a[88:91], a[4:7], v[68:71]
    buffer_load_dwordx4 a[172:175], v15, s[8:11], s69 offen offset:2048 sc1
    v_mfma_f32_16x16x32_bf16 v[72:75], a[92:95], a[0:3], v[72:75]
    ds_read_b128 a[84:87], v8 offset:41984
    v_mfma_f32_16x16x32_bf16 v[76:79], a[92:95], a[4:7], v[76:79]
    s_waitcnt lgkmcnt(6)
    v_mfma_f32_16x16x32_bf16 v[80:83], a[64:67], a[0:3], v[80:83]
    ds_read_b128 a[88:91], v5 offset:43008
    ds_read_b128 v[212:215], v128 offset:1152
    v_mfma_f32_16x16x32_bf16 v[84:87], a[64:67], a[4:7], v[84:87]
    buffer_load_dwordx4 a[176:179], v3, s[8:11], s69 offen offset:2048 sc1
    v_mfma_f32_16x16x32_bf16 v[88:91], a[68:71], a[0:3], v[88:91]
    ds_read_b128 a[92:95], v5 offset:44032
    v_mfma_f32_16x16x32_bf16 v[92:95], a[68:71], a[4:7], v[92:95]
    s_waitcnt lgkmcnt(6)
    v_mfma_f32_16x16x32_bf16 v[96:99], a[72:75], a[0:3], v[96:99]
    ds_read_b128 a[64:67], v5 offset:45056
    ds_read_b128 v[216:219], v128 offset:1088
    v_mfma_f32_16x16x32_bf16 v[100:103], a[72:75], a[4:7], v[100:103]
    buffer_load_dwordx4 a[180:183], v12, s[8:11], s69 offen offset:3072 sc1
    v_mfma_f32_16x16x32_bf16 v[104:107], a[76:79], a[0:3], v[104:107]
    ds_read_b128 a[68:71], v5 offset:46080
    v_mfma_f32_16x16x32_bf16 v[108:111], a[76:79], a[4:7], v[108:111]
    s_waitcnt lgkmcnt(6)
    v_mfma_f32_16x16x32_bf16 v[112:115], a[80:83], a[0:3], v[112:115]
    ds_read_b128 a[72:75], v5 offset:47104
    ds_read_b128 v[220:223], v128 offset:1216
    v_mfma_f32_16x16x32_bf16 v[116:119], a[80:83], a[4:7], v[116:119]
    buffer_load_dwordx4 a[184:187], v13, s[8:11], s69 offen offset:3072 sc1
    v_mfma_f32_16x16x32_bf16 v[120:123], a[84:87], a[0:3], v[120:123]
    ds_read_b128 a[76:79], v5 offset:48128
    v_mfma_f32_16x16x32_bf16 v[124:127], a[84:87], a[4:7], v[124:127]
    s_waitcnt lgkmcnt(6)
    v_mfma_f32_16x16x32_bf16 v[16:19], a[88:91], a[8:11], v[16:19]
    ds_read_b128 a[80:83], v5 offset:49152
    ds_read_b128 v[224:227], v128 offset:1280
    v_mfma_f32_16x16x32_bf16 v[20:23], a[88:91], a[12:15], v[20:23]
    buffer_load_dwordx4 a[188:191], v14, s[8:11], s69 offen offset:3072 sc1
    v_mfma_f32_16x16x32_bf16 v[24:27], a[92:95], a[8:11], v[24:27]
    ds_read_b128 a[84:87], v5 offset:50176
    v_mfma_f32_16x16x32_bf16 v[28:31], a[92:95], a[12:15], v[28:31]
    s_waitcnt lgkmcnt(6)
    v_mfma_f32_16x16x32_bf16 v[32:35], a[64:67], a[8:11], v[32:35]
    ds_read_b128 a[88:91], v5 offset:51200
    ds_read_b128 v[228:231], v128 offset:1408
    v_mfma_f32_16x16x32_bf16 v[36:39], a[64:67], a[12:15], v[36:39]
    buffer_load_dwordx4 a[192:195], v15, s[8:11], s69 offen offset:3072 sc1
    v_mfma_f32_16x16x32_bf16 v[40:43], a[68:71], a[8:11], v[40:43]
    ds_read_b128 a[92:95], v5 offset:52224
    v_mfma_f32_16x16x32_bf16 v[44:47], a[68:71], a[12:15], v[44:47]
    s_waitcnt lgkmcnt(6)
    v_mfma_f32_16x16x32_bf16 v[48:51], a[72:75], a[8:11], v[48:51]
    ds_read_b128 a[64:67], v5 offset:53248
    ds_read_b128 v[232:235], v128 offset:1344
    v_mfma_f32_16x16x32_bf16 v[52:55], a[72:75], a[12:15], v[52:55]
    buffer_load_dwordx4 a[196:199], v3, s[8:11], s69 offen offset:3072 sc1
    v_mfma_f32_16x16x32_bf16 v[56:59], a[76:79], a[8:11], v[56:59]
    ds_read_b128 a[68:71], v5 offset:54272
    v_mfma_f32_16x16x32_bf16 v[60:63], a[76:79], a[12:15], v[60:63]
    s_waitcnt lgkmcnt(6)
    v_mfma_f32_16x16x32_bf16 v[64:67], a[80:83], a[8:11], v[64:67]
    ds_read_b128 a[72:75], v8 offset:55296
    ds_read_b128 v[236:239], v128 offset:1472
    v_mfma_f32_16x16x32_bf16 v[68:71], a[80:83], a[12:15], v[68:71]
    v_mfma_f32_16x16x32_bf16 v[72:75], a[84:87], a[8:11], v[72:75]
    ds_read_b128 a[76:79], v8 offset:56320
    v_mfma_f32_16x16x32_bf16 v[76:79], a[84:87], a[12:15], v[76:79]
    s_waitcnt vmcnt(24)
    s_barrier
    s_waitcnt lgkmcnt(6)
    v_mfma_f32_16x16x32_bf16 v[80:83], a[88:91], a[8:11], v[80:83]
    ds_read_b128 a[80:83], v6 offset:0
    ds_read_b128 v[240:243], v129 offset:1536
    v_mfma_f32_16x16x32_bf16 v[84:87], a[88:91], a[12:15], v[84:87]
    v_mfma_f32_16x16x32_bf16 v[88:91], a[92:95], a[8:11], v[88:91]
    ds_read_b128 a[84:87], v6 offset:1024
    v_mfma_f32_16x16x32_bf16 v[92:95], a[92:95], a[12:15], v[92:95]
    s_waitcnt lgkmcnt(6)
    v_mfma_f32_16x16x32_bf16 v[96:99], a[64:67], a[8:11], v[96:99]
    ds_read_b128 a[88:91], v6 offset:2048
    ds_read_b128 v[244:247], v129 offset:1664
    v_mfma_f32_16x16x32_bf16 v[100:103], a[64:67], a[12:15], v[100:103]
    v_mfma_f32_16x16x32_bf16 v[104:107], a[68:71], a[8:11], v[104:107]
    ds_read_b128 a[92:95], v6 offset:3072
    v_mfma_f32_16x16x32_bf16 v[108:111], a[68:71], a[12:15], v[108:111]
    s_waitcnt lgkmcnt(6)
    v_mfma_f32_16x16x32_bf16 v[112:115], a[72:75], a[8:11], v[112:115]
    ds_read_b128 a[64:67], v6 offset:4096
    ds_read_b128 v[248:251], v129 offset:1600
    v_mfma_f32_16x16x32_bf16 v[116:119], a[72:75], a[12:15], v[116:119]
    v_mfma_f32_16x16x32_bf16 v[120:123], a[76:79], a[8:11], v[120:123]
    ds_read_b128 a[68:71], v6 offset:5120
    v_mfma_f32_16x16x32_bf16 v[124:127], a[76:79], a[12:15], v[124:127]
    s_waitcnt vmcnt(20)
    s_waitcnt lgkmcnt(6)
    v_mfma_f32_16x16x32_bf16 v[16:19], a[80:83], a[16:19], v[16:19]
    ds_read_b128 a[72:75], v6 offset:6144
    ds_read_b128 v[252:255], v129 offset:1728
    v_mfma_f32_16x16x32_bf16 v[20:23], a[80:83], a[20:23], v[20:23]
    s_add_u32 s69, s62, 12288
    s_cmp_lt_u32 s3, 3
    v_mfma_f32_16x16x32_bf16 v[24:27], a[84:87], a[16:19], v[24:27]
    ds_read_b128 a[76:79], v6 offset:7168
    s_cselect_b32 s69, s69, 0x70000000
    v_mfma_f32_16x16x32_bf16 v[28:31], a[84:87], a[20:23], v[28:31]
    s_waitcnt lgkmcnt(6)
    v_mfma_f32_16x16x32_bf16 v[32:35], a[88:91], a[16:19], v[32:35]
    ds_read_b128 a[80:83], v6 offset:8192
    v_mfma_f32_16x16x32_bf16 v[36:39], a[88:91], a[20:23], v[36:39]
    buffer_load_dwordx4 a[200:203], v12, s[8:11], s69 offen offset:0 sc1
    v_mfma_f32_16x16x32_bf16 v[40:43], a[92:95], a[16:19], v[40:43]
    ds_read_b128 a[84:87], v6 offset:9216
    v_mfma_f32_16x16x32_bf16 v[44:47], a[92:95], a[20:23], v[44:47]
    s_waitcnt lgkmcnt(5)
    v_mfma_f32_16x16x32_bf16 v[48:51], a[64:67], a[16:19], v[48:51]
    ds_read_b128 a[88:91], v6 offset:10240
    v_mfma_f32_16x16x32_bf16 v[52:55], a[64:67], a[20:23], v[52:55]
    buffer_load_dwordx4 a[204:207], v13, s[8:11], s69 offen offset:0 sc1
    v_mfma_f32_16x16x32_bf16 v[56:59], a[68:71], a[16:19], v[56:59]
    ds_read_b128 a[92:95], v6 offset:11264
    v_mfma_f32_16x16x32_bf16 v[60:63], a[68:71], a[20:23], v[60:63]
    s_waitcnt lgkmcnt(4)
    v_mfma_f32_16x16x32_bf16 v[64:67], a[72:75], a[16:19], v[64:67]
    buffer_load_dwordx4 a[208:211], v14, s[8:11], s69 offen offset:0 sc1
    v_mfma_f32_16x16x32_bf16 v[68:71], a[72:75], a[20:23], v[68:71]
    ds_read_b128 a[64:67], v9 offset:12288
    v_mfma_f32_16x16x32_bf16 v[72:75], a[76:79], a[16:19], v[72:75]
    ds_read_b128 a[68:71], v9 offset:13312
    v_mfma_f32_16x16x32_bf16 v[76:79], a[76:79], a[20:23], v[76:79]
    s_waitcnt lgkmcnt(4)
    v_mfma_f32_16x16x32_bf16 v[80:83], a[80:83], a[16:19], v[80:83]
    buffer_load_dwordx4 a[212:215], v15, s[8:11], s69 offen offset:0 sc1
    v_mfma_f32_16x16x32_bf16 v[84:87], a[80:83], a[20:23], v[84:87]
    ds_read_b128 a[72:75], v6 offset:14336
    v_mfma_f32_16x16x32_bf16 v[88:91], a[84:87], a[16:19], v[88:91]
    buffer_load_dwordx4 a[216:219], v3, s[8:11], s69 offen offset:0 sc1
    v_mfma_f32_16x16x32_bf16 v[92:95], a[84:87], a[20:23], v[92:95]
    ds_read_b128 a[76:79], v6 offset:15360
    s_waitcnt lgkmcnt(4)
    v_mfma_f32_16x16x32_bf16 v[96:99], a[88:91], a[16:19], v[96:99]
    ds_read_b128 a[80:83], v6 offset:16384
    v_mfma_f32_16x16x32_bf16 v[100:103], a[88:91], a[20:23], v[100:103]
    buffer_load_dwordx4 a[220:223], v12, s[8:11], s69 offen offset:1024 sc1
    v_mfma_f32_16x16x32_bf16 v[104:107], a[92:95], a[16:19], v[104:107]
    ds_read_b128 a[84:87], v6 offset:17408
    v_mfma_f32_16x16x32_bf16 v[108:111], a[92:95], a[20:23], v[108:111]
    s_waitcnt lgkmcnt(4)
    v_mfma_f32_16x16x32_bf16 v[112:115], a[64:67], a[16:19], v[112:115]
    buffer_load_dwordx4 a[224:227], v13, s[8:11], s69 offen offset:1024 sc1
    v_mfma_f32_16x16x32_bf16 v[116:119], a[64:67], a[20:23], v[116:119]
    ds_read_b128 a[88:91], v6 offset:18432
    v_mfma_f32_16x16x32_bf16 v[120:123], a[68:71], a[16:19], v[120:123]
    buffer_load_dwordx4 a[228:231], v14, s[8:11], s69 offen offset:1024 sc1
    v_mfma_f32_16x16x32_bf16 v[124:127], a[68:71], a[20:23], v[124:127]
    ds_read_b128 a[92:95], v6 offset:19456
    s_waitcnt lgkmcnt(4)
    v_mfma_f32_16x16x32_bf16 v[16:19], a[72:75], a[24:27], v[16:19]
    ds_read_b128 a[64:67], v6 offset:20480
    v_mfma_f32_16x16x32_bf16 v[20:23], a[72:75], a[28:31], v[20:23]
    buffer_load_dwordx4 a[232:235], v15, s[8:11], s69 offen offset:1024 sc1
    v_mfma_f32_16x16x32_bf16 v[24:27], a[76:79], a[24:27], v[24:27]
    ds_read_b128 a[68:71], v6 offset:21504
    v_mfma_f32_16x16x32_bf16 v[28:31], a[76:79], a[28:31], v[28:31]
    s_waitcnt lgkmcnt(4)
    v_mfma_f32_16x16x32_bf16 v[32:35], a[80:83], a[24:27], v[32:35]
    buffer_load_dwordx4 a[236:239], v3, s[8:11], s69 offen offset:1024 sc1
    v_mfma_f32_16x16x32_bf16 v[36:39], a[80:83], a[28:31], v[36:39]
    ds_read_b128 a[72:75], v6 offset:22528
    v_mfma_f32_16x16x32_bf16 v[40:43], a[84:87], a[24:27], v[40:43]
    ds_read_b128 a[76:79], v6 offset:23552
    v_mfma_f32_16x16x32_bf16 v[44:47], a[84:87], a[28:31], v[44:47]
    s_waitcnt lgkmcnt(4)
    v_mfma_f32_16x16x32_bf16 v[48:51], a[88:91], a[24:27], v[48:51]
    ds_read_b128 a[80:83], v6 offset:24576
    v_mfma_f32_16x16x32_bf16 v[52:55], a[88:91], a[28:31], v[52:55]
    v_mfma_f32_16x16x32_bf16 v[56:59], a[92:95], a[24:27], v[56:59]
    ds_read_b128 a[84:87], v6 offset:25600
    v_pk_fma_f32 v[16:17], v[130:131], v[144:145], v[16:17] op_sel_hi:[0,1,1] neg_lo:[1,0,0] neg_hi:[1,0,0]
    v_mfma_f32_16x16x32_bf16 v[60:63], a[92:95], a[28:31], v[60:63]
    v_pk_fma_f32 v[18:19], v[130:131], v[146:147], v[18:19] op_sel_hi:[0,1,1] neg_lo:[1,0,0] neg_hi:[1,0,0]
    s_waitcnt lgkmcnt(4)
    v_mfma_f32_16x16x32_bf16 v[64:67], a[64:67], a[24:27], v[64:67]
    ds_read_b128 a[88:91], v9 offset:26624
    v_pk_fma_f32 v[24:25], v[130:131], v[148:149], v[24:25] op_sel_hi:[0,1,1] neg_lo:[1,0,0] neg_hi:[1,0,0]
    v_mfma_f32_16x16x32_bf16 v[68:71], a[64:67], a[28:31], v[68:71]
    v_pk_fma_f32 v[26:27], v[130:131], v[150:151], v[26:27] op_sel_hi:[0,1,1] neg_lo:[1,0,0] neg_hi:[1,0,0]
    v_pk_fma_f32 v[16:17], v[134:135], v[16:17], v[152:153] op_sel_hi:[0,1,1]
    v_mfma_f32_16x16x32_bf16 v[72:75], a[68:71], a[24:27], v[72:75]
    v_pk_fma_f32 v[18:19], v[134:135], v[18:19], v[154:155] op_sel_hi:[0,1,1]
    v_pk_fma_f32 v[24:25], v[134:135], v[24:25], v[156:157] op_sel_hi:[0,1,1]
    v_mfma_f32_16x16x32_bf16 v[76:79], a[68:71], a[28:31], v[76:79]
    v_pk_fma_f32 v[26:27], v[134:135], v[26:27], v[158:159] op_sel_hi:[0,1,1]
    ds_read_b128 a[92:95], v9 offset:27648
    s_waitcnt lgkmcnt(4)
    v_mfma_f32_16x16x32_bf16 v[80:83], a[72:75], a[24:27], v[80:83]
    v_max_f32 v16, 0, v16
    v_max_f32 v17, 0, v17
    v_max_f32 v18, 0, v18
    v_max_f32 v19, 0, v19
    v_mfma_f32_16x16x32_bf16 v[84:87], a[72:75], a[28:31], v[84:87]
    v_pk_mul_f32 v[16:17], v[16:17], v[24:25]
    v_pk_mul_f32 v[18:19], v[18:19], v[26:27]
    v_cvt_pk_bf16_f32 v24, v16, v17
    v_cvt_pk_bf16_f32 v25, v18, v19
    v_mfma_f32_16x16x32_bf16 v[88:91], a[76:79], a[24:27], v[88:91]
    v_pk_fma_f32 v[20:21], v[132:133], v[144:145], v[20:21] op_sel_hi:[0,1,1] neg_lo:[1,0,0] neg_hi:[1,0,0]
    v_pk_fma_f32 v[22:23], v[132:133], v[146:147], v[22:23] op_sel_hi:[0,1,1] neg_lo:[1,0,0] neg_hi:[1,0,0]
    v_pk_fma_f32 v[28:29], v[132:133], v[148:149], v[28:29] op_sel_hi:[0,1,1] neg_lo:[1,0,0] neg_hi:[1,0,0]
    v_pk_fma_f32 v[30:31], v[132:133], v[150:151], v[30:31] op_sel_hi:[0,1,1] neg_lo:[1,0,0] neg_hi:[1,0,0]
    v_pk_fma_f32 v[20:21], v[136:137], v[20:21], v[152:153] op_sel_hi:[0,1,1]
    v_pk_fma_f32 v[22:23], v[136:137], v[22:23], v[154:155] op_sel_hi:[0,1,1]
    v_pk_fma_f32 v[28:29], v[136:137], v[28:29], v[156:157] op_sel_hi:[0,1,1]
    v_pk_fma_f32 v[30:31], v[136:137], v[30:31], v[158:159] op_sel_hi:[0,1,1]
    v_max_f32 v20, 0, v20
    v_max_f32 v21, 0, v21
    v_max_f32 v22, 0, v22
    v_max_f32 v23, 0, v23
    v_pk_mul_f32 v[20:21], v[20:21], v[28:29]
    v_pk_mul_f32 v[22:23], v[22:23], v[30:31]
    v_cvt_pk_bf16_f32 v28, v20, v21
    v_cvt_pk_bf16_f32 v29, v22, v23
    v_mfma_f32_16x16x32_bf16 v[92:95], a[76:79], a[28:31], v[92:95]
    v_pk_fma_f32 v[32:33], v[130:131], v[160:161], v[32:33] op_sel_hi:[0,1,1] neg_lo:[1,0,0] neg_hi:[1,0,0]
    s_waitcnt lgkmcnt(2)
    v_mfma_f32_16x16x32_bf16 v[96:99], a[80:83], a[24:27], v[96:99]
    v_pk_fma_f32 v[34:35], v[130:131], v[162:163], v[34:35] op_sel_hi:[0,1,1] neg_lo:[1,0,0] neg_hi:[1,0,0]
    v_pk_fma_f32 v[40:41], v[130:131], v[164:165], v[40:41] op_sel_hi:[0,1,1] neg_lo:[1,0,0] neg_hi:[1,0,0]
    v_mfma_f32_16x16x32_bf16 v[100:103], a[80:83], a[28:31], v[100:103]
    v_pk_fma_f32 v[42:43], v[130:131], v[166:167], v[42:43] op_sel_hi:[0,1,1] neg_lo:[1,0,0] neg_hi:[1,0,0]
    v_pk_fma_f32 v[32:33], v[134:135], v[32:33], v[168:169] op_sel_hi:[0,1,1]
    v_mfma_f32_16x16x32_bf16 v[104:107], a[84:87], a[24:27], v[104:107]
    v_pk_fma_f32 v[34:35], v[134:135], v[34:35], v[170:171] op_sel_hi:[0,1,1]
    v_pk_fma_f32 v[40:41], v[134:135], v[40:41], v[172:173] op_sel_hi:[0,1,1]
    v_mfma_f32_16x16x32_bf16 v[108:111], a[84:87], a[28:31], v[108:111]
    v_pk_fma_f32 v[42:43], v[134:135], v[42:43], v[174:175] op_sel_hi:[0,1,1]
    s_waitcnt lgkmcnt(0)
    v_mfma_f32_16x16x32_bf16 v[112:115], a[88:91], a[24:27], v[112:115]
    v_max_f32 v32, 0, v32
    v_max_f32 v33, 0, v33
    v_mfma_f32_16x16x32_bf16 v[116:119], a[88:91], a[28:31], v[116:119]
    v_max_f32 v34, 0, v34
    v_max_f32 v35, 0, v35
    v_pk_mul_f32 v[32:33], v[32:33], v[40:41]
    v_pk_mul_f32 v[34:35], v[34:35], v[42:43]
    v_cvt_pk_bf16_f32 v26, v32, v33
    v_mfma_f32_16x16x32_bf16 v[120:123], a[92:95], a[24:27], v[120:123]
    v_cvt_pk_bf16_f32 v27, v34, v35
    buffer_store_dwordx4 v[24:27], v2, s[24:27], s36 offen offset:0 sc1
    v_pk_fma_f32 v[36:37], v[132:133], v[160:161], v[36:37] op_sel_hi:[0,1,1] neg_lo:[1,0,0] neg_hi:[1,0,0]
    v_pk_fma_f32 v[38:39], v[132:133], v[162:163], v[38:39] op_sel_hi:[0,1,1] neg_lo:[1,0,0] neg_hi:[1,0,0]
    v_pk_fma_f32 v[44:45], v[132:133], v[164:165], v[44:45] op_sel_hi:[0,1,1] neg_lo:[1,0,0] neg_hi:[1,0,0]
    v_pk_fma_f32 v[46:47], v[132:133], v[166:167], v[46:47] op_sel_hi:[0,1,1] neg_lo:[1,0,0] neg_hi:[1,0,0]
    v_pk_fma_f32 v[36:37], v[136:137], v[36:37], v[168:169] op_sel_hi:[0,1,1]
    v_pk_fma_f32 v[38:39], v[136:137], v[38:39], v[170:171] op_sel_hi:[0,1,1]
    v_pk_fma_f32 v[44:45], v[136:137], v[44:45], v[172:173] op_sel_hi:[0,1,1]
    v_pk_fma_f32 v[46:47], v[136:137], v[46:47], v[174:175] op_sel_hi:[0,1,1]
    v_max_f32 v36, 0, v36
    v_max_f32 v37, 0, v37
    v_max_f32 v38, 0, v38
    v_max_f32 v39, 0, v39
    v_pk_mul_f32 v[36:37], v[36:37], v[44:45]
    v_pk_mul_f32 v[38:39], v[38:39], v[46:47]
    v_cvt_pk_bf16_f32 v30, v36, v37
    v_cvt_pk_bf16_f32 v31, v38, v39
    buffer_store_dwordx4 v[28:31], v138, s[24:27], s36 offen offset:0 sc1
    v_mfma_f32_16x16x32_bf16 v[124:127], a[92:95], a[28:31], v[124:127]
    s_barrier
    v_pk_fma_f32 v[48:49], v[130:131], v[176:177], v[48:49] op_sel_hi:[0,1,1] neg_lo:[1,0,0] neg_hi:[1,0,0]
    v_pk_fma_f32 v[50:51], v[130:131], v[178:179], v[50:51] op_sel_hi:[0,1,1] neg_lo:[1,0,0] neg_hi:[1,0,0]
    v_pk_fma_f32 v[56:57], v[130:131], v[180:181], v[56:57] op_sel_hi:[0,1,1] neg_lo:[1,0,0] neg_hi:[1,0,0]
    v_pk_fma_f32 v[58:59], v[130:131], v[182:183], v[58:59] op_sel_hi:[0,1,1] neg_lo:[1,0,0] neg_hi:[1,0,0]
    v_pk_fma_f32 v[48:49], v[134:135], v[48:49], v[184:185] op_sel_hi:[0,1,1]
    v_pk_fma_f32 v[50:51], v[134:135], v[50:51], v[186:187] op_sel_hi:[0,1,1]
    v_pk_fma_f32 v[56:57], v[134:135], v[56:57], v[188:189] op_sel_hi:[0,1,1]
    v_pk_fma_f32 v[58:59], v[134:135], v[58:59], v[190:191] op_sel_hi:[0,1,1]
    v_max_f32 v48, 0, v48
    v_max_f32 v49, 0, v49
    v_max_f32 v50, 0, v50
    v_max_f32 v51, 0, v51
    v_pk_mul_f32 v[48:49], v[48:49], v[56:57]
    v_pk_mul_f32 v[50:51], v[50:51], v[58:59]
    v_cvt_pk_bf16_f32 v56, v48, v49
    v_cvt_pk_bf16_f32 v57, v50, v51
    v_pk_fma_f32 v[52:53], v[132:133], v[176:177], v[52:53] op_sel_hi:[0,1,1] neg_lo:[1,0,0] neg_hi:[1,0,0]
    v_pk_fma_f32 v[54:55], v[132:133], v[178:179], v[54:55] op_sel_hi:[0,1,1] neg_lo:[1,0,0] neg_hi:[1,0,0]
    v_pk_fma_f32 v[60:61], v[132:133], v[180:181], v[60:61] op_sel_hi:[0,1,1] neg_lo:[1,0,0] neg_hi:[1,0,0]
    v_pk_fma_f32 v[62:63], v[132:133], v[182:183], v[62:63] op_sel_hi:[0,1,1] neg_lo:[1,0,0] neg_hi:[1,0,0]
    v_pk_fma_f32 v[52:53], v[136:137], v[52:53], v[184:185] op_sel_hi:[0,1,1]
    v_pk_fma_f32 v[54:55], v[136:137], v[54:55], v[186:187] op_sel_hi:[0,1,1]
    v_pk_fma_f32 v[60:61], v[136:137], v[60:61], v[188:189] op_sel_hi:[0,1,1]
    v_pk_fma_f32 v[62:63], v[136:137], v[62:63], v[190:191] op_sel_hi:[0,1,1]
    v_max_f32 v52, 0, v52
    v_max_f32 v53, 0, v53
    v_max_f32 v54, 0, v54
    v_max_f32 v55, 0, v55
    v_pk_mul_f32 v[52:53], v[52:53], v[60:61]
    v_pk_mul_f32 v[54:55], v[54:55], v[62:63]
    v_cvt_pk_bf16_f32 v60, v52, v53
    v_cvt_pk_bf16_f32 v61, v54, v55
    v_pk_fma_f32 v[64:65], v[130:131], v[192:193], v[64:65] op_sel_hi:[0,1,1] neg_lo:[1,0,0] neg_hi:[1,0,0]
    v_pk_fma_f32 v[66:67], v[130:131], v[194:195], v[66:67] op_sel_hi:[0,1,1] neg_lo:[1,0,0] neg_hi:[1,0,0]
    v_pk_fma_f32 v[72:73], v[130:131], v[196:197], v[72:73] op_sel_hi:[0,1,1] neg_lo:[1,0,0] neg_hi:[1,0,0]
    v_pk_fma_f32 v[74:75], v[130:131], v[198:199], v[74:75] op_sel_hi:[0,1,1] neg_lo:[1,0,0] neg_hi:[1,0,0]
    v_pk_fma_f32 v[64:65], v[134:135], v[64:65], v[200:201] op_sel_hi:[0,1,1]
    v_pk_fma_f32 v[66:67], v[134:135], v[66:67], v[202:203] op_sel_hi:[0,1,1]
    v_pk_fma_f32 v[72:73], v[134:135], v[72:73], v[204:205] op_sel_hi:[0,1,1]
    v_pk_fma_f32 v[74:75], v[134:135], v[74:75], v[206:207] op_sel_hi:[0,1,1]
    v_max_f32 v64, 0, v64
    v_max_f32 v65, 0, v65
    v_max_f32 v66, 0, v66
    v_max_f32 v67, 0, v67
    v_pk_mul_f32 v[64:65], v[64:65], v[72:73]
    v_pk_mul_f32 v[66:67], v[66:67], v[74:75]
    v_cvt_pk_bf16_f32 v58, v64, v65
    v_cvt_pk_bf16_f32 v59, v66, v67
    buffer_store_dwordx4 v[56:59], v2, s[24:27], s36 offen offset:1024 sc1
    v_pk_fma_f32 v[68:69], v[132:133], v[192:193], v[68:69] op_sel_hi:[0,1,1] neg_lo:[1,0,0] neg_hi:[1,0,0]
    v_pk_fma_f32 v[70:71], v[132:133], v[194:195], v[70:71] op_sel_hi:[0,1,1] neg_lo:[1,0,0] neg_hi:[1,0,0]
    v_pk_fma_f32 v[76:77], v[132:133], v[196:197], v[76:77] op_sel_hi:[0,1,1] neg_lo:[1,0,0] neg_hi:[1,0,0]
    v_pk_fma_f32 v[78:79], v[132:133], v[198:199], v[78:79] op_sel_hi:[0,1,1] neg_lo:[1,0,0] neg_hi:[1,0,0]
    v_pk_fma_f32 v[68:69], v[136:137], v[68:69], v[200:201] op_sel_hi:[0,1,1]
    v_pk_fma_f32 v[70:71], v[136:137], v[70:71], v[202:203] op_sel_hi:[0,1,1]
    v_pk_fma_f32 v[76:77], v[136:137], v[76:77], v[204:205] op_sel_hi:[0,1,1]
    v_pk_fma_f32 v[78:79], v[136:137], v[78:79], v[206:207] op_sel_hi:[0,1,1]
    v_max_f32 v68, 0, v68
    v_max_f32 v69, 0, v69
    v_max_f32 v70, 0, v70
    v_max_f32 v71, 0, v71
    v_pk_mul_f32 v[68:69], v[68:69], v[76:77]
    v_pk_mul_f32 v[70:71], v[70:71], v[78:79]
    v_cvt_pk_bf16_f32 v62, v68, v69
    v_cvt_pk_bf16_f32 v63, v70, v71
    buffer_store_dwordx4 v[60:63], v138, s[24:27], s36 offen offset:1024 sc1
    v_pk_fma_f32 v[80:81], v[130:131], v[208:209], v[80:81] op_sel_hi:[0,1,1] neg_lo:[1,0,0] neg_hi:[1,0,0]
    v_pk_fma_f32 v[82:83], v[130:131], v[210:211], v[82:83] op_sel_hi:[0,1,1] neg_lo:[1,0,0] neg_hi:[1,0,0]
    v_pk_fma_f32 v[88:89], v[130:131], v[212:213], v[88:89] op_sel_hi:[0,1,1] neg_lo:[1,0,0] neg_hi:[1,0,0]
    v_pk_fma_f32 v[90:91], v[130:131], v[214:215], v[90:91] op_sel_hi:[0,1,1] neg_lo:[1,0,0] neg_hi:[1,0,0]
    v_pk_fma_f32 v[80:81], v[134:135], v[80:81], v[216:217] op_sel_hi:[0,1,1]
    v_pk_fma_f32 v[82:83], v[134:135], v[82:83], v[218:219] op_sel_hi:[0,1,1]
    v_pk_fma_f32 v[88:89], v[134:135], v[88:89], v[220:221] op_sel_hi:[0,1,1]
    v_pk_fma_f32 v[90:91], v[134:135], v[90:91], v[222:223] op_sel_hi:[0,1,1]
    v_max_f32 v80, 0, v80
    v_max_f32 v81, 0, v81
    v_max_f32 v82, 0, v82
    v_max_f32 v83, 0, v83
    v_pk_mul_f32 v[80:81], v[80:81], v[88:89]
    v_pk_mul_f32 v[82:83], v[82:83], v[90:91]
    v_cvt_pk_bf16_f32 v88, v80, v81
    v_cvt_pk_bf16_f32 v89, v82, v83
    v_pk_fma_f32 v[84:85], v[132:133], v[208:209], v[84:85] op_sel_hi:[0,1,1] neg_lo:[1,0,0] neg_hi:[1,0,0]
    v_pk_fma_f32 v[86:87], v[132:133], v[210:211], v[86:87] op_sel_hi:[0,1,1] neg_lo:[1,0,0] neg_hi:[1,0,0]
    v_pk_fma_f32 v[92:93], v[132:133], v[212:213], v[92:93] op_sel_hi:[0,1,1] neg_lo:[1,0,0] neg_hi:[1,0,0]
    v_pk_fma_f32 v[94:95], v[132:133], v[214:215], v[94:95] op_sel_hi:[0,1,1] neg_lo:[1,0,0] neg_hi:[1,0,0]
    v_pk_fma_f32 v[84:85], v[136:137], v[84:85], v[216:217] op_sel_hi:[0,1,1]
    v_pk_fma_f32 v[86:87], v[136:137], v[86:87], v[218:219] op_sel_hi:[0,1,1]
    v_pk_fma_f32 v[92:93], v[136:137], v[92:93], v[220:221] op_sel_hi:[0,1,1]
    v_pk_fma_f32 v[94:95], v[136:137], v[94:95], v[222:223] op_sel_hi:[0,1,1]
    v_max_f32 v84, 0, v84
    v_max_f32 v85, 0, v85
    v_max_f32 v86, 0, v86
    v_max_f32 v87, 0, v87
    v_pk_mul_f32 v[84:85], v[84:85], v[92:93]
    v_pk_mul_f32 v[86:87], v[86:87], v[94:95]
    v_cvt_pk_bf16_f32 v92, v84, v85
    v_cvt_pk_bf16_f32 v93, v86, v87
    v_pk_fma_f32 v[96:97], v[130:131], v[224:225], v[96:97] op_sel_hi:[0,1,1] neg_lo:[1,0,0] neg_hi:[1,0,0]
    v_pk_fma_f32 v[98:99], v[130:131], v[226:227], v[98:99] op_sel_hi:[0,1,1] neg_lo:[1,0,0] neg_hi:[1,0,0]
    v_pk_fma_f32 v[104:105], v[130:131], v[228:229], v[104:105] op_sel_hi:[0,1,1] neg_lo:[1,0,0] neg_hi:[1,0,0]
    v_pk_fma_f32 v[106:107], v[130:131], v[230:231], v[106:107] op_sel_hi:[0,1,1] neg_lo:[1,0,0] neg_hi:[1,0,0]
    v_pk_fma_f32 v[96:97], v[134:135], v[96:97], v[232:233] op_sel_hi:[0,1,1]
    v_pk_fma_f32 v[98:99], v[134:135], v[98:99], v[234:235] op_sel_hi:[0,1,1]
    v_pk_fma_f32 v[104:105], v[134:135], v[104:105], v[236:237] op_sel_hi:[0,1,1]
    v_pk_fma_f32 v[106:107], v[134:135], v[106:107], v[238:239] op_sel_hi:[0,1,1]
    v_max_f32 v96, 0, v96
    v_max_f32 v97, 0, v97
    v_max_f32 v98, 0, v98
    v_max_f32 v99, 0, v99
    v_pk_mul_f32 v[96:97], v[96:97], v[104:105]
    v_pk_mul_f32 v[98:99], v[98:99], v[106:107]
    v_cvt_pk_bf16_f32 v90, v96, v97
    v_cvt_pk_bf16_f32 v91, v98, v99
    buffer_store_dwordx4 v[88:91], v2, s[24:27], s36 offen offset:2048 sc1
    v_pk_fma_f32 v[100:101], v[132:133], v[224:225], v[100:101] op_sel_hi:[0,1,1] neg_lo:[1,0,0] neg_hi:[1,0,0]
    v_pk_fma_f32 v[102:103], v[132:133], v[226:227], v[102:103] op_sel_hi:[0,1,1] neg_lo:[1,0,0] neg_hi:[1,0,0]
    v_pk_fma_f32 v[108:109], v[132:133], v[228:229], v[108:109] op_sel_hi:[0,1,1] neg_lo:[1,0,0] neg_hi:[1,0,0]
    v_pk_fma_f32 v[110:111], v[132:133], v[230:231], v[110:111] op_sel_hi:[0,1,1] neg_lo:[1,0,0] neg_hi:[1,0,0]
    v_pk_fma_f32 v[100:101], v[136:137], v[100:101], v[232:233] op_sel_hi:[0,1,1]
    v_pk_fma_f32 v[102:103], v[136:137], v[102:103], v[234:235] op_sel_hi:[0,1,1]
    v_pk_fma_f32 v[108:109], v[136:137], v[108:109], v[236:237] op_sel_hi:[0,1,1]
    v_pk_fma_f32 v[110:111], v[136:137], v[110:111], v[238:239] op_sel_hi:[0,1,1]
    v_max_f32 v100, 0, v100
    v_max_f32 v101, 0, v101
    v_max_f32 v102, 0, v102
    v_max_f32 v103, 0, v103
    v_pk_mul_f32 v[100:101], v[100:101], v[108:109]
    v_pk_mul_f32 v[102:103], v[102:103], v[110:111]
    v_cvt_pk_bf16_f32 v94, v100, v101
    v_cvt_pk_bf16_f32 v95, v102, v103
    buffer_store_dwordx4 v[92:95], v138, s[24:27], s36 offen offset:2048 sc1
    v_pk_fma_f32 v[112:113], v[130:131], v[240:241], v[112:113] op_sel_hi:[0,1,1] neg_lo:[1,0,0] neg_hi:[1,0,0]
    v_pk_fma_f32 v[114:115], v[130:131], v[242:243], v[114:115] op_sel_hi:[0,1,1] neg_lo:[1,0,0] neg_hi:[1,0,0]
    v_pk_fma_f32 v[120:121], v[130:131], v[244:245], v[120:121] op_sel_hi:[0,1,1] neg_lo:[1,0,0] neg_hi:[1,0,0]
    v_pk_fma_f32 v[122:123], v[130:131], v[246:247], v[122:123] op_sel_hi:[0,1,1] neg_lo:[1,0,0] neg_hi:[1,0,0]
    v_pk_fma_f32 v[112:113], v[134:135], v[112:113], v[248:249] op_sel_hi:[0,1,1]
    v_pk_fma_f32 v[114:115], v[134:135], v[114:115], v[250:251] op_sel_hi:[0,1,1]
    v_pk_fma_f32 v[120:121], v[134:135], v[120:121], v[252:253] op_sel_hi:[0,1,1]
    v_pk_fma_f32 v[122:123], v[134:135], v[122:123], v[254:255] op_sel_hi:[0,1,1]
    v_max_f32 v112, 0, v112
    v_max_f32 v113, 0, v113
    v_max_f32 v114, 0, v114
    v_max_f32 v115, 0, v115
    v_pk_mul_f32 v[112:113], v[112:113], v[120:121]
    v_pk_mul_f32 v[114:115], v[114:115], v[122:123]
    v_cvt_pk_bf16_f32 v120, v112, v113
    v_cvt_pk_bf16_f32 v121, v114, v115
    buffer_store_dwordx2 v[120:121], v139, s[24:27], s38 offen sc1
    v_pk_fma_f32 v[116:117], v[132:133], v[240:241], v[116:117] op_sel_hi:[0,1,1] neg_lo:[1,0,0] neg_hi:[1,0,0]
    v_pk_fma_f32 v[118:119], v[132:133], v[242:243], v[118:119] op_sel_hi:[0,1,1] neg_lo:[1,0,0] neg_hi:[1,0,0]
    v_pk_fma_f32 v[124:125], v[132:133], v[244:245], v[124:125] op_sel_hi:[0,1,1] neg_lo:[1,0,0] neg_hi:[1,0,0]
    v_pk_fma_f32 v[126:127], v[132:133], v[246:247], v[126:127] op_sel_hi:[0,1,1] neg_lo:[1,0,0] neg_hi:[1,0,0]
    v_pk_fma_f32 v[116:117], v[136:137], v[116:117], v[248:249] op_sel_hi:[0,1,1]
    v_pk_fma_f32 v[118:119], v[136:137], v[118:119], v[250:251] op_sel_hi:[0,1,1]
    v_pk_fma_f32 v[124:125], v[136:137], v[124:125], v[252:253] op_sel_hi:[0,1,1]
    v_pk_fma_f32 v[126:127], v[136:137], v[126:127], v[254:255] op_sel_hi:[0,1,1]
    v_max_f32 v116, 0, v116
    v_max_f32 v117, 0, v117
    v_max_f32 v118, 0, v118
    v_max_f32 v119, 0, v119
    v_pk_mul_f32 v[116:117], v[116:117], v[124:125]
    v_pk_mul_f32 v[118:119], v[118:119], v[126:127]
    v_cvt_pk_bf16_f32 v124, v116, v117
    v_cvt_pk_bf16_f32 v125, v118, v119
    buffer_store_dwordx2 v[124:125], v140, s[24:27], s38 offen sc1
    s_add_u32 m0, s71, 0
    s_add_u32 s37, s62, 0
    buffer_load_dwordx4 v12, s[8:11], s37 offen offset:0 sc1 lds
    buffer_load_dwordx4 v12, s[8:11], s37 offen offset:1024 sc1 lds
    buffer_load_dwordx4 v12, s[8:11], s37 offen offset:2048 sc1 lds
    buffer_load_dwordx4 v12, s[8:11], s37 offen offset:3072 sc1 lds
    s_add_u32 m0, s71, 4096
    s_add_u32 s37, s62, 4096
    buffer_load_dwordx4 v12, s[8:11], s37 offen offset:0 sc1 lds
    buffer_load_dwordx4 v12, s[8:11], s37 offen offset:1024 sc1 lds
    buffer_load_dwordx4 v12, s[8:11], s37 offen offset:2048 sc1 lds
    buffer_load_dwordx4 v12, s[8:11], s37 offen offset:3072 sc1 lds
    v_mov_b32 v142, 0
    s_mov_b64 exec, 1
    s_waitcnt vmcnt(8)
    buffer_store_dword v0, v142, s[28:31], s60 offen sc1
    s_mov_b64 exec, -1
    s_add_u32 m0, s71, 8192
    s_add_u32 s37, s62, 0
    buffer_load_dwordx4 v13, s[8:11], s37 offen offset:0 sc1 lds
    buffer_load_dwordx4 v13, s[8:11], s37 offen offset:1024 sc1 lds
    buffer_load_dwordx4 v13, s[8:11], s37 offen offset:2048 sc1 lds
    buffer_load_dwordx4 v13, s[8:11], s37 offen offset:3072 sc1 lds
    s_add_u32 m0, s71, 12288
    s_add_u32 s37, s62, 4096
    buffer_load_dwordx4 v13, s[8:11], s37 offen offset:0 sc1 lds
    buffer_load_dwordx4 v13, s[8:11], s37 offen offset:1024 sc1 lds
    buffer_load_dwordx4 v13, s[8:11], s37 offen offset:2048 sc1 lds
    buffer_load_dwordx4 v13, s[8:11], s37 offen offset:3072 sc1 lds
    s_add_u32 m0, s71, 16384
    s_add_u32 s37, s62, 0
    buffer_load_dwordx4 v14, s[8:11], s37 offen offset:0 sc1 lds
    buffer_load_dwordx4 v14, s[8:11], s37 offen offset:1024 sc1 lds
    buffer_load_dwordx4 v14, s[8:11], s37 offen offset:2048 sc1 lds
    buffer_load_dwordx4 v14, s[8:11], s37 offen offset:3072 sc1 lds
    s_add_u32 m0, s71, 20480
    s_add_u32 s37, s62, 4096
    buffer_load_dwordx4 v14, s[8:11], s37 offen offset:0 sc1 lds
    buffer_load_dwordx4 v14, s[8:11], s37 offen offset:1024 sc1 lds
    buffer_load_dwordx4 v14, s[8:11], s37 offen offset:2048 sc1 lds
    buffer_load_dwordx4 v14, s[8:11], s37 offen offset:3072 sc1 lds
    s_add_u32 m0, s71, 24576
    s_add_u32 s37, s62, 0
    buffer_load_dwordx4 v15, s[8:11], s37 offen offset:0 sc1 lds
    buffer_load_dwordx4 v15, s[8:11], s37 offen offset:1024 sc1 lds
    buffer_load_dwordx4 v15, s[8:11], s37 offen offset:2048 sc1 lds
    buffer_load_dwordx4 v15, s[8:11], s37 offen offset:3072 sc1 lds
    s_add_u32 m0, s71, 28672
    s_add_u32 s37, s62, 4096
    buffer_load_dwordx4 v15, s[8:11], s37 offen offset:0 sc1 lds
    buffer_load_dwordx4 v15, s[8:11], s37 offen offset:1024 sc1 lds
    buffer_load_dwordx4 v15, s[8:11], s37 offen offset:2048 sc1 lds
    buffer_load_dwordx4 v15, s[8:11], s37 offen offset:3072 sc1 lds
    s_add_u32 m0, s71, 32768
    s_add_u32 s37, s62, 0
    buffer_load_dwordx4 v3, s[8:11], s37 offen offset:0 sc1 lds
    buffer_load_dwordx4 v3, s[8:11], s37 offen offset:1024 sc1 lds
    buffer_load_dwordx4 v3, s[8:11], s37 offen offset:2048 sc1 lds
    buffer_load_dwordx4 v3, s[8:11], s37 offen offset:3072 sc1 lds
    s_add_u32 m0, s71, 36864
    s_add_u32 s37, s62, 4096
    buffer_load_dwordx4 v3, s[8:11], s37 offen offset:0 sc1 lds
    buffer_load_dwordx4 v3, s[8:11], s37 offen offset:1024 sc1 lds
    buffer_load_dwordx4 v3, s[8:11], s37 offen offset:2048 sc1 lds
    buffer_load_dwordx4 v3, s[8:11], s37 offen offset:3072 sc1 lds
    s_bfe_u32 s4, s2, 0x20001
    s_lshl_b32 s4, s4, 3
    s_bfe_u32 s37, s2, 0x30003
    s_add_u32 s4, s4, s37
    s_and_b32 s5, s2, 1
    s_lshl_b32 s5, s5, 2
    s_lshr_b32 s37, s2, 6
    s_add_u32 s5, s5, s37
    s_add_u32 s12, s64, 0x600000
    s_addc_u32 s13, s65, 0
    s_mov_b32 s14, 0x700000
    s_mov_b32 s15, 0x20000
    s_mov_b32 s24, s66
    s_mov_b32 s25, s67
    s_mov_b32 s26, 0x280000
    s_mov_b32 s27, 0x20000
    v_lshlrev_b32 v8, 3, v1
    v_add_u32 v4, 0, v2
    v_add_u32 v5, 57344, v2
    v_add_u32 v9, 57344, v8
    v_add_u32 v6, 114688, v2
    v_add_u32 v10, 114688, v8
    v_add_u32 v7, 172032, v2
    v_add_u32 v11, 172032, v8
    s_mul_i32 s37, s4, 229376
    s_add_u32 s63, s63, s37
    s_lshl_b32 s61, s4, 7
    s_add_u32 s61, s61, 139264
    s_add_u32 s51, s51, 7680
    s_add_u32 s55, s55, 7680
    v_and_b32 v128, 15, v1
    v_lshrrev_b32 v129, 4, v1
    v_mul_u32_u24 v130, 1280, v128
    v_lshl_add_u32 v130, v129, 3, v130
    v_lshlrev_b32 v131, 4, v129
    v_add_u32 v132, s71, v2
    s_mul_i32 s37, s3, 5120
    v_add_u32 v134, s37, v2
    v_add_u32 v135, 81920, v134
    v_lshlrev_b32 v141, 2, v1
    buffer_load_dwordx4 v[108:111], v131, s[20:23], s51 offen offset:0 sc1
    buffer_load_dwordx4 v[112:115], v131, s[20:23], s51 offen offset:64 sc1
    buffer_load_dwordx4 v[116:119], v131, s[20:23], s51 offen offset:128 sc1
    buffer_load_dwordx4 v[120:123], v131, s[20:23], s51 offen offset:192 sc1
    buffer_load_dwordx4 v[124:127], v131, s[20:23], s55 offen offset:256 sc1
    s_mov_b32 s37, 0
TC_POLL:
    buffer_load_dword v250, v141, s[28:31], s61 offen sc1
    s_add_u32 s37, s37, 1
    s_waitcnt vmcnt(0)
    v_cmp_eq_u32 vcc, v0, v250
    s_and_b32 s38, vcc_lo, 0xffffffff
    s_cmp_eq_u32 s38, 0xffffffff
    s_cbranch_scc1 TC_GO
    s_sleep 1
    s_cmp_lt_u32 s37, 0x80000
    s_cbranch_scc1 TC_POLL
TC_GO:
    s_or_b32 s37, s2, s3
    s_cmp_eq_u32 s37, 0
    s_cselect_b32 s37, 157696, s37
    s_cselect_b32 s37, s37, 0x70000000
    v_mov_b32 v142, 0
    s_mov_b64 exec, 1
    buffer_store_dword v0, v142, s[28:31], s37 offen
    s_mov_b64 exec, -1
    buffer_load_dwordx4 a[0:3], v4, s[12:15], s63 offen offset:0 sc1
    buffer_load_dwordx4 a[4:7], v5, s[12:15], s63 offen offset:0 sc1
    buffer_load_dwordx4 a[8:11], v6, s[12:15], s63 offen offset:0 sc1
    buffer_load_dwordx4 a[12:15], v7, s[12:15], s63 offen offset:0 sc1
    buffer_load_dwordx4 a[16:19], v4, s[12:15], s63 offen offset:1024 sc1
    buffer_load_dwordx4 a[20:23], v5, s[12:15], s63 offen offset:1024 sc1
    buffer_load_dwordx4 a[24:27], v6, s[12:15], s63 offen offset:1024 sc1
    buffer_load_dwordx4 a[28:31], v7, s[12:15], s63 offen offset:1024 sc1
    buffer_load_dwordx4 a[32:35], v4, s[12:15], s63 offen offset:2048 sc1
    buffer_load_dwordx4 a[36:39], v5, s[12:15], s63 offen offset:2048 sc1
    buffer_load_dwordx4 a[40:43], v6, s[12:15], s63 offen offset:2048 sc1
    buffer_load_dwordx4 a[44:47], v7, s[12:15], s63 offen offset:2048 sc1
    buffer_load_dwordx2 a[48:49], v8, s[12:15], s63 offen offset:3072 sc1
    buffer_load_dwordx2 a[50:51], v8, s[12:15], s63 offen offset:3584 sc1
    buffer_load_dwordx2 a[52:53], v9, s[12:15], s63 offen offset:3072 sc1
    buffer_load_dwordx2 a[54:55], v9, s[12:15], s63 offen offset:3584 sc1
    buffer_load_dwordx2 a[56:57], v10, s[12:15], s63 offen offset:3072 sc1
    buffer_load_dwordx2 a[58:59], v10, s[12:15], s63 offen offset:3584 sc1
    buffer_load_dwordx2 a[60:61], v11, s[12:15], s63 offen offset:3072 sc1
    buffer_load_dwordx2 a[62:63], v11, s[12:15], s63 offen offset:3584 sc1
    ds_read_b128 a[80:83], v132 offset:0
    ds_read_b128 a[84:87], v132 offset:8192
    ds_read_b128 a[88:91], v132 offset:16384
    ds_read_b128 a[92:95], v132 offset:24576
    ds_read_b128 a[96:99], v132 offset:32768
    s_waitcnt lgkmcnt(0)
    s_waitcnt vmcnt(16)
    v_mfma_f32_16x16x32_bf16 v[16:19], a[80:83], a[0:3], 0
    v_mfma_f32_16x16x32_bf16 v[36:39], a[80:83], a[4:7], 0
    s_add_u32 s63, s63, 4096
    buffer_load_dwordx4 a[64:67], v4, s[12:15], s63 offen offset:0 sc1
    v_mfma_f32_16x16x32_bf16 v[56:59], a[80:83], a[8:11], 0
    v_mfma_f32_16x16x32_bf16 v[76:79], a[80:83], a[12:15], 0
    ds_read_b128 a[100:103], v132 offset:1024
    v_mfma_f32_16x16x32_bf16 v[20:23], a[84:87], a[0:3], 0
    v_mfma_f32_16x16x32_bf16 v[40:43], a[84:87], a[4:7], 0
    buffer_load_dwordx4 a[68:71], v5, s[12:15], s63 offen offset:0 sc1
    v_mfma_f32_16x16x32_bf16 v[60:63], a[84:87], a[8:11], 0
    v_mfma_f32_16x16x32_bf16 v[80:83], a[84:87], a[12:15], 0
    ds_read_b128 a[104:107], v132 offset:9216
    v_mfma_f32_16x16x32_bf16 v[24:27], a[88:91], a[0:3], 0
    v_mfma_f32_16x16x32_bf16 v[44:47], a[88:91], a[4:7], 0
    buffer_load_dwordx4 a[72:75], v6, s[12:15], s63 offen offset:0 sc1
    v_mfma_f32_16x16x32_bf16 v[64:67], a[88:91], a[8:11], 0
    v_mfma_f32_16x16x32_bf16 v[84:87], a[88:91], a[12:15], 0
    ds_read_b128 a[108:111], v132 offset:17408
    v_mfma_f32_16x16x32_bf16 v[28:31], a[92:95], a[0:3], 0
    v_mfma_f32_16x16x32_bf16 v[48:51], a[92:95], a[4:7], 0
    buffer_load_dwordx4 a[76:79], v7, s[12:15], s63 offen offset:0 sc1
    v_mfma_f32_16x16x32_bf16 v[68:71], a[92:95], a[8:11], 0
    v_mfma_f32_16x16x32_bf16 v[88:91], a[92:95], a[12:15], 0
    ds_read_b128 a[112:115], v132 offset:25600
    v_mfma_f32_16x16x32_bf16 v[32:35], a[96:99], a[0:3], 0
    v_mfma_f32_16x16x32_bf16 v[52:55], a[96:99], a[4:7], 0
    v_mfma_f32_16x16x32_bf16 v[72:75], a[96:99], a[8:11], 0
    v_mfma_f32_16x16x32_bf16 v[92:95], a[96:99], a[12:15], 0
    ds_read_b128 a[116:119], v132 offset:33792
    s_waitcnt lgkmcnt(0)
    s_waitcnt vmcnt(16)
    v_mfma_f32_16x16x32_bf16 v[16:19], a[100:103], a[16:19], v[16:19]
    v_mfma_f32_16x16x32_bf16 v[36:39], a[100:103], a[20:23], v[36:39]
    buffer_load_dwordx4 a[0:3], v4, s[12:15], s63 offen offset:1024 sc1
    v_mfma_f32_16x16x32_bf16 v[56:59], a[100:103], a[24:27], v[56:59]
    v_mfma_f32_16x16x32_bf16 v[76:79], a[100:103], a[28:31], v[76:79]
    ds_read_b128 a[80:83], v132 offset:2048
    v_mfma_f32_16x16x32_bf16 v[20:23], a[104:107], a[16:19], v[20:23]
    v_mfma_f32_16x16x32_bf16 v[40:43], a[104:107], a[20:23], v[40:43]
    buffer_load_dwordx4 a[4:7], v5, s[12:15], s63 offen offset:1024 sc1
    v_mfma_f32_16x16x32_bf16 v[60:63], a[104:107], a[24:27], v[60:63]
    v_mfma_f32_16x16x32_bf16 v[80:83], a[104:107], a[28:31], v[80:83]
    ds_read_b128 a[84:87], v132 offset:10240
    v_mfma_f32_16x16x32_bf16 v[24:27], a[108:111], a[16:19], v[24:27]
    v_mfma_f32_16x16x32_bf16 v[44:47], a[108:111], a[20:23], v[44:47]
    buffer_load_dwordx4 a[8:11], v6, s[12:15], s63 offen offset:1024 sc1
    v_mfma_f32_16x16x32_bf16 v[64:67], a[108:111], a[24:27], v[64:67]
    v_mfma_f32_16x16x32_bf16 v[84:87], a[108:111], a[28:31], v[84:87]
    ds_read_b128 a[88:91], v132 offset:18432
    v_mfma_f32_16x16x32_bf16 v[28:31], a[112:115], a[16:19], v[28:31]
    v_mfma_f32_16x16x32_bf16 v[48:51], a[112:115], a[20:23], v[48:51]
    buffer_load_dwordx4 a[12:15], v7, s[12:15], s63 offen offset:1024 sc1
    v_mfma_f32_16x16x32_bf16 v[68:71], a[112:115], a[24:27], v[68:71]
    v_mfma_f32_16x16x32_bf16 v[88:91], a[112:115], a[28:31], v[88:91]
    ds_read_b128 a[92:95], v132 offset:26624
    v_mfma_f32_16x16x32_bf16 v[32:35], a[116:119], a[16:19], v[32:35]
    v_mfma_f32_16x16x32_bf16 v[52:55], a[116:119], a[20:23], v[52:55]
    v_mfma_f32_16x16x32_bf16 v[72:75], a[116:119], a[24:27], v[72:75]
    v_mfma_f32_16x16x32_bf16 v[92:95], a[116:119], a[28:31], v[92:95]
    ds_read_b128 a[96:99], v132 offset:34816
    s_waitcnt lgkmcnt(0)
    s_waitcnt vmcnt(16)
    v_mfma_f32_16x16x32_bf16 v[16:19], a[80:83], a[32:35], v[16:19]
    v_mfma_f32_16x16x32_bf16 v[36:39], a[80:83], a[36:39], v[36:39]
    buffer_load_dwordx4 a[16:19], v4, s[12:15], s63 offen offset:2048 sc1
    v_mfma_f32_16x16x32_bf16 v[56:59], a[80:83], a[40:43], v[56:59]
    v_mfma_f32_16x16x32_bf16 v[76:79], a[80:83], a[44:47], v[76:79]
    ds_read_b128 a[100:103], v132 offset:3072
    v_mfma_f32_16x16x32_bf16 v[20:23], a[84:87], a[32:35], v[20:23]
    v_mfma_f32_16x16x32_bf16 v[40:43], a[84:87], a[36:39], v[40:43]
    buffer_load_dwordx4 a[20:23], v5, s[12:15], s63 offen offset:2048 sc1
    v_mfma_f32_16x16x32_bf16 v[60:63], a[84:87], a[40:43], v[60:63]
    v_mfma_f32_16x16x32_bf16 v[80:83], a[84:87], a[44:47], v[80:83]
    ds_read_b128 a[104:107], v132 offset:11264
    v_mfma_f32_16x16x32_bf16 v[24:27], a[88:91], a[32:35], v[24:27]
    v_mfma_f32_16x16x32_bf16 v[44:47], a[88:91], a[36:39], v[44:47]
    buffer_load_dwordx4 a[24:27], v6, s[12:15], s63 offen offset:2048 sc1
    v_mfma_f32_16x16x32_bf16 v[64:67], a[88:91], a[40:43], v[64:67]
    v_mfma_f32_16x16x32_bf16 v[84:87], a[88:91], a[44:47], v[84:87]
    ds_read_b128 a[108:111], v132 offset:19456
    v_mfma_f32_16x16x32_bf16 v[28:31], a[92:95], a[32:35], v[28:31]
    v_mfma_f32_16x16x32_bf16 v[48:51], a[92:95], a[36:39], v[48:51]
    buffer_load_dwordx4 a[28:31], v7, s[12:15], s63 offen offset:2048 sc1
    v_mfma_f32_16x16x32_bf16 v[68:71], a[92:95], a[40:43], v[68:71]
    v_mfma_f32_16x16x32_bf16 v[88:91], a[92:95], a[44:47], v[88:91]
    ds_read_b128 a[112:115], v132 offset:27648
    v_mfma_f32_16x16x32_bf16 v[32:35], a[96:99], a[32:35], v[32:35]
    v_mfma_f32_16x16x32_bf16 v[52:55], a[96:99], a[36:39], v[52:55]
    v_mfma_f32_16x16x32_bf16 v[72:75], a[96:99], a[40:43], v[72:75]
    v_mfma_f32_16x16x32_bf16 v[92:95], a[96:99], a[44:47], v[92:95]
    ds_read_b128 a[116:119], v132 offset:35840
    s_waitcnt lgkmcnt(0)
    s_waitcnt vmcnt(12)
    v_mfma_f32_16x16x32_bf16 v[16:19], a[100:103], a[48:51], v[16:19]
    v_mfma_f32_16x16x32_bf16 v[36:39], a[100:103], a[52:55], v[36:39]
    buffer_load_dwordx4 a[32:35], v4, s[12:15], s63 offen offset:3072 sc1
    v_mfma_f32_16x16x32_bf16 v[56:59], a[100:103], a[56:59], v[56:59]
    v_mfma_f32_16x16x32_bf16 v[76:79], a[100:103], a[60:63], v[76:79]
    ds_read_b128 a[80:83], v132 offset:4096
    v_mfma_f32_16x16x32_bf16 v[20:23], a[104:107], a[48:51], v[20:23]
    v_mfma_f32_16x16x32_bf16 v[40:43], a[104:107], a[52:55], v[40:43]
    buffer_load_dwordx4 a[36:39], v5, s[12:15], s63 offen offset:3072 sc1
    v_mfma_f32_16x16x32_bf16 v[60:63], a[104:107], a[56:59], v[60:63]
    v_mfma_f32_16x16x32_bf16 v[80:83], a[104:107], a[60:63], v[80:83]
    ds_read_b128 a[84:87], v132 offset:12288
    v_mfma_f32_16x16x32_bf16 v[24:27], a[108:111], a[48:51], v[24:27]
    v_mfma_f32_16x16x32_bf16 v[44:47], a[108:111], a[52:55], v[44:47]
    buffer_load_dwordx4 a[40:43], v6, s[12:15], s63 offen offset:3072 sc1
    v_mfma_f32_16x16x32_bf16 v[64:67], a[108:111], a[56:59], v[64:67]
    v_mfma_f32_16x16x32_bf16 v[84:87], a[108:111], a[60:63], v[84:87]
    ds_read_b128 a[88:91], v132 offset:20480
    v_mfma_f32_16x16x32_bf16 v[28:31], a[112:115], a[48:51], v[28:31]
    v_mfma_f32_16x16x32_bf16 v[48:51], a[112:115], a[52:55], v[48:51]
    buffer_load_dwordx4 a[44:47], v7, s[12:15], s63 offen offset:3072 sc1
    v_mfma_f32_16x16x32_bf16 v[68:71], a[112:115], a[56:59], v[68:71]
    v_mfma_f32_16x16x32_bf16 v[88:91], a[112:115], a[60:63], v[88:91]
    ds_read_b128 a[92:95], v132 offset:28672
    v_mfma_f32_16x16x32_bf16 v[32:35], a[116:119], a[48:51], v[32:35]
    v_mfma_f32_16x16x32_bf16 v[52:55], a[116:119], a[52:55], v[52:55]
    v_mfma_f32_16x16x32_bf16 v[72:75], a[116:119], a[56:59], v[72:75]
    v_mfma_f32_16x16x32_bf16 v[92:95], a[116:119], a[60:63], v[92:95]
    ds_read_b128 a[96:99], v132 offset:36864
    s_waitcnt lgkmcnt(0)
    s_waitcnt vmcnt(12)
    v_mfma_f32_16x16x32_bf16 v[16:19], a[80:83], a[64:67], v[16:19]
    v_mfma_f32_16x16x32_bf16 v[36:39], a[80:83], a[68:71], v[36:39]
    s_add_u32 s63, s63, 4096
    buffer_load_dwordx4 a[48:51], v4, s[12:15], s63 offen offset:0 sc1
    v_mfma_f32_16x16x32_bf16 v[56:59], a[80:83], a[72:75], v[56:59]
    v_mfma_f32_16x16x32_bf16 v[76:79], a[80:83], a[76:79], v[76:79]
    ds_read_b128 a[100:103], v132 offset:5120
    v_mfma_f32_16x16x32_bf16 v[20:23], a[84:87], a[64:67], v[20:23]
    v_mfma_f32_16x16x32_bf16 v[40:43], a[84:87], a[68:71], v[40:43]
    buffer_load_dwordx4 a[52:55], v5, s[12:15], s63 offen offset:0 sc1
    v_mfma_f32_16x16x32_bf16 v[60:63], a[84:87], a[72:75], v[60:63]
    v_mfma_f32_16x16x32_bf16 v[80:83], a[84:87], a[76:79], v[80:83]
    ds_read_b128 a[104:107], v132 offset:13312
    v_mfma_f32_16x16x32_bf16 v[24:27], a[88:91], a[64:67], v[24:27]
    v_mfma_f32_16x16x32_bf16 v[44:47], a[88:91], a[68:71], v[44:47]
    buffer_load_dwordx4 a[56:59], v6, s[12:15], s63 offen offset:0 sc1
    v_mfma_f32_16x16x32_bf16 v[64:67], a[88:91], a[72:75], v[64:67]
    v_mfma_f32_16x16x32_bf16 v[84:87], a[88:91], a[76:79], v[84:87]
    ds_read_b128 a[108:111], v132 offset:21504
    v_mfma_f32_16x16x32_bf16 v[28:31], a[92:95], a[64:67], v[28:31]
    v_mfma_f32_16x16x32_bf16 v[48:51], a[92:95], a[68:71], v[48:51]
    buffer_load_dwordx4 a[60:63], v7, s[12:15], s63 offen offset:0 sc1
    v_mfma_f32_16x16x32_bf16 v[68:71], a[92:95], a[72:75], v[68:71]
    v_mfma_f32_16x16x32_bf16 v[88:91], a[92:95], a[76:79], v[88:91]
    ds_read_b128 a[112:115], v132 offset:29696
    v_mfma_f32_16x16x32_bf16 v[32:35], a[96:99], a[64:67], v[32:35]
    v_mfma_f32_16x16x32_bf16 v[52:55], a[96:99], a[68:71], v[52:55]
    v_mfma_f32_16x16x32_bf16 v[72:75], a[96:99], a[72:75], v[72:75]
    v_mfma_f32_16x16x32_bf16 v[92:95], a[96:99], a[76:79], v[92:95]
    ds_read_b128 a[116:119], v132 offset:37888
    s_waitcnt lgkmcnt(0)
    s_waitcnt vmcnt(12)
    v_mfma_f32_16x16x32_bf16 v[16:19], a[100:103], a[0:3], v[16:19]
    v_mfma_f32_16x16x32_bf16 v[36:39], a[100:103], a[4:7], v[36:39]
    buffer_load_dwordx4 a[64:67], v4, s[12:15], s63 offen offset:1024 sc1
    v_mfma_f32_16x16x32_bf16 v[56:59], a[100:103], a[8:11], v[56:59]
    v_mfma_f32_16x16x32_bf16 v[76:79], a[100:103], a[12:15], v[76:79]
    ds_read_b128 a[80:83], v132 offset:6144
    v_mfma_f32_16x16x32_bf16 v[20:23], a[104:107], a[0:3], v[20:23]
    v_mfma_f32_16x16x32_bf16 v[40:43], a[104:107], a[4:7], v[40:43]
    buffer_load_dwordx4 a[68:71], v5, s[12:15], s63 offen offset:1024 sc1
    v_mfma_f32_16x16x32_bf16 v[60:63], a[104:107], a[8:11], v[60:63]
    v_mfma_f32_16x16x32_bf16 v[80:83], a[104:107], a[12:15], v[80:83]
    ds_read_b128 a[84:87], v132 offset:14336
    v_mfma_f32_16x16x32_bf16 v[24:27], a[108:111], a[0:3], v[24:27]
    v_mfma_f32_16x16x32_bf16 v[44:47], a[108:111], a[4:7], v[44:47]
    buffer_load_dwordx4 a[72:75], v6, s[12:15], s63 offen offset:1024 sc1
    v_mfma_f32_16x16x32_bf16 v[64:67], a[108:111], a[8:11], v[64:67]
    v_mfma_f32_16x16x32_bf16 v[84:87], a[108:111], a[12:15], v[84:87]
    ds_read_b128 a[88:91], v132 offset:22528
    v_mfma_f32_16x16x32_bf16 v[28:31], a[112:115], a[0:3], v[28:31]
    v_mfma_f32_16x16x32_bf16 v[48:51], a[112:115], a[4:7], v[48:51]
    buffer_load_dwordx4 a[76:79], v7, s[12:15], s63 offen offset:1024 sc1
    v_mfma_f32_16x16x32_bf16 v[68:71], a[112:115], a[8:11], v[68:71]
    v_mfma_f32_16x16x32_bf16 v[88:91], a[112:115], a[12:15], v[88:91]
    ds_read_b128 a[92:95], v132 offset:30720
    v_mfma_f32_16x16x32_bf16 v[32:35], a[116:119], a[0:3], v[32:35]
    v_mfma_f32_16x16x32_bf16 v[52:55], a[116:119], a[4:7], v[52:55]
    v_mfma_f32_16x16x32_bf16 v[72:75], a[116:119], a[8:11], v[72:75]
    v_mfma_f32_16x16x32_bf16 v[92:95], a[116:119], a[12:15], v[92:95]
    ds_read_b128 a[96:99], v132 offset:38912
    s_waitcnt lgkmcnt(0)
    s_waitcnt vmcnt(12)
    v_mfma_f32_16x16x32_bf16 v[16:19], a[80:83], a[16:19], v[16:19]
    v_mfma_f32_16x16x32_bf16 v[36:39], a[80:83], a[20:23], v[36:39]
    buffer_load_dwordx2 a[0:1], v8, s[12:15], s63 offen offset:2048 sc1
    buffer_load_dwordx2 a[2:3], v8, s[12:15], s63 offen offset:2560 sc1
    v_mfma_f32_16x16x32_bf16 v[56:59], a[80:83], a[24:27], v[56:59]
    v_mfma_f32_16x16x32_bf16 v[76:79], a[80:83], a[28:31], v[76:79]
    ds_read_b128 a[100:103], v132 offset:7168
    v_mfma_f32_16x16x32_bf16 v[20:23], a[84:87], a[16:19], v[20:23]
    v_mfma_f32_16x16x32_bf16 v[40:43], a[84:87], a[20:23], v[40:43]
    buffer_load_dwordx2 a[4:5], v9, s[12:15], s63 offen offset:2048 sc1
    buffer_load_dwordx2 a[6:7], v9, s[12:15], s63 offen offset:2560 sc1
    v_mfma_f32_16x16x32_bf16 v[60:63], a[84:87], a[24:27], v[60:63]
    v_mfma_f32_16x16x32_bf16 v[80:83], a[84:87], a[28:31], v[80:83]
    ds_read_b128 a[104:107], v132 offset:15360
    v_mfma_f32_16x16x32_bf16 v[24:27], a[88:91], a[16:19], v[24:27]
    v_mfma_f32_16x16x32_bf16 v[44:47], a[88:91], a[20:23], v[44:47]
    buffer_load_dwordx2 a[8:9], v10, s[12:15], s63 offen offset:2048 sc1
    buffer_load_dwordx2 a[10:11], v10, s[12:15], s63 offen offset:2560 sc1
    v_mfma_f32_16x16x32_bf16 v[64:67], a[88:91], a[24:27], v[64:67]
    v_mfma_f32_16x16x32_bf16 v[84:87], a[88:91], a[28:31], v[84:87]
    ds_read_b128 a[108:111], v132 offset:23552
    v_mfma_f32_16x16x32_bf16 v[28:31], a[92:95], a[16:19], v[28:31]
    v_mfma_f32_16x16x32_bf16 v[48:51], a[92:95], a[20:23], v[48:51]
    buffer_load_dwordx2 a[12:13], v11, s[12:15], s63 offen offset:2048 sc1
    buffer_load_dwordx2 a[14:15], v11, s[12:15], s63 offen offset:2560 sc1
    v_mfma_f32_16x16x32_bf16 v[68:71], a[92:95], a[24:27], v[68:71]
    v_mfma_f32_16x16x32_bf16 v[88:91], a[92:95], a[28:31], v[88:91]
    ds_read_b128 a[112:115], v132 offset:31744
    v_mfma_f32_16x16x32_bf16 v[32:35], a[96:99], a[16:19], v[32:35]
    v_mfma_f32_16x16x32_bf16 v[52:55], a[96:99], a[20:23], v[52:55]
    v_mfma_f32_16x16x32_bf16 v[72:75], a[96:99], a[24:27], v[72:75]
    v_mfma_f32_16x16x32_bf16 v[92:95], a[96:99], a[28:31], v[92:95]
    ds_read_b128 a[116:119], v132 offset:39936
    s_waitcnt lgkmcnt(0)
    s_waitcnt vmcnt(16)
    v_mfma_f32_16x16x32_bf16 v[16:19], a[100:103], a[32:35], v[16:19]
    v_mfma_f32_16x16x32_bf16 v[36:39], a[100:103], a[36:39], v[36:39]
    buffer_load_dwordx4 a[16:19], v4, s[12:15], s63 offen offset:3072 sc1
    v_mfma_f32_16x16x32_bf16 v[56:59], a[100:103], a[40:43], v[56:59]
    v_mfma_f32_16x16x32_bf16 v[76:79], a[100:103], a[44:47], v[76:79]
    v_mfma_f32_16x16x32_bf16 v[20:23], a[104:107], a[32:35], v[20:23]
    v_mfma_f32_16x16x32_bf16 v[40:43], a[104:107], a[36:39], v[40:43]
    buffer_load_dwordx4 a[20:23], v5, s[12:15], s63 offen offset:3072 sc1
    v_mfma_f32_16x16x32_bf16 v[60:63], a[104:107], a[40:43], v[60:63]
    v_mfma_f32_16x16x32_bf16 v[80:83], a[104:107], a[44:47], v[80:83]
    v_mfma_f32_16x16x32_bf16 v[24:27], a[108:111], a[32:35], v[24:27]
    v_mfma_f32_16x16x32_bf16 v[44:47], a[108:111], a[36:39], v[44:47]
    buffer_load_dwordx4 a[24:27], v6, s[12:15], s63 offen offset:3072 sc1
    v_mfma_f32_16x16x32_bf16 v[64:67], a[108:111], a[40:43], v[64:67]
    v_mfma_f32_16x16x32_bf16 v[84:87], a[108:111], a[44:47], v[84:87]
    v_mfma_f32_16x16x32_bf16 v[28:31], a[112:115], a[32:35], v[28:31]
    v_mfma_f32_16x16x32_bf16 v[48:51], a[112:115], a[36:39], v[48:51]
    buffer_load_dwordx4 a[28:31], v7, s[12:15], s63 offen offset:3072 sc1
    v_mfma_f32_16x16x32_bf16 v[68:71], a[112:115], a[40:43], v[68:71]
    v_mfma_f32_16x16x32_bf16 v[88:91], a[112:115], a[44:47], v[88:91]
    v_mfma_f32_16x16x32_bf16 v[32:35], a[116:119], a[32:35], v[32:35]
    v_mfma_f32_16x16x32_bf16 v[52:55], a[116:119], a[36:39], v[52:55]
    v_mfma_f32_16x16x32_bf16 v[72:75], a[116:119], a[40:43], v[72:75]
    v_mfma_f32_16x16x32_bf16 v[92:95], a[116:119], a[44:47], v[92:95]
    s_waitcnt vmcnt(16)
    v_mfma_f32_16x16x32_bf16 v[16:19], a[120:123], a[48:51], v[16:19]
    v_mfma_f32_16x16x32_bf16 v[36:39], a[120:123], a[52:55], v[36:39]
    s_add_u32 s63, s63, 4096
    s_cmp_lt_u32 s3, 3
    s_cselect_b32 s63, s63, 0x70000000
    buffer_load_dwordx4 a[32:35], v4, s[12:15], s63 offen offset:0 sc1
    v_mfma_f32_16x16x32_bf16 v[56:59], a[120:123], a[56:59], v[56:59]
    v_mfma_f32_16x16x32_bf16 v[76:79], a[120:123], a[60:63], v[76:79]
    v_mfma_f32_16x16x32_bf16 v[20:23], a[124:127], a[48:51], v[20:23]
    v_mfma_f32_16x16x32_bf16 v[40:43], a[124:127], a[52:55], v[40:43]
    buffer_load_dwordx4 a[36:39], v5, s[12:15], s63 offen offset:0 sc1
    v_mfma_f32_16x16x32_bf16 v[60:63], a[124:127], a[56:59], v[60:63]
    v_mfma_f32_16x16x32_bf16 v[80:83], a[124:127], a[60:63], v[80:83]
    v_mfma_f32_16x16x32_bf16 v[24:27], a[128:131], a[48:51], v[24:27]
    v_mfma_f32_16x16x32_bf16 v[44:47], a[128:131], a[52:55], v[44:47]
    buffer_load_dwordx4 a[40:43], v6, s[12:15], s63 offen offset:0 sc1
    v_mfma_f32_16x16x32_bf16 v[64:67], a[128:131], a[56:59], v[64:67]
    v_mfma_f32_16x16x32_bf16 v[84:87], a[128:131], a[60:63], v[84:87]
    v_mfma_f32_16x16x32_bf16 v[28:31], a[132:135], a[48:51], v[28:31]
    v_mfma_f32_16x16x32_bf16 v[48:51], a[132:135], a[52:55], v[48:51]
    buffer_load_dwordx4 a[44:47], v7, s[12:15], s63 offen offset:0 sc1
    v_mfma_f32_16x16x32_bf16 v[68:71], a[132:135], a[56:59], v[68:71]
    v_mfma_f32_16x16x32_bf16 v[88:91], a[132:135], a[60:63], v[88:91]
    v_mfma_f32_16x16x32_bf16 v[32:35], a[136:139], a[48:51], v[32:35]
    v_mfma_f32_16x16x32_bf16 v[52:55], a[136:139], a[52:55], v[52:55]
    v_mfma_f32_16x16x32_bf16 v[72:75], a[136:139], a[56:59], v[72:75]
    v_mfma_f32_16x16x32_bf16 v[92:95], a[136:139], a[60:63], v[92:95]
    s_waitcnt vmcnt(16)
    v_mfma_f32_16x16x32_bf16 v[16:19], a[140:143], a[64:67], v[16:19]
    v_mfma_f32_16x16x32_bf16 v[36:39], a[140:143], a[68:71], v[36:39]
    buffer_load_dwordx4 a[48:51], v4, s[12:15], s63 offen offset:1024 sc1
    v_mfma_f32_16x16x32_bf16 v[56:59], a[140:143], a[72:75], v[56:59]
    v_mfma_f32_16x16x32_bf16 v[76:79], a[140:143], a[76:79], v[76:79]
    v_mfma_f32_16x16x32_bf16 v[20:23], a[144:147], a[64:67], v[20:23]
    v_mfma_f32_16x16x32_bf16 v[40:43], a[144:147], a[68:71], v[40:43]
    buffer_load_dwordx4 a[52:55], v5, s[12:15], s63 offen offset:1024 sc1
    v_mfma_f32_16x16x32_bf16 v[60:63], a[144:147], a[72:75], v[60:63]
    v_mfma_f32_16x16x32_bf16 v[80:83], a[144:147], a[76:79], v[80:83]
    v_mfma_f32_16x16x32_bf16 v[24:27], a[148:151], a[64:67], v[24:27]
    v_mfma_f32_16x16x32_bf16 v[44:47], a[148:151], a[68:71], v[44:47]
    buffer_load_dwordx4 a[56:59], v6, s[12:15], s63 offen offset:1024 sc1
    v_mfma_f32_16x16x32_bf16 v[64:67], a[148:151], a[72:75], v[64:67]
    v_mfma_f32_16x16x32_bf16 v[84:87], a[148:151], a[76:79], v[84:87]
    v_mfma_f32_16x16x32_bf16 v[28:31], a[152:155], a[64:67], v[28:31]
    v_mfma_f32_16x16x32_bf16 v[48:51], a[152:155], a[68:71], v[48:51]
    buffer_load_dwordx4 a[60:63], v7, s[12:15], s63 offen offset:1024 sc1
    v_mfma_f32_16x16x32_bf16 v[68:71], a[152:155], a[72:75], v[68:71]
    v_mfma_f32_16x16x32_bf16 v[88:91], a[152:155], a[76:79], v[88:91]
    v_mfma_f32_16x16x32_bf16 v[32:35], a[156:159], a[64:67], v[32:35]
    v_mfma_f32_16x16x32_bf16 v[52:55], a[156:159], a[68:71], v[52:55]
    v_mfma_f32_16x16x32_bf16 v[72:75], a[156:159], a[72:75], v[72:75]
    v_mfma_f32_16x16x32_bf16 v[92:95], a[156:159], a[76:79], v[92:95]
    s_waitcnt vmcnt(12)
    v_mfma_f32_16x16x32_bf16 v[16:19], a[160:163], a[0:3], v[16:19]
    v_mfma_f32_16x16x32_bf16 v[36:39], a[160:163], a[4:7], v[36:39]
    v_mfma_f32_16x16x32_bf16 v[56:59], a[160:163], a[8:11], v[56:59]
    v_mfma_f32_16x16x32_bf16 v[76:79], a[160:163], a[12:15], v[76:79]
    v_mfma_f32_16x16x32_bf16 v[20:23], a[164:167], a[0:3], v[20:23]
    v_mfma_f32_16x16x32_bf16 v[40:43], a[164:167], a[4:7], v[40:43]
    v_mfma_f32_16x16x32_bf16 v[60:63], a[164:167], a[8:11], v[60:63]
    v_mfma_f32_16x16x32_bf16 v[80:83], a[164:167], a[12:15], v[80:83]
    v_mfma_f32_16x16x32_bf16 v[24:27], a[168:171], a[0:3], v[24:27]
    v_mfma_f32_16x16x32_bf16 v[44:47], a[168:171], a[4:7], v[44:47]
    v_mfma_f32_16x16x32_bf16 v[64:67], a[168:171], a[8:11], v[64:67]
    v_mfma_f32_16x16x32_bf16 v[84:87], a[168:171], a[12:15], v[84:87]
    v_mfma_f32_16x16x32_bf16 v[28:31], a[172:175], a[0:3], v[28:31]
    v_mfma_f32_16x16x32_bf16 v[48:51], a[172:175], a[4:7], v[48:51]
    v_mfma_f32_16x16x32_bf16 v[68:71], a[172:175], a[8:11], v[68:71]
    v_mfma_f32_16x16x32_bf16 v[88:91], a[172:175], a[12:15], v[88:91]
    v_mfma_f32_16x16x32_bf16 v[32:35], a[176:179], a[0:3], v[32:35]
    v_mfma_f32_16x16x32_bf16 v[52:55], a[176:179], a[4:7], v[52:55]
    v_mfma_f32_16x16x32_bf16 v[72:75], a[176:179], a[8:11], v[72:75]
    v_mfma_f32_16x16x32_bf16 v[92:95], a[176:179], a[12:15], v[92:95]
    s_waitcnt vmcnt(8)
    v_mfma_f32_16x16x32_bf16 v[16:19], a[180:183], a[16:19], v[16:19]
    v_mfma_f32_16x16x32_bf16 v[36:39], a[180:183], a[20:23], v[36:39]
    v_mfma_f32_16x16x32_bf16 v[56:59], a[180:183], a[24:27], v[56:59]
    v_mfma_f32_16x16x32_bf16 v[76:79], a[180:183], a[28:31], v[76:79]
    v_mfma_f32_16x16x32_bf16 v[20:23], a[184:187], a[16:19], v[20:23]
    v_mfma_f32_16x16x32_bf16 v[40:43], a[184:187], a[20:23], v[40:43]
    v_mfma_f32_16x16x32_bf16 v[60:63], a[184:187], a[24:27], v[60:63]
    v_mfma_f32_16x16x32_bf16 v[80:83], a[184:187], a[28:31], v[80:83]
    v_mfma_f32_16x16x32_bf16 v[24:27], a[188:191], a[16:19], v[24:27]
    v_mfma_f32_16x16x32_bf16 v[44:47], a[188:191], a[20:23], v[44:47]
    v_mfma_f32_16x16x32_bf16 v[64:67], a[188:191], a[24:27], v[64:67]
    v_mfma_f32_16x16x32_bf16 v[84:87], a[188:191], a[28:31], v[84:87]
    v_mfma_f32_16x16x32_bf16 v[28:31], a[192:195], a[16:19], v[28:31]
    v_mfma_f32_16x16x32_bf16 v[48:51], a[192:195], a[20:23], v[48:51]
    v_mfma_f32_16x16x32_bf16 v[68:71], a[192:195], a[24:27], v[68:71]
    v_mfma_f32_16x16x32_bf16 v[88:91], a[192:195], a[28:31], v[88:91]
    v_mfma_f32_16x16x32_bf16 v[32:35], a[196:199], a[16:19], v[32:35]
    v_mfma_f32_16x16x32_bf16 v[52:55], a[196:199], a[20:23], v[52:55]
    v_mfma_f32_16x16x32_bf16 v[72:75], a[196:199], a[24:27], v[72:75]
    v_mfma_f32_16x16x32_bf16 v[92:95], a[196:199], a[28:31], v[92:95]
    s_waitcnt vmcnt(4)
    v_mfma_f32_16x16x32_bf16 v[16:19], a[200:203], a[32:35], v[16:19]
    v_mfma_f32_16x16x32_bf16 v[36:39], a[200:203], a[36:39], v[36:39]
    v_mfma_f32_16x16x32_bf16 v[56:59], a[200:203], a[40:43], v[56:59]
    v_mfma_f32_16x16x32_bf16 v[76:79], a[200:203], a[44:47], v[76:79]
    v_mfma_f32_16x16x32_bf16 v[20:23], a[204:207], a[32:35], v[20:23]
    v_mfma_f32_16x16x32_bf16 v[40:43], a[204:207], a[36:39], v[40:43]
    v_mfma_f32_16x16x32_bf16 v[60:63], a[204:207], a[40:43], v[60:63]
    v_mfma_f32_16x16x32_bf16 v[80:83], a[204:207], a[44:47], v[80:83]
    v_mfma_f32_16x16x32_bf16 v[24:27], a[208:211], a[32:35], v[24:27]
    v_mfma_f32_16x16x32_bf16 v[44:47], a[208:211], a[36:39], v[44:47]
    v_mfma_f32_16x16x32_bf16 v[64:67], a[208:211], a[40:43], v[64:67]
    v_mfma_f32_16x16x32_bf16 v[84:87], a[208:211], a[44:47], v[84:87]
    v_mfma_f32_16x16x32_bf16 v[28:31], a[212:215], a[32:35], v[28:31]
    v_mfma_f32_16x16x32_bf16 v[48:51], a[212:215], a[36:39], v[48:51]
    v_mfma_f32_16x16x32_bf16 v[68:71], a[212:215], a[40:43], v[68:71]
    v_mfma_f32_16x16x32_bf16 v[88:91], a[212:215], a[44:47], v[88:91]
    v_mfma_f32_16x16x32_bf16 v[32:35], a[216:219], a[32:35], v[32:35]
    v_mfma_f32_16x16x32_bf16 v[52:55], a[216:219], a[36:39], v[52:55]
    v_mfma_f32_16x16x32_bf16 v[72:75], a[216:219], a[40:43], v[72:75]
    v_mfma_f32_16x16x32_bf16 v[92:95], a[216:219], a[44:47], v[92:95]
    s_waitcnt vmcnt(0)
    v_mfma_f32_16x16x32_bf16 v[16:19], a[220:223], a[48:51], v[16:19]
    v_mfma_f32_16x16x32_bf16 v[36:39], a[220:223], a[52:55], v[36:39]
    v_mfma_f32_16x16x32_bf16 v[56:59], a[220:223], a[56:59], v[56:59]
    v_mfma_f32_16x16x32_bf16 v[76:79], a[220:223], a[60:63], v[76:79]
    v_mfma_f32_16x16x32_bf16 v[20:23], a[224:227], a[48:51], v[20:23]
    v_mfma_f32_16x16x32_bf16 v[40:43], a[224:227], a[52:55], v[40:43]
    v_mfma_f32_16x16x32_bf16 v[60:63], a[224:227], a[56:59], v[60:63]
    v_mfma_f32_16x16x32_bf16 v[80:83], a[224:227], a[60:63], v[80:83]
    v_mfma_f32_16x16x32_bf16 v[24:27], a[228:231], a[48:51], v[24:27]
    ds_write_b128 v132, v[16:19] offset:0
    v_mfma_f32_16x16x32_bf16 v[44:47], a[228:231], a[52:55], v[44:47]
    ds_write_b128 v132, v[36:39] offset:5120
    v_mfma_f32_16x16x32_bf16 v[64:67], a[228:231], a[56:59], v[64:67]
    ds_write_b128 v132, v[56:59] offset:10240
    v_mfma_f32_16x16x32_bf16 v[84:87], a[228:231], a[60:63], v[84:87]
    ds_write_b128 v132, v[76:79] offset:15360
    v_mfma_f32_16x16x32_bf16 v[28:31], a[232:235], a[48:51], v[28:31]
    ds_write_b128 v132, v[20:23] offset:1024
    v_mfma_f32_16x16x32_bf16 v[48:51], a[232:235], a[52:55], v[48:51]
    ds_write_b128 v132, v[40:43] offset:6144
    v_mfma_f32_16x16x32_bf16 v[68:71], a[232:235], a[56:59], v[68:71]
    ds_write_b128 v132, v[60:63] offset:11264
    v_mfma_f32_16x16x32_bf16 v[88:91], a[232:235], a[60:63], v[88:91]
    ds_write_b128 v132, v[80:83] offset:16384
    v_mfma_f32_16x16x32_bf16 v[32:35], a[236:239], a[48:51], v[32:35]
    ds_write_b128 v132, v[24:27] offset:2048
    v_mfma_f32_16x16x32_bf16 v[52:55], a[236:239], a[52:55], v[52:55]
    ds_write_b128 v132, v[44:47] offset:7168
    v_mfma_f32_16x16x32_bf16 v[72:75], a[236:239], a[56:59], v[72:75]
    ds_write_b128 v132, v[64:67] offset:12288
    v_mfma_f32_16x16x32_bf16 v[92:95], a[236:239], a[60:63], v[92:95]
    ds_write_b128 v132, v[84:87] offset:17408
    ds_write_b128 v132, v[28:31] offset:3072
    ds_write_b128 v132, v[48:51] offset:8192
    ds_write_b128 v132, v[68:71] offset:13312
    ds_write_b128 v132, v[88:91] offset:18432
    s_nop 3
    ds_write_b128 v132, v[32:35] offset:4096
    ds_write_b128 v132, v[52:55] offset:9216
    ds_write_b128 v132, v[72:75] offset:14336
    ds_write_b128 v132, v[92:95] offset:19456
    s_waitcnt lgkmcnt(0)
    s_barrier
    ds_read_b128 v[16:19], v134 offset:0
    ds_read_b128 v[20:23], v134 offset:1024
    ds_read_b128 v[24:27], v134 offset:2048
    ds_read_b128 v[28:31], v134 offset:3072
    ds_read_b128 v[32:35], v134 offset:4096
    ds_read_b128 v[36:39], v134 offset:40960
    ds_read_b128 v[40:43], v134 offset:41984
    ds_read_b128 v[44:47], v134 offset:43008
    ds_read_b128 v[48:51], v134 offset:44032
    ds_read_b128 v[52:55], v134 offset:45056
    ds_read_b128 v[56:59], v135 offset:0
    ds_read_b128 v[60:63], v135 offset:1024
    ds_read_b128 v[64:67], v135 offset:2048
    ds_read_b128 v[68:71], v135 offset:3072
    ds_read_b128 v[72:75], v135 offset:4096
    ds_read_b128 v[76:79], v135 offset:40960
    ds_read_b128 v[80:83], v135 offset:41984
    ds_read_b128 v[84:87], v135 offset:43008
    ds_read_b128 v[88:91], v135 offset:44032
    ds_read_b128 v[92:95], v135 offset:45056
    v_accvgpr_read_b32 v96, a240
    v_accvgpr_read_b32 v97, a241
    v_accvgpr_read_b32 v98, a242
    v_accvgpr_read_b32 v99, a243
    v_accvgpr_read_b32 v100, a244
    v_accvgpr_read_b32 v101, a245
    v_accvgpr_read_b32 v102, a246
    v_accvgpr_read_b32 v103, a247
    v_accvgpr_read_b32 v104, a248
    v_accvgpr_read_b32 v105, a249
    v_lshlrev_b32 v176, 16, v96
    v_and_b32 v177, 0xffff0000, v96
    v_lshlrev_b32 v178, 16, v97
    v_and_b32 v179, 0xffff0000, v97
    v_lshlrev_b32 v180, 16, v98
    v_and_b32 v181, 0xffff0000, v98
    v_lshlrev_b32 v182, 16, v99
    v_and_b32 v183, 0xffff0000, v99
    v_lshlrev_b32 v184, 16, v100
    v_and_b32 v185, 0xffff0000, v100
    v_lshlrev_b32 v186, 16, v101
    v_and_b32 v187, 0xffff0000, v101
    v_lshlrev_b32 v188, 16, v102
    v_and_b32 v189, 0xffff0000, v102
    v_lshlrev_b32 v190, 16, v103
    v_and_b32 v191, 0xffff0000, v103
    v_lshlrev_b32 v192, 16, v104
    v_and_b32 v193, 0xffff0000, v104
    v_lshlrev_b32 v194, 16, v105
    v_and_b32 v195, 0xffff0000, v105
    s_waitcnt lgkmcnt(10)
    v_pk_add_f32 v[16:17], v[16:17], v[36:37]
    v_pk_add_f32 v[18:19], v[18:19], v[38:39]
    v_pk_add_f32 v[20:21], v[20:21], v[40:41]
    v_pk_add_f32 v[22:23], v[22:23], v[42:43]
    v_pk_add_f32 v[24:25], v[24:25], v[44:45]
    v_pk_add_f32 v[26:27], v[26:27], v[46:47]
    v_pk_add_f32 v[28:29], v[28:29], v[48:49]
    v_pk_add_f32 v[30:31], v[30:31], v[50:51]
    v_pk_add_f32 v[32:33], v[32:33], v[52:53]
    v_pk_add_f32 v[34:35], v[34:35], v[54:55]
    s_waitcnt lgkmcnt(5)
    v_pk_add_f32 v[16:17], v[16:17], v[56:57]
    v_pk_add_f32 v[18:19], v[18:19], v[58:59]
    v_pk_add_f32 v[20:21], v[20:21], v[60:61]
    v_pk_add_f32 v[22:23], v[22:23], v[62:63]
    v_pk_add_f32 v[24:25], v[24:25], v[64:65]
    v_pk_add_f32 v[26:27], v[26:27], v[66:67]
    v_pk_add_f32 v[28:29], v[28:29], v[68:69]
    v_pk_add_f32 v[30:31], v[30:31], v[70:71]
    v_pk_add_f32 v[32:33], v[32:33], v[72:73]
    v_pk_add_f32 v[34:35], v[34:35], v[74:75]
    s_waitcnt lgkmcnt(0)
    v_pk_add_f32 v[16:17], v[16:17], v[76:77]
    v_pk_add_f32 v[18:19], v[18:19], v[78:79]
    v_pk_add_f32 v[20:21], v[20:21], v[80:81]
    v_pk_add_f32 v[22:23], v[22:23], v[82:83]
    v_pk_add_f32 v[24:25], v[24:25], v[84:85]
    v_pk_add_f32 v[26:27], v[26:27], v[86:87]
    v_pk_add_f32 v[28:29], v[28:29], v[88:89]
    v_pk_add_f32 v[30:31], v[30:31], v[90:91]
    v_pk_add_f32 v[32:33], v[32:33], v[92:93]
    v_pk_add_f32 v[34:35], v[34:35], v[94:95]
    v_pk_fma_f32 v[176:177], v[108:109], v[16:17], v[176:177]
    v_pk_fma_f32 v[178:179], v[110:111], v[18:19], v[178:179]
    v_cvt_pk_bf16_f32 v96, v176, v177
    v_cvt_pk_bf16_f32 v97, v178, v179
    buffer_store_dwordx2 v[96:97], v130, s[24:27], s50 offen offset:0
    v_pk_fma_f32 v[180:181], v[112:113], v[20:21], v[180:181]
    v_pk_fma_f32 v[182:183], v[114:115], v[22:23], v[182:183]
    v_cvt_pk_bf16_f32 v98, v180, v181
    v_cvt_pk_bf16_f32 v99, v182, v183
    buffer_store_dwordx2 v[98:99], v130, s[24:27], s50 offen offset:32
    v_pk_fma_f32 v[184:185], v[116:117], v[24:25], v[184:185]
    v_pk_fma_f32 v[186:187], v[118:119], v[26:27], v[186:187]
    v_cvt_pk_bf16_f32 v100, v184, v185
    v_cvt_pk_bf16_f32 v101, v186, v187
    buffer_store_dwordx2 v[100:101], v130, s[24:27], s50 offen offset:64
    v_pk_fma_f32 v[188:189], v[120:121], v[28:29], v[188:189]
    v_pk_fma_f32 v[190:191], v[122:123], v[30:31], v[190:191]
    v_cvt_pk_bf16_f32 v102, v188, v189
    v_cvt_pk_bf16_f32 v103, v190, v191
    buffer_store_dwordx2 v[102:103], v130, s[24:27], s50 offen offset:96
    v_pk_fma_f32 v[192:193], v[124:125], v[32:33], v[192:193]
    v_pk_fma_f32 v[194:195], v[126:127], v[34:35], v[194:195]
    v_cvt_pk_bf16_f32 v104, v192, v193
    v_cvt_pk_bf16_f32 v105, v194, v195
    buffer_store_dwordx2 v[104:105], v130, s[24:27], s54 offen offset:128
    s_endpgm
TG_SLOW:
    v_lshlrev_b32 v240, 2, v1
    s_mov_b32 s43, 746496
    s_mov_b32 s41, 0
TG1_POLL:
    buffer_load_dword v3, v240, s[16:19], s43 offen sc1
    s_add_u32 s41, s41, 1
    s_waitcnt vmcnt(0)
    v_cmp_eq_u32 vcc, v0, v3
    s_and_b32 s42, vcc_lo, 0xffffffff
    s_cmp_eq_u32 s42, 0xffffffff
    s_cbranch_scc1 TG1_GO
    s_sleep 1
    s_cmp_lt_u32 s41, 0x80000
    s_cbranch_scc1 TG1_POLL
TG1_GO:
    s_add_u32 s43, s43, 32
    s_mov_b32 s41, 0
TG3_POLL:
    buffer_load_dword v3, v240, s[16:19], s43 offen sc1
    s_add_u32 s41, s41, 1
    s_waitcnt vmcnt(0)
    v_cmp_eq_u32 vcc, v0, v3
    s_and_b32 s42, vcc_lo, 0xffffffff
    s_cmp_eq_u32 s42, 0xffffffff
    s_cbranch_scc1 TG3_GO
    s_sleep 1
    s_cmp_lt_u32 s41, 0x80000
    s_cbranch_scc1 TG3_POLL
TG3_GO:
    s_branch TG2_GO
K1_SLOW:
    s_mov_b32 s6, 0x70000000
    s_waitcnt vmcnt(0) lgkmcnt(0)
    v_and_b32 v240, 15, v1
    v_lshlrev_b32 v28, 8, v240
    v_lshrrev_b32 v240, 4, v1
    v_lshl_add_u32 v28, v240, 4, v28
    v_lshrrev_b32 v241, 3, v1
    v_and_b32 v242, 7, v1
    v_lshlrev_b32 v240, 1, v240
    v_xor_b32 v242, v242, v240
    v_lshlrev_b32 v29, 8, v241
    v_lshl_add_u32 v29, v242, 4, v29
    s_lshl_b32 s43, s3, 13
    s_add_u32 s43, s43, 0x18000
    v_add_u32 v12, s43, v20
    v_add_u32 v13, s43, v21
    v_add_u32 v14, s43, v22
    v_add_u32 v15, s43, v23
    v_mov_b32 v248, 0xff800000
    v_mov_b32 v249, 0xff800000
    v_mov_b32 v250, 0xff800000
    v_mov_b32 v251, 0xff800000
    s_mov_b32 s41, s44
    s_mov_b32 s40, 0
K1_S1:
    buffer_load_dwordx4 a[0:3], v28, s[28:31], s41 offen offset:0
    buffer_load_dwordx4 a[4:7], v28, s[28:31], s41 offen offset:64
    buffer_load_dwordx4 a[8:11], v28, s[28:31], s41 offen offset:128
    buffer_load_dwordx4 a[12:15], v28, s[28:31], s41 offen offset:192
    s_waitcnt vmcnt(0)
    v_mfma_f32_16x16x32_bf16 v[48:51], a[0:3], a[64:67], 0
    v_mfma_f32_16x16x32_bf16 v[56:59], a[0:3], a[80:83], 0
    v_mfma_f32_16x16x32_bf16 v[64:67], a[0:3], a[96:99], 0
    v_mfma_f32_16x16x32_bf16 v[72:75], a[0:3], a[112:115], 0
    v_mfma_f32_16x16x32_bf16 v[48:51], a[4:7], a[68:71], v[48:51]
    v_mfma_f32_16x16x32_bf16 v[56:59], a[4:7], a[84:87], v[56:59]
    v_mfma_f32_16x16x32_bf16 v[64:67], a[4:7], a[100:103], v[64:67]
    v_mfma_f32_16x16x32_bf16 v[72:75], a[4:7], a[116:119], v[72:75]
    v_mfma_f32_16x16x32_bf16 v[48:51], a[8:11], a[72:75], v[48:51]
    v_mfma_f32_16x16x32_bf16 v[56:59], a[8:11], a[88:91], v[56:59]
    v_mfma_f32_16x16x32_bf16 v[64:67], a[8:11], a[104:107], v[64:67]
    v_mfma_f32_16x16x32_bf16 v[72:75], a[8:11], a[120:123], v[72:75]
    v_mfma_f32_16x16x32_bf16 v[48:51], a[12:15], a[76:79], v[48:51]
    v_mfma_f32_16x16x32_bf16 v[56:59], a[12:15], a[92:95], v[56:59]
    v_mfma_f32_16x16x32_bf16 v[64:67], a[12:15], a[108:111], v[64:67]
    v_mfma_f32_16x16x32_bf16 v[72:75], a[12:15], a[124:127], v[72:75]
    s_nop 7
    v_max3_f32 v248, v248, v48, v49
    v_max3_f32 v248, v248, v50, v51
    v_max3_f32 v249, v249, v56, v57
    v_max3_f32 v249, v249, v58, v59
    v_max3_f32 v250, v250, v64, v65
    v_max3_f32 v250, v250, v66, v67
    v_max3_f32 v251, v251, v72, v73
    v_max3_f32 v251, v251, v74, v75
    s_add_u32 s41, s41, 4096
    s_add_u32 s40, s40, 1
    s_cmp_lt_u32 s40, 32
    s_cbranch_scc1 K1_S1
    v_mov_b32 v244, v248
    v_mov_b32 v245, v249
    v_mov_b32 v246, v250
    v_mov_b32 v247, v251
    s_nop 0
    v_permlane16_swap_b32 v248, v244
    v_permlane16_swap_b32 v249, v245
    v_permlane16_swap_b32 v250, v246
    v_permlane16_swap_b32 v251, v247
    s_nop 0
    v_max_f32 v248, v248, v244
    v_max_f32 v249, v249, v245
    v_max_f32 v250, v250, v246
    v_max_f32 v251, v251, v247
    v_mov_b32 v244, v248
    v_mov_b32 v245, v249
    v_mov_b32 v246, v250
    v_mov_b32 v247, v251
    s_nop 0
    v_permlane32_swap_b32 v248, v244
    v_permlane32_swap_b32 v249, v245
    v_permlane32_swap_b32 v250, v246
    v_permlane32_swap_b32 v251, v247
    s_nop 0
    v_max_f32 v248, v248, v244
    v_max_f32 v249, v249, v245
    v_max_f32 v250, v250, v246
    v_max_f32 v251, v251, v247
    v_sub_f32 v32, 0, v248
    v_sub_f32 v33, 0, v248
    v_sub_f32 v34, 0, v248
    v_sub_f32 v35, 0, v248
    v_sub_f32 v36, 0, v249
    v_sub_f32 v37, 0, v249
    v_sub_f32 v38, 0, v249
    v_sub_f32 v39, 0, v249
    v_sub_f32 v40, 0, v250
    v_sub_f32 v41, 0, v250
    v_sub_f32 v42, 0, v250
    v_sub_f32 v43, 0, v250
    v_sub_f32 v44, 0, v251
    v_sub_f32 v45, 0, v251
    v_sub_f32 v46, 0, v251
    v_sub_f32 v47, 0, v251
    v_mov_b32 v112, 0
    v_mov_b32 v113, 0
    v_mov_b32 v114, 0
    v_mov_b32 v115, 0
    v_mov_b32 v116, 0
    v_mov_b32 v117, 0
    v_mov_b32 v118, 0
    v_mov_b32 v119, 0
    v_mov_b32 v120, 0
    v_mov_b32 v121, 0
    v_mov_b32 v122, 0
    v_mov_b32 v123, 0
    v_mov_b32 v124, 0
    v_mov_b32 v125, 0
    v_mov_b32 v126, 0
    v_mov_b32 v127, 0
    v_mov_b32 v128, 0
    v_mov_b32 v129, 0
    v_mov_b32 v130, 0
    v_mov_b32 v131, 0
    v_mov_b32 v132, 0
    v_mov_b32 v133, 0
    v_mov_b32 v134, 0
    v_mov_b32 v135, 0
    v_mov_b32 v136, 0
    v_mov_b32 v137, 0
    v_mov_b32 v138, 0
    v_mov_b32 v139, 0
    v_mov_b32 v140, 0
    v_mov_b32 v141, 0
    v_mov_b32 v142, 0
    v_mov_b32 v143, 0
    v_mov_b32 v144, 0
    v_mov_b32 v145, 0
    v_mov_b32 v146, 0
    v_mov_b32 v147, 0
    v_mov_b32 v148, 0
    v_mov_b32 v149, 0
    v_mov_b32 v150, 0
    v_mov_b32 v151, 0
    v_mov_b32 v152, 0
    v_mov_b32 v153, 0
    v_mov_b32 v154, 0
    v_mov_b32 v155, 0
    v_mov_b32 v156, 0
    v_mov_b32 v157, 0
    v_mov_b32 v158, 0
    v_mov_b32 v159, 0
    v_mov_b32 v160, 0
    v_mov_b32 v161, 0
    v_mov_b32 v162, 0
    v_mov_b32 v163, 0
    v_mov_b32 v164, 0
    v_mov_b32 v165, 0
    v_mov_b32 v166, 0
    v_mov_b32 v167, 0
    v_mov_b32 v168, 0
    v_mov_b32 v169, 0
    v_mov_b32 v170, 0
    v_mov_b32 v171, 0
    v_mov_b32 v172, 0
    v_mov_b32 v173, 0
    v_mov_b32 v174, 0
    v_mov_b32 v175, 0
    v_mov_b32 v176, 0
    v_mov_b32 v177, 0
    v_mov_b32 v178, 0
    v_mov_b32 v179, 0
    v_mov_b32 v180, 0
    v_mov_b32 v181, 0
    v_mov_b32 v182, 0
    v_mov_b32 v183, 0
    v_mov_b32 v184, 0
    v_mov_b32 v185, 0
    v_mov_b32 v186, 0
    v_mov_b32 v187, 0
    v_mov_b32 v188, 0
    v_mov_b32 v189, 0
    v_mov_b32 v190, 0
    v_mov_b32 v191, 0
    v_mov_b32 v192, 0
    v_mov_b32 v193, 0
    v_mov_b32 v194, 0
    v_mov_b32 v195, 0
    v_mov_b32 v196, 0
    v_mov_b32 v197, 0
    v_mov_b32 v198, 0
    v_mov_b32 v199, 0
    v_mov_b32 v200, 0
    v_mov_b32 v201, 0
    v_mov_b32 v202, 0
    v_mov_b32 v203, 0
    v_mov_b32 v204, 0
    v_mov_b32 v205, 0
    v_mov_b32 v206, 0
    v_mov_b32 v207, 0
    v_mov_b32 v208, 0
    v_mov_b32 v209, 0
    v_mov_b32 v210, 0
    v_mov_b32 v211, 0
    v_mov_b32 v212, 0
    v_mov_b32 v213, 0
    v_mov_b32 v214, 0
    v_mov_b32 v215, 0
    v_mov_b32 v216, 0
    v_mov_b32 v217, 0
    v_mov_b32 v218, 0
    v_mov_b32 v219, 0
    v_mov_b32 v220, 0
    v_mov_b32 v221, 0
    v_mov_b32 v222, 0
    v_mov_b32 v223, 0
    v_mov_b32 v224, 0
    v_mov_b32 v225, 0
    v_mov_b32 v226, 0
    v_mov_b32 v227, 0
    v_mov_b32 v228, 0
    v_mov_b32 v229, 0
    v_mov_b32 v230, 0
    v_mov_b32 v231, 0
    v_mov_b32 v232, 0
    v_mov_b32 v233, 0
    v_mov_b32 v234, 0
    v_mov_b32 v235, 0
    v_mov_b32 v236, 0
    v_mov_b32 v237, 0
    v_mov_b32 v238, 0
    v_mov_b32 v239, 0
    v_accvgpr_write_b32 a128, 0
    v_accvgpr_write_b32 a129, 0
    v_accvgpr_write_b32 a130, 0
    v_accvgpr_write_b32 a131, 0
    v_accvgpr_write_b32 a132, 0
    v_accvgpr_write_b32 a133, 0
    v_accvgpr_write_b32 a134, 0
    v_accvgpr_write_b32 a135, 0
    v_accvgpr_write_b32 a136, 0
    v_accvgpr_write_b32 a137, 0
    v_accvgpr_write_b32 a138, 0
    v_accvgpr_write_b32 a139, 0
    v_accvgpr_write_b32 a140, 0
    v_accvgpr_write_b32 a141, 0
    v_accvgpr_write_b32 a142, 0
    v_accvgpr_write_b32 a143, 0
    s_mov_b32 s41, s44
    s_mov_b32 s40, 0
K1_S2:
    s_add_u32 m0, s43, 0
    s_add_u32 s42, s41, 0
    buffer_load_dwordx4 v29, s[24:27], s42 offen lds
    s_add_u32 m0, s43, 1024
    s_add_u32 s42, s41, 2048
    buffer_load_dwordx4 v29, s[24:27], s42 offen lds
    s_add_u32 m0, s43, 2048
    s_add_u32 s42, s41, 4096
    buffer_load_dwordx4 v29, s[24:27], s42 offen lds
    s_add_u32 m0, s43, 3072
    s_add_u32 s42, s41, 6144
    buffer_load_dwordx4 v29, s[24:27], s42 offen lds
    s_add_u32 m0, s43, 4096
    s_add_u32 s42, s41, 128
    buffer_load_dwordx4 v29, s[24:27], s42 offen lds
    s_add_u32 m0, s43, 5120
    s_add_u32 s42, s41, 2176
    buffer_load_dwordx4 v29, s[24:27], s42 offen lds
    s_add_u32 m0, s43, 6144
    s_add_u32 s42, s41, 4224
    buffer_load_dwordx4 v29, s[24:27], s42 offen lds
    s_add_u32 m0, s43, 7168
    s_add_u32 s42, s41, 6272
    buffer_load_dwordx4 v29, s[24:27], s42 offen lds
    s_add_u32 s42, s41, 4096
    buffer_load_dwordx4 a[0:3], v28, s[28:31], s41 offen offset:0
    buffer_load_dwordx4 a[4:7], v28, s[28:31], s41 offen offset:64
    buffer_load_dwordx4 a[8:11], v28, s[28:31], s41 offen offset:128
    buffer_load_dwordx4 a[12:15], v28, s[28:31], s41 offen offset:192
    buffer_load_dwordx4 a[16:19], v28, s[28:31], s42 offen offset:0
    buffer_load_dwordx4 a[20:23], v28, s[28:31], s42 offen offset:64
    buffer_load_dwordx4 a[24:27], v28, s[28:31], s42 offen offset:128
    buffer_load_dwordx4 a[28:31], v28, s[28:31], s42 offen offset:192
    s_waitcnt vmcnt(0)
    ds_read_b64_tr_b16 a[32:33], v12 offset:0
    ds_read_b64_tr_b16 a[34:35], v12 offset:2048
    ds_read_b64_tr_b16 a[36:37], v13 offset:0
    ds_read_b64_tr_b16 a[38:39], v13 offset:2048
    ds_read_b64_tr_b16 a[40:41], v14 offset:0
    ds_read_b64_tr_b16 a[42:43], v14 offset:2048
    ds_read_b64_tr_b16 a[44:45], v15 offset:0
    ds_read_b64_tr_b16 a[46:47], v15 offset:2048
    ds_read_b64_tr_b16 a[48:49], v12 offset:4096
    ds_read_b64_tr_b16 a[50:51], v12 offset:6144
    ds_read_b64_tr_b16 a[52:53], v13 offset:4096
    ds_read_b64_tr_b16 a[54:55], v13 offset:6144
    ds_read_b64_tr_b16 a[56:57], v14 offset:4096
    ds_read_b64_tr_b16 a[58:59], v14 offset:6144
    ds_read_b64_tr_b16 a[60:61], v15 offset:4096
    ds_read_b64_tr_b16 a[62:63], v15 offset:6144
    v_mfma_f32_16x16x32_bf16 v[48:51], a[0:3], a[64:67], v[32:35]
    v_mfma_f32_16x16x32_bf16 v[56:59], a[0:3], a[80:83], v[36:39]
    v_mfma_f32_16x16x32_bf16 v[64:67], a[0:3], a[96:99], v[40:43]
    v_mfma_f32_16x16x32_bf16 v[72:75], a[0:3], a[112:115], v[44:47]
    v_mfma_f32_16x16x32_bf16 v[52:55], a[16:19], a[64:67], v[32:35]
    v_mfma_f32_16x16x32_bf16 v[60:63], a[16:19], a[80:83], v[36:39]
    v_mfma_f32_16x16x32_bf16 v[68:71], a[16:19], a[96:99], v[40:43]
    v_mfma_f32_16x16x32_bf16 v[76:79], a[16:19], a[112:115], v[44:47]
    v_mfma_f32_16x16x32_bf16 v[48:51], a[4:7], a[68:71], v[48:51]
    v_mfma_f32_16x16x32_bf16 v[56:59], a[4:7], a[84:87], v[56:59]
    v_mfma_f32_16x16x32_bf16 v[64:67], a[4:7], a[100:103], v[64:67]
    v_mfma_f32_16x16x32_bf16 v[72:75], a[4:7], a[116:119], v[72:75]
    v_mfma_f32_16x16x32_bf16 v[52:55], a[20:23], a[68:71], v[52:55]
    v_mfma_f32_16x16x32_bf16 v[60:63], a[20:23], a[84:87], v[60:63]
    v_mfma_f32_16x16x32_bf16 v[68:71], a[20:23], a[100:103], v[68:71]
    v_mfma_f32_16x16x32_bf16 v[76:79], a[20:23], a[116:119], v[76:79]
    v_mfma_f32_16x16x32_bf16 v[48:51], a[8:11], a[72:75], v[48:51]
    v_mfma_f32_16x16x32_bf16 v[56:59], a[8:11], a[88:91], v[56:59]
    v_mfma_f32_16x16x32_bf16 v[64:67], a[8:11], a[104:107], v[64:67]
    v_mfma_f32_16x16x32_bf16 v[72:75], a[8:11], a[120:123], v[72:75]
    v_mfma_f32_16x16x32_bf16 v[52:55], a[24:27], a[72:75], v[52:55]
    v_mfma_f32_16x16x32_bf16 v[60:63], a[24:27], a[88:91], v[60:63]
    v_mfma_f32_16x16x32_bf16 v[68:71], a[24:27], a[104:107], v[68:71]
    v_mfma_f32_16x16x32_bf16 v[76:79], a[24:27], a[120:123], v[76:79]
    v_mfma_f32_16x16x32_bf16 v[48:51], a[12:15], a[76:79], v[48:51]
    v_mfma_f32_16x16x32_bf16 v[56:59], a[12:15], a[92:95], v[56:59]
    v_mfma_f32_16x16x32_bf16 v[64:67], a[12:15], a[108:111], v[64:67]
    v_mfma_f32_16x16x32_bf16 v[72:75], a[12:15], a[124:127], v[72:75]
    v_mfma_f32_16x16x32_bf16 v[52:55], a[28:31], a[76:79], v[52:55]
    v_mfma_f32_16x16x32_bf16 v[60:63], a[28:31], a[92:95], v[60:63]
    v_mfma_f32_16x16x32_bf16 v[68:71], a[28:31], a[108:111], v[68:71]
    v_mfma_f32_16x16x32_bf16 v[76:79], a[28:31], a[124:127], v[76:79]
    s_nop 7
    v_exp_f32 v48, v48
    v_exp_f32 v49, v49
    v_exp_f32 v50, v50
    v_exp_f32 v51, v51
    v_cvt_pk_bf16_f32 v48, v48, v49
    v_exp_f32 v52, v52
    v_exp_f32 v53, v53
    v_cvt_pk_bf16_f32 v49, v50, v51
    v_exp_f32 v54, v54
    v_exp_f32 v55, v55
    v_cvt_pk_bf16_f32 v50, v52, v53
    v_exp_f32 v56, v56
    v_exp_f32 v57, v57
    v_cvt_pk_bf16_f32 v51, v54, v55
    v_exp_f32 v58, v58
    v_exp_f32 v59, v59
    v_cvt_pk_bf16_f32 v56, v56, v57
    v_exp_f32 v60, v60
    v_exp_f32 v61, v61
    v_cvt_pk_bf16_f32 v57, v58, v59
    v_exp_f32 v62, v62
    v_exp_f32 v63, v63
    v_cvt_pk_bf16_f32 v58, v60, v61
    v_exp_f32 v64, v64
    v_exp_f32 v65, v65
    v_cvt_pk_bf16_f32 v59, v62, v63
    v_exp_f32 v66, v66
    v_exp_f32 v67, v67
    v_cvt_pk_bf16_f32 v64, v64, v65
    v_exp_f32 v68, v68
    v_exp_f32 v69, v69
    v_cvt_pk_bf16_f32 v65, v66, v67
    v_exp_f32 v70, v70
    v_exp_f32 v71, v71
    v_cvt_pk_bf16_f32 v66, v68, v69
    v_exp_f32 v72, v72
    v_exp_f32 v73, v73
    v_cvt_pk_bf16_f32 v67, v70, v71
    v_exp_f32 v74, v74
    v_exp_f32 v75, v75
    v_cvt_pk_bf16_f32 v72, v72, v73
    v_exp_f32 v76, v76
    v_exp_f32 v77, v77
    v_cvt_pk_bf16_f32 v73, v74, v75
    v_exp_f32 v78, v78
    v_exp_f32 v79, v79
    v_cvt_pk_bf16_f32 v74, v76, v77
    s_nop 0
    v_cvt_pk_bf16_f32 v75, v78, v79
    s_waitcnt lgkmcnt(0)
    s_nop 1
    v_mfma_f32_16x16x32_bf16 v[112:115], a[32:35], v[48:51], v[112:115]
    v_mfma_f32_16x16x32_bf16 v[116:119], a[32:35], v[56:59], v[116:119]
    v_mfma_f32_16x16x32_bf16 v[120:123], a[32:35], v[64:67], v[120:123]
    v_mfma_f32_16x16x32_bf16 v[124:127], a[32:35], v[72:75], v[124:127]
    v_mfma_f32_16x16x32_bf16 v[128:131], a[36:39], v[48:51], v[128:131]
    v_mfma_f32_16x16x32_bf16 v[132:135], a[36:39], v[56:59], v[132:135]
    v_mfma_f32_16x16x32_bf16 v[136:139], a[36:39], v[64:67], v[136:139]
    v_mfma_f32_16x16x32_bf16 v[140:143], a[36:39], v[72:75], v[140:143]
    v_mfma_f32_16x16x32_bf16 v[144:147], a[40:43], v[48:51], v[144:147]
    v_mfma_f32_16x16x32_bf16 v[148:151], a[40:43], v[56:59], v[148:151]
    v_mfma_f32_16x16x32_bf16 v[152:155], a[40:43], v[64:67], v[152:155]
    v_mfma_f32_16x16x32_bf16 v[156:159], a[40:43], v[72:75], v[156:159]
    v_mfma_f32_16x16x32_bf16 v[160:163], a[44:47], v[48:51], v[160:163]
    v_mfma_f32_16x16x32_bf16 v[164:167], a[44:47], v[56:59], v[164:167]
    v_mfma_f32_16x16x32_bf16 v[168:171], a[44:47], v[64:67], v[168:171]
    v_mfma_f32_16x16x32_bf16 v[172:175], a[44:47], v[72:75], v[172:175]
    v_mfma_f32_16x16x32_bf16 v[176:179], a[48:51], v[48:51], v[176:179]
    v_mfma_f32_16x16x32_bf16 v[180:183], a[48:51], v[56:59], v[180:183]
    v_mfma_f32_16x16x32_bf16 v[184:187], a[48:51], v[64:67], v[184:187]
    v_mfma_f32_16x16x32_bf16 v[188:191], a[48:51], v[72:75], v[188:191]
    v_mfma_f32_16x16x32_bf16 v[192:195], a[52:55], v[48:51], v[192:195]
    v_mfma_f32_16x16x32_bf16 v[196:199], a[52:55], v[56:59], v[196:199]
    v_mfma_f32_16x16x32_bf16 v[200:203], a[52:55], v[64:67], v[200:203]
    v_mfma_f32_16x16x32_bf16 v[204:207], a[52:55], v[72:75], v[204:207]
    v_mfma_f32_16x16x32_bf16 v[208:211], a[56:59], v[48:51], v[208:211]
    v_mfma_f32_16x16x32_bf16 v[212:215], a[56:59], v[56:59], v[212:215]
    v_mfma_f32_16x16x32_bf16 v[216:219], a[56:59], v[64:67], v[216:219]
    v_mfma_f32_16x16x32_bf16 v[220:223], a[56:59], v[72:75], v[220:223]
    v_mfma_f32_16x16x32_bf16 v[224:227], a[60:63], v[48:51], v[224:227]
    v_mfma_f32_16x16x32_bf16 v[228:231], a[60:63], v[56:59], v[228:231]
    v_mfma_f32_16x16x32_bf16 v[232:235], a[60:63], v[64:67], v[232:235]
    v_mfma_f32_16x16x32_bf16 v[236:239], a[60:63], v[72:75], v[236:239]
    v_mfma_f32_16x16x32_bf16 a[128:131], a[144:147], v[48:51], a[128:131]
    v_mfma_f32_16x16x32_bf16 a[132:135], a[144:147], v[56:59], a[132:135]
    v_mfma_f32_16x16x32_bf16 a[136:139], a[144:147], v[64:67], a[136:139]
    v_mfma_f32_16x16x32_bf16 a[140:143], a[144:147], v[72:75], a[140:143]
    s_add_u32 s41, s41, 8192
    s_add_u32 s40, s40, 1
    s_cmp_lt_u32 s40, 16
    s_cbranch_scc1 K1_S2
    s_nop 7
    v_accvgpr_read_b32 v248, a128
    v_accvgpr_read_b32 v250, a132
    v_accvgpr_read_b32 v252, a136
    v_accvgpr_read_b32 v254, a140
    v_add_f32 v249, v248, v250
    v_add_f32 v251, v252, v254
    v_rcp_f32 v248, v248
    v_rcp_f32 v250, v250
    v_rcp_f32 v252, v252
    v_rcp_f32 v254, v254
    v_add_f32 v249, v249, v251
    s_nop 0
    v_pk_mul_f32 v[112:113], v[112:113], v[248:249] op_sel_hi:[1,0]
    v_pk_mul_f32 v[114:115], v[114:115], v[248:249] op_sel_hi:[1,0]
    v_pk_mul_f32 v[128:129], v[128:129], v[248:249] op_sel_hi:[1,0]
    v_pk_mul_f32 v[130:131], v[130:131], v[248:249] op_sel_hi:[1,0]
    v_cvt_pk_bf16_f32 v48, v112, v113
    v_cvt_pk_bf16_f32 v49, v114, v115
    v_cvt_pk_bf16_f32 v50, v128, v129
    v_cvt_pk_bf16_f32 v51, v130, v131
    buffer_store_dwordx4 v[48:51], v2, s[20:23], s48 offen offset:0 sc1
    v_pk_mul_f32 v[116:117], v[116:117], v[250:251] op_sel_hi:[1,0]
    v_pk_mul_f32 v[118:119], v[118:119], v[250:251] op_sel_hi:[1,0]
    v_pk_mul_f32 v[132:133], v[132:133], v[250:251] op_sel_hi:[1,0]
    v_pk_mul_f32 v[134:135], v[134:135], v[250:251] op_sel_hi:[1,0]
    v_cvt_pk_bf16_f32 v52, v116, v117
    v_cvt_pk_bf16_f32 v53, v118, v119
    v_cvt_pk_bf16_f32 v54, v132, v133
    v_cvt_pk_bf16_f32 v55, v134, v135
    buffer_store_dwordx4 v[52:55], v2, s[20:23], s49 offen offset:0 sc1
    v_pk_mul_f32 v[120:121], v[120:121], v[252:253] op_sel_hi:[1,0]
    v_pk_mul_f32 v[122:123], v[122:123], v[252:253] op_sel_hi:[1,0]
    v_pk_mul_f32 v[136:137], v[136:137], v[252:253] op_sel_hi:[1,0]
    v_pk_mul_f32 v[138:139], v[138:139], v[252:253] op_sel_hi:[1,0]
    v_cvt_pk_bf16_f32 v56, v120, v121
    v_cvt_pk_bf16_f32 v57, v122, v123
    v_cvt_pk_bf16_f32 v58, v136, v137
    v_cvt_pk_bf16_f32 v59, v138, v139
    buffer_store_dwordx4 v[56:59], v2, s[20:23], s50 offen offset:0 sc1
    v_pk_mul_f32 v[124:125], v[124:125], v[254:255] op_sel_hi:[1,0]
    v_pk_mul_f32 v[126:127], v[126:127], v[254:255] op_sel_hi:[1,0]
    v_pk_mul_f32 v[140:141], v[140:141], v[254:255] op_sel_hi:[1,0]
    v_pk_mul_f32 v[142:143], v[142:143], v[254:255] op_sel_hi:[1,0]
    v_cvt_pk_bf16_f32 v60, v124, v125
    v_cvt_pk_bf16_f32 v61, v126, v127
    v_cvt_pk_bf16_f32 v62, v140, v141
    v_cvt_pk_bf16_f32 v63, v142, v143
    buffer_store_dwordx4 v[60:63], v2, s[20:23], s51 offen offset:0 sc1
    v_pk_mul_f32 v[144:145], v[144:145], v[248:249] op_sel_hi:[1,0]
    v_pk_mul_f32 v[146:147], v[146:147], v[248:249] op_sel_hi:[1,0]
    v_pk_mul_f32 v[160:161], v[160:161], v[248:249] op_sel_hi:[1,0]
    v_pk_mul_f32 v[162:163], v[162:163], v[248:249] op_sel_hi:[1,0]
    v_cvt_pk_bf16_f32 v64, v144, v145
    v_cvt_pk_bf16_f32 v65, v146, v147
    v_cvt_pk_bf16_f32 v66, v160, v161
    v_cvt_pk_bf16_f32 v67, v162, v163
    buffer_store_dwordx4 v[64:67], v2, s[20:23], s48 offen offset:1024 sc1
    v_pk_mul_f32 v[148:149], v[148:149], v[250:251] op_sel_hi:[1,0]
    v_pk_mul_f32 v[150:151], v[150:151], v[250:251] op_sel_hi:[1,0]
    v_pk_mul_f32 v[164:165], v[164:165], v[250:251] op_sel_hi:[1,0]
    v_pk_mul_f32 v[166:167], v[166:167], v[250:251] op_sel_hi:[1,0]
    v_cvt_pk_bf16_f32 v68, v148, v149
    v_cvt_pk_bf16_f32 v69, v150, v151
    v_cvt_pk_bf16_f32 v70, v164, v165
    v_cvt_pk_bf16_f32 v71, v166, v167
    buffer_store_dwordx4 v[68:71], v2, s[20:23], s49 offen offset:1024 sc1
    v_pk_mul_f32 v[152:153], v[152:153], v[252:253] op_sel_hi:[1,0]
    v_pk_mul_f32 v[154:155], v[154:155], v[252:253] op_sel_hi:[1,0]
    v_pk_mul_f32 v[168:169], v[168:169], v[252:253] op_sel_hi:[1,0]
    v_pk_mul_f32 v[170:171], v[170:171], v[252:253] op_sel_hi:[1,0]
    v_cvt_pk_bf16_f32 v72, v152, v153
    v_cvt_pk_bf16_f32 v73, v154, v155
    v_cvt_pk_bf16_f32 v74, v168, v169
    v_cvt_pk_bf16_f32 v75, v170, v171
    buffer_store_dwordx4 v[72:75], v2, s[20:23], s50 offen offset:1024 sc1
    v_pk_mul_f32 v[156:157], v[156:157], v[254:255] op_sel_hi:[1,0]
    v_pk_mul_f32 v[158:159], v[158:159], v[254:255] op_sel_hi:[1,0]
    v_pk_mul_f32 v[172:173], v[172:173], v[254:255] op_sel_hi:[1,0]
    v_pk_mul_f32 v[174:175], v[174:175], v[254:255] op_sel_hi:[1,0]
    v_cvt_pk_bf16_f32 v76, v156, v157
    v_cvt_pk_bf16_f32 v77, v158, v159
    v_cvt_pk_bf16_f32 v78, v172, v173
    v_cvt_pk_bf16_f32 v79, v174, v175
    buffer_store_dwordx4 v[76:79], v2, s[20:23], s51 offen offset:1024 sc1
    v_pk_mul_f32 v[176:177], v[176:177], v[248:249] op_sel_hi:[1,0]
    v_pk_mul_f32 v[178:179], v[178:179], v[248:249] op_sel_hi:[1,0]
    v_pk_mul_f32 v[192:193], v[192:193], v[248:249] op_sel_hi:[1,0]
    v_pk_mul_f32 v[194:195], v[194:195], v[248:249] op_sel_hi:[1,0]
    v_cvt_pk_bf16_f32 v48, v176, v177
    v_cvt_pk_bf16_f32 v49, v178, v179
    v_cvt_pk_bf16_f32 v50, v192, v193
    v_cvt_pk_bf16_f32 v51, v194, v195
    buffer_store_dwordx4 v[48:51], v2, s[20:23], s48 offen offset:2048 sc1
    v_pk_mul_f32 v[180:181], v[180:181], v[250:251] op_sel_hi:[1,0]
    v_pk_mul_f32 v[182:183], v[182:183], v[250:251] op_sel_hi:[1,0]
    v_pk_mul_f32 v[196:197], v[196:197], v[250:251] op_sel_hi:[1,0]
    v_pk_mul_f32 v[198:199], v[198:199], v[250:251] op_sel_hi:[1,0]
    v_cvt_pk_bf16_f32 v52, v180, v181
    v_cvt_pk_bf16_f32 v53, v182, v183
    v_cvt_pk_bf16_f32 v54, v196, v197
    v_cvt_pk_bf16_f32 v55, v198, v199
    buffer_store_dwordx4 v[52:55], v2, s[20:23], s49 offen offset:2048 sc1
    v_pk_mul_f32 v[184:185], v[184:185], v[252:253] op_sel_hi:[1,0]
    v_pk_mul_f32 v[186:187], v[186:187], v[252:253] op_sel_hi:[1,0]
    v_pk_mul_f32 v[200:201], v[200:201], v[252:253] op_sel_hi:[1,0]
    v_pk_mul_f32 v[202:203], v[202:203], v[252:253] op_sel_hi:[1,0]
    v_cvt_pk_bf16_f32 v56, v184, v185
    v_cvt_pk_bf16_f32 v57, v186, v187
    v_cvt_pk_bf16_f32 v58, v200, v201
    v_cvt_pk_bf16_f32 v59, v202, v203
    buffer_store_dwordx4 v[56:59], v2, s[20:23], s50 offen offset:2048 sc1
    v_pk_mul_f32 v[188:189], v[188:189], v[254:255] op_sel_hi:[1,0]
    v_pk_mul_f32 v[190:191], v[190:191], v[254:255] op_sel_hi:[1,0]
    v_pk_mul_f32 v[204:205], v[204:205], v[254:255] op_sel_hi:[1,0]
    v_pk_mul_f32 v[206:207], v[206:207], v[254:255] op_sel_hi:[1,0]
    v_cvt_pk_bf16_f32 v60, v188, v189
    v_cvt_pk_bf16_f32 v61, v190, v191
    v_cvt_pk_bf16_f32 v62, v204, v205
    v_cvt_pk_bf16_f32 v63, v206, v207
    buffer_store_dwordx4 v[60:63], v2, s[20:23], s51 offen offset:2048 sc1
    v_pk_mul_f32 v[208:209], v[208:209], v[248:249] op_sel_hi:[1,0]
    v_pk_mul_f32 v[210:211], v[210:211], v[248:249] op_sel_hi:[1,0]
    v_pk_mul_f32 v[224:225], v[224:225], v[248:249] op_sel_hi:[1,0]
    v_pk_mul_f32 v[226:227], v[226:227], v[248:249] op_sel_hi:[1,0]
    v_cvt_pk_bf16_f32 v64, v208, v209
    v_cvt_pk_bf16_f32 v65, v210, v211
    v_cvt_pk_bf16_f32 v66, v224, v225
    v_cvt_pk_bf16_f32 v67, v226, v227
    buffer_store_dwordx4 v[64:67], v2, s[20:23], s48 offen offset:3072 sc1
    v_pk_mul_f32 v[212:213], v[212:213], v[250:251] op_sel_hi:[1,0]
    v_pk_mul_f32 v[214:215], v[214:215], v[250:251] op_sel_hi:[1,0]
    v_pk_mul_f32 v[228:229], v[228:229], v[250:251] op_sel_hi:[1,0]
    v_pk_mul_f32 v[230:231], v[230:231], v[250:251] op_sel_hi:[1,0]
    v_cvt_pk_bf16_f32 v68, v212, v213
    v_cvt_pk_bf16_f32 v69, v214, v215
    v_cvt_pk_bf16_f32 v70, v228, v229
    v_cvt_pk_bf16_f32 v71, v230, v231
    buffer_store_dwordx4 v[68:71], v2, s[20:23], s49 offen offset:3072 sc1
    v_pk_mul_f32 v[216:217], v[216:217], v[252:253] op_sel_hi:[1,0]
    v_pk_mul_f32 v[218:219], v[218:219], v[252:253] op_sel_hi:[1,0]
    v_pk_mul_f32 v[232:233], v[232:233], v[252:253] op_sel_hi:[1,0]
    v_pk_mul_f32 v[234:235], v[234:235], v[252:253] op_sel_hi:[1,0]
    v_cvt_pk_bf16_f32 v72, v216, v217
    v_cvt_pk_bf16_f32 v73, v218, v219
    v_cvt_pk_bf16_f32 v74, v232, v233
    v_cvt_pk_bf16_f32 v75, v234, v235
    buffer_store_dwordx4 v[72:75], v2, s[20:23], s50 offen offset:3072 sc1
    v_pk_mul_f32 v[220:221], v[220:221], v[254:255] op_sel_hi:[1,0]
    v_pk_mul_f32 v[222:223], v[222:223], v[254:255] op_sel_hi:[1,0]
    v_pk_mul_f32 v[236:237], v[236:237], v[254:255] op_sel_hi:[1,0]
    v_pk_mul_f32 v[238:239], v[238:239], v[254:255] op_sel_hi:[1,0]
    v_cvt_pk_bf16_f32 v76, v220, v221
    v_cvt_pk_bf16_f32 v77, v222, v223
    v_cvt_pk_bf16_f32 v78, v236, v237
    v_cvt_pk_bf16_f32 v79, v238, v239
    buffer_store_dwordx4 v[76:79], v2, s[20:23], s51 offen offset:3072 sc1
    s_branch K1_EXIT
K1_END:
    s_endpgm
.section .rodata,"a"
.p2align 6
.amdhsa_kernel adaLN_cond__sliding_block_cached__glu_gated_reglu__prompt_kernel
  .amdhsa_next_free_vgpr 512
  .amdhsa_next_free_sgpr 102
  .amdhsa_accum_offset 256
  .amdhsa_group_segment_fixed_size 0
  .amdhsa_kernarg_size 112
  .amdhsa_user_sgpr_count 2
  .amdhsa_user_sgpr_kernarg_segment_ptr 1
  .amdhsa_system_sgpr_workgroup_id_x 1
.end_amdhsa_kernel
```
